```python
import torch

def _softmax(x, axis=-1):
    return torch.softmax(x, dim=axis)
def _gelu(x):
    return torch.nn.functional.gelu(x, approximate="tanh")
def _silu(x):
    return torch.nn.functional.silu(x)
def _sigmoid(x):
    return torch.sigmoid(x)
def _layernorm(x, axis=-1, eps=1e-5):
    m = x.mean(dim=axis, keepdim=True)
    v = x.var(dim=axis, keepdim=True, unbiased=False)
    return (x - m) / torch.sqrt(v + eps)
def _scatter_add(tgt, idx, src, axis=0):
    return tgt.clone().index_add_(axis, idx, src)
def _segment_sum(src, seg, n):
    out = torch.zeros((n,) + src.shape[1:], dtype=src.dtype)
    return out.index_add_(0, seg, src)
def _pad(x, pw):
    flat = tuple(v for pair in reversed(pw) for v in pair)
    return torch.nn.functional.pad(x, flat)

kernel_name = 'recurrent_scan__sliding_block_cached__mixer_s_mlp__prompt'

def setup_inputs():

    _w = (lambda a: (lambda t: t.to(torch.bfloat16) if t.is_floating_point() else t)(torch.as_tensor(a)))
    def _A_setup():
        B, Sq, D = 1, 2048, 512
        Hq, Hkv, Sk, Dh = 32, 8, 2048, 128
        assert Hq % Hkv == 0, (Hq, Hkv)
        return {
            "x": _w((lambda *s: torch.randn(*s, dtype=torch.bfloat16) * 0.05)(B, Sq, D)),
            "k_cache": _w((lambda *s: torch.randn(*s, dtype=torch.bfloat16) * 0.8)(B, Hkv, Sk, Dh)),
            "v_cache": _w((lambda *s: torch.randn(*s, dtype=torch.bfloat16) * 0.8)(B, Hkv, Sk, Dh)),
            "wq": _w((lambda *s: torch.randn(*s, dtype=torch.bfloat16) * 0.8)(D, Hq * Dh) * (D ** -0.5)),
            "wo": _w((lambda *s: torch.randn(*s, dtype=torch.bfloat16) * 0.8)(Hq * Dh, D) * ((Hq * Dh) ** -0.5)),
        }
    _A_in = _A_setup()

    def _B_setup():
        B, S, D, F = 1, 2048, 512, 1792
        return {
            "x":  _w((lambda *s: torch.randn(*s, dtype=torch.bfloat16) * 0.05)(B, S, D)),
            "w1": _w((lambda *s: torch.randn(*s, dtype=torch.bfloat16) * 3.2)(D, D) * (D ** -0.5)),
            "w2": _w((lambda *s: torch.randn(*s, dtype=torch.bfloat16) * 3.2)(D, D) * (D ** -0.5)),
            "w3": _w((lambda *s: torch.randn(*s, dtype=torch.bfloat16) * 3.2)(D, F) * (D ** -0.5)),
            "w4": _w((lambda *s: torch.randn(*s, dtype=torch.bfloat16) * 3.2)(F, D) * (F ** -0.5)),
        }
    _B_in = _B_setup()

    return {
        "A_x": _A_in["x"],
        "A_k_cache": _A_in["k_cache"],
        "A_v_cache": _A_in["v_cache"],
        "A_wq": _A_in["wq"],
        "A_wo": _A_in["wo"],
        "B_x": _B_in["x"],
        "B_w1": _B_in["w1"],
        "B_w2": _B_in["w2"],
        "B_w3": _B_in["w3"],
        "B_w4": _B_in["w4"],
    }

def reference(A_x, A_k_cache, A_v_cache, A_wq, A_wo, B_x, B_w1, B_w2, B_w3, B_w4):
    def _A_ref(x, k_cache, v_cache, wq, wo):
        B, Sq, D = x.shape
        Hq, Dh = 32, 128
        Hkv, Sk = k_cache.shape[1], k_cache.shape[2]
        W = min(4096, max(256, Sk // 4))
        rep = Hq // Hkv
        q = (lambda x, *d: x.permute(*d))((x @ wq).reshape(B, Sq, Hq, Dh), 0, 2, 1, 3)
        k = (lambda x, n, axis: torch.repeat_interleave(x, n, dim=axis))(k_cache[:, :, Sk - W:, :], rep, axis=1)
        v = (lambda x, n, axis: torch.repeat_interleave(x, n, dim=axis))(v_cache[:, :, Sk - W:, :], rep, axis=1)
        scores = torch.einsum("bhqd,bhkd->bhqk", q, k) * (Dh ** -0.5)
        p = _softmax(scores, axis=-1)
        o = torch.einsum("bhqk,bhkd->bhqd", p, v)
        return (lambda x, *d: x.permute(*d))(o, 0, 2, 1, 3).reshape(B, Sq, Hq * Dh) @ wo

    def _B_ref(x, w1, w2, w3, w4):
        B, S, D = x.shape
        h = _gelu(_layernorm(x, axis=-1) @ w1)
        c = D // 4
        g0 = _pad(h[:, :, 0*c:1*c], ((0, 0), (1, 0), (0, 0)))[:, :S, :]
        g1 = _pad(h[:, :, 1*c:2*c], ((0, 0), (0, 1), (0, 0)))[:, 1:, :]
        g2 = _pad(h[:, :, 2*c:3*c], ((0, 0), (2, 0), (0, 0)))[:, :S, :]
        g3 = _pad(h[:, :, 3*c:   ], ((0, 0), (0, 2), (0, 0)))[:, 2:, :]
        hs = torch.concatenate([g0, g1, g2, g3], axis=-1) @ w2
        x1 = x + hs
        h2 = _gelu(_layernorm(x1, axis=-1) @ w3) @ w4
        return x1 + h2

    x = A_x
    xn = _layernorm(x, axis=-1)
    s = _A_ref(xn, A_k_cache, A_v_cache, A_wq, A_wo)
    g = _silu(_B_ref(xn, B_w1, B_w2, B_w3, B_w4))
    return x + s * g
```

```asm
; @launch grid=(256,1,1) block=(256,1,1) lds=163840
.amdgcn_target "amdgcn-amd-amdhsa--gfx950"
.text
.globl recurrent_scan__sliding_block_cached__mixer_s_mlp__prompt_kernel
.p2align 8
.type recurrent_scan__sliding_block_cached__mixer_s_mlp__prompt_kernel,@function
recurrent_scan__sliding_block_cached__mixer_s_mlp__prompt_kernel:
s_cmp_ge_u32 s2, 256
s_cbranch_scc1 L_code_end
s_load_dwordx16 s[56:71], s[0:1], 0
s_load_dwordx8 s[72:79], s[0:1], 64
s_load_dwordx2 s[80:81], s[0:1], 96
v_lshrrev_b32 v26, 6, v0
v_and_b32 v0, 63, v0
v_readfirstlane_b32 s3, v26
v_lshlrev_b32 v1, 4, v0
s_lshr_b32 s84, s2, 3
s_and_b32 s82, s2, 6
s_and_b32 s85, s84, 1
s_or_b32 s82, s82, s85
s_lshr_b32 s89, s84, 1
s_and_b32 s83, s2, 1
s_lshl_b32 s83, s83, 4
s_or_b32 s83, s83, s89
v_lshrrev_b32 v27, 2, v0
s_lshl_b32 s84, s3, 4
v_add_u32 v27, s84, v27
v_lshlrev_b32 v27, 10, v27
v_and_b32 v28, 3, v0
v_lshl_add_u32 v27, v28, 4, v27
s_lshl_b32 s84, s83, 16
s_waitcnt lgkmcnt(0)
s_add_u32 s4, s56, s84
s_addc_u32 s5, s57, 0
s_mov_b32 s6, 65536
s_mov_b32 s7, 0x20000
buffer_load_dwordx4 v[128:131], v27, s[4:7], 0 offen offset:0
buffer_load_dwordx4 v[132:135], v27, s[4:7], 0 offen offset:64
buffer_load_dwordx4 v[136:139], v27, s[4:7], 0 offen offset:128
buffer_load_dwordx4 v[140:143], v27, s[4:7], 0 offen offset:192
buffer_load_dwordx4 v[144:147], v27, s[4:7], 0 offen offset:256
buffer_load_dwordx4 v[148:151], v27, s[4:7], 0 offen offset:320
buffer_load_dwordx4 v[152:155], v27, s[4:7], 0 offen offset:384
buffer_load_dwordx4 v[156:159], v27, s[4:7], 0 offen offset:448
buffer_load_dwordx4 v[160:163], v27, s[4:7], 0 offen offset:512
buffer_load_dwordx4 v[164:167], v27, s[4:7], 0 offen offset:576
buffer_load_dwordx4 v[168:171], v27, s[4:7], 0 offen offset:640
buffer_load_dwordx4 v[172:175], v27, s[4:7], 0 offen offset:704
buffer_load_dwordx4 v[176:179], v27, s[4:7], 0 offen offset:768
buffer_load_dwordx4 v[180:183], v27, s[4:7], 0 offen offset:832
buffer_load_dwordx4 v[184:187], v27, s[4:7], 0 offen offset:896
buffer_load_dwordx4 v[188:191], v27, s[4:7], 0 offen offset:960
s_mov_b32 s44, s80
s_mov_b32 s45, s81
s_mov_b32 s46, 0x2800000
s_mov_b32 s47, 0x20000
buffer_load_dword v14, off, s[44:47], 0 sc1
v_mov_b32 v28, 0x40000000
v_cmp_ne_u32 vcc, 0, v0
s_nop 1
v_cndmask_b32 v15, 0, v28, vcc
s_add_u32 s40, s76, s84
s_addc_u32 s41, s77, 0
s_mov_b32 s42, 65536
s_mov_b32 s43, 0x20000
s_mov_b32 s52, s78
s_mov_b32 s53, s79
s_mov_b32 s54, 256
s_mov_b32 s55, 0x20000
s_add_u32 s48, s80, 0x100000
s_addc_u32 s49, s81, 0
s_mov_b32 s50, 0x200000
s_mov_b32 s51, 0x20000
s_lshl_b32 s84, s82, 7
s_add_u32 s24, s68, s84
s_addc_u32 s25, s69, 0
s_mov_b32 s26, 0x7fc80
s_mov_b32 s27, 0x20000
s_add_u32 s28, s70, s84
s_addc_u32 s29, s71, 0
s_mov_b32 s30, 0x7fc80
s_mov_b32 s31, 0x20000
s_lshl_b32 s84, s82, 10
s_add_u32 s16, s62, s84
s_addc_u32 s17, s63, 0
s_mov_b32 s18, 0x3fe400
s_mov_b32 s19, 0x20000
s_lshl_b32 s84, s82, 19
s_add_u32 s20, s64, s84
s_addc_u32 s21, s65, 0
s_mov_b32 s22, 0x80000
s_mov_b32 s23, 0x20000
s_add_u32 s84, s84, 393216
s_add_u32 s8, s58, s84
s_addc_u32 s9, s59, 0
s_mov_b32 s10, 0x20000
s_mov_b32 s11, 0x20000
s_add_u32 s12, s60, s84
s_addc_u32 s13, s61, 0
s_mov_b32 s14, 0x20000
s_mov_b32 s15, 0x20000
s_mul_i32 s84, s82, 448
s_add_u32 s32, s72, s84
s_addc_u32 s33, s73, 0
s_mov_b32 s34, 0x1bf3c0
s_mov_b32 s35, 0x20000
s_mul_i32 s84, s82, 229376
s_add_u32 s36, s74, s84
s_addc_u32 s37, s75, 0
s_mov_b32 s38, 0x38000
s_mov_b32 s39, 0x20000
s_mov_b32 s56, s3
s_mov_b32 s57, s82
s_mov_b32 s58, s83
s_lshl_b32 s59, s56, 14
s_add_u32 s60, s59, 65536
s_lshl_b32 s68, s56, 17
s_lshl_b32 s69, s56, 8
s_lshl_b32 s80, s56, 11
s_lshl_b32 s91, s56, 13
s_add_u32 s91, s91, 131072
s_add_u32 s64, s56, 0
s_and_b32 s64, s64, 3
s_lshl_b32 s64, s64, 20
s_add_u32 s65, s56, 1
s_and_b32 s65, s65, 3
s_lshl_b32 s65, s65, 20
s_add_u32 s66, s56, 2
s_and_b32 s66, s66, 3
s_lshl_b32 s66, s66, 20
s_add_u32 s67, s56, 3
s_and_b32 s67, s67, 3
s_lshl_b32 s67, s67, 20
s_mul_i32 s90, s58, 1024
s_add_u32 s90, s90, 4096
s_mov_b32 s70, 0
s_mov_b32 s72, 0x3f803f80
s_mov_b32 s73, 0x00003f80
s_mov_b32 s74, 0x3f800000
v_lshrrev_b32 v26, 3, v0
v_and_b32 v28, 7, v0
v_and_b32 v29, 6, v26
v_xor_b32 v28, v28, v29
v_lshlrev_b32 v28, 4, v28
v_lshl_add_u32 v2, v26, 10, v28
v_add_u32 v3, 7168, v2
v_add_u32 v4, 14336, v2
v_add_u32 v5, 21504, v2
v_lshl_add_u32 v6, v26, 13, v28
v_add_u32 v6, s69, v6
v_add_u32 v7, 64512, v6
v_add_u32 v8, 129024, v6
v_add_u32 v9, 193536, v6
s_add_u32 m0, s60, 0
s_add_u32 s61, s68, 0
buffer_load_dwordx4 v2, s[24:27], s61 offen offset:0 lds
buffer_load_dwordx4 v3, s[24:27], s61 offen offset:1024 lds
buffer_load_dwordx4 v4, s[24:27], s61 offen offset:2048 lds
buffer_load_dwordx4 v5, s[24:27], s61 offen offset:3072 lds
s_add_u32 m0, s60, 4096
s_add_u32 s61, s68, 32768
buffer_load_dwordx4 v2, s[24:27], s61 offen offset:0 lds
buffer_load_dwordx4 v3, s[24:27], s61 offen offset:1024 lds
buffer_load_dwordx4 v4, s[24:27], s61 offen offset:2048 lds
buffer_load_dwordx4 v5, s[24:27], s61 offen offset:3072 lds
s_add_u32 m0, s60, 8192
s_add_u32 s61, s68, 65536
buffer_load_dwordx4 v2, s[24:27], s61 offen offset:0 lds
buffer_load_dwordx4 v3, s[24:27], s61 offen offset:1024 lds
buffer_load_dwordx4 v4, s[24:27], s61 offen offset:2048 lds
buffer_load_dwordx4 v5, s[24:27], s61 offen offset:3072 lds
s_add_u32 m0, s60, 12288
s_add_u32 s61, s68, 98304
buffer_load_dwordx4 v2, s[24:27], s61 offen offset:0 lds
buffer_load_dwordx4 v3, s[24:27], s61 offen offset:1024 lds
buffer_load_dwordx4 v4, s[24:27], s61 offen offset:2048 lds
buffer_load_dwordx4 v5, s[24:27], s61 offen offset:3072 lds
s_lshl_b32 s62, s89, 2
s_add_u32 s62, s62, s56
s_getpc_b64 s[84:85]
L_pc:
s_lshr_b32 s63, s2, 3
s_lshl_b32 s63, s63, 2
s_add_u32 s63, s63, s56
s_lshl_b32 s63, s63, 3
v_and_b32 v26, 7, v0
v_add_u32 v26, s63, v26
v_lshlrev_b32 v26, 7, v26
v_min_u32 v26, (L_code_end-L_pc), v26
global_load_dword v248, v26, s[84:85]
s_lshl_b32 s63, s62, 6
v_and_b32 v26, 63, v0
v_add_u32 v26, s63, v26
v_and_b32 v28, 3, v26
v_lshrrev_b32 v26, 2, v26
v_lshlrev_b32 v26, 13, v26
v_lshl_add_u32 v26, v28, 8, v26
buffer_load_dword v249, v26, s[16:19], 0 offen offset:0
v_lshrrev_b32 v26, 2, v0
v_and_b32 v28, 3, v0
v_and_b32 v29, 6, v26
v_lshlrev_b32 v29, 4, v29
v_lshlrev_b32 v26, 7, v26
v_lshl_add_u32 v26, v28, 3, v26
v_add_u32 v26, v26, v29
v_add_u32 v10, s60, v26
v_xor_b32 v11, 32, v10
v_xor_b32 v12, 64, v10
v_xor_b32 v13, 96, v10
s_waitcnt vmcnt(34)
v_dot2_f32_bf16 v64, v128, s72, 0
v_dot2_f32_bf16 v68, v128, v128, 0
v_dot2_f32_bf16 v65, v129, s72, 0
v_dot2_f32_bf16 v69, v129, v129, 0
v_dot2_f32_bf16 v66, v130, s72, 0
v_dot2_f32_bf16 v70, v130, v130, 0
v_dot2_f32_bf16 v67, v131, s72, 0
v_dot2_f32_bf16 v71, v131, v131, 0
s_waitcnt vmcnt(33)
v_dot2_f32_bf16 v64, v132, s72, v64
v_dot2_f32_bf16 v68, v132, v132, v68
v_dot2_f32_bf16 v65, v133, s72, v65
v_dot2_f32_bf16 v69, v133, v133, v69
v_dot2_f32_bf16 v66, v134, s72, v66
v_dot2_f32_bf16 v70, v134, v134, v70
v_dot2_f32_bf16 v67, v135, s72, v67
v_dot2_f32_bf16 v71, v135, v135, v71
s_waitcnt vmcnt(32)
v_dot2_f32_bf16 v64, v136, s72, v64
v_dot2_f32_bf16 v68, v136, v136, v68
v_dot2_f32_bf16 v65, v137, s72, v65
v_dot2_f32_bf16 v69, v137, v137, v69
v_dot2_f32_bf16 v66, v138, s72, v66
v_dot2_f32_bf16 v70, v138, v138, v70
v_dot2_f32_bf16 v67, v139, s72, v67
v_dot2_f32_bf16 v71, v139, v139, v71
s_waitcnt vmcnt(31)
v_dot2_f32_bf16 v64, v140, s72, v64
v_dot2_f32_bf16 v68, v140, v140, v68
v_dot2_f32_bf16 v65, v141, s72, v65
v_dot2_f32_bf16 v69, v141, v141, v69
v_dot2_f32_bf16 v66, v142, s72, v66
v_dot2_f32_bf16 v70, v142, v142, v70
v_dot2_f32_bf16 v67, v143, s72, v67
v_dot2_f32_bf16 v71, v143, v143, v71
s_waitcnt vmcnt(30)
v_dot2_f32_bf16 v64, v144, s72, v64
v_dot2_f32_bf16 v68, v144, v144, v68
v_dot2_f32_bf16 v65, v145, s72, v65
v_dot2_f32_bf16 v69, v145, v145, v69
v_dot2_f32_bf16 v66, v146, s72, v66
v_dot2_f32_bf16 v70, v146, v146, v70
v_dot2_f32_bf16 v67, v147, s72, v67
v_dot2_f32_bf16 v71, v147, v147, v71
s_waitcnt vmcnt(29)
v_dot2_f32_bf16 v64, v148, s72, v64
v_dot2_f32_bf16 v68, v148, v148, v68
v_dot2_f32_bf16 v65, v149, s72, v65
v_dot2_f32_bf16 v69, v149, v149, v69
v_dot2_f32_bf16 v66, v150, s72, v66
v_dot2_f32_bf16 v70, v150, v150, v70
v_dot2_f32_bf16 v67, v151, s72, v67
v_dot2_f32_bf16 v71, v151, v151, v71
s_waitcnt vmcnt(28)
v_dot2_f32_bf16 v64, v152, s72, v64
v_dot2_f32_bf16 v68, v152, v152, v68
v_dot2_f32_bf16 v65, v153, s72, v65
v_dot2_f32_bf16 v69, v153, v153, v69
v_dot2_f32_bf16 v66, v154, s72, v66
v_dot2_f32_bf16 v70, v154, v154, v70
v_dot2_f32_bf16 v67, v155, s72, v67
v_dot2_f32_bf16 v71, v155, v155, v71
s_waitcnt vmcnt(27)
v_dot2_f32_bf16 v64, v156, s72, v64
v_dot2_f32_bf16 v68, v156, v156, v68
v_dot2_f32_bf16 v65, v157, s72, v65
v_dot2_f32_bf16 v69, v157, v157, v69
v_dot2_f32_bf16 v66, v158, s72, v66
v_dot2_f32_bf16 v70, v158, v158, v70
v_dot2_f32_bf16 v67, v159, s72, v67
v_dot2_f32_bf16 v71, v159, v159, v71
s_waitcnt vmcnt(26)
v_dot2_f32_bf16 v64, v160, s72, v64
v_dot2_f32_bf16 v68, v160, v160, v68
v_dot2_f32_bf16 v65, v161, s72, v65
v_dot2_f32_bf16 v69, v161, v161, v69
v_dot2_f32_bf16 v66, v162, s72, v66
v_dot2_f32_bf16 v70, v162, v162, v70
v_dot2_f32_bf16 v67, v163, s72, v67
v_dot2_f32_bf16 v71, v163, v163, v71
s_waitcnt vmcnt(25)
v_dot2_f32_bf16 v64, v164, s72, v64
v_dot2_f32_bf16 v68, v164, v164, v68
v_dot2_f32_bf16 v65, v165, s72, v65
v_dot2_f32_bf16 v69, v165, v165, v69
v_dot2_f32_bf16 v66, v166, s72, v66
v_dot2_f32_bf16 v70, v166, v166, v70
v_dot2_f32_bf16 v67, v167, s72, v67
v_dot2_f32_bf16 v71, v167, v167, v71
s_waitcnt vmcnt(24)
v_dot2_f32_bf16 v64, v168, s72, v64
v_dot2_f32_bf16 v68, v168, v168, v68
v_dot2_f32_bf16 v65, v169, s72, v65
v_dot2_f32_bf16 v69, v169, v169, v69
v_dot2_f32_bf16 v66, v170, s72, v66
v_dot2_f32_bf16 v70, v170, v170, v70
v_dot2_f32_bf16 v67, v171, s72, v67
v_dot2_f32_bf16 v71, v171, v171, v71
s_waitcnt vmcnt(23)
v_dot2_f32_bf16 v64, v172, s72, v64
v_dot2_f32_bf16 v68, v172, v172, v68
v_dot2_f32_bf16 v65, v173, s72, v65
v_dot2_f32_bf16 v69, v173, v173, v69
v_dot2_f32_bf16 v66, v174, s72, v66
v_dot2_f32_bf16 v70, v174, v174, v70
v_dot2_f32_bf16 v67, v175, s72, v67
v_dot2_f32_bf16 v71, v175, v175, v71
s_waitcnt vmcnt(22)
v_dot2_f32_bf16 v64, v176, s72, v64
v_dot2_f32_bf16 v68, v176, v176, v68
v_dot2_f32_bf16 v65, v177, s72, v65
v_dot2_f32_bf16 v69, v177, v177, v69
v_dot2_f32_bf16 v66, v178, s72, v66
v_dot2_f32_bf16 v70, v178, v178, v70
v_dot2_f32_bf16 v67, v179, s72, v67
v_dot2_f32_bf16 v71, v179, v179, v71
s_waitcnt vmcnt(21)
v_dot2_f32_bf16 v64, v180, s72, v64
v_dot2_f32_bf16 v68, v180, v180, v68
v_dot2_f32_bf16 v65, v181, s72, v65
v_dot2_f32_bf16 v69, v181, v181, v69
v_dot2_f32_bf16 v66, v182, s72, v66
v_dot2_f32_bf16 v70, v182, v182, v70
v_dot2_f32_bf16 v67, v183, s72, v67
v_dot2_f32_bf16 v71, v183, v183, v71
s_waitcnt vmcnt(20)
v_dot2_f32_bf16 v64, v184, s72, v64
v_dot2_f32_bf16 v68, v184, v184, v68
v_dot2_f32_bf16 v65, v185, s72, v65
v_dot2_f32_bf16 v69, v185, v185, v69
v_dot2_f32_bf16 v66, v186, s72, v66
v_dot2_f32_bf16 v70, v186, v186, v70
v_dot2_f32_bf16 v67, v187, s72, v67
v_dot2_f32_bf16 v71, v187, v187, v71
s_waitcnt vmcnt(19)
v_dot2_f32_bf16 v64, v188, s72, v64
v_dot2_f32_bf16 v68, v188, v188, v68
v_dot2_f32_bf16 v65, v189, s72, v65
v_dot2_f32_bf16 v69, v189, v189, v69
v_dot2_f32_bf16 v66, v190, s72, v66
v_dot2_f32_bf16 v70, v190, v190, v70
v_dot2_f32_bf16 v67, v191, s72, v67
v_dot2_f32_bf16 v71, v191, v191, v71
s_lshl_b32 s62, s89, 2
s_add_u32 s62, s62, s56
s_lshl_b32 s63, s62, 6
v_and_b32 v26, 63, v0
v_add_u32 v26, s63, v26
v_and_b32 v28, 3, v26
v_lshrrev_b32 v26, 2, v26
v_lshlrev_b32 v26, 13, v26
v_lshl_add_u32 v26, v28, 8, v26
buffer_load_dword v252, v26, s[16:19], 0 offen offset:128
s_lshl_b32 s63, s62, 4
v_and_b32 v26, 15, v0
v_add_u32 v26, s63, v26
v_lshlrev_b32 v26, 10, v26
buffer_load_dword v253, v26, s[28:31], 0 offen
s_waitcnt vmcnt(20)
v_add_u32 v14, 1, v14
v_add_f32 v64, v64, v65
v_add_f32 v66, v66, v67
v_add_f32 v64, v64, v66
v_add_f32 v68, v68, v69
v_add_f32 v70, v70, v71
v_add_f32 v68, v68, v70
v_add_f32_dpp v64, v64, v64 quad_perm:[1,0,3,2] row_mask:0xf bank_mask:0xf
s_nop 0
v_add_f32_dpp v68, v68, v68 quad_perm:[1,0,3,2] row_mask:0xf bank_mask:0xf
v_add_f32_dpp v64, v64, v64 quad_perm:[2,3,0,1] row_mask:0xf bank_mask:0xf
s_nop 0
v_add_f32_dpp v68, v68, v68 quad_perm:[2,3,0,1] row_mask:0xf bank_mask:0xf
v_mul_f32 v72, 0xbb000000, v64
v_mul_f32 v73, 0x3b000000, v68
v_fma_f32 v73, -v72, v72, v73
v_max_f32 v73, 0, v73
v_add_f32 v74, 0x3727c5ac, v73
v_rsq_f32 v77, v74
s_nop 0
v_mul_f32 v73, v73, v77
v_fmaak_f32 v73, v73, v77, 0x3727c5ac
v_rsq_f32 v73, v73
v_mul_f32 v78, 0x3e0293ee, v77
v_mul_f32 v76, v77, v73
v_mov_b32 v79, 0
v_lshrrev_b32 v26, 2, v0
s_lshl_b32 s63, s56, 8
s_add_u32 s63, s63, 159808
v_lshl_add_u32 v28, v26, 4, s63
ds_write_b128 v28, v[76:79]
v_and_b32 v28, 1, v0
v_lshlrev_b32 v28, 1, v28
v_lshlrev_b32 v29, 1, v28
v_xor_b32 v27, v26, v29
v_lshl_add_u32 v27, v28, 4, v27
v_lshlrev_b32 v27, 4, v27
v_or_b32 v29, 2, v29
v_xor_b32 v29, v26, v29
v_add_u32 v28, 1, v28
v_lshl_add_u32 v28, v28, 4, v29
v_lshlrev_b32 v28, 4, v28
v_and_b32 v29, 2, v0
v_lshlrev_b32 v29, 2, v29
s_lshl_b32 s63, s56, 10
v_add_u32 v29, s63, v29
v_add_u32 v27, v27, v29
v_add_u32 v28, v28, v29
v_dot2_f32_bf16 v80, v128, s73, v72
v_dot2_f32_bf16 v81, v128, s74, v72
v_dot2_f32_bf16 v82, v129, s73, v72
v_dot2_f32_bf16 v83, v129, s74, v72
v_dot2_f32_bf16 v84, v130, s73, v72
v_dot2_f32_bf16 v85, v130, s74, v72
v_dot2_f32_bf16 v86, v131, s73, v72
v_dot2_f32_bf16 v87, v131, s74, v72
v_dot2_f32_bf16 v88, v132, s73, v72
v_dot2_f32_bf16 v89, v132, s74, v72
v_dot2_f32_bf16 v90, v133, s73, v72
v_dot2_f32_bf16 v91, v133, s74, v72
v_dot2_f32_bf16 v92, v134, s73, v72
v_dot2_f32_bf16 v93, v134, s74, v72
v_dot2_f32_bf16 v94, v135, s73, v72
v_dot2_f32_bf16 v95, v135, s74, v72
v_cvt_pk_bf16_f32 v128, v80, v81
v_cvt_pk_bf16_f32 v129, v82, v83
v_cvt_pk_bf16_f32 v130, v84, v85
v_cvt_pk_bf16_f32 v131, v86, v87
ds_write_b64 v27, v[128:129] offset:0
ds_write_b64 v28, v[130:131] offset:0
v_dot2_f32_bf16 v80, v136, s73, v72
v_dot2_f32_bf16 v81, v136, s74, v72
v_dot2_f32_bf16 v82, v137, s73, v72
v_dot2_f32_bf16 v83, v137, s74, v72
v_dot2_f32_bf16 v84, v138, s73, v72
v_dot2_f32_bf16 v85, v138, s74, v72
v_dot2_f32_bf16 v86, v139, s73, v72
v_dot2_f32_bf16 v87, v139, s74, v72
v_cvt_pk_bf16_f32 v132, v88, v89
v_cvt_pk_bf16_f32 v133, v90, v91
v_cvt_pk_bf16_f32 v134, v92, v93
v_cvt_pk_bf16_f32 v135, v94, v95
ds_write_b64 v27, v[132:133] offset:4096
ds_write_b64 v28, v[134:135] offset:4096
v_dot2_f32_bf16 v88, v140, s73, v72
v_dot2_f32_bf16 v89, v140, s74, v72
v_dot2_f32_bf16 v90, v141, s73, v72
v_dot2_f32_bf16 v91, v141, s74, v72
v_dot2_f32_bf16 v92, v142, s73, v72
v_dot2_f32_bf16 v93, v142, s74, v72
v_dot2_f32_bf16 v94, v143, s73, v72
v_dot2_f32_bf16 v95, v143, s74, v72
v_cvt_pk_bf16_f32 v136, v80, v81
v_cvt_pk_bf16_f32 v137, v82, v83
v_cvt_pk_bf16_f32 v138, v84, v85
v_cvt_pk_bf16_f32 v139, v86, v87
ds_write_b64 v27, v[136:137] offset:8192
ds_write_b64 v28, v[138:139] offset:8192
v_dot2_f32_bf16 v80, v144, s73, v72
v_dot2_f32_bf16 v81, v144, s74, v72
v_dot2_f32_bf16 v82, v145, s73, v72
v_dot2_f32_bf16 v83, v145, s74, v72
v_dot2_f32_bf16 v84, v146, s73, v72
v_dot2_f32_bf16 v85, v146, s74, v72
v_dot2_f32_bf16 v86, v147, s73, v72
v_dot2_f32_bf16 v87, v147, s74, v72
v_cvt_pk_bf16_f32 v140, v88, v89
v_cvt_pk_bf16_f32 v141, v90, v91
v_cvt_pk_bf16_f32 v142, v92, v93
v_cvt_pk_bf16_f32 v143, v94, v95
ds_write_b64 v27, v[140:141] offset:12288
ds_write_b64 v28, v[142:143] offset:12288
v_dot2_f32_bf16 v88, v148, s73, v72
v_dot2_f32_bf16 v89, v148, s74, v72
v_dot2_f32_bf16 v90, v149, s73, v72
v_dot2_f32_bf16 v91, v149, s74, v72
v_dot2_f32_bf16 v92, v150, s73, v72
v_dot2_f32_bf16 v93, v150, s74, v72
v_dot2_f32_bf16 v94, v151, s73, v72
v_dot2_f32_bf16 v95, v151, s74, v72
v_cvt_pk_bf16_f32 v144, v80, v81
v_cvt_pk_bf16_f32 v145, v82, v83
v_cvt_pk_bf16_f32 v146, v84, v85
v_cvt_pk_bf16_f32 v147, v86, v87
ds_write_b64 v27, v[144:145] offset:16384
ds_write_b64 v28, v[146:147] offset:16384
v_dot2_f32_bf16 v80, v152, s73, v72
v_dot2_f32_bf16 v81, v152, s74, v72
v_dot2_f32_bf16 v82, v153, s73, v72
v_dot2_f32_bf16 v83, v153, s74, v72
v_dot2_f32_bf16 v84, v154, s73, v72
v_dot2_f32_bf16 v85, v154, s74, v72
v_dot2_f32_bf16 v86, v155, s73, v72
v_dot2_f32_bf16 v87, v155, s74, v72
v_cvt_pk_bf16_f32 v148, v88, v89
v_cvt_pk_bf16_f32 v149, v90, v91
v_cvt_pk_bf16_f32 v150, v92, v93
v_cvt_pk_bf16_f32 v151, v94, v95
ds_write_b64 v27, v[148:149] offset:20480
ds_write_b64 v28, v[150:151] offset:20480
v_dot2_f32_bf16 v88, v156, s73, v72
v_dot2_f32_bf16 v89, v156, s74, v72
v_dot2_f32_bf16 v90, v157, s73, v72
v_dot2_f32_bf16 v91, v157, s74, v72
v_dot2_f32_bf16 v92, v158, s73, v72
v_dot2_f32_bf16 v93, v158, s74, v72
v_dot2_f32_bf16 v94, v159, s73, v72
v_dot2_f32_bf16 v95, v159, s74, v72
v_cvt_pk_bf16_f32 v152, v80, v81
v_cvt_pk_bf16_f32 v153, v82, v83
v_cvt_pk_bf16_f32 v154, v84, v85
v_cvt_pk_bf16_f32 v155, v86, v87
ds_write_b64 v27, v[152:153] offset:24576
ds_write_b64 v28, v[154:155] offset:24576
v_dot2_f32_bf16 v80, v160, s73, v72
v_dot2_f32_bf16 v81, v160, s74, v72
v_dot2_f32_bf16 v82, v161, s73, v72
v_dot2_f32_bf16 v83, v161, s74, v72
v_dot2_f32_bf16 v84, v162, s73, v72
v_dot2_f32_bf16 v85, v162, s74, v72
v_dot2_f32_bf16 v86, v163, s73, v72
v_dot2_f32_bf16 v87, v163, s74, v72
v_cvt_pk_bf16_f32 v156, v88, v89
v_cvt_pk_bf16_f32 v157, v90, v91
v_cvt_pk_bf16_f32 v158, v92, v93
v_cvt_pk_bf16_f32 v159, v94, v95
ds_write_b64 v27, v[156:157] offset:28672
ds_write_b64 v28, v[158:159] offset:28672
v_dot2_f32_bf16 v88, v164, s73, v72
v_dot2_f32_bf16 v89, v164, s74, v72
v_dot2_f32_bf16 v90, v165, s73, v72
v_dot2_f32_bf16 v91, v165, s74, v72
v_dot2_f32_bf16 v92, v166, s73, v72
v_dot2_f32_bf16 v93, v166, s74, v72
v_dot2_f32_bf16 v94, v167, s73, v72
v_dot2_f32_bf16 v95, v167, s74, v72
v_cvt_pk_bf16_f32 v160, v80, v81
v_cvt_pk_bf16_f32 v161, v82, v83
v_cvt_pk_bf16_f32 v162, v84, v85
v_cvt_pk_bf16_f32 v163, v86, v87
ds_write_b64 v27, v[160:161] offset:32768
ds_write_b64 v28, v[162:163] offset:32768
v_dot2_f32_bf16 v80, v168, s73, v72
v_dot2_f32_bf16 v81, v168, s74, v72
v_dot2_f32_bf16 v82, v169, s73, v72
v_dot2_f32_bf16 v83, v169, s74, v72
v_dot2_f32_bf16 v84, v170, s73, v72
v_dot2_f32_bf16 v85, v170, s74, v72
v_dot2_f32_bf16 v86, v171, s73, v72
v_dot2_f32_bf16 v87, v171, s74, v72
v_cvt_pk_bf16_f32 v164, v88, v89
v_cvt_pk_bf16_f32 v165, v90, v91
v_cvt_pk_bf16_f32 v166, v92, v93
v_cvt_pk_bf16_f32 v167, v94, v95
ds_write_b64 v27, v[164:165] offset:36864
ds_write_b64 v28, v[166:167] offset:36864
v_dot2_f32_bf16 v88, v172, s73, v72
v_dot2_f32_bf16 v89, v172, s74, v72
v_dot2_f32_bf16 v90, v173, s73, v72
v_dot2_f32_bf16 v91, v173, s74, v72
v_dot2_f32_bf16 v92, v174, s73, v72
v_dot2_f32_bf16 v93, v174, s74, v72
v_dot2_f32_bf16 v94, v175, s73, v72
v_dot2_f32_bf16 v95, v175, s74, v72
v_cvt_pk_bf16_f32 v168, v80, v81
v_cvt_pk_bf16_f32 v169, v82, v83
v_cvt_pk_bf16_f32 v170, v84, v85
v_cvt_pk_bf16_f32 v171, v86, v87
ds_write_b64 v27, v[168:169] offset:40960
ds_write_b64 v28, v[170:171] offset:40960
v_dot2_f32_bf16 v80, v176, s73, v72
v_dot2_f32_bf16 v81, v176, s74, v72
v_dot2_f32_bf16 v82, v177, s73, v72
v_dot2_f32_bf16 v83, v177, s74, v72
v_dot2_f32_bf16 v84, v178, s73, v72
v_dot2_f32_bf16 v85, v178, s74, v72
v_dot2_f32_bf16 v86, v179, s73, v72
v_dot2_f32_bf16 v87, v179, s74, v72
v_cvt_pk_bf16_f32 v172, v88, v89
v_cvt_pk_bf16_f32 v173, v90, v91
v_cvt_pk_bf16_f32 v174, v92, v93
v_cvt_pk_bf16_f32 v175, v94, v95
ds_write_b64 v27, v[172:173] offset:45056
ds_write_b64 v28, v[174:175] offset:45056
v_dot2_f32_bf16 v88, v180, s73, v72
v_dot2_f32_bf16 v89, v180, s74, v72
v_dot2_f32_bf16 v90, v181, s73, v72
v_dot2_f32_bf16 v91, v181, s74, v72
v_dot2_f32_bf16 v92, v182, s73, v72
v_dot2_f32_bf16 v93, v182, s74, v72
v_dot2_f32_bf16 v94, v183, s73, v72
v_dot2_f32_bf16 v95, v183, s74, v72
v_cvt_pk_bf16_f32 v176, v80, v81
v_cvt_pk_bf16_f32 v177, v82, v83
v_cvt_pk_bf16_f32 v178, v84, v85
v_cvt_pk_bf16_f32 v179, v86, v87
ds_write_b64 v27, v[176:177] offset:49152
ds_write_b64 v28, v[178:179] offset:49152
v_dot2_f32_bf16 v80, v184, s73, v72
v_dot2_f32_bf16 v81, v184, s74, v72
v_dot2_f32_bf16 v82, v185, s73, v72
v_dot2_f32_bf16 v83, v185, s74, v72
v_dot2_f32_bf16 v84, v186, s73, v72
v_dot2_f32_bf16 v85, v186, s74, v72
v_dot2_f32_bf16 v86, v187, s73, v72
v_dot2_f32_bf16 v87, v187, s74, v72
v_cvt_pk_bf16_f32 v180, v88, v89
v_cvt_pk_bf16_f32 v181, v90, v91
v_cvt_pk_bf16_f32 v182, v92, v93
v_cvt_pk_bf16_f32 v183, v94, v95
ds_write_b64 v27, v[180:181] offset:53248
ds_write_b64 v28, v[182:183] offset:53248
v_dot2_f32_bf16 v88, v188, s73, v72
v_dot2_f32_bf16 v89, v188, s74, v72
v_dot2_f32_bf16 v90, v189, s73, v72
v_dot2_f32_bf16 v91, v189, s74, v72
v_dot2_f32_bf16 v92, v190, s73, v72
v_dot2_f32_bf16 v93, v190, s74, v72
v_dot2_f32_bf16 v94, v191, s73, v72
v_dot2_f32_bf16 v95, v191, s74, v72
v_cvt_pk_bf16_f32 v184, v80, v81
v_cvt_pk_bf16_f32 v185, v82, v83
v_cvt_pk_bf16_f32 v186, v84, v85
v_cvt_pk_bf16_f32 v187, v86, v87
ds_write_b64 v27, v[184:185] offset:57344
ds_write_b64 v28, v[186:187] offset:57344
v_cvt_pk_bf16_f32 v188, v88, v89
v_cvt_pk_bf16_f32 v189, v90, v91
v_cvt_pk_bf16_f32 v190, v92, v93
v_cvt_pk_bf16_f32 v191, v94, v95
ds_write_b64 v27, v[188:189] offset:61440
ds_write_b64 v28, v[190:191] offset:61440
v_lshrrev_b32 v29, 4, v0
v_lshlrev_b32 v29, 1, v29
v_xor_b32 v26, v0, v29
v_lshlrev_b32 v26, 4, v26
s_add_u32 s63, s56, 0
s_and_b32 s63, s63, 3
s_lshl_b32 s62, s63, 10
v_add_u32 v112, s62, v26
s_lshl_b32 s62, s63, 8
s_add_u32 s62, s62, 159808
v_and_b32 v29, 15, v0
v_lshl_add_u32 v116, v29, 4, s62
s_add_u32 s63, s56, 1
s_and_b32 s63, s63, 3
s_lshl_b32 s62, s63, 10
v_add_u32 v113, s62, v26
s_lshl_b32 s62, s63, 8
s_add_u32 s62, s62, 159808
v_and_b32 v29, 15, v0
v_lshl_add_u32 v117, v29, 4, s62
s_add_u32 s63, s56, 2
s_and_b32 s63, s63, 3
s_lshl_b32 s62, s63, 10
v_add_u32 v114, s62, v26
s_lshl_b32 s62, s63, 8
s_add_u32 s62, s62, 159808
v_and_b32 v29, 15, v0
v_lshl_add_u32 v118, v29, 4, s62
s_add_u32 s63, s56, 3
s_and_b32 s63, s63, 3
s_lshl_b32 s62, s63, 10
v_add_u32 v115, s62, v26
s_lshl_b32 s62, s63, 8
s_add_u32 s62, s62, 159808
v_and_b32 v29, 15, v0
v_lshl_add_u32 v119, v29, 4, s62
s_waitcnt lgkmcnt(0)
s_barrier
s_waitcnt vmcnt(16)
ds_read_b64_tr_b16 v[32:33], v10 offset:0
ds_read_b64_tr_b16 v[34:35], v10 offset:2048
ds_read_b64_tr_b16 v[36:37], v11 offset:0
ds_read_b64_tr_b16 v[38:39], v11 offset:2048
ds_read_b64_tr_b16 v[40:41], v12 offset:0
ds_read_b64_tr_b16 v[42:43], v12 offset:2048
ds_read_b64_tr_b16 v[44:45], v13 offset:0
ds_read_b64_tr_b16 v[46:47], v13 offset:2048
s_lshr_b32 s62, s64, 6
v_add_u32 v30, s62, v112
ds_read_b128 a[0:3], v30 offset:0
ds_read_b128 a[16:19], v30 offset:4096
ds_read_b128 a[32:35], v30 offset:8192
ds_read_b128 a[48:51], v30 offset:12288
v_add_u32 v31, s62, v113
ds_read_b128 a[4:7], v31 offset:0
ds_read_b128 a[20:23], v31 offset:4096
ds_read_b128 a[36:39], v31 offset:8192
ds_read_b128 a[52:55], v31 offset:12288
v_add_u32 v30, s62, v114
ds_read_b128 a[8:11], v30 offset:0
ds_read_b128 a[24:27], v30 offset:4096
ds_read_b128 a[40:43], v30 offset:8192
ds_read_b128 a[56:59], v30 offset:12288
v_add_u32 v31, s62, v115
ds_read_b128 a[12:15], v31 offset:0
ds_read_b128 a[28:31], v31 offset:4096
ds_read_b128 a[44:47], v31 offset:8192
ds_read_b128 a[60:63], v31 offset:12288
s_waitcnt lgkmcnt(15)
v_mfma_f32_16x16x32_bf16 v[128:131], v[32:35], a[0:3], 0
s_waitcnt vmcnt(12)
ds_read_b64_tr_b16 v[48:49], v10 offset:4096
s_waitcnt lgkmcnt(12)
v_mfma_f32_16x16x32_bf16 v[132:135], v[32:35], a[4:7], 0
ds_read_b32 v16, v116 offset:8
ds_read_b32 v17, v117 offset:8
s_waitcnt lgkmcnt(10)
v_mfma_f32_16x16x32_bf16 v[136:139], v[32:35], a[8:11], 0
ds_read_b64_tr_b16 v[50:51], v10 offset:6144
ds_read_b32 v18, v118 offset:8
s_add_u32 m0, s60, 0
s_waitcnt lgkmcnt(8)
v_mfma_f32_16x16x32_bf16 v[140:143], v[32:35], a[12:15], 0
ds_read_b32 v19, v119 offset:8
ds_read_b64 v[24:25], v116
s_add_u32 s61, s64, 0
v_mfma_f32_16x16x32_bf16 v[144:147], v[36:39], a[0:3], 0
ds_read_b64_tr_b16 v[52:53], v11 offset:4096
ds_read_b64_tr_b16 v[54:55], v11 offset:6144
s_lshl_b32 s62, s57, 13
v_mfma_f32_16x16x32_bf16 v[148:151], v[36:39], a[4:7], 0
buffer_load_dwordx4 v6, s[16:19], s61 offen offset:0 lds
v_mfma_f32_16x16x32_bf16 v[152:155], v[36:39], a[8:11], 0
ds_read_b64_tr_b16 v[56:57], v12 offset:4096
ds_read_b64_tr_b16 v[58:59], v12 offset:6144
v_mfma_f32_16x16x32_bf16 v[156:159], v[36:39], a[12:15], 0
buffer_load_dwordx4 v7, s[16:19], s61 offen offset:1024 lds
v_mfma_f32_16x16x32_bf16 v[160:163], v[40:43], a[0:3], 0
ds_read_b64_tr_b16 v[60:61], v13 offset:4096
ds_read_b64_tr_b16 v[62:63], v13 offset:6144
v_mfma_f32_16x16x32_bf16 v[164:167], v[40:43], a[4:7], 0
buffer_load_dwordx4 v8, s[16:19], s61 offen offset:2048 lds
v_mfma_f32_16x16x32_bf16 v[168:171], v[40:43], a[8:11], 0
buffer_load_dwordx4 v9, s[16:19], s61 offen offset:3072 lds
v_mfma_f32_16x16x32_bf16 v[172:175], v[40:43], a[12:15], 0
v_add_u32 v27, s62, v112
v_mfma_f32_16x16x32_bf16 v[176:179], v[44:47], a[0:3], 0
ds_read_b128 v[120:123], v27 offset:0
ds_read_b128 v[124:127], v27 offset:4096
s_lshr_b32 s62, s65, 6
v_mfma_f32_16x16x32_bf16 v[180:183], v[44:47], a[4:7], 0
v_add_u32 v30, s62, v112
v_mfma_f32_16x16x32_bf16 v[184:187], v[44:47], a[8:11], 0
ds_read_b128 a[64:67], v30 offset:0
ds_read_b128 a[80:83], v30 offset:4096
ds_read_b128 a[96:99], v30 offset:8192
v_mfma_f32_16x16x32_bf16 v[188:191], v[44:47], a[12:15], 0
ds_read_b128 a[112:115], v30 offset:12288
v_add_u32 v31, s62, v113
ds_read_b128 a[68:71], v31 offset:0
ds_read_b128 a[84:87], v31 offset:4096
s_waitcnt lgkmcnt(8)
v_mfma_f32_16x16x32_bf16 v[128:131], v[48:51], a[16:19], v[128:131]
s_waitcnt vmcnt(12)
ds_read_b64_tr_b16 v[32:33], v10 offset:8192
v_mfma_f32_16x16x32_bf16 v[132:135], v[48:51], a[20:23], v[132:135]
ds_read_b128 a[100:103], v31 offset:8192
ds_read_b128 a[116:119], v31 offset:12288
v_add_u32 v30, s62, v114
v_mfma_f32_16x16x32_bf16 v[136:139], v[48:51], a[24:27], v[136:139]
ds_read_b64_tr_b16 v[34:35], v10 offset:10240
ds_read_b128 a[72:75], v30 offset:0
s_add_u32 m0, s60, 4096
v_mfma_f32_16x16x32_bf16 v[140:143], v[48:51], a[28:31], v[140:143]
ds_read_b128 a[88:91], v30 offset:4096
ds_read_b128 a[104:107], v30 offset:8192
s_add_u32 s61, s64, 262144
v_mfma_f32_16x16x32_bf16 v[144:147], v[52:55], a[16:19], v[144:147]
ds_read_b64_tr_b16 v[36:37], v11 offset:8192
ds_read_b64_tr_b16 v[38:39], v11 offset:10240
v_mfma_f32_16x16x32_bf16 v[148:151], v[52:55], a[20:23], v[148:151]
buffer_load_dwordx4 v6, s[16:19], s61 offen offset:0 lds
v_mfma_f32_16x16x32_bf16 v[152:155], v[52:55], a[24:27], v[152:155]
ds_read_b128 a[120:123], v30 offset:12288
ds_read_b64_tr_b16 v[40:41], v12 offset:8192
v_mfma_f32_16x16x32_bf16 v[156:159], v[52:55], a[28:31], v[156:159]
ds_read_b64_tr_b16 v[42:43], v12 offset:10240
v_add_u32 v31, s62, v115
v_mfma_f32_16x16x32_bf16 v[160:163], v[56:59], a[16:19], v[160:163]
ds_read_b128 a[76:79], v31 offset:0
ds_read_b128 a[92:95], v31 offset:4096
v_mfma_f32_16x16x32_bf16 v[164:167], v[56:59], a[20:23], v[164:167]
buffer_load_dwordx4 v7, s[16:19], s61 offen offset:1024 lds
v_mfma_f32_16x16x32_bf16 v[168:171], v[56:59], a[24:27], v[168:171]
ds_read_b128 a[108:111], v31 offset:8192
ds_read_b128 a[124:127], v31 offset:12288
s_lshr_b32 s62, s66, 6
v_mfma_f32_16x16x32_bf16 v[172:175], v[56:59], a[28:31], v[172:175]
ds_read_b64_tr_b16 v[44:45], v13 offset:8192
ds_read_b64_tr_b16 v[46:47], v13 offset:10240
v_add_u32 v30, s62, v112
v_mfma_f32_16x16x32_bf16 v[176:179], v[60:63], a[16:19], v[176:179]
buffer_load_dwordx4 v8, s[16:19], s61 offen offset:2048 lds
v_mfma_f32_16x16x32_bf16 v[180:183], v[60:63], a[20:23], v[180:183]
ds_read_b128 a[128:131], v30 offset:0
ds_read_b128 a[144:147], v30 offset:4096
v_mfma_f32_16x16x32_bf16 v[184:187], v[60:63], a[24:27], v[184:187]
buffer_load_dwordx4 v9, s[16:19], s61 offen offset:3072 lds
v_mfma_f32_16x16x32_bf16 v[188:191], v[60:63], a[28:31], v[188:191]
ds_read_b128 a[160:163], v30 offset:8192
ds_read_b128 a[176:179], v30 offset:12288
s_waitcnt lgkmcnt(4)
v_mfma_f32_16x16x32_bf16 v[128:131], v[32:35], a[32:35], v[128:131]
s_waitcnt vmcnt(12)
ds_read_b64_tr_b16 v[48:49], v10 offset:12288
v_add_u32 v31, s62, v113
v_mfma_f32_16x16x32_bf16 v[132:135], v[32:35], a[36:39], v[132:135]
ds_read_b128 a[132:135], v31 offset:0
ds_read_b64_tr_b16 v[50:51], v10 offset:14336
s_add_u32 m0, s60, 8192
v_mfma_f32_16x16x32_bf16 v[136:139], v[32:35], a[40:43], v[136:139]
ds_read_b128 a[148:151], v31 offset:4096
ds_read_b128 a[164:167], v31 offset:8192
s_add_u32 s61, s64, 524288
v_mfma_f32_16x16x32_bf16 v[140:143], v[32:35], a[44:47], v[140:143]
ds_read_b64_tr_b16 v[52:53], v11 offset:12288
ds_read_b128 a[180:183], v31 offset:12288
v_add_u32 v30, s62, v114
v_mfma_f32_16x16x32_bf16 v[144:147], v[36:39], a[32:35], v[144:147]
ds_read_b64_tr_b16 v[54:55], v11 offset:14336
v_mfma_f32_16x16x32_bf16 v[148:151], v[36:39], a[36:39], v[148:151]
buffer_load_dwordx4 v6, s[16:19], s61 offen offset:0 lds
v_mfma_f32_16x16x32_bf16 v[152:155], v[36:39], a[40:43], v[152:155]
ds_read_b128 a[136:139], v30 offset:0
ds_read_b128 a[152:155], v30 offset:4096
v_mfma_f32_16x16x32_bf16 v[156:159], v[36:39], a[44:47], v[156:159]
ds_read_b128 a[168:171], v30 offset:8192
ds_read_b64_tr_b16 v[56:57], v12 offset:12288
v_mfma_f32_16x16x32_bf16 v[160:163], v[40:43], a[32:35], v[160:163]
ds_read_b64_tr_b16 v[58:59], v12 offset:14336
ds_read_b128 a[184:187], v30 offset:12288
v_add_u32 v31, s62, v115
v_mfma_f32_16x16x32_bf16 v[164:167], v[40:43], a[36:39], v[164:167]
buffer_load_dwordx4 v7, s[16:19], s61 offen offset:1024 lds
v_mfma_f32_16x16x32_bf16 v[168:171], v[40:43], a[40:43], v[168:171]
ds_read_b128 a[140:143], v31 offset:0
ds_read_b64_tr_b16 v[60:61], v13 offset:12288
v_mfma_f32_16x16x32_bf16 v[172:175], v[40:43], a[44:47], v[172:175]
ds_read_b128 a[156:159], v31 offset:4096
ds_read_b64_tr_b16 v[62:63], v13 offset:14336
v_mfma_f32_16x16x32_bf16 v[176:179], v[44:47], a[32:35], v[176:179]
ds_read_b128 a[172:175], v31 offset:8192
v_mfma_f32_16x16x32_bf16 v[180:183], v[44:47], a[36:39], v[180:183]
buffer_load_dwordx4 v8, s[16:19], s61 offen offset:2048 lds
v_mfma_f32_16x16x32_bf16 v[184:187], v[44:47], a[40:43], v[184:187]
ds_read_b128 a[188:191], v31 offset:12288
s_lshr_b32 s62, s67, 6
v_add_u32 v30, s62, v112
v_mfma_f32_16x16x32_bf16 v[188:191], v[44:47], a[44:47], v[188:191]
buffer_load_dwordx4 v9, s[16:19], s61 offen offset:3072 lds
ds_read_b128 a[192:195], v30 offset:0
s_waitcnt lgkmcnt(3)
v_mfma_f32_16x16x32_bf16 v[128:131], v[48:51], a[48:51], v[128:131]
s_waitcnt vmcnt(8)
ds_read_b64_tr_b16 v[32:33], v10 offset:0
v_mfma_f32_16x16x32_bf16 v[132:135], v[48:51], a[52:55], v[132:135]
ds_read_b128 a[208:211], v30 offset:4096
ds_read_b128 a[224:227], v30 offset:8192
v_mfma_f32_16x16x32_bf16 v[136:139], v[48:51], a[56:59], v[136:139]
ds_read_b64_tr_b16 v[34:35], v10 offset:2048
ds_read_b128 a[240:243], v30 offset:12288
s_add_u32 m0, s60, 12288
v_mfma_f32_16x16x32_bf16 v[140:143], v[48:51], a[60:63], v[140:143]
s_add_u32 s61, s64, 786432
v_add_u32 v31, s62, v113
v_mfma_f32_16x16x32_bf16 v[144:147], v[52:55], a[48:51], v[144:147]
ds_read_b64_tr_b16 v[36:37], v11 offset:0
ds_read_b128 a[196:199], v31 offset:0
v_mfma_f32_16x16x32_bf16 v[148:151], v[52:55], a[52:55], v[148:151]
ds_read_b64_tr_b16 v[38:39], v11 offset:2048
v_mfma_f32_16x16x32_bf16 v[152:155], v[52:55], a[56:59], v[152:155]
buffer_load_dwordx4 v6, s[16:19], s61 offen offset:0 lds
v_mfma_f32_16x16x32_bf16 v[156:159], v[52:55], a[60:63], v[156:159]
ds_read_b128 a[212:215], v31 offset:4096
ds_read_b128 a[228:231], v31 offset:8192
v_mfma_f32_16x16x32_bf16 v[160:163], v[56:59], a[48:51], v[160:163]
ds_read_b128 a[244:247], v31 offset:12288
ds_read_b64_tr_b16 v[40:41], v12 offset:0
v_add_u32 v30, s62, v114
v_mfma_f32_16x16x32_bf16 v[164:167], v[56:59], a[52:55], v[164:167]
ds_read_b64_tr_b16 v[42:43], v12 offset:2048
ds_read_b128 a[200:203], v30 offset:0
v_mfma_f32_16x16x32_bf16 v[168:171], v[56:59], a[56:59], v[168:171]
buffer_load_dwordx4 v7, s[16:19], s61 offen offset:1024 lds
v_mfma_f32_16x16x32_bf16 v[172:175], v[56:59], a[60:63], v[172:175]
ds_read_b128 a[216:219], v30 offset:4096
ds_read_b128 a[232:235], v30 offset:8192
ds_read_b64_tr_b16 v[44:45], v13 offset:0
v_mfma_f32_16x16x32_bf16 v[176:179], v[60:63], a[48:51], v[176:179]
ds_read_b128 a[248:251], v30 offset:12288
ds_read_b64_tr_b16 v[46:47], v13 offset:2048
v_add_u32 v31, s62, v115
v_mfma_f32_16x16x32_bf16 v[180:183], v[60:63], a[52:55], v[180:183]
buffer_load_dwordx4 v8, s[16:19], s61 offen offset:2048 lds
v_mfma_f32_16x16x32_bf16 v[184:187], v[60:63], a[56:59], v[184:187]
ds_read_b128 a[204:207], v31 offset:0
ds_read_b128 a[220:223], v31 offset:4096
v_mfma_f32_16x16x32_bf16 v[188:191], v[60:63], a[60:63], v[188:191]
buffer_load_dwordx4 v9, s[16:19], s61 offen offset:3072 lds
ds_read_b128 a[236:239], v31 offset:8192
ds_read_b128 a[252:255], v31 offset:12288
s_waitcnt lgkmcnt(4)
v_mfma_f32_16x16x32_bf16 v[192:195], v[32:35], a[0:3], 0
s_waitcnt vmcnt(8)
ds_read_b64_tr_b16 v[48:49], v10 offset:4096
ds_read_b64_tr_b16 v[50:51], v10 offset:6144
s_add_u32 m0, s60, 0
s_add_u32 s61, s65, 0
v_mfma_f32_16x16x32_bf16 v[196:199], v[32:35], a[4:7], 0
ds_read_b64_tr_b16 v[52:53], v11 offset:4096
ds_read_b64_tr_b16 v[54:55], v11 offset:6144
buffer_load_dwordx4 v6, s[16:19], s61 offen offset:0 lds
v_mfma_f32_16x16x32_bf16 v[200:203], v[32:35], a[8:11], 0
ds_read_b64_tr_b16 v[56:57], v12 offset:4096
ds_read_b64_tr_b16 v[58:59], v12 offset:6144
buffer_load_dwordx4 v7, s[16:19], s61 offen offset:1024 lds
ds_read_b64_tr_b16 v[60:61], v13 offset:4096
v_mfma_f32_16x16x32_bf16 v[204:207], v[32:35], a[12:15], 0
ds_read_b64_tr_b16 v[62:63], v13 offset:6144
buffer_load_dwordx4 v8, s[16:19], s61 offen offset:2048 lds
s_waitcnt lgkmcnt(8)
s_barrier
s_add_u32 s63, s56, 1
v_mfma_f32_16x16x32_bf16 v[208:211], v[36:39], a[0:3], 0
buffer_load_dwordx4 v9, s[16:19], s61 offen offset:3072 lds
s_and_b32 s63, s63, 3
s_mul_i32 s63, s63, 12288
v_add_u32 v31, s63, v1
v_mfma_f32_16x16x32_bf16 v[212:215], v[36:39], a[4:7], 0
ds_write_b128 v31, v[132:135] offset:0
v_mfma_f32_16x16x32_bf16 v[216:219], v[36:39], a[8:11], 0
ds_write_b128 v31, v[148:151] offset:1024
v_mfma_f32_16x16x32_bf16 v[220:223], v[36:39], a[12:15], 0
ds_write_b128 v31, v[164:167] offset:2048
v_mfma_f32_16x16x32_bf16 v[224:227], v[40:43], a[0:3], 0
ds_write_b128 v31, v[180:183] offset:3072
s_add_u32 s63, s56, 2
s_and_b32 s63, s63, 3
v_mfma_f32_16x16x32_bf16 v[228:231], v[40:43], a[4:7], 0
s_mul_i32 s63, s63, 12288
v_add_u32 v30, s63, v1
v_mfma_f32_16x16x32_bf16 v[232:235], v[40:43], a[8:11], 0
ds_write_b128 v30, v[136:139] offset:4096
v_mfma_f32_16x16x32_bf16 v[236:239], v[40:43], a[12:15], 0
ds_write_b128 v30, v[152:155] offset:5120
v_mfma_f32_16x16x32_bf16 v[240:243], v[44:47], a[0:3], 0
ds_write_b128 v30, v[168:171] offset:6144
ds_write_b128 v30, v[184:187] offset:7168
v_mfma_f32_16x16x32_bf16 v[244:247], v[44:47], a[4:7], 0
s_add_u32 s63, s56, 3
s_and_b32 s63, s63, 3
s_mul_i32 s63, s63, 12288
v_add_u32 v31, s63, v1
v_mfma_f32_16x16x32_bf16 v[248:251], v[44:47], a[8:11], 0
ds_write_b128 v31, v[140:143] offset:8192
ds_write_b128 v31, v[156:159] offset:9216
v_mfma_f32_16x16x32_bf16 v[252:255], v[44:47], a[12:15], 0
ds_write_b128 v31, v[172:175] offset:10240
ds_write_b128 v31, v[188:191] offset:11264
s_waitcnt lgkmcnt(0)
s_barrier
s_mul_i32 s63, s56, 12288
v_add_u32 v30, s63, v1
ds_read_b128 v[64:67], v30 offset:0
ds_read_b128 v[68:71], v30 offset:1024
v_mfma_f32_16x16x32_bf16 v[192:195], v[48:51], a[16:19], v[192:195]
ds_read_b128 v[72:75], v30 offset:2048
s_waitcnt vmcnt(8)
ds_read_b64_tr_b16 v[32:33], v10 offset:8192
v_mfma_f32_16x16x32_bf16 v[196:199], v[48:51], a[20:23], v[196:199]
ds_read_b128 v[76:79], v30 offset:3072
ds_read_b128 v[80:83], v30 offset:4096
ds_read_b64_tr_b16 v[34:35], v10 offset:10240
v_mfma_f32_16x16x32_bf16 v[200:203], v[48:51], a[24:27], v[200:203]
ds_read_b128 v[84:87], v30 offset:5120
ds_read_b128 v[88:91], v30 offset:6144
ds_read_b128 v[92:95], v30 offset:7168
v_mfma_f32_16x16x32_bf16 v[204:207], v[48:51], a[28:31], v[204:207]
ds_read_b128 v[96:99], v30 offset:8192
ds_read_b128 v[100:103], v30 offset:9216
ds_read_b128 v[104:107], v30 offset:10240
v_mfma_f32_16x16x32_bf16 v[208:211], v[52:55], a[16:19], v[208:211]
ds_read_b128 v[108:111], v30 offset:11264
s_add_u32 m0, s60, 4096
s_add_u32 s61, s65, 262144
v_mfma_f32_16x16x32_bf16 v[212:215], v[52:55], a[20:23], v[212:215]
ds_read_b64_tr_b16 v[36:37], v11 offset:8192
ds_read_b64_tr_b16 v[38:39], v11 offset:10240
s_waitcnt lgkmcnt(15)
v_add_f32 v128, v128, v64
v_add_f32 v129, v129, v65
v_mfma_f32_16x16x32_bf16 v[216:219], v[52:55], a[24:27], v[216:219]
buffer_load_dwordx4 v6, s[16:19], s61 offen offset:0 lds
v_mfma_f32_16x16x32_bf16 v[220:223], v[52:55], a[28:31], v[220:223]
ds_read_b64_tr_b16 v[40:41], v12 offset:8192
ds_read_b64_tr_b16 v[42:43], v12 offset:10240
v_add_f32 v130, v130, v66
v_mfma_f32_16x16x32_bf16 v[224:227], v[56:59], a[16:19], v[224:227]
buffer_load_dwordx4 v7, s[16:19], s61 offen offset:1024 lds
v_add_f32 v131, v131, v67
v_mfma_f32_16x16x32_bf16 v[228:231], v[56:59], a[20:23], v[228:231]
ds_read_b64_tr_b16 v[44:45], v13 offset:8192
ds_read_b64_tr_b16 v[46:47], v13 offset:10240
s_waitcnt lgkmcnt(15)
v_add_f32 v144, v144, v68
v_mfma_f32_16x16x32_bf16 v[232:235], v[56:59], a[24:27], v[232:235]
buffer_load_dwordx4 v8, s[16:19], s61 offen offset:2048 lds
v_add_f32 v145, v145, v69
v_mfma_f32_16x16x32_bf16 v[236:239], v[56:59], a[28:31], v[236:239]
buffer_load_dwordx4 v9, s[16:19], s61 offen offset:3072 lds
v_add_f32 v146, v146, v70
v_mfma_f32_16x16x32_bf16 v[240:243], v[60:63], a[16:19], v[240:243]
v_add_f32 v147, v147, v71
v_add_f32 v160, v160, v72
v_add_f32 v161, v161, v73
v_mfma_f32_16x16x32_bf16 v[244:247], v[60:63], a[20:23], v[244:247]
v_add_f32 v162, v162, v74
v_add_f32 v163, v163, v75
v_add_f32 v176, v176, v76
v_mfma_f32_16x16x32_bf16 v[248:251], v[60:63], a[24:27], v[248:251]
v_add_f32 v177, v177, v77
v_add_f32 v178, v178, v78
v_add_f32 v179, v179, v79
s_waitcnt lgkmcnt(14)
v_add_f32 v128, v128, v80
v_mfma_f32_16x16x32_bf16 v[252:255], v[60:63], a[28:31], v[252:255]
v_add_f32 v129, v129, v81
v_add_f32 v130, v130, v82
v_add_f32 v131, v131, v83
s_waitcnt lgkmcnt(0)
v_mfma_f32_16x16x32_bf16 v[192:195], v[32:35], a[32:35], v[192:195]
s_waitcnt vmcnt(8)
ds_read_b64_tr_b16 v[48:49], v10 offset:12288
ds_read_b64_tr_b16 v[50:51], v10 offset:14336
v_mfma_f32_16x16x32_bf16 v[196:199], v[32:35], a[36:39], v[196:199]
s_add_u32 m0, s60, 8192
s_add_u32 s61, s65, 524288
v_add_f32 v144, v144, v84
v_mfma_f32_16x16x32_bf16 v[200:203], v[32:35], a[40:43], v[200:203]
ds_read_b64_tr_b16 v[52:53], v11 offset:12288
ds_read_b64_tr_b16 v[54:55], v11 offset:14336
v_add_f32 v145, v145, v85
v_mfma_f32_16x16x32_bf16 v[204:207], v[32:35], a[44:47], v[204:207]
buffer_load_dwordx4 v6, s[16:19], s61 offen offset:0 lds
v_mfma_f32_16x16x32_bf16 v[208:211], v[36:39], a[32:35], v[208:211]
ds_read_b64_tr_b16 v[56:57], v12 offset:12288
ds_read_b64_tr_b16 v[58:59], v12 offset:14336
v_add_f32 v146, v146, v86
v_mfma_f32_16x16x32_bf16 v[212:215], v[36:39], a[36:39], v[212:215]
buffer_load_dwordx4 v7, s[16:19], s61 offen offset:1024 lds
v_add_f32 v147, v147, v87
v_mfma_f32_16x16x32_bf16 v[216:219], v[36:39], a[40:43], v[216:219]
ds_read_b64_tr_b16 v[60:61], v13 offset:12288
ds_read_b64_tr_b16 v[62:63], v13 offset:14336
v_add_f32 v160, v160, v88
v_mfma_f32_16x16x32_bf16 v[220:223], v[36:39], a[44:47], v[220:223]
buffer_load_dwordx4 v8, s[16:19], s61 offen offset:2048 lds
v_add_f32 v161, v161, v89
v_mfma_f32_16x16x32_bf16 v[224:227], v[40:43], a[32:35], v[224:227]
buffer_load_dwordx4 v9, s[16:19], s61 offen offset:3072 lds
v_add_f32 v162, v162, v90
v_mfma_f32_16x16x32_bf16 v[228:231], v[40:43], a[36:39], v[228:231]
v_add_f32 v163, v163, v91
v_add_f32 v176, v176, v92
v_add_f32 v177, v177, v93
v_mfma_f32_16x16x32_bf16 v[232:235], v[40:43], a[40:43], v[232:235]
v_add_f32 v178, v178, v94
v_add_f32 v179, v179, v95
v_add_f32 v128, v128, v96
v_mfma_f32_16x16x32_bf16 v[236:239], v[40:43], a[44:47], v[236:239]
v_add_f32 v129, v129, v97
v_add_f32 v130, v130, v98
v_add_f32 v131, v131, v99
v_mfma_f32_16x16x32_bf16 v[240:243], v[44:47], a[32:35], v[240:243]
v_add_f32 v144, v144, v100
v_add_f32 v145, v145, v101
v_add_f32 v146, v146, v102
v_add_f32 v147, v147, v103
v_mfma_f32_16x16x32_bf16 v[244:247], v[44:47], a[36:39], v[244:247]
v_add_f32 v160, v160, v104
v_add_f32 v161, v161, v105
v_add_f32 v162, v162, v106
v_mfma_f32_16x16x32_bf16 v[248:251], v[44:47], a[40:43], v[248:251]
v_add_f32 v163, v163, v107
v_add_f32 v176, v176, v108
v_add_f32 v177, v177, v109
v_add_f32 v178, v178, v110
v_mfma_f32_16x16x32_bf16 v[252:255], v[44:47], a[44:47], v[252:255]
v_add_f32 v179, v179, v111
s_barrier
s_waitcnt lgkmcnt(0)
v_mfma_f32_16x16x32_bf16 v[192:195], v[48:51], a[48:51], v[192:195]
s_waitcnt vmcnt(8)
ds_read_b64_tr_b16 v[32:33], v10 offset:0
ds_read_b64_tr_b16 v[34:35], v10 offset:2048
s_add_u32 m0, s59, 0
s_add_u32 s61, s65, 786432
v_mfma_f32_16x16x32_bf16 v[196:199], v[48:51], a[52:55], v[196:199]
ds_read_b64_tr_b16 v[36:37], v11 offset:0
ds_read_b64_tr_b16 v[38:39], v11 offset:2048
buffer_load_dwordx4 v6, s[16:19], s61 offen offset:0 lds
v_mfma_f32_16x16x32_bf16 v[200:203], v[48:51], a[56:59], v[200:203]
ds_read_b64_tr_b16 v[40:41], v12 offset:0
ds_read_b64_tr_b16 v[42:43], v12 offset:2048
buffer_load_dwordx4 v7, s[16:19], s61 offen offset:1024 lds
v_mfma_f32_16x16x32_bf16 v[204:207], v[48:51], a[60:63], v[204:207]
ds_read_b64_tr_b16 v[44:45], v13 offset:0
ds_read_b64_tr_b16 v[46:47], v13 offset:2048
buffer_load_dwordx4 v8, s[16:19], s61 offen offset:2048 lds
v_mfma_f32_16x16x32_bf16 v[208:211], v[52:55], a[48:51], v[208:211]
buffer_load_dwordx4 v9, s[16:19], s61 offen offset:3072 lds
s_add_u32 m0, s59, 4096
s_add_u32 s61, s66, 0
s_sub_u32 s63, s59, s60
v_mfma_f32_16x16x32_bf16 v[212:215], v[52:55], a[52:55], v[212:215]
buffer_load_dwordx4 v6, s[16:19], s61 offen offset:0 lds
v_add_u32 v112, s63, v10
v_add_u32 v113, s63, v11
v_mfma_f32_16x16x32_bf16 v[216:219], v[52:55], a[56:59], v[216:219]
buffer_load_dwordx4 v7, s[16:19], s61 offen offset:1024 lds
v_add_u32 v114, s63, v12
v_add_u32 v115, s63, v13
v_mov_b32 v29, 0xbdd2d3e8
v_mfma_f32_16x16x32_bf16 v[220:223], v[52:55], a[60:63], v[220:223]
buffer_load_dwordx4 v8, s[16:19], s61 offen offset:2048 lds
v_mul_f32 v128, v128, v24
v_mul_f32 v129, v129, v24
v_mfma_f32_16x16x32_bf16 v[224:227], v[56:59], a[48:51], v[224:227]
buffer_load_dwordx4 v9, s[16:19], s61 offen offset:3072 lds
v_mul_f32 v130, v130, v24
v_mul_f32 v131, v131, v24
v_mul_f32 v144, v144, v24
v_mfma_f32_16x16x32_bf16 v[228:231], v[56:59], a[52:55], v[228:231]
v_mul_f32 v145, v145, v24
v_mul_f32 v146, v146, v24
v_mul_f32 v147, v147, v24
v_mul_f32 v160, v160, v24
v_mul_f32 v161, v161, v24
v_mfma_f32_16x16x32_bf16 v[232:235], v[56:59], a[56:59], v[232:235]
v_mul_f32 v162, v162, v24
v_mul_f32 v163, v163, v24
v_mul_f32 v176, v176, v24
v_mul_f32 v177, v177, v24
v_mul_f32 v178, v178, v24
v_mfma_f32_16x16x32_bf16 v[236:239], v[56:59], a[60:63], v[236:239]
v_mul_f32 v179, v179, v24
v_mul_f32 v64, v128, v128
v_mul_f32 v65, v129, v129
v_mul_f32 v66, v130, v130
v_mul_f32 v67, v131, v131
v_mfma_f32_16x16x32_bf16 v[240:243], v[60:63], a[48:51], v[240:243]
v_mul_f32 v68, v144, v144
v_mul_f32 v69, v145, v145
v_mul_f32 v70, v146, v146
v_mul_f32 v71, v147, v147
v_fmaak_f32 v64, v29, v64, 0xc0135761
v_fmaak_f32 v65, v29, v65, 0xc0135761
v_mfma_f32_16x16x32_bf16 v[244:247], v[60:63], a[52:55], v[244:247]
v_fmaak_f32 v66, v29, v66, 0xc0135761
v_fmaak_f32 v67, v29, v67, 0xc0135761
v_fmaak_f32 v68, v29, v68, 0xc0135761
v_fmaak_f32 v69, v29, v69, 0xc0135761
v_fmaak_f32 v70, v29, v70, 0xc0135761
v_mfma_f32_16x16x32_bf16 v[248:251], v[60:63], a[56:59], v[248:251]
v_fmaak_f32 v71, v29, v71, 0xc0135761
v_mul_f32 v64, v64, v128
v_mul_f32 v65, v65, v129
v_mul_f32 v66, v66, v130
v_mul_f32 v67, v67, v131
v_mul_f32 v68, v68, v144
v_mfma_f32_16x16x32_bf16 v[252:255], v[60:63], a[60:63], v[252:255]
v_mul_f32 v69, v69, v145
v_mul_f32 v70, v70, v146
v_mul_f32 v71, v71, v147
v_exp_f32 v64, v64
s_waitcnt lgkmcnt(0)
v_mfma_f32_16x16x32_bf16 v[192:195], v[32:35], a[64:67], v[192:195]
s_waitcnt vmcnt(12)
ds_read_b64_tr_b16 v[48:49], v10 offset:4096
ds_read_b64_tr_b16 v[50:51], v10 offset:6144
s_add_u32 m0, s59, 8192
s_add_u32 s61, s66, 262144
v_mfma_f32_16x16x32_bf16 v[196:199], v[32:35], a[68:71], v[196:199]
ds_read_b64_tr_b16 v[52:53], v11 offset:4096
ds_read_b64_tr_b16 v[54:55], v11 offset:6144
buffer_load_dwordx4 v6, s[16:19], s61 offen offset:0 lds
v_mfma_f32_16x16x32_bf16 v[200:203], v[32:35], a[72:75], v[200:203]
ds_read_b64_tr_b16 v[56:57], v12 offset:4096
ds_read_b64_tr_b16 v[58:59], v12 offset:6144
buffer_load_dwordx4 v7, s[16:19], s61 offen offset:1024 lds
v_mfma_f32_16x16x32_bf16 v[204:207], v[32:35], a[76:79], v[204:207]
ds_read_b64_tr_b16 v[60:61], v13 offset:4096
ds_read_b64_tr_b16 v[62:63], v13 offset:6144
buffer_load_dwordx4 v8, s[16:19], s61 offen offset:2048 lds
v_mfma_f32_16x16x32_bf16 v[208:211], v[36:39], a[64:67], v[208:211]
buffer_load_dwordx4 v9, s[16:19], s61 offen offset:3072 lds
s_add_u32 m0, s59, 12288
s_add_u32 s61, s66, 524288
v_mfma_f32_16x16x32_bf16 v[212:215], v[36:39], a[68:71], v[212:215]
buffer_load_dwordx4 v6, s[16:19], s61 offen offset:0 lds
v_exp_f32 v65, v65
v_mfma_f32_16x16x32_bf16 v[216:219], v[36:39], a[72:75], v[216:219]
buffer_load_dwordx4 v7, s[16:19], s61 offen offset:1024 lds
v_exp_f32 v66, v66
v_mfma_f32_16x16x32_bf16 v[220:223], v[36:39], a[76:79], v[220:223]
buffer_load_dwordx4 v8, s[16:19], s61 offen offset:2048 lds
v_exp_f32 v67, v67
v_mfma_f32_16x16x32_bf16 v[224:227], v[40:43], a[64:67], v[224:227]
buffer_load_dwordx4 v9, s[16:19], s61 offen offset:3072 lds
v_exp_f32 v68, v68
v_mfma_f32_16x16x32_bf16 v[228:231], v[40:43], a[68:71], v[228:231]
v_exp_f32 v69, v69
v_exp_f32 v70, v70
v_mfma_f32_16x16x32_bf16 v[232:235], v[40:43], a[72:75], v[232:235]
v_exp_f32 v71, v71
v_add_f32 v64, 1.0, v64
v_add_f32 v65, 1.0, v65
v_add_f32 v66, 1.0, v66
v_add_f32 v67, 1.0, v67
v_mfma_f32_16x16x32_bf16 v[236:239], v[40:43], a[76:79], v[236:239]
v_add_f32 v68, 1.0, v68
v_add_f32 v69, 1.0, v69
v_add_f32 v70, 1.0, v70
v_add_f32 v71, 1.0, v71
v_mfma_f32_16x16x32_bf16 v[240:243], v[44:47], a[64:67], v[240:243]
v_rcp_f32 v64, v64
v_rcp_f32 v65, v65
v_rcp_f32 v66, v66
v_mfma_f32_16x16x32_bf16 v[244:247], v[44:47], a[68:71], v[244:247]
v_rcp_f32 v67, v67
v_rcp_f32 v68, v68
v_rcp_f32 v69, v69
v_mfma_f32_16x16x32_bf16 v[248:251], v[44:47], a[72:75], v[248:251]
v_rcp_f32 v70, v70
v_rcp_f32 v71, v71
v_mul_f32 v128, v128, v64
v_mul_f32 v129, v129, v65
v_mfma_f32_16x16x32_bf16 v[252:255], v[44:47], a[76:79], v[252:255]
v_mul_f32 v130, v130, v66
v_mul_f32 v131, v131, v67
v_mul_f32 v144, v144, v68
v_mul_f32 v145, v145, v69
v_mul_f32 v146, v146, v70
s_waitcnt lgkmcnt(0)
v_mfma_f32_16x16x32_bf16 v[192:195], v[48:51], a[80:83], v[192:195]
s_waitcnt vmcnt(16)
ds_read_b64_tr_b16 v[32:33], v10 offset:8192
ds_read_b64_tr_b16 v[34:35], v10 offset:10240
s_add_u32 m0, s60, 12288
s_add_u32 s61, s66, 786432
v_mfma_f32_16x16x32_bf16 v[196:199], v[48:51], a[84:87], v[196:199]
ds_read_b64_tr_b16 v[36:37], v11 offset:8192
ds_read_b64_tr_b16 v[38:39], v11 offset:10240
v_mul_f32 v147, v147, v71
v_mul_f32 v64, v160, v160
v_mul_f32 v65, v161, v161
v_mfma_f32_16x16x32_bf16 v[200:203], v[48:51], a[88:91], v[200:203]
buffer_load_dwordx4 v6, s[16:19], s61 offen offset:0 lds
ds_read_b64_tr_b16 v[40:41], v12 offset:8192
v_mul_f32 v66, v162, v162
v_mfma_f32_16x16x32_bf16 v[204:207], v[48:51], a[92:95], v[204:207]
ds_read_b64_tr_b16 v[42:43], v12 offset:10240
buffer_load_dwordx4 v7, s[16:19], s61 offen offset:1024 lds
ds_read_b64_tr_b16 v[44:45], v13 offset:8192
v_mfma_f32_16x16x32_bf16 v[208:211], v[52:55], a[80:83], v[208:211]
ds_read_b64_tr_b16 v[46:47], v13 offset:10240
buffer_load_dwordx4 v8, s[16:19], s61 offen offset:2048 lds
v_mul_f32 v67, v163, v163
v_mul_f32 v68, v176, v176
v_mfma_f32_16x16x32_bf16 v[212:215], v[52:55], a[84:87], v[212:215]
buffer_load_dwordx4 v9, s[16:19], s61 offen offset:3072 lds
s_add_u32 m0, s60, 0
s_add_u32 s61, s67, 0
v_mfma_f32_16x16x32_bf16 v[216:219], v[52:55], a[88:91], v[216:219]
buffer_load_dwordx4 v6, s[16:19], s61 offen offset:0 lds
v_mul_f32 v69, v177, v177
v_mul_f32 v70, v178, v178
v_mfma_f32_16x16x32_bf16 v[220:223], v[52:55], a[92:95], v[220:223]
buffer_load_dwordx4 v7, s[16:19], s61 offen offset:1024 lds
v_mul_f32 v71, v179, v179
v_fmaak_f32 v64, v29, v64, 0xc0135761
v_mfma_f32_16x16x32_bf16 v[224:227], v[56:59], a[80:83], v[224:227]
buffer_load_dwordx4 v8, s[16:19], s61 offen offset:2048 lds
v_fmaak_f32 v65, v29, v65, 0xc0135761
v_fmaak_f32 v66, v29, v66, 0xc0135761
v_mfma_f32_16x16x32_bf16 v[228:231], v[56:59], a[84:87], v[228:231]
buffer_load_dwordx4 v9, s[16:19], s61 offen offset:3072 lds
v_fmaak_f32 v67, v29, v67, 0xc0135761
v_fmaak_f32 v68, v29, v68, 0xc0135761
v_fmaak_f32 v69, v29, v69, 0xc0135761
v_mfma_f32_16x16x32_bf16 v[232:235], v[56:59], a[88:91], v[232:235]
v_fmaak_f32 v70, v29, v70, 0xc0135761
v_fmaak_f32 v71, v29, v71, 0xc0135761
v_mul_f32 v64, v64, v160
v_mul_f32 v65, v65, v161
v_mul_f32 v66, v66, v162
v_mfma_f32_16x16x32_bf16 v[236:239], v[56:59], a[92:95], v[236:239]
v_mul_f32 v67, v67, v163
v_mul_f32 v68, v68, v176
v_mul_f32 v69, v69, v177
v_mul_f32 v70, v70, v178
v_mul_f32 v71, v71, v179
v_mfma_f32_16x16x32_bf16 v[240:243], v[60:63], a[80:83], v[240:243]
v_exp_f32 v64, v64
v_exp_f32 v65, v65
v_exp_f32 v66, v66
v_mfma_f32_16x16x32_bf16 v[244:247], v[60:63], a[84:87], v[244:247]
v_exp_f32 v67, v67
v_exp_f32 v68, v68
v_mfma_f32_16x16x32_bf16 v[248:251], v[60:63], a[88:91], v[248:251]
v_exp_f32 v69, v69
v_exp_f32 v70, v70
v_exp_f32 v71, v71
v_mfma_f32_16x16x32_bf16 v[252:255], v[60:63], a[92:95], v[252:255]
v_add_f32 v64, 1.0, v64
v_add_f32 v65, 1.0, v65
v_add_f32 v66, 1.0, v66
v_add_f32 v67, 1.0, v67
v_add_f32 v68, 1.0, v68
v_add_f32 v69, 1.0, v69
s_waitcnt lgkmcnt(0)
v_mfma_f32_16x16x32_bf16 v[192:195], v[32:35], a[96:99], v[192:195]
s_waitcnt vmcnt(20)
ds_read_b64_tr_b16 v[48:49], v112 offset:0
ds_read_b64_tr_b16 v[50:51], v112 offset:2048
s_add_u32 m0, s60, 4096
s_add_u32 s61, s67, 262144
v_add_f32 v70, 1.0, v70
v_mfma_f32_16x16x32_bf16 v[196:199], v[32:35], a[100:103], v[196:199]
ds_read_b64_tr_b16 v[52:53], v113 offset:0
ds_read_b64_tr_b16 v[54:55], v113 offset:2048
v_add_f32 v71, 1.0, v71
v_rcp_f32 v64, v64
v_mfma_f32_16x16x32_bf16 v[200:203], v[32:35], a[104:107], v[200:203]
buffer_load_dwordx4 v6, s[16:19], s61 offen offset:0 lds
ds_read_b64_tr_b16 v[56:57], v114 offset:0
v_mfma_f32_16x16x32_bf16 v[204:207], v[32:35], a[108:111], v[204:207]
ds_read_b64_tr_b16 v[58:59], v114 offset:2048
buffer_load_dwordx4 v7, s[16:19], s61 offen offset:1024 lds
ds_read_b64_tr_b16 v[60:61], v115 offset:0
v_mfma_f32_16x16x32_bf16 v[208:211], v[36:39], a[96:99], v[208:211]
ds_read_b64_tr_b16 v[62:63], v115 offset:2048
buffer_load_dwordx4 v8, s[16:19], s61 offen offset:2048 lds
v_rcp_f32 v65, v65
v_mfma_f32_16x16x32_bf16 v[212:215], v[36:39], a[100:103], v[212:215]
buffer_load_dwordx4 v9, s[16:19], s61 offen offset:3072 lds
s_add_u32 m0, s60, 8192
s_add_u32 s61, s67, 524288
v_mfma_f32_16x16x32_bf16 v[216:219], v[36:39], a[104:107], v[216:219]
buffer_load_dwordx4 v6, s[16:19], s61 offen offset:0 lds
v_rcp_f32 v66, v66
v_mfma_f32_16x16x32_bf16 v[220:223], v[36:39], a[108:111], v[220:223]
buffer_load_dwordx4 v7, s[16:19], s61 offen offset:1024 lds
buffer_load_dwordx4 v8, s[16:19], s61 offen offset:2048 lds
v_mfma_f32_16x16x32_bf16 v[224:227], v[40:43], a[96:99], v[224:227]
buffer_load_dwordx4 v9, s[16:19], s61 offen offset:3072 lds
v_rcp_f32 v67, v67
v_mfma_f32_16x16x32_bf16 v[228:231], v[40:43], a[100:103], v[228:231]
v_rcp_f32 v68, v68
v_rcp_f32 v69, v69
v_rcp_f32 v70, v70
v_mfma_f32_16x16x32_bf16 v[232:235], v[40:43], a[104:107], v[232:235]
v_rcp_f32 v71, v71
v_mul_f32 v160, v160, v64
v_mul_f32 v161, v161, v65
v_mul_f32 v162, v162, v66
v_mul_f32 v163, v163, v67
v_mfma_f32_16x16x32_bf16 v[236:239], v[40:43], a[108:111], v[236:239]
v_mul_f32 v176, v176, v68
v_mul_f32 v177, v177, v69
v_mul_f32 v178, v178, v70
v_mul_f32 v179, v179, v71
v_cvt_pk_bf16_f32 v128, v128, v129
v_cvt_pk_bf16_f32 v129, v130, v131
v_mfma_f32_16x16x32_bf16 v[240:243], v[44:47], a[96:99], v[240:243]
v_cvt_pk_bf16_f32 v130, v144, v145
v_cvt_pk_bf16_f32 v131, v146, v147
v_cvt_pk_bf16_f32 v160, v160, v161
v_cvt_pk_bf16_f32 v161, v162, v163
v_cvt_pk_bf16_f32 v162, v176, v177
v_cvt_pk_bf16_f32 v163, v178, v179
v_mfma_f32_16x16x32_bf16 v[244:247], v[44:47], a[100:103], v[244:247]
v_lshrrev_b32 v26, 4, v0
v_and_b32 v27, 15, v0
s_lshl_b32 s63, s56, 4
v_add_u32 v27, s63, v27
v_lshlrev_b32 v27, 4, v27
v_lshl_add_u32 v27, v26, 15, v27
v_mfma_f32_16x16x32_bf16 v[248:251], v[44:47], a[104:107], v[248:251]
s_lshl_b32 s63, s57, 18
s_lshl_b32 s62, s58, 10
s_add_u32 s63, s63, s62
v_mfma_f32_16x16x32_bf16 v[252:255], v[44:47], a[108:111], v[252:255]
buffer_store_dwordx4 v[128:131], v27, s[48:51], s63 offen sc1
s_add_u32 s63, s63, 131072
buffer_store_dwordx4 v[160:163], v27, s[48:51], s63 offen sc1
s_waitcnt lgkmcnt(0)
v_mfma_f32_16x16x32_bf16 v[192:195], v[48:51], a[112:115], v[192:195]
s_waitcnt vmcnt(26)
ds_read_b64_tr_b16 v[32:33], v112 offset:4096
v_mfma_f32_16x16x32_bf16 v[196:199], v[48:51], a[116:119], v[196:199]
ds_read_b64_tr_b16 v[34:35], v112 offset:6144
s_add_u32 m0, s59, 0
v_mfma_f32_16x16x32_bf16 v[200:203], v[48:51], a[120:123], v[200:203]
s_add_u32 s61, s67, 786432
v_mfma_f32_16x16x32_bf16 v[204:207], v[48:51], a[124:127], v[204:207]
ds_read_b64_tr_b16 v[36:37], v113 offset:4096
ds_read_b64_tr_b16 v[38:39], v113 offset:6144
v_mfma_f32_16x16x32_bf16 v[208:211], v[52:55], a[112:115], v[208:211]
buffer_load_dwordx4 v6, s[16:19], s61 offen offset:0 lds
v_mfma_f32_16x16x32_bf16 v[212:215], v[52:55], a[116:119], v[212:215]
v_mfma_f32_16x16x32_bf16 v[216:219], v[52:55], a[120:123], v[216:219]
v_mfma_f32_16x16x32_bf16 v[220:223], v[52:55], a[124:127], v[220:223]
ds_read_b64_tr_b16 v[40:41], v114 offset:4096
ds_read_b64_tr_b16 v[42:43], v114 offset:6144
v_mfma_f32_16x16x32_bf16 v[224:227], v[56:59], a[112:115], v[224:227]
buffer_load_dwordx4 v7, s[16:19], s61 offen offset:1024 lds
v_mfma_f32_16x16x32_bf16 v[228:231], v[56:59], a[116:119], v[228:231]
v_mfma_f32_16x16x32_bf16 v[232:235], v[56:59], a[120:123], v[232:235]
ds_read_b64_tr_b16 v[44:45], v115 offset:4096
v_mfma_f32_16x16x32_bf16 v[236:239], v[56:59], a[124:127], v[236:239]
ds_read_b64_tr_b16 v[46:47], v115 offset:6144
v_mfma_f32_16x16x32_bf16 v[240:243], v[60:63], a[112:115], v[240:243]
buffer_load_dwordx4 v8, s[16:19], s61 offen offset:2048 lds
v_mfma_f32_16x16x32_bf16 v[244:247], v[60:63], a[116:119], v[244:247]
buffer_load_dwordx4 v9, s[16:19], s61 offen offset:3072 lds
v_mfma_f32_16x16x32_bf16 v[248:251], v[60:63], a[120:123], v[248:251]
v_mfma_f32_16x16x32_bf16 v[252:255], v[60:63], a[124:127], v[252:255]
s_waitcnt lgkmcnt(0)
v_mfma_f32_16x16x32_bf16 v[192:195], v[32:35], a[128:131], v[192:195]
s_waitcnt vmcnt(26)
ds_read_b64_tr_b16 v[48:49], v112 offset:8192
v_mfma_f32_16x16x32_bf16 v[196:199], v[32:35], a[132:135], v[196:199]
ds_read_b64_tr_b16 v[50:51], v112 offset:10240
s_add_u32 m0, s59, 4096
v_mfma_f32_16x16x32_bf16 v[200:203], v[32:35], a[136:139], v[200:203]
s_add_u32 s61, s64, 128
v_mfma_f32_16x16x32_bf16 v[204:207], v[32:35], a[140:143], v[204:207]
ds_read_b64_tr_b16 v[52:53], v113 offset:8192
ds_read_b64_tr_b16 v[54:55], v113 offset:10240
v_mfma_f32_16x16x32_bf16 v[208:211], v[36:39], a[128:131], v[208:211]
buffer_load_dwordx4 v6, s[16:19], s61 offen offset:0 lds
v_mfma_f32_16x16x32_bf16 v[212:215], v[36:39], a[132:135], v[212:215]
v_mfma_f32_16x16x32_bf16 v[216:219], v[36:39], a[136:139], v[216:219]
v_mfma_f32_16x16x32_bf16 v[220:223], v[36:39], a[140:143], v[220:223]
ds_read_b64_tr_b16 v[56:57], v114 offset:8192
ds_read_b64_tr_b16 v[58:59], v114 offset:10240
v_mfma_f32_16x16x32_bf16 v[224:227], v[40:43], a[128:131], v[224:227]
buffer_load_dwordx4 v7, s[16:19], s61 offen offset:1024 lds
v_mfma_f32_16x16x32_bf16 v[228:231], v[40:43], a[132:135], v[228:231]
v_mfma_f32_16x16x32_bf16 v[232:235], v[40:43], a[136:139], v[232:235]
ds_read_b64_tr_b16 v[60:61], v115 offset:8192
v_mfma_f32_16x16x32_bf16 v[236:239], v[40:43], a[140:143], v[236:239]
ds_read_b64_tr_b16 v[62:63], v115 offset:10240
v_mfma_f32_16x16x32_bf16 v[240:243], v[44:47], a[128:131], v[240:243]
buffer_load_dwordx4 v8, s[16:19], s61 offen offset:2048 lds
v_mfma_f32_16x16x32_bf16 v[244:247], v[44:47], a[132:135], v[244:247]
buffer_load_dwordx4 v9, s[16:19], s61 offen offset:3072 lds
v_mfma_f32_16x16x32_bf16 v[248:251], v[44:47], a[136:139], v[248:251]
v_mfma_f32_16x16x32_bf16 v[252:255], v[44:47], a[140:143], v[252:255]
s_waitcnt lgkmcnt(0)
v_mfma_f32_16x16x32_bf16 v[192:195], v[48:51], a[144:147], v[192:195]
s_waitcnt vmcnt(26)
ds_read_b64_tr_b16 v[32:33], v112 offset:12288
v_mfma_f32_16x16x32_bf16 v[196:199], v[48:51], a[148:151], v[196:199]
ds_read_b64_tr_b16 v[34:35], v112 offset:14336
s_add_u32 m0, s59, 8192
v_mfma_f32_16x16x32_bf16 v[200:203], v[48:51], a[152:155], v[200:203]
s_add_u32 s61, s64, 262272
s_mul_i32 s63, s57, 128
v_mfma_f32_16x16x32_bf16 v[204:207], v[48:51], a[156:159], v[204:207]
ds_read_b64_tr_b16 v[36:37], v113 offset:12288
ds_read_b64_tr_b16 v[38:39], v113 offset:14336
v_mfma_f32_16x16x32_bf16 v[208:211], v[52:55], a[144:147], v[208:211]
buffer_load_dwordx4 v6, s[16:19], s61 offen offset:0 lds
v_mfma_f32_16x16x32_bf16 v[212:215], v[52:55], a[148:151], v[212:215]
ds_read_b64_tr_b16 v[40:41], v114 offset:12288
ds_read_b64_tr_b16 v[42:43], v114 offset:14336
v_mfma_f32_16x16x32_bf16 v[216:219], v[52:55], a[152:155], v[216:219]
buffer_load_dwordx4 v7, s[16:19], s61 offen offset:1024 lds
v_mfma_f32_16x16x32_bf16 v[220:223], v[52:55], a[156:159], v[220:223]
ds_read_b64_tr_b16 v[44:45], v115 offset:12288
ds_read_b64_tr_b16 v[46:47], v115 offset:14336
v_mfma_f32_16x16x32_bf16 v[224:227], v[56:59], a[144:147], v[224:227]
buffer_load_dwordx4 v8, s[16:19], s61 offen offset:2048 lds
v_mfma_f32_16x16x32_bf16 v[228:231], v[56:59], a[148:151], v[228:231]
s_lshl_b32 s62, s56, 2
s_add_u32 s63, s63, s62
v_mfma_f32_16x16x32_bf16 v[232:235], v[56:59], a[152:155], v[232:235]
s_add_u32 s63, s63, s90
s_add_u32 s63, s63, 0
v_mfma_f32_16x16x32_bf16 v[236:239], v[56:59], a[156:159], v[236:239]
s_waitcnt vmcnt(11)
buffer_store_dword v14, v15, s[44:47], s63 offen sc1
v_mfma_f32_16x16x32_bf16 v[240:243], v[60:63], a[144:147], v[240:243]
v_mfma_f32_16x16x32_bf16 v[244:247], v[60:63], a[148:151], v[244:247]
buffer_load_dwordx4 v9, s[16:19], s61 offen offset:3072 lds
v_mfma_f32_16x16x32_bf16 v[248:251], v[60:63], a[152:155], v[248:251]
v_mfma_f32_16x16x32_bf16 v[252:255], v[60:63], a[156:159], v[252:255]
s_waitcnt lgkmcnt(0)
v_mfma_f32_16x16x32_bf16 v[192:195], v[32:35], a[160:163], v[192:195]
ds_read_b64_tr_b16 v[48:49], v10 offset:12288
v_mfma_f32_16x16x32_bf16 v[196:199], v[32:35], a[164:167], v[196:199]
ds_read_b64_tr_b16 v[50:51], v10 offset:14336
s_add_u32 m0, s59, 12288
v_mfma_f32_16x16x32_bf16 v[200:203], v[32:35], a[168:171], v[200:203]
s_add_u32 s61, s64, 524416
v_mfma_f32_16x16x32_bf16 v[204:207], v[32:35], a[172:175], v[204:207]
ds_read_b64_tr_b16 v[52:53], v11 offset:12288
ds_read_b64_tr_b16 v[54:55], v11 offset:14336
v_mfma_f32_16x16x32_bf16 v[208:211], v[36:39], a[160:163], v[208:211]
buffer_load_dwordx4 v6, s[16:19], s61 offen offset:0 lds
v_mfma_f32_16x16x32_bf16 v[212:215], v[36:39], a[164:167], v[212:215]
v_mfma_f32_16x16x32_bf16 v[216:219], v[36:39], a[168:171], v[216:219]
v_mfma_f32_16x16x32_bf16 v[220:223], v[36:39], a[172:175], v[220:223]
ds_read_b64_tr_b16 v[56:57], v12 offset:12288
ds_read_b64_tr_b16 v[58:59], v12 offset:14336
v_mfma_f32_16x16x32_bf16 v[224:227], v[40:43], a[160:163], v[224:227]
buffer_load_dwordx4 v7, s[16:19], s61 offen offset:1024 lds
v_mfma_f32_16x16x32_bf16 v[228:231], v[40:43], a[164:167], v[228:231]
v_mfma_f32_16x16x32_bf16 v[232:235], v[40:43], a[168:171], v[232:235]
ds_read_b64_tr_b16 v[60:61], v13 offset:12288
v_mfma_f32_16x16x32_bf16 v[236:239], v[40:43], a[172:175], v[236:239]
ds_read_b64_tr_b16 v[62:63], v13 offset:14336
v_mfma_f32_16x16x32_bf16 v[240:243], v[44:47], a[160:163], v[240:243]
buffer_load_dwordx4 v8, s[16:19], s61 offen offset:2048 lds
v_mfma_f32_16x16x32_bf16 v[244:247], v[44:47], a[164:167], v[244:247]
buffer_load_dwordx4 v9, s[16:19], s61 offen offset:3072 lds
v_mfma_f32_16x16x32_bf16 v[248:251], v[44:47], a[168:171], v[248:251]
v_mfma_f32_16x16x32_bf16 v[252:255], v[44:47], a[172:175], v[252:255]
s_waitcnt lgkmcnt(0)
v_mfma_f32_16x16x32_bf16 v[192:195], v[48:51], a[176:179], v[192:195]
ds_read_b64_tr_b16 v[32:33], v10 offset:0
v_mfma_f32_16x16x32_bf16 v[196:199], v[48:51], a[180:183], v[196:199]
ds_read_b64_tr_b16 v[34:35], v10 offset:2048
s_add_u32 m0, s60, 12288
v_mfma_f32_16x16x32_bf16 v[200:203], v[48:51], a[184:187], v[200:203]
s_add_u32 s61, s64, 786560
v_mfma_f32_16x16x32_bf16 v[204:207], v[48:51], a[188:191], v[204:207]
ds_read_b64_tr_b16 v[36:37], v11 offset:0
ds_read_b64_tr_b16 v[38:39], v11 offset:2048
v_mfma_f32_16x16x32_bf16 v[208:211], v[52:55], a[176:179], v[208:211]
buffer_load_dwordx4 v6, s[16:19], s61 offen offset:0 lds
v_mfma_f32_16x16x32_bf16 v[212:215], v[52:55], a[180:183], v[212:215]
v_mfma_f32_16x16x32_bf16 v[216:219], v[52:55], a[184:187], v[216:219]
v_mfma_f32_16x16x32_bf16 v[220:223], v[52:55], a[188:191], v[220:223]
ds_read_b64_tr_b16 v[40:41], v12 offset:0
ds_read_b64_tr_b16 v[42:43], v12 offset:2048
v_mfma_f32_16x16x32_bf16 v[224:227], v[56:59], a[176:179], v[224:227]
buffer_load_dwordx4 v7, s[16:19], s61 offen offset:1024 lds
v_mfma_f32_16x16x32_bf16 v[228:231], v[56:59], a[180:183], v[228:231]
v_mfma_f32_16x16x32_bf16 v[232:235], v[56:59], a[184:187], v[232:235]
ds_read_b64_tr_b16 v[44:45], v13 offset:0
v_mfma_f32_16x16x32_bf16 v[236:239], v[56:59], a[188:191], v[236:239]
ds_read_b64_tr_b16 v[46:47], v13 offset:2048
v_mfma_f32_16x16x32_bf16 v[240:243], v[60:63], a[176:179], v[240:243]
buffer_load_dwordx4 v8, s[16:19], s61 offen offset:2048 lds
v_mfma_f32_16x16x32_bf16 v[244:247], v[60:63], a[180:183], v[244:247]
buffer_load_dwordx4 v9, s[16:19], s61 offen offset:3072 lds
v_mfma_f32_16x16x32_bf16 v[248:251], v[60:63], a[184:187], v[248:251]
v_mfma_f32_16x16x32_bf16 v[252:255], v[60:63], a[188:191], v[252:255]
s_waitcnt lgkmcnt(0)
v_mfma_f32_16x16x32_bf16 v[192:195], v[32:35], a[192:195], v[192:195]
ds_read_b64_tr_b16 v[48:49], v10 offset:4096
v_mfma_f32_16x16x32_bf16 v[196:199], v[32:35], a[196:199], v[196:199]
ds_read_b64_tr_b16 v[50:51], v10 offset:6144
s_add_u32 m0, s60, 0
v_mfma_f32_16x16x32_bf16 v[200:203], v[32:35], a[200:203], v[200:203]
s_add_u32 s61, s65, 128
v_mfma_f32_16x16x32_bf16 v[204:207], v[32:35], a[204:207], v[204:207]
ds_read_b64_tr_b16 v[52:53], v11 offset:4096
ds_read_b64_tr_b16 v[54:55], v11 offset:6144
v_mfma_f32_16x16x32_bf16 v[208:211], v[36:39], a[192:195], v[208:211]
buffer_load_dwordx4 v6, s[16:19], s61 offen offset:0 lds
v_mfma_f32_16x16x32_bf16 v[212:215], v[36:39], a[196:199], v[212:215]
v_mfma_f32_16x16x32_bf16 v[216:219], v[36:39], a[200:203], v[216:219]
v_mfma_f32_16x16x32_bf16 v[220:223], v[36:39], a[204:207], v[220:223]
ds_read_b64_tr_b16 v[56:57], v12 offset:4096
ds_read_b64_tr_b16 v[58:59], v12 offset:6144
v_mfma_f32_16x16x32_bf16 v[224:227], v[40:43], a[192:195], v[224:227]
buffer_load_dwordx4 v7, s[16:19], s61 offen offset:1024 lds
v_mfma_f32_16x16x32_bf16 v[228:231], v[40:43], a[196:199], v[228:231]
v_mfma_f32_16x16x32_bf16 v[232:235], v[40:43], a[200:203], v[232:235]
ds_read_b64_tr_b16 v[60:61], v13 offset:4096
v_mfma_f32_16x16x32_bf16 v[236:239], v[40:43], a[204:207], v[236:239]
ds_read_b64_tr_b16 v[62:63], v13 offset:6144
v_mfma_f32_16x16x32_bf16 v[240:243], v[44:47], a[192:195], v[240:243]
buffer_load_dwordx4 v8, s[16:19], s61 offen offset:2048 lds
v_mfma_f32_16x16x32_bf16 v[244:247], v[44:47], a[196:199], v[244:247]
buffer_load_dwordx4 v9, s[16:19], s61 offen offset:3072 lds
v_mfma_f32_16x16x32_bf16 v[248:251], v[44:47], a[200:203], v[248:251]
v_mfma_f32_16x16x32_bf16 v[252:255], v[44:47], a[204:207], v[252:255]
s_waitcnt lgkmcnt(0)
v_mfma_f32_16x16x32_bf16 v[192:195], v[48:51], a[208:211], v[192:195]
ds_read_b64_tr_b16 v[32:33], v10 offset:8192
v_mfma_f32_16x16x32_bf16 v[196:199], v[48:51], a[212:215], v[196:199]
ds_read_b64_tr_b16 v[34:35], v10 offset:10240
s_add_u32 m0, s60, 4096
v_mfma_f32_16x16x32_bf16 v[200:203], v[48:51], a[216:219], v[200:203]
s_add_u32 s61, s65, 262272
v_mfma_f32_16x16x32_bf16 v[204:207], v[48:51], a[220:223], v[204:207]
ds_read_b64_tr_b16 v[36:37], v11 offset:8192
ds_read_b64_tr_b16 v[38:39], v11 offset:10240
v_mfma_f32_16x16x32_bf16 v[208:211], v[52:55], a[208:211], v[208:211]
buffer_load_dwordx4 v6, s[16:19], s61 offen offset:0 lds
v_mfma_f32_16x16x32_bf16 v[212:215], v[52:55], a[212:215], v[212:215]
v_mfma_f32_16x16x32_bf16 v[216:219], v[52:55], a[216:219], v[216:219]
v_mfma_f32_16x16x32_bf16 v[220:223], v[52:55], a[220:223], v[220:223]
ds_read_b64_tr_b16 v[40:41], v12 offset:8192
ds_read_b64_tr_b16 v[42:43], v12 offset:10240
v_mfma_f32_16x16x32_bf16 v[224:227], v[56:59], a[208:211], v[224:227]
buffer_load_dwordx4 v7, s[16:19], s61 offen offset:1024 lds
v_mfma_f32_16x16x32_bf16 v[228:231], v[56:59], a[212:215], v[228:231]
v_mfma_f32_16x16x32_bf16 v[232:235], v[56:59], a[216:219], v[232:235]
ds_read_b64_tr_b16 v[44:45], v13 offset:8192
v_mfma_f32_16x16x32_bf16 v[236:239], v[56:59], a[220:223], v[236:239]
ds_read_b64_tr_b16 v[46:47], v13 offset:10240
v_mfma_f32_16x16x32_bf16 v[240:243], v[60:63], a[208:211], v[240:243]
buffer_load_dwordx4 v8, s[16:19], s61 offen offset:2048 lds
v_mfma_f32_16x16x32_bf16 v[244:247], v[60:63], a[212:215], v[244:247]
buffer_load_dwordx4 v9, s[16:19], s61 offen offset:3072 lds
v_mfma_f32_16x16x32_bf16 v[248:251], v[60:63], a[216:219], v[248:251]
v_mfma_f32_16x16x32_bf16 v[252:255], v[60:63], a[220:223], v[252:255]
s_waitcnt lgkmcnt(0)
v_mfma_f32_16x16x32_bf16 v[192:195], v[32:35], a[224:227], v[192:195]
s_waitcnt vmcnt(25)
ds_read_b64_tr_b16 v[48:49], v112 offset:0
v_mfma_f32_16x16x32_bf16 v[196:199], v[32:35], a[228:231], v[196:199]
ds_read_b64_tr_b16 v[50:51], v112 offset:2048
s_add_u32 m0, s60, 8192
v_mfma_f32_16x16x32_bf16 v[200:203], v[32:35], a[232:235], v[200:203]
s_add_u32 s61, s65, 524416
v_mfma_f32_16x16x32_bf16 v[204:207], v[32:35], a[236:239], v[204:207]
ds_read_b64_tr_b16 v[52:53], v113 offset:0
ds_read_b64_tr_b16 v[54:55], v113 offset:2048
v_mfma_f32_16x16x32_bf16 v[208:211], v[36:39], a[224:227], v[208:211]
buffer_load_dwordx4 v6, s[16:19], s61 offen offset:0 lds
v_mfma_f32_16x16x32_bf16 v[212:215], v[36:39], a[228:231], v[212:215]
v_mfma_f32_16x16x32_bf16 v[216:219], v[36:39], a[232:235], v[216:219]
v_mfma_f32_16x16x32_bf16 v[220:223], v[36:39], a[236:239], v[220:223]
ds_read_b64_tr_b16 v[56:57], v114 offset:0
ds_read_b64_tr_b16 v[58:59], v114 offset:2048
v_mfma_f32_16x16x32_bf16 v[224:227], v[40:43], a[224:227], v[224:227]
buffer_load_dwordx4 v7, s[16:19], s61 offen offset:1024 lds
v_mfma_f32_16x16x32_bf16 v[228:231], v[40:43], a[228:231], v[228:231]
v_mfma_f32_16x16x32_bf16 v[232:235], v[40:43], a[232:235], v[232:235]
ds_read_b64_tr_b16 v[60:61], v115 offset:0
v_mfma_f32_16x16x32_bf16 v[236:239], v[40:43], a[236:239], v[236:239]
ds_read_b64_tr_b16 v[62:63], v115 offset:2048
v_mfma_f32_16x16x32_bf16 v[240:243], v[44:47], a[224:227], v[240:243]
buffer_load_dwordx4 v8, s[16:19], s61 offen offset:2048 lds
v_mfma_f32_16x16x32_bf16 v[244:247], v[44:47], a[228:231], v[244:247]
buffer_load_dwordx4 v9, s[16:19], s61 offen offset:3072 lds
v_mfma_f32_16x16x32_bf16 v[248:251], v[44:47], a[232:235], v[248:251]
v_mfma_f32_16x16x32_bf16 v[252:255], v[44:47], a[236:239], v[252:255]
s_waitcnt lgkmcnt(0)
v_mfma_f32_16x16x32_bf16 v[192:195], v[48:51], a[240:243], v[192:195]
s_waitcnt vmcnt(25)
ds_read_b64_tr_b16 v[32:33], v112 offset:4096
v_mfma_f32_16x16x32_bf16 v[196:199], v[48:51], a[244:247], v[196:199]
ds_read_b64_tr_b16 v[34:35], v112 offset:6144
s_add_u32 m0, s59, 0
v_mfma_f32_16x16x32_bf16 v[200:203], v[48:51], a[248:251], v[200:203]
s_add_u32 s61, s65, 786560
v_mfma_f32_16x16x32_bf16 v[204:207], v[48:51], a[252:255], v[204:207]
ds_read_b64_tr_b16 v[36:37], v113 offset:4096
ds_read_b64_tr_b16 v[38:39], v113 offset:6144
v_mfma_f32_16x16x32_bf16 v[208:211], v[52:55], a[240:243], v[208:211]
buffer_load_dwordx4 v6, s[16:19], s61 offen offset:0 lds
v_mfma_f32_16x16x32_bf16 v[212:215], v[52:55], a[244:247], v[212:215]
v_mfma_f32_16x16x32_bf16 v[216:219], v[52:55], a[248:251], v[216:219]
v_mfma_f32_16x16x32_bf16 v[220:223], v[52:55], a[252:255], v[220:223]
ds_read_b64_tr_b16 v[40:41], v114 offset:4096
ds_read_b64_tr_b16 v[42:43], v114 offset:6144
v_mfma_f32_16x16x32_bf16 v[224:227], v[56:59], a[240:243], v[224:227]
buffer_load_dwordx4 v7, s[16:19], s61 offen offset:1024 lds
v_mfma_f32_16x16x32_bf16 v[228:231], v[56:59], a[244:247], v[228:231]
v_mfma_f32_16x16x32_bf16 v[232:235], v[56:59], a[248:251], v[232:235]
ds_read_b64_tr_b16 v[44:45], v115 offset:4096
v_mfma_f32_16x16x32_bf16 v[236:239], v[56:59], a[252:255], v[236:239]
ds_read_b64_tr_b16 v[46:47], v115 offset:6144
v_mfma_f32_16x16x32_bf16 v[240:243], v[60:63], a[240:243], v[240:243]
buffer_load_dwordx4 v8, s[16:19], s61 offen offset:2048 lds
v_mfma_f32_16x16x32_bf16 v[244:247], v[60:63], a[244:247], v[244:247]
buffer_load_dwordx4 v9, s[16:19], s61 offen offset:3072 lds
v_mfma_f32_16x16x32_bf16 v[248:251], v[60:63], a[248:251], v[248:251]
v_mfma_f32_16x16x32_bf16 v[252:255], v[60:63], a[252:255], v[252:255]
s_waitcnt lgkmcnt(0)
v_mfma_f32_16x16x32_bf16 v[128:131], v[32:35], a[0:3], 0
s_waitcnt vmcnt(24)
ds_read_b64_tr_b16 v[48:49], v112 offset:8192
v_mfma_f32_16x16x32_bf16 v[132:135], v[32:35], a[4:7], 0
ds_read_b64_tr_b16 v[50:51], v112 offset:10240
s_add_u32 m0, s59, 4096
v_mfma_f32_16x16x32_bf16 v[136:139], v[32:35], a[8:11], 0
s_add_u32 s61, s66, 128
s_and_b32 s62, s56, 1
v_mfma_f32_16x16x32_bf16 v[140:143], v[32:35], a[12:15], 0
ds_read_b64_tr_b16 v[52:53], v113 offset:8192
ds_read_b64_tr_b16 v[54:55], v113 offset:10240
v_mfma_f32_16x16x32_bf16 v[144:147], v[36:39], a[0:3], 0
buffer_load_dwordx4 v6, s[16:19], s61 offen offset:0 lds
v_mfma_f32_16x16x32_bf16 v[148:151], v[36:39], a[4:7], 0
ds_read_b64_tr_b16 v[56:57], v114 offset:8192
ds_read_b64_tr_b16 v[58:59], v114 offset:10240
v_mfma_f32_16x16x32_bf16 v[152:155], v[36:39], a[8:11], 0
buffer_load_dwordx4 v7, s[16:19], s61 offen offset:1024 lds
v_mfma_f32_16x16x32_bf16 v[156:159], v[36:39], a[12:15], 0
ds_read_b64_tr_b16 v[60:61], v115 offset:8192
ds_read_b64_tr_b16 v[62:63], v115 offset:10240
v_mfma_f32_16x16x32_bf16 v[160:163], v[40:43], a[0:3], 0
buffer_load_dwordx4 v8, s[16:19], s61 offen offset:2048 lds
v_mfma_f32_16x16x32_bf16 v[164:167], v[40:43], a[4:7], 0
buffer_load_dwordx4 v9, s[16:19], s61 offen offset:3072 lds
v_mfma_f32_16x16x32_bf16 v[168:171], v[40:43], a[8:11], 0
s_mul_i32 s63, s62, 31
s_cmp_eq_u32 s63, s58
s_cselect_b32 s63, 1, 0
v_mfma_f32_16x16x32_bf16 v[172:175], v[40:43], a[12:15], 0
s_mul_i32 s81, s62, 2036
s_add_u32 s81, s81, 12
v_mfma_f32_16x16x32_bf16 v[176:179], v[44:47], a[0:3], 0
s_cmp_eq_u32 s63, 1
s_cselect_b32 s81, 1024, s81
v_mfma_f32_16x16x32_bf16 v[180:183], v[44:47], a[4:7], 0
v_and_b32 v26, 1, v0
v_lshl_add_u32 v26, v26, 7, s81
v_mfma_f32_16x16x32_bf16 v[184:187], v[44:47], a[8:11], 0
v_and_b32 v27, 3, v0
v_lshlrev_b32 v27, 2, v27
v_mfma_f32_16x16x32_bf16 v[188:191], v[44:47], a[12:15], 0
v_bfe_u32 v30, v0, 2, 1
s_waitcnt lgkmcnt(0)
v_mfma_f32_16x16x32_bf16 v[128:131], v[48:51], a[16:19], v[128:131]
s_waitcnt vmcnt(24)
ds_read_b64_tr_b16 v[32:33], v112 offset:12288
v_mfma_f32_16x16x32_bf16 v[132:135], v[48:51], a[20:23], v[132:135]
ds_read_b64_tr_b16 v[34:35], v112 offset:14336
s_add_u32 m0, s59, 8192
v_mfma_f32_16x16x32_bf16 v[136:139], v[48:51], a[24:27], v[136:139]
s_add_u32 s61, s66, 262272
v_lshl_add_u32 v27, v30, 7, v27
v_mfma_f32_16x16x32_bf16 v[140:143], v[48:51], a[28:31], v[140:143]
ds_read_b64_tr_b16 v[36:37], v113 offset:12288
ds_read_b64_tr_b16 v[38:39], v113 offset:14336
v_mfma_f32_16x16x32_bf16 v[144:147], v[52:55], a[16:19], v[144:147]
buffer_load_dwordx4 v6, s[16:19], s61 offen offset:0 lds
v_mfma_f32_16x16x32_bf16 v[148:151], v[52:55], a[20:23], v[148:151]
ds_read_b64_tr_b16 v[40:41], v114 offset:12288
ds_read_b64_tr_b16 v[42:43], v114 offset:14336
v_mfma_f32_16x16x32_bf16 v[152:155], v[52:55], a[24:27], v[152:155]
buffer_load_dwordx4 v7, s[16:19], s61 offen offset:1024 lds
v_mfma_f32_16x16x32_bf16 v[156:159], v[52:55], a[28:31], v[156:159]
ds_read_b64_tr_b16 v[44:45], v115 offset:12288
ds_read_b64_tr_b16 v[46:47], v115 offset:14336
v_mfma_f32_16x16x32_bf16 v[160:163], v[56:59], a[16:19], v[160:163]
buffer_load_dwordx4 v8, s[16:19], s61 offen offset:2048 lds
v_mfma_f32_16x16x32_bf16 v[164:167], v[56:59], a[20:23], v[164:167]
buffer_load_dwordx4 v9, s[16:19], s61 offen offset:3072 lds
v_mfma_f32_16x16x32_bf16 v[168:171], v[56:59], a[24:27], v[168:171]
v_add_u32 v27, 1024, v27
v_cmp_gt_u32 vcc, 8, v0
v_mfma_f32_16x16x32_bf16 v[172:175], v[56:59], a[28:31], v[172:175]
s_nop 0
v_cndmask_b32 v68, v26, v27, vcc
s_mul_i32 s63, s56, 256
v_mfma_f32_16x16x32_bf16 v[176:179], v[60:63], a[16:19], v[176:179]
v_add_u32 v68, s63, v68
s_lshr_b32 s62, s56, 1
v_mfma_f32_16x16x32_bf16 v[180:183], v[60:63], a[20:23], v[180:183]
s_add_u32 s62, s62, 1
s_sub_u32 s63, 0, s62
v_mfma_f32_16x16x32_bf16 v[184:187], v[60:63], a[24:27], v[184:187]
s_bitcmp1_b32 s56, 0
s_cselect_b32 s62, s62, s63
v_mfma_f32_16x16x32_bf16 v[188:191], v[60:63], a[28:31], v[188:191]
s_lshl_b32 s63, s58, 6
s_add_u32 s81, s63, s62
s_waitcnt lgkmcnt(0)
v_mfma_f32_16x16x32_bf16 v[128:131], v[32:35], a[32:35], v[128:131]
s_waitcnt vmcnt(24)
ds_read_b64_tr_b16 v[48:49], v10 offset:12288
v_mfma_f32_16x16x32_bf16 v[132:135], v[32:35], a[36:39], v[132:135]
ds_read_b64_tr_b16 v[50:51], v10 offset:14336
s_add_u32 m0, s59, 12288
v_mfma_f32_16x16x32_bf16 v[136:139], v[32:35], a[40:43], v[136:139]
s_add_u32 s61, s66, 524416
v_lshrrev_b32 v26, 4, v0
v_mfma_f32_16x16x32_bf16 v[140:143], v[32:35], a[44:47], v[140:143]
ds_read_b64_tr_b16 v[52:53], v11 offset:12288
ds_read_b64_tr_b16 v[54:55], v11 offset:14336
v_mfma_f32_16x16x32_bf16 v[144:147], v[36:39], a[32:35], v[144:147]
buffer_load_dwordx4 v6, s[16:19], s61 offen offset:0 lds
v_mfma_f32_16x16x32_bf16 v[148:151], v[36:39], a[36:39], v[148:151]
ds_read_b64_tr_b16 v[56:57], v12 offset:12288
ds_read_b64_tr_b16 v[58:59], v12 offset:14336
v_mfma_f32_16x16x32_bf16 v[152:155], v[36:39], a[40:43], v[152:155]
buffer_load_dwordx4 v7, s[16:19], s61 offen offset:1024 lds
v_mfma_f32_16x16x32_bf16 v[156:159], v[36:39], a[44:47], v[156:159]
ds_read_b64_tr_b16 v[60:61], v13 offset:12288
ds_read_b64_tr_b16 v[62:63], v13 offset:14336
v_mfma_f32_16x16x32_bf16 v[160:163], v[40:43], a[32:35], v[160:163]
buffer_load_dwordx4 v8, s[16:19], s61 offen offset:2048 lds
v_mfma_f32_16x16x32_bf16 v[164:167], v[40:43], a[36:39], v[164:167]
buffer_load_dwordx4 v9, s[16:19], s61 offen offset:3072 lds
v_mfma_f32_16x16x32_bf16 v[168:171], v[40:43], a[40:43], v[168:171]
v_lshlrev_b32 v26, 15, v26
v_and_b32 v27, 15, v0
v_mfma_f32_16x16x32_bf16 v[172:175], v[40:43], a[44:47], v[172:175]
v_mov_b32 v31, 0x40000000
s_add_u32 s63, s56, 0
v_mfma_f32_16x16x32_bf16 v[176:179], v[44:47], a[32:35], v[176:179]
s_and_b32 s63, s63, 3
s_lshl_b32 s63, s63, 4
v_mfma_f32_16x16x32_bf16 v[180:183], v[44:47], a[36:39], v[180:183]
s_add_u32 s63, s63, s81
v_add_u32 v30, s63, v27
v_mfma_f32_16x16x32_bf16 v[184:187], v[44:47], a[40:43], v[184:187]
v_lshl_add_u32 v64, v30, 4, v26
v_cmp_gt_u32 vcc, 0x800, v30
v_mfma_f32_16x16x32_bf16 v[188:191], v[44:47], a[44:47], v[188:191]
s_nop 0
v_cndmask_b32 v64, v31, v64, vcc
s_add_u32 s63, s56, 1
s_waitcnt lgkmcnt(0)
v_mfma_f32_16x16x32_bf16 v[128:131], v[48:51], a[48:51], v[128:131]
s_waitcnt vmcnt(24)
ds_read_b64_tr_b16 v[32:33], v10 offset:0
v_mfma_f32_16x16x32_bf16 v[132:135], v[48:51], a[52:55], v[132:135]
ds_read_b64_tr_b16 v[34:35], v10 offset:2048
s_add_u32 m0, s60, 12288
v_mfma_f32_16x16x32_bf16 v[136:139], v[48:51], a[56:59], v[136:139]
s_add_u32 s61, s66, 786560
s_and_b32 s63, s63, 3
v_mfma_f32_16x16x32_bf16 v[140:143], v[48:51], a[60:63], v[140:143]
ds_read_b64_tr_b16 v[36:37], v11 offset:0
ds_read_b64_tr_b16 v[38:39], v11 offset:2048
v_mfma_f32_16x16x32_bf16 v[144:147], v[52:55], a[48:51], v[144:147]
buffer_load_dwordx4 v6, s[16:19], s61 offen offset:0 lds
v_mfma_f32_16x16x32_bf16 v[148:151], v[52:55], a[52:55], v[148:151]
ds_read_b64_tr_b16 v[40:41], v12 offset:0
ds_read_b64_tr_b16 v[42:43], v12 offset:2048
v_mfma_f32_16x16x32_bf16 v[152:155], v[52:55], a[56:59], v[152:155]
buffer_load_dwordx4 v7, s[16:19], s61 offen offset:1024 lds
v_mfma_f32_16x16x32_bf16 v[156:159], v[52:55], a[60:63], v[156:159]
ds_read_b64_tr_b16 v[44:45], v13 offset:0
ds_read_b64_tr_b16 v[46:47], v13 offset:2048
v_mfma_f32_16x16x32_bf16 v[160:163], v[56:59], a[48:51], v[160:163]
buffer_load_dwordx4 v8, s[16:19], s61 offen offset:2048 lds
v_mfma_f32_16x16x32_bf16 v[164:167], v[56:59], a[52:55], v[164:167]
buffer_load_dwordx4 v9, s[16:19], s61 offen offset:3072 lds
v_mfma_f32_16x16x32_bf16 v[168:171], v[56:59], a[56:59], v[168:171]
s_lshl_b32 s63, s63, 4
s_add_u32 s63, s63, s81
v_mfma_f32_16x16x32_bf16 v[172:175], v[56:59], a[60:63], v[172:175]
v_add_u32 v30, s63, v27
v_lshl_add_u32 v65, v30, 4, v26
v_mfma_f32_16x16x32_bf16 v[176:179], v[60:63], a[48:51], v[176:179]
v_cmp_gt_u32 vcc, 0x800, v30
s_nop 1
v_cndmask_b32 v65, v31, v65, vcc
v_mfma_f32_16x16x32_bf16 v[180:183], v[60:63], a[52:55], v[180:183]
s_add_u32 s63, s56, 2
s_and_b32 s63, s63, 3
v_mfma_f32_16x16x32_bf16 v[184:187], v[60:63], a[56:59], v[184:187]
s_lshl_b32 s63, s63, 4
s_add_u32 s63, s63, s81
v_mfma_f32_16x16x32_bf16 v[188:191], v[60:63], a[60:63], v[188:191]
v_add_u32 v30, s63, v27
v_lshl_add_u32 v66, v30, 4, v26
s_waitcnt lgkmcnt(0)
v_mfma_f32_16x16x32_bf16 v[128:131], v[32:35], a[64:67], v[128:131]
s_waitcnt vmcnt(24)
ds_read_b64_tr_b16 v[48:49], v10 offset:4096
v_mfma_f32_16x16x32_bf16 v[132:135], v[32:35], a[68:71], v[132:135]
ds_read_b64_tr_b16 v[50:51], v10 offset:6144
s_add_u32 m0, s60, 0
v_mfma_f32_16x16x32_bf16 v[136:139], v[32:35], a[72:75], v[136:139]
s_add_u32 s61, s67, 128
v_cmp_gt_u32 vcc, 0x800, v30
v_mfma_f32_16x16x32_bf16 v[140:143], v[32:35], a[76:79], v[140:143]
ds_read_b64_tr_b16 v[52:53], v11 offset:4096
ds_read_b64_tr_b16 v[54:55], v11 offset:6144
v_mfma_f32_16x16x32_bf16 v[144:147], v[36:39], a[64:67], v[144:147]
buffer_load_dwordx4 v6, s[16:19], s61 offen offset:0 lds
v_mfma_f32_16x16x32_bf16 v[148:151], v[36:39], a[68:71], v[148:151]
ds_read_b64_tr_b16 v[56:57], v12 offset:4096
ds_read_b64_tr_b16 v[58:59], v12 offset:6144
v_mfma_f32_16x16x32_bf16 v[152:155], v[36:39], a[72:75], v[152:155]
buffer_load_dwordx4 v7, s[16:19], s61 offen offset:1024 lds
v_mfma_f32_16x16x32_bf16 v[156:159], v[36:39], a[76:79], v[156:159]
ds_read_b64_tr_b16 v[60:61], v13 offset:4096
ds_read_b64_tr_b16 v[62:63], v13 offset:6144
v_mfma_f32_16x16x32_bf16 v[160:163], v[40:43], a[64:67], v[160:163]
buffer_load_dwordx4 v8, s[16:19], s61 offen offset:2048 lds
v_mfma_f32_16x16x32_bf16 v[164:167], v[40:43], a[68:71], v[164:167]
buffer_load_dwordx4 v9, s[16:19], s61 offen offset:3072 lds
v_mfma_f32_16x16x32_bf16 v[168:171], v[40:43], a[72:75], v[168:171]
v_cndmask_b32 v66, v31, v66, vcc
s_add_u32 s63, s56, 3
v_mfma_f32_16x16x32_bf16 v[172:175], v[40:43], a[76:79], v[172:175]
s_and_b32 s63, s63, 3
s_lshl_b32 s63, s63, 4
v_mfma_f32_16x16x32_bf16 v[176:179], v[44:47], a[64:67], v[176:179]
s_add_u32 s63, s63, s81
v_add_u32 v30, s63, v27
v_mfma_f32_16x16x32_bf16 v[180:183], v[44:47], a[68:71], v[180:183]
v_lshl_add_u32 v67, v30, 4, v26
v_cmp_gt_u32 vcc, 0x800, v30
v_mfma_f32_16x16x32_bf16 v[184:187], v[44:47], a[72:75], v[184:187]
s_nop 0
v_cndmask_b32 v67, v31, v67, vcc
s_add_u32 s63, s90, -1024
v_mfma_f32_16x16x32_bf16 v[188:191], v[44:47], a[76:79], v[188:191]
buffer_load_dword v70, v68, s[44:47], s63 offen sc1
s_waitcnt lgkmcnt(0)
v_mfma_f32_16x16x32_bf16 v[128:131], v[48:51], a[80:83], v[128:131]
s_waitcnt vmcnt(25)
ds_read_b64_tr_b16 v[32:33], v10 offset:8192
v_mfma_f32_16x16x32_bf16 v[132:135], v[48:51], a[84:87], v[132:135]
ds_read_b64_tr_b16 v[34:35], v10 offset:10240
s_add_u32 m0, s60, 4096
v_mfma_f32_16x16x32_bf16 v[136:139], v[48:51], a[88:91], v[136:139]
s_add_u32 s61, s67, 262272
v_mfma_f32_16x16x32_bf16 v[140:143], v[48:51], a[92:95], v[140:143]
ds_read_b64_tr_b16 v[36:37], v11 offset:8192
ds_read_b64_tr_b16 v[38:39], v11 offset:10240
v_mfma_f32_16x16x32_bf16 v[144:147], v[52:55], a[80:83], v[144:147]
buffer_load_dwordx4 v6, s[16:19], s61 offen offset:0 lds
v_mfma_f32_16x16x32_bf16 v[148:151], v[52:55], a[84:87], v[148:151]
v_mfma_f32_16x16x32_bf16 v[152:155], v[52:55], a[88:91], v[152:155]
v_mfma_f32_16x16x32_bf16 v[156:159], v[52:55], a[92:95], v[156:159]
ds_read_b64_tr_b16 v[40:41], v12 offset:8192
ds_read_b64_tr_b16 v[42:43], v12 offset:10240
v_mfma_f32_16x16x32_bf16 v[160:163], v[56:59], a[80:83], v[160:163]
buffer_load_dwordx4 v7, s[16:19], s61 offen offset:1024 lds
v_mfma_f32_16x16x32_bf16 v[164:167], v[56:59], a[84:87], v[164:167]
v_mfma_f32_16x16x32_bf16 v[168:171], v[56:59], a[88:91], v[168:171]
ds_read_b64_tr_b16 v[44:45], v13 offset:8192
v_mfma_f32_16x16x32_bf16 v[172:175], v[56:59], a[92:95], v[172:175]
ds_read_b64_tr_b16 v[46:47], v13 offset:10240
v_mfma_f32_16x16x32_bf16 v[176:179], v[60:63], a[80:83], v[176:179]
buffer_load_dwordx4 v8, s[16:19], s61 offen offset:2048 lds
v_mfma_f32_16x16x32_bf16 v[180:183], v[60:63], a[84:87], v[180:183]
buffer_load_dwordx4 v9, s[16:19], s61 offen offset:3072 lds
v_mfma_f32_16x16x32_bf16 v[184:187], v[60:63], a[88:91], v[184:187]
v_mfma_f32_16x16x32_bf16 v[188:191], v[60:63], a[92:95], v[188:191]
s_waitcnt lgkmcnt(0)
v_mfma_f32_16x16x32_bf16 v[128:131], v[32:35], a[96:99], v[128:131]
s_waitcnt vmcnt(25)
ds_read_b64_tr_b16 v[48:49], v112 offset:0
v_mfma_f32_16x16x32_bf16 v[132:135], v[32:35], a[100:103], v[132:135]
ds_read_b64_tr_b16 v[50:51], v112 offset:2048
s_add_u32 m0, s60, 8192
v_mfma_f32_16x16x32_bf16 v[136:139], v[32:35], a[104:107], v[136:139]
s_add_u32 s61, s67, 524416
v_mfma_f32_16x16x32_bf16 v[140:143], v[32:35], a[108:111], v[140:143]
ds_read_b64_tr_b16 v[52:53], v113 offset:0
ds_read_b64_tr_b16 v[54:55], v113 offset:2048
v_mfma_f32_16x16x32_bf16 v[144:147], v[36:39], a[96:99], v[144:147]
buffer_load_dwordx4 v6, s[16:19], s61 offen offset:0 lds
v_mfma_f32_16x16x32_bf16 v[148:151], v[36:39], a[100:103], v[148:151]
v_mfma_f32_16x16x32_bf16 v[152:155], v[36:39], a[104:107], v[152:155]
v_mfma_f32_16x16x32_bf16 v[156:159], v[36:39], a[108:111], v[156:159]
ds_read_b64_tr_b16 v[56:57], v114 offset:0
ds_read_b64_tr_b16 v[58:59], v114 offset:2048
v_mfma_f32_16x16x32_bf16 v[160:163], v[40:43], a[96:99], v[160:163]
buffer_load_dwordx4 v7, s[16:19], s61 offen offset:1024 lds
v_mfma_f32_16x16x32_bf16 v[164:167], v[40:43], a[100:103], v[164:167]
v_mfma_f32_16x16x32_bf16 v[168:171], v[40:43], a[104:107], v[168:171]
ds_read_b64_tr_b16 v[60:61], v115 offset:0
v_mfma_f32_16x16x32_bf16 v[172:175], v[40:43], a[108:111], v[172:175]
ds_read_b64_tr_b16 v[62:63], v115 offset:2048
v_mfma_f32_16x16x32_bf16 v[176:179], v[44:47], a[96:99], v[176:179]
buffer_load_dwordx4 v8, s[16:19], s61 offen offset:2048 lds
v_mfma_f32_16x16x32_bf16 v[180:183], v[44:47], a[100:103], v[180:183]
buffer_load_dwordx4 v9, s[16:19], s61 offen offset:3072 lds
v_mfma_f32_16x16x32_bf16 v[184:187], v[44:47], a[104:107], v[184:187]
v_mfma_f32_16x16x32_bf16 v[188:191], v[44:47], a[108:111], v[188:191]
s_waitcnt lgkmcnt(0)
v_mfma_f32_16x16x32_bf16 v[128:131], v[48:51], a[112:115], v[128:131]
s_waitcnt vmcnt(25)
ds_read_b64_tr_b16 v[32:33], v112 offset:4096
v_mfma_f32_16x16x32_bf16 v[132:135], v[48:51], a[116:119], v[132:135]
ds_read_b64_tr_b16 v[34:35], v112 offset:6144
s_add_u32 m0, s59, 0
v_mfma_f32_16x16x32_bf16 v[136:139], v[48:51], a[120:123], v[136:139]
s_add_u32 s61, s67, 786560
v_mfma_f32_16x16x32_bf16 v[140:143], v[48:51], a[124:127], v[140:143]
ds_read_b64_tr_b16 v[36:37], v113 offset:4096
ds_read_b64_tr_b16 v[38:39], v113 offset:6144
v_mfma_f32_16x16x32_bf16 v[144:147], v[52:55], a[112:115], v[144:147]
buffer_load_dwordx4 v6, s[16:19], s61 offen offset:0 lds
v_mfma_f32_16x16x32_bf16 v[148:151], v[52:55], a[116:119], v[148:151]
v_mfma_f32_16x16x32_bf16 v[152:155], v[52:55], a[120:123], v[152:155]
v_mfma_f32_16x16x32_bf16 v[156:159], v[52:55], a[124:127], v[156:159]
ds_read_b64_tr_b16 v[40:41], v114 offset:4096
ds_read_b64_tr_b16 v[42:43], v114 offset:6144
v_mfma_f32_16x16x32_bf16 v[160:163], v[56:59], a[112:115], v[160:163]
buffer_load_dwordx4 v7, s[16:19], s61 offen offset:1024 lds
v_mfma_f32_16x16x32_bf16 v[164:167], v[56:59], a[116:119], v[164:167]
v_mfma_f32_16x16x32_bf16 v[168:171], v[56:59], a[120:123], v[168:171]
ds_read_b64_tr_b16 v[44:45], v115 offset:4096
v_mfma_f32_16x16x32_bf16 v[172:175], v[56:59], a[124:127], v[172:175]
ds_read_b64_tr_b16 v[46:47], v115 offset:6144
v_mfma_f32_16x16x32_bf16 v[176:179], v[60:63], a[112:115], v[176:179]
buffer_load_dwordx4 v8, s[16:19], s61 offen offset:2048 lds
v_mfma_f32_16x16x32_bf16 v[180:183], v[60:63], a[116:119], v[180:183]
buffer_load_dwordx4 v9, s[16:19], s61 offen offset:3072 lds
v_mfma_f32_16x16x32_bf16 v[184:187], v[60:63], a[120:123], v[184:187]
v_mfma_f32_16x16x32_bf16 v[188:191], v[60:63], a[124:127], v[188:191]
s_waitcnt lgkmcnt(0)
v_mfma_f32_16x16x32_bf16 v[128:131], v[32:35], a[128:131], v[128:131]
s_waitcnt vmcnt(25)
ds_read_b64_tr_b16 v[48:49], v112 offset:8192
v_mfma_f32_16x16x32_bf16 v[132:135], v[32:35], a[132:135], v[132:135]
ds_read_b64_tr_b16 v[50:51], v112 offset:10240
s_add_u32 m0, s59, 4096
v_mfma_f32_16x16x32_bf16 v[136:139], v[32:35], a[136:139], v[136:139]
s_add_u32 s61, s68, 0
v_mfma_f32_16x16x32_bf16 v[140:143], v[32:35], a[140:143], v[140:143]
ds_read_b64_tr_b16 v[52:53], v113 offset:8192
ds_read_b64_tr_b16 v[54:55], v113 offset:10240
v_mfma_f32_16x16x32_bf16 v[144:147], v[36:39], a[128:131], v[144:147]
buffer_load_dwordx4 v2, s[28:31], s61 offen offset:0 lds
v_mfma_f32_16x16x32_bf16 v[148:151], v[36:39], a[132:135], v[148:151]
v_mfma_f32_16x16x32_bf16 v[152:155], v[36:39], a[136:139], v[152:155]
v_mfma_f32_16x16x32_bf16 v[156:159], v[36:39], a[140:143], v[156:159]
ds_read_b64_tr_b16 v[56:57], v114 offset:8192
ds_read_b64_tr_b16 v[58:59], v114 offset:10240
v_mfma_f32_16x16x32_bf16 v[160:163], v[40:43], a[128:131], v[160:163]
buffer_load_dwordx4 v3, s[28:31], s61 offen offset:1024 lds
v_mfma_f32_16x16x32_bf16 v[164:167], v[40:43], a[132:135], v[164:167]
v_mfma_f32_16x16x32_bf16 v[168:171], v[40:43], a[136:139], v[168:171]
ds_read_b64_tr_b16 v[60:61], v115 offset:8192
v_mfma_f32_16x16x32_bf16 v[172:175], v[40:43], a[140:143], v[172:175]
ds_read_b64_tr_b16 v[62:63], v115 offset:10240
v_mfma_f32_16x16x32_bf16 v[176:179], v[44:47], a[128:131], v[176:179]
buffer_load_dwordx4 v4, s[28:31], s61 offen offset:2048 lds
v_mfma_f32_16x16x32_bf16 v[180:183], v[44:47], a[132:135], v[180:183]
buffer_load_dwordx4 v5, s[28:31], s61 offen offset:3072 lds
v_mfma_f32_16x16x32_bf16 v[184:187], v[44:47], a[136:139], v[184:187]
v_mfma_f32_16x16x32_bf16 v[188:191], v[44:47], a[140:143], v[188:191]
s_waitcnt vmcnt(16)
v_cmp_ne_u32 vcc, v70, v14
s_nop 3
s_cbranch_vccnz L_spin2
L_back1:
s_waitcnt lgkmcnt(0)
v_mfma_f32_16x16x32_bf16 v[128:131], v[48:51], a[144:147], v[128:131]
ds_read_b64_tr_b16 v[32:33], v112 offset:12288
ds_read_b64_tr_b16 v[34:35], v112 offset:14336
s_add_u32 m0, s59, 8192
v_mfma_f32_16x16x32_bf16 v[132:135], v[48:51], a[148:151], v[132:135]
s_add_u32 s61, s68, 32768
s_lshl_b32 s63, s56, 19
s_add_u32 s63, s63, 0
v_mfma_f32_16x16x32_bf16 v[136:139], v[48:51], a[152:155], v[136:139]
buffer_load_dwordx4 a[0:3], v64, s[48:51], s63 offen sc1
s_lshl_b32 s63, s56, 19
v_mfma_f32_16x16x32_bf16 v[140:143], v[48:51], a[156:159], v[140:143]
ds_read_b64_tr_b16 v[36:37], v113 offset:12288
ds_read_b64_tr_b16 v[38:39], v113 offset:14336
s_add_u32 s63, s63, 0
v_mfma_f32_16x16x32_bf16 v[144:147], v[52:55], a[144:147], v[144:147]
buffer_load_dwordx4 a[4:7], v65, s[48:51], s63 offen sc1
s_lshl_b32 s63, s56, 19
v_mfma_f32_16x16x32_bf16 v[148:151], v[52:55], a[148:151], v[148:151]
buffer_load_dwordx4 v2, s[28:31], s61 offen offset:0 lds
v_mfma_f32_16x16x32_bf16 v[152:155], v[52:55], a[152:155], v[152:155]
ds_read_b64_tr_b16 v[40:41], v114 offset:12288
ds_read_b64_tr_b16 v[42:43], v114 offset:14336
s_add_u32 s63, s63, 0
v_mfma_f32_16x16x32_bf16 v[156:159], v[52:55], a[156:159], v[156:159]
buffer_load_dwordx4 a[8:11], v66, s[48:51], s63 offen sc1
v_lshrrev_b32 v28, 5, v0
v_mfma_f32_16x16x32_bf16 v[160:163], v[56:59], a[144:147], v[160:163]
buffer_load_dwordx4 v3, s[28:31], s61 offen offset:1024 lds
v_lshlrev_b32 v28, 4, v28
v_mfma_f32_16x16x32_bf16 v[164:167], v[56:59], a[148:151], v[164:167]
ds_read_b64_tr_b16 v[44:45], v115 offset:12288
ds_read_b64_tr_b16 v[46:47], v115 offset:14336
v_and_b32 v29, 15, v0
v_add_u32 v28, v28, v29
v_mfma_f32_16x16x32_bf16 v[168:171], v[56:59], a[152:155], v[168:171]
buffer_load_dwordx4 v4, s[28:31], s61 offen offset:2048 lds
v_lshlrev_b32 v28, 4, v28
v_mfma_f32_16x16x32_bf16 v[172:175], v[56:59], a[156:159], v[172:175]
buffer_load_dwordx4 v5, s[28:31], s61 offen offset:3072 lds
v_lshrrev_b32 v29, 1, v0
v_mfma_f32_16x16x32_bf16 v[176:179], v[60:63], a[144:147], v[176:179]
v_and_b32 v29, 8, v29
s_lshl_b32 s63, s56, 13
s_add_u32 s63, s63, 131072
v_add3_u32 v28, v28, v29, s63
v_mfma_f32_16x16x32_bf16 v[180:183], v[60:63], a[148:151], v[180:183]
v_add_u32 v29, s63, v1
v_mul_f32 v192, v192, v16
v_mul_f32 v193, v193, v16
v_mul_f32 v194, v194, v16
v_mfma_f32_16x16x32_bf16 v[184:187], v[60:63], a[152:155], v[184:187]
v_mul_f32 v195, v195, v16
v_mul_f32 v208, v208, v16
v_mul_f32 v209, v209, v16
v_mul_f32 v210, v210, v16
v_mfma_f32_16x16x32_bf16 v[188:191], v[60:63], a[156:159], v[188:191]
v_mul_f32 v211, v211, v16
v_cvt_pk_bf16_f32 v192, v192, v193
v_cvt_pk_bf16_f32 v193, v194, v195
s_waitcnt lgkmcnt(0)
v_mfma_f32_16x16x32_bf16 v[128:131], v[32:35], a[160:163], v[128:131]
ds_read_b64_tr_b16 v[48:49], v10 offset:12288
ds_read_b64_tr_b16 v[50:51], v10 offset:14336
s_add_u32 m0, s59, 12288
v_mfma_f32_16x16x32_bf16 v[132:135], v[32:35], a[164:167], v[132:135]
s_add_u32 s61, s68, 65536
s_lshl_b32 s63, s56, 19
s_add_u32 s63, s63, 0
v_mfma_f32_16x16x32_bf16 v[136:139], v[32:35], a[168:171], v[136:139]
buffer_load_dwordx4 a[12:15], v67, s[48:51], s63 offen sc1
ds_read_b64_tr_b16 v[52:53], v11 offset:12288
v_mfma_f32_16x16x32_bf16 v[140:143], v[32:35], a[172:175], v[140:143]
ds_read_b64_tr_b16 v[54:55], v11 offset:14336
s_lshl_b32 s63, s56, 19
s_add_u32 s63, s63, 131072
v_mfma_f32_16x16x32_bf16 v[144:147], v[36:39], a[160:163], v[144:147]
buffer_load_dwordx4 a[16:19], v64, s[48:51], s63 offen sc1
v_cvt_pk_bf16_f32 v194, v208, v209
v_mfma_f32_16x16x32_bf16 v[148:151], v[36:39], a[164:167], v[148:151]
buffer_load_dwordx4 v2, s[28:31], s61 offen offset:0 lds
v_mfma_f32_16x16x32_bf16 v[152:155], v[36:39], a[168:171], v[152:155]
ds_read_b64_tr_b16 v[56:57], v12 offset:12288
ds_read_b64_tr_b16 v[58:59], v12 offset:14336
v_cvt_pk_bf16_f32 v195, v210, v211
v_mfma_f32_16x16x32_bf16 v[156:159], v[36:39], a[172:175], v[156:159]
ds_write_b64 v28, v[192:193] offset:0
v_mfma_f32_16x16x32_bf16 v[160:163], v[40:43], a[160:163], v[160:163]
ds_write_b64 v28, v[194:195] offset:512
v_mul_f32 v196, v196, v17
v_mfma_f32_16x16x32_bf16 v[164:167], v[40:43], a[164:167], v[164:167]
buffer_load_dwordx4 v3, s[28:31], s61 offen offset:1024 lds
ds_read_b64_tr_b16 v[60:61], v13 offset:12288
v_mfma_f32_16x16x32_bf16 v[168:171], v[40:43], a[168:171], v[168:171]
ds_read_b64_tr_b16 v[62:63], v13 offset:14336
buffer_load_dwordx4 v4, s[28:31], s61 offen offset:2048 lds
v_mfma_f32_16x16x32_bf16 v[172:175], v[40:43], a[172:175], v[172:175]
buffer_load_dwordx4 v5, s[28:31], s61 offen offset:3072 lds
v_mul_f32 v197, v197, v17
v_mul_f32 v198, v198, v17
v_mfma_f32_16x16x32_bf16 v[176:179], v[44:47], a[160:163], v[176:179]
v_mul_f32 v199, v199, v17
v_mul_f32 v212, v212, v17
v_mul_f32 v213, v213, v17
v_mul_f32 v214, v214, v17
v_mfma_f32_16x16x32_bf16 v[180:183], v[44:47], a[164:167], v[180:183]
v_mul_f32 v215, v215, v17
v_cvt_pk_bf16_f32 v196, v196, v197
v_cvt_pk_bf16_f32 v197, v198, v199
v_cvt_pk_bf16_f32 v198, v212, v213
v_mfma_f32_16x16x32_bf16 v[184:187], v[44:47], a[168:171], v[184:187]
v_cvt_pk_bf16_f32 v199, v214, v215
v_mfma_f32_16x16x32_bf16 v[188:191], v[44:47], a[172:175], v[188:191]
ds_write_b64 v28, v[196:197] offset:1024
ds_write_b64 v28, v[198:199] offset:1536
v_mul_f32 v200, v200, v18
v_mul_f32 v201, v201, v18
s_waitcnt lgkmcnt(2)
v_mfma_f32_16x16x32_bf16 v[128:131], v[48:51], a[176:179], v[128:131]
ds_read_b64_tr_b16 v[32:33], v10 offset:0
ds_read_b64_tr_b16 v[34:35], v10 offset:2048
s_add_u32 m0, s60, 12288
v_mfma_f32_16x16x32_bf16 v[132:135], v[48:51], a[180:183], v[132:135]
s_add_u32 s61, s68, 98304
s_lshl_b32 s63, s56, 19
s_add_u32 s63, s63, 131072
v_mfma_f32_16x16x32_bf16 v[136:139], v[48:51], a[184:187], v[136:139]
buffer_load_dwordx4 a[20:23], v65, s[48:51], s63 offen sc1
s_lshl_b32 s63, s56, 19
v_mfma_f32_16x16x32_bf16 v[140:143], v[48:51], a[188:191], v[140:143]
ds_read_b64_tr_b16 v[36:37], v11 offset:0
ds_read_b64_tr_b16 v[38:39], v11 offset:2048
s_add_u32 s63, s63, 131072
v_mfma_f32_16x16x32_bf16 v[144:147], v[52:55], a[176:179], v[144:147]
buffer_load_dwordx4 a[24:27], v66, s[48:51], s63 offen sc1
v_mul_f32 v202, v202, v18
v_mfma_f32_16x16x32_bf16 v[148:151], v[52:55], a[180:183], v[148:151]
buffer_load_dwordx4 v2, s[28:31], s61 offen offset:0 lds
v_mfma_f32_16x16x32_bf16 v[152:155], v[52:55], a[184:187], v[152:155]
ds_read_b64_tr_b16 v[40:41], v12 offset:0
ds_read_b64_tr_b16 v[42:43], v12 offset:2048
v_mul_f32 v203, v203, v18
v_mul_f32 v216, v216, v18
v_mfma_f32_16x16x32_bf16 v[156:159], v[52:55], a[188:191], v[156:159]
buffer_load_dwordx4 v3, s[28:31], s61 offen offset:1024 lds
v_mul_f32 v217, v217, v18
v_mfma_f32_16x16x32_bf16 v[160:163], v[56:59], a[176:179], v[160:163]
ds_read_b64_tr_b16 v[44:45], v13 offset:0
ds_read_b64_tr_b16 v[46:47], v13 offset:2048
v_mul_f32 v218, v218, v18
v_mul_f32 v219, v219, v18
v_mfma_f32_16x16x32_bf16 v[164:167], v[56:59], a[180:183], v[164:167]
buffer_load_dwordx4 v4, s[28:31], s61 offen offset:2048 lds
v_cvt_pk_bf16_f32 v200, v200, v201
v_mfma_f32_16x16x32_bf16 v[168:171], v[56:59], a[184:187], v[168:171]
buffer_load_dwordx4 v5, s[28:31], s61 offen offset:3072 lds
v_cvt_pk_bf16_f32 v201, v202, v203
v_mfma_f32_16x16x32_bf16 v[172:175], v[56:59], a[188:191], v[172:175]
v_cvt_pk_bf16_f32 v202, v216, v217
v_cvt_pk_bf16_f32 v203, v218, v219
v_mfma_f32_16x16x32_bf16 v[176:179], v[60:63], a[176:179], v[176:179]
ds_write_b64 v28, v[200:201] offset:2048
v_mfma_f32_16x16x32_bf16 v[180:183], v[60:63], a[180:183], v[180:183]
ds_write_b64 v28, v[202:203] offset:2560
v_mul_f32 v204, v204, v19
v_mfma_f32_16x16x32_bf16 v[184:187], v[60:63], a[184:187], v[184:187]
v_mul_f32 v205, v205, v19
v_mul_f32 v206, v206, v19
v_mul_f32 v207, v207, v19
v_mul_f32 v220, v220, v19
v_mfma_f32_16x16x32_bf16 v[188:191], v[60:63], a[188:191], v[188:191]
v_mul_f32 v221, v221, v19
v_mul_f32 v222, v222, v19
v_mul_f32 v223, v223, v19
v_cvt_pk_bf16_f32 v204, v204, v205
s_waitcnt lgkmcnt(2)
v_mfma_f32_16x16x32_bf16 v[128:131], v[32:35], a[192:195], v[128:131]
s_waitcnt vmcnt(31)
ds_read_b64_tr_b16 v[48:49], v10 offset:4096
ds_read_b64_tr_b16 v[50:51], v10 offset:6144
v_mfma_f32_16x16x32_bf16 v[132:135], v[32:35], a[196:199], v[132:135]
ds_read_b64_tr_b16 v[52:53], v11 offset:4096
ds_read_b64_tr_b16 v[54:55], v11 offset:6144
ds_read_b64_tr_b16 v[56:57], v12 offset:4096
v_mfma_f32_16x16x32_bf16 v[136:139], v[32:35], a[200:203], v[136:139]
ds_read_b64_tr_b16 v[58:59], v12 offset:6144
ds_read_b64_tr_b16 v[60:61], v13 offset:4096
ds_read_b64_tr_b16 v[62:63], v13 offset:6144
v_mfma_f32_16x16x32_bf16 v[140:143], v[32:35], a[204:207], v[140:143]
s_lshl_b32 s63, s56, 19
s_add_u32 s63, s63, 131072
v_mfma_f32_16x16x32_bf16 v[144:147], v[36:39], a[192:195], v[144:147]
buffer_load_dwordx4 a[28:31], v67, s[48:51], s63 offen sc1
s_lshl_b32 s63, s56, 19
v_mfma_f32_16x16x32_bf16 v[148:151], v[36:39], a[196:199], v[148:151]
s_add_u32 s63, s63, 262144
v_mfma_f32_16x16x32_bf16 v[152:155], v[36:39], a[200:203], v[152:155]
buffer_load_dwordx4 a[32:35], v64, s[48:51], s63 offen sc1
s_lshl_b32 s63, s56, 19
v_mfma_f32_16x16x32_bf16 v[156:159], v[36:39], a[204:207], v[156:159]
s_add_u32 s63, s63, 262144
v_mfma_f32_16x16x32_bf16 v[160:163], v[40:43], a[192:195], v[160:163]
buffer_load_dwordx4 a[36:39], v65, s[48:51], s63 offen sc1
v_cvt_pk_bf16_f32 v205, v206, v207
v_mfma_f32_16x16x32_bf16 v[164:167], v[40:43], a[196:199], v[164:167]
v_cvt_pk_bf16_f32 v206, v220, v221
v_cvt_pk_bf16_f32 v207, v222, v223
v_mfma_f32_16x16x32_bf16 v[168:171], v[40:43], a[200:203], v[168:171]
ds_write_b64 v28, v[204:205] offset:3072
v_mfma_f32_16x16x32_bf16 v[172:175], v[40:43], a[204:207], v[172:175]
ds_write_b64 v28, v[206:207] offset:3584
v_mul_f32 v224, v224, v16
v_mfma_f32_16x16x32_bf16 v[176:179], v[44:47], a[192:195], v[176:179]
v_mul_f32 v225, v225, v16
v_mul_f32 v226, v226, v16
v_mul_f32 v227, v227, v16
v_mul_f32 v240, v240, v16
v_mul_f32 v241, v241, v16
v_mfma_f32_16x16x32_bf16 v[180:183], v[44:47], a[196:199], v[180:183]
v_mul_f32 v242, v242, v16
v_mul_f32 v243, v243, v16
v_cvt_pk_bf16_f32 v224, v224, v225
v_cvt_pk_bf16_f32 v225, v226, v227
v_mfma_f32_16x16x32_bf16 v[184:187], v[44:47], a[200:203], v[184:187]
v_cvt_pk_bf16_f32 v226, v240, v241
v_cvt_pk_bf16_f32 v227, v242, v243
v_mfma_f32_16x16x32_bf16 v[188:191], v[44:47], a[204:207], v[188:191]
ds_write_b64 v28, v[224:225] offset:4096
ds_write_b64 v28, v[226:227] offset:4608
v_mul_f32 v228, v228, v17
s_waitcnt lgkmcnt(4)
v_mfma_f32_16x16x32_bf16 v[128:131], v[48:51], a[208:211], v[128:131]
s_waitcnt vmcnt(30)
ds_read_b64_tr_b16 v[32:33], v10 offset:8192
s_lshl_b32 s63, s56, 19
v_mfma_f32_16x16x32_bf16 v[132:135], v[48:51], a[212:215], v[132:135]
ds_read_b64_tr_b16 v[34:35], v10 offset:10240
ds_read_b64_tr_b16 v[36:37], v11 offset:8192
s_add_u32 s63, s63, 262144
v_mfma_f32_16x16x32_bf16 v[136:139], v[48:51], a[216:219], v[136:139]
buffer_load_dwordx4 a[40:43], v66, s[48:51], s63 offen sc1
v_mfma_f32_16x16x32_bf16 v[140:143], v[48:51], a[220:223], v[140:143]
ds_read_b64_tr_b16 v[38:39], v11 offset:10240
ds_read_b64_tr_b16 v[40:41], v12 offset:8192
s_lshl_b32 s63, s56, 19
v_mfma_f32_16x16x32_bf16 v[144:147], v[52:55], a[208:211], v[144:147]
ds_read_b64_tr_b16 v[42:43], v12 offset:10240
ds_read_b64_tr_b16 v[44:45], v13 offset:8192
s_add_u32 s63, s63, 262144
v_mfma_f32_16x16x32_bf16 v[148:151], v[52:55], a[212:215], v[148:151]
buffer_load_dwordx4 a[44:47], v67, s[48:51], s63 offen sc1
v_mfma_f32_16x16x32_bf16 v[152:155], v[52:55], a[216:219], v[152:155]
ds_read_b64_tr_b16 v[46:47], v13 offset:10240
v_mul_f32 v229, v229, v17
v_mul_f32 v230, v230, v17
v_mfma_f32_16x16x32_bf16 v[156:159], v[52:55], a[220:223], v[156:159]
v_mul_f32 v231, v231, v17
v_mul_f32 v244, v244, v17
v_mul_f32 v245, v245, v17
v_mfma_f32_16x16x32_bf16 v[160:163], v[56:59], a[208:211], v[160:163]
v_mul_f32 v246, v246, v17
v_mul_f32 v247, v247, v17
v_cvt_pk_bf16_f32 v228, v228, v229
v_mfma_f32_16x16x32_bf16 v[164:167], v[56:59], a[212:215], v[164:167]
v_cvt_pk_bf16_f32 v229, v230, v231
v_cvt_pk_bf16_f32 v230, v244, v245
v_mfma_f32_16x16x32_bf16 v[168:171], v[56:59], a[216:219], v[168:171]
v_cvt_pk_bf16_f32 v231, v246, v247
v_mfma_f32_16x16x32_bf16 v[172:175], v[56:59], a[220:223], v[172:175]
ds_write_b64 v28, v[228:229] offset:5120
v_mfma_f32_16x16x32_bf16 v[176:179], v[60:63], a[208:211], v[176:179]
ds_write_b64 v28, v[230:231] offset:5632
v_mfma_f32_16x16x32_bf16 v[180:183], v[60:63], a[212:215], v[180:183]
v_mul_f32 v232, v232, v18
v_mul_f32 v233, v233, v18
v_mul_f32 v234, v234, v18
v_mfma_f32_16x16x32_bf16 v[184:187], v[60:63], a[216:219], v[184:187]
v_mul_f32 v235, v235, v18
v_mul_f32 v248, v248, v18
v_mul_f32 v249, v249, v18
v_mfma_f32_16x16x32_bf16 v[188:191], v[60:63], a[220:223], v[188:191]
v_mul_f32 v250, v250, v18
v_mul_f32 v251, v251, v18
s_waitcnt lgkmcnt(2)
v_mfma_f32_16x16x32_bf16 v[128:131], v[32:35], a[224:227], v[128:131]
s_waitcnt vmcnt(28)
ds_read_b64_tr_b16 v[48:49], v112 offset:0
s_lshl_b32 s63, s56, 19
v_mfma_f32_16x16x32_bf16 v[132:135], v[32:35], a[228:231], v[132:135]
ds_read_b64_tr_b16 v[50:51], v112 offset:2048
ds_read_b64_tr_b16 v[52:53], v113 offset:0
s_add_u32 s63, s63, 393216
v_mfma_f32_16x16x32_bf16 v[136:139], v[32:35], a[232:235], v[136:139]
buffer_load_dwordx4 a[48:51], v64, s[48:51], s63 offen sc1
v_mfma_f32_16x16x32_bf16 v[140:143], v[32:35], a[236:239], v[140:143]
ds_read_b64_tr_b16 v[54:55], v113 offset:2048
ds_read_b64_tr_b16 v[56:57], v114 offset:0
s_lshl_b32 s63, s56, 19
v_mfma_f32_16x16x32_bf16 v[144:147], v[36:39], a[224:227], v[144:147]
ds_read_b64_tr_b16 v[58:59], v114 offset:2048
ds_read_b64_tr_b16 v[60:61], v115 offset:0
s_add_u32 s63, s63, 393216
v_mfma_f32_16x16x32_bf16 v[148:151], v[36:39], a[228:231], v[148:151]
buffer_load_dwordx4 a[52:55], v65, s[48:51], s63 offen sc1
v_mfma_f32_16x16x32_bf16 v[152:155], v[36:39], a[232:235], v[152:155]
ds_read_b64_tr_b16 v[62:63], v115 offset:2048
v_cvt_pk_bf16_f32 v232, v232, v233
v_cvt_pk_bf16_f32 v233, v234, v235
v_mfma_f32_16x16x32_bf16 v[156:159], v[36:39], a[236:239], v[156:159]
v_cvt_pk_bf16_f32 v234, v248, v249
v_cvt_pk_bf16_f32 v235, v250, v251
v_mfma_f32_16x16x32_bf16 v[160:163], v[40:43], a[224:227], v[160:163]
ds_write_b64 v28, v[232:233] offset:6144
v_mfma_f32_16x16x32_bf16 v[164:167], v[40:43], a[228:231], v[164:167]
ds_write_b64 v28, v[234:235] offset:6656
v_mfma_f32_16x16x32_bf16 v[168:171], v[40:43], a[232:235], v[168:171]
v_mul_f32 v236, v236, v19
v_mul_f32 v237, v237, v19
v_mul_f32 v238, v238, v19
v_mfma_f32_16x16x32_bf16 v[172:175], v[40:43], a[236:239], v[172:175]
v_mul_f32 v239, v239, v19
v_mul_f32 v252, v252, v19
v_mul_f32 v253, v253, v19
v_mfma_f32_16x16x32_bf16 v[176:179], v[44:47], a[224:227], v[176:179]
v_mul_f32 v254, v254, v19
v_mul_f32 v255, v255, v19
v_cvt_pk_bf16_f32 v236, v236, v237
v_mfma_f32_16x16x32_bf16 v[180:183], v[44:47], a[228:231], v[180:183]
v_cvt_pk_bf16_f32 v237, v238, v239
v_cvt_pk_bf16_f32 v238, v252, v253
v_cvt_pk_bf16_f32 v239, v254, v255
v_mfma_f32_16x16x32_bf16 v[184:187], v[44:47], a[232:235], v[184:187]
ds_write_b64 v28, v[236:237] offset:7168
v_mfma_f32_16x16x32_bf16 v[188:191], v[44:47], a[236:239], v[188:191]
ds_write_b64 v28, v[238:239] offset:7680
s_waitcnt lgkmcnt(4)
v_mfma_f32_16x16x32_bf16 v[128:131], v[48:51], a[240:243], v[128:131]
s_waitcnt vmcnt(26)
ds_read_b64_tr_b16 v[32:33], v112 offset:4096
v_mfma_f32_16x16x32_bf16 v[132:135], v[48:51], a[244:247], v[132:135]
s_lshl_b32 s63, s56, 19
s_add_u32 s63, s63, 393216
v_mfma_f32_16x16x32_bf16 v[136:139], v[48:51], a[248:251], v[136:139]
buffer_load_dwordx4 a[56:59], v66, s[48:51], s63 offen sc1
v_mfma_f32_16x16x32_bf16 v[140:143], v[48:51], a[252:255], v[140:143]
ds_read_b64_tr_b16 v[34:35], v112 offset:6144
s_lshl_b32 s63, s56, 19
v_mfma_f32_16x16x32_bf16 v[144:147], v[52:55], a[240:243], v[144:147]
ds_read_b64_tr_b16 v[36:37], v113 offset:4096
s_add_u32 s63, s63, 393216
v_mfma_f32_16x16x32_bf16 v[148:151], v[52:55], a[244:247], v[148:151]
buffer_load_dwordx4 a[60:63], v67, s[48:51], s63 offen sc1
v_mfma_f32_16x16x32_bf16 v[152:155], v[52:55], a[248:251], v[152:155]
ds_read_b64_tr_b16 v[38:39], v113 offset:6144
v_mfma_f32_16x16x32_bf16 v[156:159], v[52:55], a[252:255], v[156:159]
v_mfma_f32_16x16x32_bf16 v[160:163], v[56:59], a[240:243], v[160:163]
ds_read_b128 a[64:67], v29 offset:0
ds_read_b64_tr_b16 v[40:41], v114 offset:4096
v_mfma_f32_16x16x32_bf16 v[164:167], v[56:59], a[244:247], v[164:167]
ds_read_b128 a[68:71], v29 offset:1024
ds_read_b64_tr_b16 v[42:43], v114 offset:6144
v_mfma_f32_16x16x32_bf16 v[168:171], v[56:59], a[248:251], v[168:171]
ds_read_b128 a[72:75], v29 offset:2048
v_mfma_f32_16x16x32_bf16 v[172:175], v[56:59], a[252:255], v[172:175]
ds_read_b128 a[76:79], v29 offset:3072
ds_read_b64_tr_b16 v[44:45], v115 offset:4096
v_mfma_f32_16x16x32_bf16 v[176:179], v[60:63], a[240:243], v[176:179]
ds_read_b128 a[80:83], v29 offset:4096
ds_read_b128 a[84:87], v29 offset:5120
v_mfma_f32_16x16x32_bf16 v[180:183], v[60:63], a[244:247], v[180:183]
ds_read_b64_tr_b16 v[46:47], v115 offset:6144
ds_read_b128 a[88:91], v29 offset:6144
v_mfma_f32_16x16x32_bf16 v[184:187], v[60:63], a[248:251], v[184:187]
ds_read_b128 a[92:95], v29 offset:7168
v_mfma_f32_16x16x32_bf16 v[188:191], v[60:63], a[252:255], v[188:191]
s_waitcnt vmcnt(27) lgkmcnt(2)
v_mfma_f32_16x16x32_bf16 v[192:195], v[32:35], a[0:3], 0
s_waitcnt vmcnt(21)
ds_read_b64_tr_b16 v[48:49], v112 offset:8192
v_lshrrev_b32 v28, 5, v0
v_mfma_f32_16x16x32_bf16 v[196:199], v[32:35], a[4:7], 0
ds_read_b64_tr_b16 v[50:51], v112 offset:10240
ds_read_b64_tr_b16 v[52:53], v113 offset:8192
v_lshlrev_b32 v28, 4, v28
v_mfma_f32_16x16x32_bf16 v[200:203], v[32:35], a[8:11], 0
ds_read_b64_tr_b16 v[54:55], v113 offset:10240
ds_read_b64_tr_b16 v[56:57], v114 offset:8192
v_and_b32 v29, 15, v0
s_waitcnt vmcnt(20)
v_mfma_f32_16x16x32_bf16 v[204:207], v[32:35], a[12:15], 0
ds_read_b64_tr_b16 v[58:59], v114 offset:10240
ds_read_b64_tr_b16 v[60:61], v115 offset:8192
v_add_u32 v28, v28, v29
v_mfma_f32_16x16x32_bf16 v[208:211], v[36:39], a[0:3], 0
ds_read_b64_tr_b16 v[62:63], v115 offset:10240
v_lshlrev_b32 v28, 4, v28
v_lshrrev_b32 v29, 1, v0
v_mfma_f32_16x16x32_bf16 v[212:215], v[36:39], a[4:7], 0
v_and_b32 v29, 8, v29
s_lshl_b32 s63, s56, 13
s_add_u32 s63, s63, 131072
v_mfma_f32_16x16x32_bf16 v[216:219], v[36:39], a[8:11], 0
v_add3_u32 v28, v28, v29, s63
v_add_u32 v29, s63, v1
v_mul_f32 v128, v128, v16
v_mfma_f32_16x16x32_bf16 v[220:223], v[36:39], a[12:15], 0
v_mul_f32 v129, v129, v16
v_mul_f32 v130, v130, v16
v_mul_f32 v131, v131, v16
v_mfma_f32_16x16x32_bf16 v[224:227], v[40:43], a[0:3], 0
v_mul_f32 v144, v144, v16
v_mul_f32 v145, v145, v16
v_mul_f32 v146, v146, v16
v_mfma_f32_16x16x32_bf16 v[228:231], v[40:43], a[4:7], 0
v_mul_f32 v147, v147, v16
v_cvt_pk_bf16_f32 v128, v128, v129
v_mfma_f32_16x16x32_bf16 v[232:235], v[40:43], a[8:11], 0
v_cvt_pk_bf16_f32 v129, v130, v131
v_cvt_pk_bf16_f32 v130, v144, v145
v_cvt_pk_bf16_f32 v131, v146, v147
v_mfma_f32_16x16x32_bf16 v[236:239], v[40:43], a[12:15], 0
ds_write_b64 v28, v[128:129] offset:0
v_mfma_f32_16x16x32_bf16 v[240:243], v[44:47], a[0:3], 0
ds_write_b64 v28, v[130:131] offset:512
v_mfma_f32_16x16x32_bf16 v[244:247], v[44:47], a[4:7], 0
v_mul_f32 v132, v132, v17
v_mul_f32 v133, v133, v17
v_mfma_f32_16x16x32_bf16 v[248:251], v[44:47], a[8:11], 0
v_mul_f32 v134, v134, v17
v_mul_f32 v135, v135, v17
v_mfma_f32_16x16x32_bf16 v[252:255], v[44:47], a[12:15], 0
v_mul_f32 v148, v148, v17
v_mul_f32 v149, v149, v17
s_waitcnt vmcnt(19) lgkmcnt(2)
v_mfma_f32_16x16x32_bf16 v[192:195], v[48:51], a[16:19], v[192:195]
s_waitcnt vmcnt(15)
ds_read_b64_tr_b16 v[32:33], v112 offset:12288
ds_read_b64_tr_b16 v[34:35], v112 offset:14336
s_waitcnt vmcnt(14)
v_mfma_f32_16x16x32_bf16 v[196:199], v[48:51], a[20:23], v[196:199]
ds_read_b64_tr_b16 v[36:37], v113 offset:12288
ds_read_b64_tr_b16 v[38:39], v113 offset:14336
ds_read_b64_tr_b16 v[40:41], v114 offset:12288
s_waitcnt vmcnt(13)
v_mfma_f32_16x16x32_bf16 v[200:203], v[48:51], a[24:27], v[200:203]
ds_read_b64_tr_b16 v[42:43], v114 offset:14336
ds_read_b64_tr_b16 v[44:45], v115 offset:12288
ds_read_b64_tr_b16 v[46:47], v115 offset:14336
s_waitcnt vmcnt(8)
v_mfma_f32_16x16x32_bf16 v[204:207], v[48:51], a[28:31], v[204:207]
v_mul_f32 v150, v150, v17
v_mul_f32 v151, v151, v17
v_cvt_pk_bf16_f32 v132, v132, v133
v_mfma_f32_16x16x32_bf16 v[208:211], v[52:55], a[16:19], v[208:211]
v_cvt_pk_bf16_f32 v133, v134, v135
v_cvt_pk_bf16_f32 v134, v148, v149
v_cvt_pk_bf16_f32 v135, v150, v151
v_mfma_f32_16x16x32_bf16 v[212:215], v[52:55], a[20:23], v[212:215]
ds_write_b64 v28, v[132:133] offset:1024
v_mfma_f32_16x16x32_bf16 v[216:219], v[52:55], a[24:27], v[216:219]
ds_write_b64 v28, v[134:135] offset:1536
v_mfma_f32_16x16x32_bf16 v[220:223], v[52:55], a[28:31], v[220:223]
v_mul_f32 v136, v136, v18
v_mul_f32 v137, v137, v18
v_mul_f32 v138, v138, v18
v_mfma_f32_16x16x32_bf16 v[224:227], v[56:59], a[16:19], v[224:227]
v_mul_f32 v139, v139, v18
v_mul_f32 v152, v152, v18
v_mul_f32 v153, v153, v18
v_mfma_f32_16x16x32_bf16 v[228:231], v[56:59], a[20:23], v[228:231]
v_mul_f32 v154, v154, v18
v_mul_f32 v155, v155, v18
v_cvt_pk_bf16_f32 v136, v136, v137
v_mfma_f32_16x16x32_bf16 v[232:235], v[56:59], a[24:27], v[232:235]
v_cvt_pk_bf16_f32 v137, v138, v139
v_cvt_pk_bf16_f32 v138, v152, v153
v_cvt_pk_bf16_f32 v139, v154, v155
v_mfma_f32_16x16x32_bf16 v[236:239], v[56:59], a[28:31], v[236:239]
ds_write_b64 v28, v[136:137] offset:2048
v_mfma_f32_16x16x32_bf16 v[240:243], v[60:63], a[16:19], v[240:243]
ds_write_b64 v28, v[138:139] offset:2560
v_mfma_f32_16x16x32_bf16 v[244:247], v[60:63], a[20:23], v[244:247]
v_mul_f32 v140, v140, v19
v_mul_f32 v141, v141, v19
v_mul_f32 v142, v142, v19
v_mfma_f32_16x16x32_bf16 v[248:251], v[60:63], a[24:27], v[248:251]
v_mul_f32 v143, v143, v19
v_mul_f32 v156, v156, v19
v_mul_f32 v157, v157, v19
v_mfma_f32_16x16x32_bf16 v[252:255], v[60:63], a[28:31], v[252:255]
v_mul_f32 v158, v158, v19
v_mul_f32 v159, v159, v19
v_cvt_pk_bf16_f32 v140, v140, v141
s_waitcnt vmcnt(7) lgkmcnt(4)
v_mfma_f32_16x16x32_bf16 v[192:195], v[32:35], a[32:35], v[192:195]
ds_read_b64_tr_b16 v[48:49], v10 offset:12288
ds_read_b64_tr_b16 v[50:51], v10 offset:14336
s_waitcnt vmcnt(6)
v_mfma_f32_16x16x32_bf16 v[196:199], v[32:35], a[36:39], v[196:199]
ds_read_b64_tr_b16 v[52:53], v11 offset:12288
ds_read_b64_tr_b16 v[54:55], v11 offset:14336
ds_read_b64_tr_b16 v[56:57], v12 offset:12288
s_waitcnt vmcnt(5)
v_mfma_f32_16x16x32_bf16 v[200:203], v[32:35], a[40:43], v[200:203]
ds_read_b64_tr_b16 v[58:59], v12 offset:14336
ds_read_b64_tr_b16 v[60:61], v13 offset:12288
ds_read_b64_tr_b16 v[62:63], v13 offset:14336
s_waitcnt vmcnt(4)
v_mfma_f32_16x16x32_bf16 v[204:207], v[32:35], a[44:47], v[204:207]
v_cvt_pk_bf16_f32 v141, v142, v143
v_cvt_pk_bf16_f32 v142, v156, v157
v_cvt_pk_bf16_f32 v143, v158, v159
v_mfma_f32_16x16x32_bf16 v[208:211], v[36:39], a[32:35], v[208:211]
ds_write_b64 v28, v[140:141] offset:3072
v_mfma_f32_16x16x32_bf16 v[212:215], v[36:39], a[36:39], v[212:215]
ds_write_b64 v28, v[142:143] offset:3584
v_mfma_f32_16x16x32_bf16 v[216:219], v[36:39], a[40:43], v[216:219]
v_mul_f32 v160, v160, v16
v_mul_f32 v161, v161, v16
v_mul_f32 v162, v162, v16
v_mfma_f32_16x16x32_bf16 v[220:223], v[36:39], a[44:47], v[220:223]
v_mul_f32 v163, v163, v16
v_mul_f32 v176, v176, v16
v_mul_f32 v177, v177, v16
v_mfma_f32_16x16x32_bf16 v[224:227], v[40:43], a[32:35], v[224:227]
v_mul_f32 v178, v178, v16
v_mul_f32 v179, v179, v16
v_cvt_pk_bf16_f32 v160, v160, v161
v_mfma_f32_16x16x32_bf16 v[228:231], v[40:43], a[36:39], v[228:231]
v_cvt_pk_bf16_f32 v161, v162, v163
v_cvt_pk_bf16_f32 v162, v176, v177
v_cvt_pk_bf16_f32 v163, v178, v179
v_mfma_f32_16x16x32_bf16 v[232:235], v[40:43], a[40:43], v[232:235]
ds_write_b64 v28, v[160:161] offset:4096
v_mfma_f32_16x16x32_bf16 v[236:239], v[40:43], a[44:47], v[236:239]
ds_write_b64 v28, v[162:163] offset:4608
v_mfma_f32_16x16x32_bf16 v[240:243], v[44:47], a[32:35], v[240:243]
v_mul_f32 v164, v164, v17
v_mul_f32 v165, v165, v17
v_mul_f32 v166, v166, v17
v_mfma_f32_16x16x32_bf16 v[244:247], v[44:47], a[36:39], v[244:247]
v_mul_f32 v167, v167, v17
v_mul_f32 v180, v180, v17
v_mul_f32 v181, v181, v17
v_mfma_f32_16x16x32_bf16 v[248:251], v[44:47], a[40:43], v[248:251]
v_mul_f32 v182, v182, v17
v_mul_f32 v183, v183, v17
v_cvt_pk_bf16_f32 v164, v164, v165
v_mfma_f32_16x16x32_bf16 v[252:255], v[44:47], a[44:47], v[252:255]
v_cvt_pk_bf16_f32 v165, v166, v167
v_cvt_pk_bf16_f32 v166, v180, v181
v_cvt_pk_bf16_f32 v167, v182, v183
s_waitcnt vmcnt(3) lgkmcnt(4)
v_mfma_f32_16x16x32_bf16 v[192:195], v[48:51], a[48:51], v[192:195]
ds_write_b64 v28, v[164:165] offset:5120
s_waitcnt vmcnt(2)
v_mfma_f32_16x16x32_bf16 v[196:199], v[48:51], a[52:55], v[196:199]
ds_write_b64 v28, v[166:167] offset:5632
s_waitcnt vmcnt(1)
v_mfma_f32_16x16x32_bf16 v[200:203], v[48:51], a[56:59], v[200:203]
v_mul_f32 v168, v168, v18
v_mul_f32 v169, v169, v18
v_mul_f32 v170, v170, v18
s_waitcnt vmcnt(0)
v_mfma_f32_16x16x32_bf16 v[204:207], v[48:51], a[60:63], v[204:207]
v_mul_f32 v171, v171, v18
v_mul_f32 v184, v184, v18
v_mul_f32 v185, v185, v18
v_mfma_f32_16x16x32_bf16 v[208:211], v[52:55], a[48:51], v[208:211]
v_mul_f32 v186, v186, v18
v_mul_f32 v187, v187, v18
v_cvt_pk_bf16_f32 v168, v168, v169
v_mfma_f32_16x16x32_bf16 v[212:215], v[52:55], a[52:55], v[212:215]
v_cvt_pk_bf16_f32 v169, v170, v171
v_cvt_pk_bf16_f32 v170, v184, v185
v_mfma_f32_16x16x32_bf16 v[216:219], v[52:55], a[56:59], v[216:219]
v_cvt_pk_bf16_f32 v171, v186, v187
v_mfma_f32_16x16x32_bf16 v[220:223], v[52:55], a[60:63], v[220:223]
ds_write_b64 v28, v[168:169] offset:6144
v_mfma_f32_16x16x32_bf16 v[224:227], v[56:59], a[48:51], v[224:227]
ds_write_b64 v28, v[170:171] offset:6656
v_mfma_f32_16x16x32_bf16 v[228:231], v[56:59], a[52:55], v[228:231]
v_mul_f32 v172, v172, v19
v_mul_f32 v173, v173, v19
v_mul_f32 v174, v174, v19
v_mfma_f32_16x16x32_bf16 v[232:235], v[56:59], a[56:59], v[232:235]
v_mul_f32 v175, v175, v19
v_mul_f32 v188, v188, v19
v_mul_f32 v189, v189, v19
v_mfma_f32_16x16x32_bf16 v[236:239], v[56:59], a[60:63], v[236:239]
v_mul_f32 v190, v190, v19
v_mul_f32 v191, v191, v19
v_mfma_f32_16x16x32_bf16 v[240:243], v[60:63], a[48:51], v[240:243]
v_cvt_pk_bf16_f32 v172, v172, v173
v_cvt_pk_bf16_f32 v173, v174, v175
v_cvt_pk_bf16_f32 v174, v188, v189
v_mfma_f32_16x16x32_bf16 v[244:247], v[60:63], a[52:55], v[244:247]
v_cvt_pk_bf16_f32 v175, v190, v191
v_mfma_f32_16x16x32_bf16 v[248:251], v[60:63], a[56:59], v[248:251]
ds_write_b64 v28, v[172:173] offset:7168
v_mfma_f32_16x16x32_bf16 v[252:255], v[60:63], a[60:63], v[252:255]
ds_write_b64 v28, v[174:175] offset:7680
ds_read_b128 a[96:99], v29 offset:0
ds_read_b128 a[100:103], v29 offset:1024
ds_read_b128 a[104:107], v29 offset:2048
ds_read_b128 a[108:111], v29 offset:3072
ds_read_b128 a[112:115], v29 offset:4096
ds_read_b128 a[116:119], v29 offset:5120
ds_read_b128 a[120:123], v29 offset:6144
ds_read_b128 a[124:127], v29 offset:7168
v_lshrrev_b32 v26, 4, v0
v_and_b32 v27, 15, v0
s_lshl_b32 s63, s56, 3
v_add_u32 v28, s63, v26
v_lshlrev_b32 v28, 8, v28
s_and_b32 s63, s63, 8
v_xor_b32 v29, v27, v26
v_xor_b32 v29, s63, v29
v_lshl_add_u32 v44, v29, 4, v28
v_xor_b32 v45, 64, v44
v_lshlrev_b32 v29, 1, v26
v_xor_b32 v29, v27, v29
v_lshl_add_u32 v46, v29, 4, v28
v_xor_b32 v47, 128, v46
s_waitcnt lgkmcnt(0)
s_barrier
s_add_u32 s63, s56, 1
s_and_b32 s63, s63, 3
s_mul_i32 s63, s63, 12288
v_add_u32 v31, s63, v1
ds_write_b128 v31, v[196:199] offset:0
ds_write_b128 v31, v[212:215] offset:1024
ds_write_b128 v31, v[228:231] offset:2048
ds_write_b128 v31, v[244:247] offset:3072
s_add_u32 s63, s56, 2
s_and_b32 s63, s63, 3
s_mul_i32 s63, s63, 12288
v_add_u32 v30, s63, v1
ds_write_b128 v30, v[200:203] offset:4096
ds_write_b128 v30, v[216:219] offset:5120
ds_write_b128 v30, v[232:235] offset:6144
ds_write_b128 v30, v[248:251] offset:7168
s_add_u32 s63, s56, 3
s_and_b32 s63, s63, 3
s_mul_i32 s63, s63, 12288
v_add_u32 v31, s63, v1
ds_write_b128 v31, v[204:207] offset:8192
ds_write_b128 v31, v[220:223] offset:9216
ds_write_b128 v31, v[236:239] offset:10240
ds_write_b128 v31, v[252:255] offset:11264
s_add_u32 m0, s80, 65536
s_mov_b32 s61, 0
buffer_load_dwordx4 v44, s[8:11], s61 offen lds
buffer_load_dwordx4 v45, s[8:11], s61 offen offset:1024 lds
s_add_u32 m0, s80, 98304
s_nop 0
buffer_load_dwordx4 v46, s[12:15], s61 offen lds
buffer_load_dwordx4 v47, s[12:15], s61 offen offset:1024 lds
s_add_u32 m0, s80, 73728
s_mov_b32 s61, 8192
buffer_load_dwordx4 v44, s[8:11], s61 offen lds
buffer_load_dwordx4 v45, s[8:11], s61 offen offset:1024 lds
s_add_u32 m0, s80, 106496
s_nop 0
buffer_load_dwordx4 v46, s[12:15], s61 offen lds
buffer_load_dwordx4 v47, s[12:15], s61 offen offset:1024 lds
s_lshl_b32 s62, s89, 2
s_add_u32 s62, s62, s56
s_lshl_b32 s63, s62, 5
v_and_b32 v26, 31, v0
v_add_u32 v26, s63, v26
v_lshlrev_b32 v26, 7, v26
buffer_load_dword v188, v26, s[8:11], 0 offen
s_lshl_b32 s63, s62, 5
v_and_b32 v26, 31, v0
v_add_u32 v26, s63, v26
v_lshlrev_b32 v26, 7, v26
buffer_load_dword v189, v26, s[12:15], 0 offen
v_lshrrev_b32 v26, 4, v0
v_and_b32 v27, 15, v0
v_xor_b32 v28, v26, v27
v_lshlrev_b32 v28, 4, v28
v_lshl_add_u32 v28, v27, 8, v28
v_add_u32 v32, 65536, v28
v_xor_b32 v33, 64, v32
v_xor_b32 v34, 128, v32
v_xor_b32 v35, 192, v32
v_lshrrev_b32 v26, 2, v0
v_and_b32 v27, 3, v0
v_and_b32 v28, 7, v26
v_lshlrev_b32 v28, 5, v28
v_lshl_add_u32 v28, v26, 8, v28
v_lshl_add_u32 v28, v27, 3, v28
v_add_u32 v36, 98304, v28
v_xor_b32 v37, 32, v36
v_xor_b32 v38, 64, v36
v_xor_b32 v39, 96, v36
v_xor_b32 v40, 128, v36
v_xor_b32 v41, 160, v36
v_xor_b32 v42, 192, v36
v_xor_b32 v43, 224, v36
v_mov_b32 v20, 0xff800000
v_mov_b32 v21, 0xff800000
v_mov_b32 v22, 0xff800000
v_mov_b32 v23, 0xff800000
v_mov_b32 v26, s72
v_accvgpr_write_b32 a16, v26
v_accvgpr_write_b32 a17, v26
v_accvgpr_write_b32 a18, v26
v_accvgpr_write_b32 a19, v26
v_lshlrev_b32 v26, 16, v120
v_and_b32 v27, 0xffff0000, v120
v_fmac_f32 v192, v26, v25
v_fmac_f32 v193, v27, v25
v_lshlrev_b32 v26, 16, v121
v_and_b32 v27, 0xffff0000, v121
v_fmac_f32 v194, v26, v25
v_fmac_f32 v195, v27, v25
v_lshlrev_b32 v26, 16, v122
v_and_b32 v27, 0xffff0000, v122
v_fmac_f32 v208, v26, v25
v_fmac_f32 v209, v27, v25
v_lshlrev_b32 v26, 16, v123
v_and_b32 v27, 0xffff0000, v123
v_fmac_f32 v210, v26, v25
v_fmac_f32 v211, v27, v25
v_lshlrev_b32 v26, 16, v124
v_and_b32 v27, 0xffff0000, v124
v_fmac_f32 v224, v26, v25
v_fmac_f32 v225, v27, v25
v_lshlrev_b32 v26, 16, v125
v_and_b32 v27, 0xffff0000, v125
v_fmac_f32 v226, v26, v25
v_fmac_f32 v227, v27, v25
v_lshlrev_b32 v26, 16, v126
v_and_b32 v27, 0xffff0000, v126
v_fmac_f32 v240, v26, v25
v_fmac_f32 v241, v27, v25
v_lshlrev_b32 v26, 16, v127
v_and_b32 v27, 0xffff0000, v127
v_fmac_f32 v242, v26, v25
v_fmac_f32 v243, v27, v25
s_waitcnt lgkmcnt(0)
s_barrier
s_mul_i32 s63, s56, 12288
v_add_u32 v30, s63, v1
ds_read_b128 v[64:67], v30 offset:0
ds_read_b128 v[68:71], v30 offset:1024
ds_read_b128 v[72:75], v30 offset:2048
ds_read_b128 v[76:79], v30 offset:3072
ds_read_b128 v[80:83], v30 offset:4096
ds_read_b128 v[84:87], v30 offset:5120
ds_read_b128 v[88:91], v30 offset:6144
ds_read_b128 v[92:95], v30 offset:7168
ds_read_b128 v[96:99], v30 offset:8192
ds_read_b128 v[100:103], v30 offset:9216
ds_read_b128 v[104:107], v30 offset:10240
ds_read_b128 v[108:111], v30 offset:11264
v_lshrrev_b32 v26, 3, v0
v_and_b32 v28, 7, v0
v_and_b32 v29, 6, v26
v_xor_b32 v28, v28, v29
s_and_b32 s62, s57, 1
s_min_u32 s63, s56, 1
s_and_b32 s63, s63, s62
s_lshl_b32 s63, s63, 6
s_lshl_b32 s81, s56, 7
s_sub_u32 s63, s81, s63
v_mul_u32_u24 v26, 3584, v26
v_lshl_add_u32 v26, v28, 4, v26
v_add_u32 v26, s63, v26
s_xor_b32 s62, s62, 1
s_mul_i32 s62, s62, 3
s_cmp_eq_u32 s62, s56
s_cselect_b32 s63, 4, 8
v_mov_b32 v29, 0x40000000
v_cmp_gt_u32 vcc, s63, v28
s_nop 1
v_cndmask_b32 v6, v29, v26, vcc
v_add_u32 v7, 27648, v6
v_add_u32 v8, 55296, v6
v_add_u32 v9, 82944, v6
s_waitcnt lgkmcnt(11)
v_pk_add_f32 v[192:193], v[192:193], v[64:65]
v_pk_add_f32 v[194:195], v[194:195], v[66:67]
s_waitcnt lgkmcnt(10)
v_pk_add_f32 v[208:209], v[208:209], v[68:69]
v_pk_add_f32 v[210:211], v[210:211], v[70:71]
s_waitcnt lgkmcnt(9)
v_pk_add_f32 v[224:225], v[224:225], v[72:73]
v_pk_add_f32 v[226:227], v[226:227], v[74:75]
s_waitcnt lgkmcnt(8)
v_pk_add_f32 v[240:241], v[240:241], v[76:77]
v_pk_add_f32 v[242:243], v[242:243], v[78:79]
s_waitcnt lgkmcnt(7)
v_pk_add_f32 v[192:193], v[192:193], v[80:81]
v_pk_add_f32 v[194:195], v[194:195], v[82:83]
s_waitcnt lgkmcnt(6)
v_pk_add_f32 v[208:209], v[208:209], v[84:85]
v_pk_add_f32 v[210:211], v[210:211], v[86:87]
s_waitcnt lgkmcnt(5)
v_pk_add_f32 v[224:225], v[224:225], v[88:89]
v_pk_add_f32 v[226:227], v[226:227], v[90:91]
s_waitcnt lgkmcnt(4)
v_pk_add_f32 v[240:241], v[240:241], v[92:93]
v_pk_add_f32 v[242:243], v[242:243], v[94:95]
s_waitcnt lgkmcnt(3)
v_pk_add_f32 v[192:193], v[192:193], v[96:97]
v_pk_add_f32 v[194:195], v[194:195], v[98:99]
s_waitcnt lgkmcnt(2)
v_pk_add_f32 v[208:209], v[208:209], v[100:101]
v_pk_add_f32 v[210:211], v[210:211], v[102:103]
s_waitcnt lgkmcnt(1)
v_pk_add_f32 v[224:225], v[224:225], v[104:105]
v_pk_add_f32 v[226:227], v[226:227], v[106:107]
s_waitcnt lgkmcnt(0)
v_pk_add_f32 v[240:241], v[240:241], v[108:109]
v_pk_add_f32 v[242:243], v[242:243], v[110:111]
s_waitcnt vmcnt(6)
s_barrier
ds_read_b128 a[128:131], v32 offset:0
ds_read_b128 a[144:147], v32 offset:4096
ds_read_b128 a[132:135], v33 offset:0
ds_read_b128 a[148:151], v33 offset:4096
ds_read_b128 a[136:139], v34 offset:0
ds_read_b128 a[152:155], v34 offset:4096
ds_read_b128 a[140:143], v35 offset:0
ds_read_b128 a[156:159], v35 offset:4096
s_waitcnt lgkmcnt(7)
v_mfma_f32_16x16x32_bf16 v[64:67], a[128:131], a[64:67], 0
ds_read_b64_tr_b16 a[192:193], v36 offset:0
ds_read_b64_tr_b16 a[194:195], v36 offset:4096
ds_read_b64_tr_b16 a[196:197], v37 offset:0
v_add_f32 v26, v192, v193
s_waitcnt lgkmcnt(9)
v_mfma_f32_16x16x32_bf16 v[68:71], a[144:147], a[64:67], 0
ds_read_b64_tr_b16 a[198:199], v37 offset:4096
ds_read_b64_tr_b16 a[200:201], v38 offset:0
ds_read_b64_tr_b16 a[202:203], v38 offset:4096
v_mul_f32 v27, v192, v192
s_waitcnt lgkmcnt(11)
v_mfma_f32_16x16x32_bf16 v[64:67], a[132:135], a[80:83], v[64:67]
ds_read_b64_tr_b16 a[204:205], v39 offset:0
ds_read_b64_tr_b16 a[206:207], v39 offset:4096
ds_read_b64_tr_b16 a[208:209], v40 offset:0
v_fmac_f32 v27, v193, v193
s_waitcnt lgkmcnt(13)
v_mfma_f32_16x16x32_bf16 v[68:71], a[148:151], a[80:83], v[68:71]
ds_read_b64_tr_b16 a[210:211], v40 offset:4096
ds_read_b64_tr_b16 a[212:213], v41 offset:0
ds_read_b64_tr_b16 a[214:215], v41 offset:4096
v_add_f32 v26, v26, v194
s_waitcnt lgkmcnt(15)
v_mfma_f32_16x16x32_bf16 v[64:67], a[136:139], a[96:99], v[64:67]
ds_read_b64_tr_b16 a[216:217], v42 offset:0
ds_read_b64_tr_b16 a[218:219], v42 offset:4096
ds_read_b64_tr_b16 a[220:221], v43 offset:0
v_fmac_f32 v27, v194, v194
s_waitcnt lgkmcnt(15)
v_mfma_f32_16x16x32_bf16 v[68:71], a[152:155], a[96:99], v[68:71]
ds_read_b64_tr_b16 a[222:223], v43 offset:4096
s_add_u32 m0, s80, 81920
s_mov_b32 s61, 16384
v_add_f32 v26, v26, v195
v_mfma_f32_16x16x32_bf16 v[64:67], a[140:143], a[112:115], v[64:67]
buffer_load_dwordx4 v44, s[8:11], s61 offen lds
v_fmac_f32 v27, v195, v195
v_mfma_f32_16x16x32_bf16 v[68:71], a[156:159], a[112:115], v[68:71]
buffer_load_dwordx4 v45, s[8:11], s61 offen offset:1024 lds
s_add_u32 m0, s80, 114688
v_mfma_f32_16x16x32_bf16 v[72:75], a[128:131], a[68:71], 0
buffer_load_dwordx4 v46, s[12:15], s61 offen lds
v_add_f32 v26, v26, v208
v_mfma_f32_16x16x32_bf16 v[76:79], a[144:147], a[68:71], 0
buffer_load_dwordx4 v47, s[12:15], s61 offen offset:1024 lds
s_add_u32 m0, s80, 90112
v_mfma_f32_16x16x32_bf16 v[72:75], a[132:135], a[84:87], v[72:75]
s_mov_b32 s61, 24576
v_fmac_f32 v27, v208, v208
v_add_f32 v26, v26, v209
v_fmac_f32 v27, v209, v209
v_mfma_f32_16x16x32_bf16 v[76:79], a[148:151], a[84:87], v[76:79]
buffer_load_dwordx4 v44, s[8:11], s61 offen lds
v_add_f32 v26, v26, v210
v_mfma_f32_16x16x32_bf16 v[72:75], a[136:139], a[100:103], v[72:75]
buffer_load_dwordx4 v45, s[8:11], s61 offen offset:1024 lds
s_add_u32 m0, s80, 122880
v_mfma_f32_16x16x32_bf16 v[76:79], a[152:155], a[100:103], v[76:79]
buffer_load_dwordx4 v46, s[12:15], s61 offen lds
v_fmac_f32 v27, v210, v210
v_mfma_f32_16x16x32_bf16 v[72:75], a[140:143], a[116:119], v[72:75]
buffer_load_dwordx4 v47, s[12:15], s61 offen offset:1024 lds
v_add_f32 v26, v26, v211
v_mfma_f32_16x16x32_bf16 v[76:79], a[156:159], a[116:119], v[76:79]
v_fmac_f32 v27, v211, v211
v_add_f32 v26, v26, v224
v_fmac_f32 v27, v224, v224
v_add_f32 v26, v26, v225
v_mfma_f32_16x16x32_bf16 v[80:83], a[128:131], a[72:75], 0
v_fmac_f32 v27, v225, v225
v_add_f32 v26, v26, v226
v_fmac_f32 v27, v226, v226
v_add_f32 v26, v26, v227
v_mfma_f32_16x16x32_bf16 v[84:87], a[144:147], a[72:75], 0
v_fmac_f32 v27, v227, v227
v_add_f32 v26, v26, v240
v_fmac_f32 v27, v240, v240
v_add_f32 v26, v26, v241
v_mfma_f32_16x16x32_bf16 v[80:83], a[132:135], a[88:91], v[80:83]
v_fmac_f32 v27, v241, v241
v_add_f32 v26, v26, v242
v_fmac_f32 v27, v242, v242
v_add_f32 v26, v26, v243
v_mfma_f32_16x16x32_bf16 v[84:87], a[148:151], a[88:91], v[84:87]
v_fmac_f32 v27, v243, v243
v_cvt_pk_bf16_f32 v192, v192, v193
v_cvt_pk_bf16_f32 v193, v194, v195
v_cvt_pk_bf16_f32 v194, v208, v209
v_mfma_f32_16x16x32_bf16 v[80:83], a[136:139], a[104:107], v[80:83]
v_cvt_pk_bf16_f32 v195, v210, v211
v_cvt_pk_bf16_f32 v224, v224, v225
v_cvt_pk_bf16_f32 v225, v226, v227
v_cvt_pk_bf16_f32 v226, v240, v241
v_mfma_f32_16x16x32_bf16 v[84:87], a[152:155], a[104:107], v[84:87]
v_cvt_pk_bf16_f32 v227, v242, v243
s_lshl_b32 s63, s58, 6
s_lshl_b32 s62, s57, 3
s_add_u32 s63, s63, s62
v_mfma_f32_16x16x32_bf16 v[80:83], a[140:143], a[120:123], v[80:83]
s_add_u32 s63, s63, s56
s_lshl_b32 s63, s63, 10
s_add_u32 s63, s63, 3145728
v_mfma_f32_16x16x32_bf16 v[84:87], a[156:159], a[120:123], v[84:87]
buffer_store_dwordx4 v[192:195], v1, s[44:47], s63 offen sc1
v_mfma_f32_16x16x32_bf16 v[88:91], a[128:131], a[76:79], 0
s_add_u32 s63, s63, 4096
v_mfma_f32_16x16x32_bf16 v[92:95], a[144:147], a[76:79], 0
buffer_store_dwordx4 v[224:227], v1, s[44:47], s63 offen sc1
v_mfma_f32_16x16x32_bf16 v[88:91], a[132:135], a[92:95], v[88:91]
v_permlane32_swap_b32 v26, v27
v_add_f32 v26, v26, v27
v_mov_b32 v27, v26
v_mfma_f32_16x16x32_bf16 v[92:95], a[148:151], a[92:95], v[92:95]
s_nop 0
v_permlane16_swap_b32 v26, v27
v_add_f32 v26, v26, v27
v_mov_b32 v27, v26
v_mfma_f32_16x16x32_bf16 v[88:91], a[136:139], a[108:111], v[88:91]
s_nop 0
v_permlane32_swap_b32 v26, v27
v_lshlrev_b32 v28, 3, v0
v_mov_b32 v29, 0x40000000
v_mfma_f32_16x16x32_bf16 v[92:95], a[152:155], a[108:111], v[92:95]
v_cmp_gt_u32 vcc, 16, v0
s_nop 1
v_cndmask_b32 v28, v29, v28, vcc
s_lshl_b32 s63, s58, 2
s_add_u32 s63, s63, s56
v_mfma_f32_16x16x32_bf16 v[88:91], a[140:143], a[124:127], v[88:91]
s_lshl_b32 s63, s63, 3
s_add_u32 s63, s63, s57
s_lshl_b32 s63, s63, 7
s_add_u32 s63, s63, 5242880
v_mfma_f32_16x16x32_bf16 v[92:95], a[156:159], a[124:127], v[92:95]
buffer_store_dwordx2 v[26:27], v28, s[44:47], s63 offen sc1
L_att:
v_max3_f32 v120, v64, v65, v66
v_max3_f32 v120, v120, v67, v68
v_max3_f32 v120, v120, v69, v70
v_max_f32 v120, v120, v71
v_max3_f32 v121, v72, v73, v74
v_max3_f32 v121, v121, v75, v76
v_max3_f32 v121, v121, v77, v78
v_max_f32 v121, v121, v79
v_max3_f32 v122, v80, v81, v82
v_max3_f32 v122, v122, v83, v84
v_max3_f32 v122, v122, v85, v86
v_max_f32 v122, v122, v87
v_max3_f32 v123, v88, v89, v90
v_max3_f32 v123, v123, v91, v92
v_max3_f32 v123, v123, v93, v94
v_max_f32 v123, v123, v95
v_permlane32_swap_b32 v120, v121
s_nop 0
v_permlane32_swap_b32 v122, v123
v_max_f32 v120, v120, v121
v_max_f32 v122, v122, v123
v_mov_b32 v121, v120
v_mov_b32 v123, v122
s_nop 0
v_permlane16_swap_b32 v120, v121
v_permlane16_swap_b32 v122, v123
v_max_f32 v120, v120, v121
v_max_f32 v122, v122, v123
v_mov_b32 v121, v120
v_mov_b32 v123, v122
s_nop 0
v_permlane32_swap_b32 v120, v121
v_permlane32_swap_b32 v122, v123
v_max_f32 v120, v120, v20
v_mul_f32 v104, -1.0, v120
v_mul_f32 v105, -1.0, v120
v_mul_f32 v106, -1.0, v120
v_mul_f32 v107, -1.0, v120
v_max_f32 v121, v121, v21
v_mul_f32 v108, -1.0, v121
v_mul_f32 v109, -1.0, v121
v_mul_f32 v110, -1.0, v121
v_mul_f32 v111, -1.0, v121
v_max_f32 v122, v122, v22
v_mul_f32 v112, -1.0, v122
v_mul_f32 v113, -1.0, v122
v_mul_f32 v114, -1.0, v122
v_mul_f32 v115, -1.0, v122
v_max_f32 v123, v123, v23
v_mul_f32 v116, -1.0, v123
v_mul_f32 v117, -1.0, v123
v_mul_f32 v118, -1.0, v123
v_mul_f32 v119, -1.0, v123
v_add_f32 v64, v64, v104
v_add_f32 v65, v65, v104
v_add_f32 v66, v66, v104
v_add_f32 v67, v67, v104
v_add_f32 v68, v68, v104
v_add_f32 v69, v69, v104
v_add_f32 v70, v70, v104
v_add_f32 v71, v71, v104
v_exp_f32 v64, v64
v_exp_f32 v65, v65
v_exp_f32 v66, v66
v_exp_f32 v67, v67
v_cvt_pk_bf16_f32 v96, v64, v65
v_exp_f32 v68, v68
v_exp_f32 v69, v69
v_cvt_pk_bf16_f32 v97, v66, v67
v_exp_f32 v70, v70
v_exp_f32 v71, v71
v_cvt_pk_bf16_f32 v98, v68, v69
v_cvt_pk_bf16_f32 v99, v70, v71
s_waitcnt vmcnt(13)
s_barrier
s_waitcnt lgkmcnt(14)
v_mfma_f32_16x16x32_bf16 v[128:131], a[192:195], v[96:99], 0
ds_read_b128 a[160:163], v32 offset:8192
ds_read_b128 a[176:179], v32 offset:12288
ds_read_b128 a[164:167], v33 offset:8192
ds_read_b128 a[180:183], v33 offset:12288
ds_read_b64_tr_b16 a[224:225], v36 offset:8192
v_add_f32 v72, v72, v108
s_waitcnt lgkmcnt(15)
v_mfma_f32_16x16x32_bf16 v[144:147], a[196:199], v[96:99], 0
ds_read_b64_tr_b16 a[226:227], v36 offset:12288
ds_read_b64_tr_b16 a[228:229], v37 offset:8192
ds_read_b64_tr_b16 a[230:231], v37 offset:12288
s_add_u32 m0, s80, 65536
s_mov_b32 s61, 32768
v_add_f32 v73, v73, v108
v_mfma_f32_16x16x32_bf16 v[160:163], a[200:203], v[96:99], 0
buffer_load_dwordx4 v44, s[8:11], s61 offen lds
v_add_f32 v74, v74, v108
v_add_f32 v75, v75, v108
v_add_f32 v76, v76, v108
s_waitcnt lgkmcnt(15)
v_mfma_f32_16x16x32_bf16 v[176:179], a[204:207], v[96:99], 0
buffer_load_dwordx4 v45, s[8:11], s61 offen offset:1024 lds
s_add_u32 m0, s80, 131072
v_add_f32 v77, v77, v108
v_add_f32 v78, v78, v108
s_waitcnt lgkmcnt(14)
v_mfma_f32_16x16x32_bf16 v[192:195], a[208:211], v[96:99], 0
buffer_load_dwordx4 v46, s[12:15], s61 offen lds
v_add_f32 v79, v79, v108
v_exp_f32 v72, v72
s_waitcnt lgkmcnt(12)
v_mfma_f32_16x16x32_bf16 v[208:211], a[212:215], v[96:99], 0
buffer_load_dwordx4 v47, s[12:15], s61 offen offset:1024 lds
v_exp_f32 v73, v73
s_waitcnt lgkmcnt(10)
v_mfma_f32_16x16x32_bf16 v[224:227], a[216:219], v[96:99], 0
v_exp_f32 v74, v74
v_exp_f32 v75, v75
v_cvt_pk_bf16_f32 v100, v72, v73
s_waitcnt lgkmcnt(8)
v_mfma_f32_16x16x32_bf16 v[240:243], a[220:223], v[96:99], 0
v_exp_f32 v76, v76
v_exp_f32 v77, v77
v_cvt_pk_bf16_f32 v101, v74, v75
v_mfma_f32_16x16x32_bf16 a[0:3], a[16:19], v[96:99], 0
v_exp_f32 v78, v78
v_exp_f32 v79, v79
v_cvt_pk_bf16_f32 v102, v76, v77
v_cvt_pk_bf16_f32 v103, v78, v79
s_nop 1
v_mfma_f32_16x16x32_bf16 v[132:135], a[192:195], v[100:103], 0
ds_read_b128 a[168:171], v34 offset:8192
ds_read_b128 a[184:187], v34 offset:12288
ds_read_b128 a[172:175], v35 offset:8192
ds_read_b128 a[188:191], v35 offset:12288
v_mfma_f32_16x16x32_bf16 v[148:151], a[196:199], v[100:103], 0
ds_read_b64_tr_b16 a[232:233], v38 offset:8192
ds_read_b64_tr_b16 a[234:235], v38 offset:12288
ds_read_b64_tr_b16 a[236:237], v39 offset:8192
ds_read_b64_tr_b16 a[238:239], v39 offset:12288
v_mfma_f32_16x16x32_bf16 v[164:167], a[200:203], v[100:103], 0
v_add_f32 v80, v80, v112
v_add_f32 v81, v81, v112
v_add_f32 v82, v82, v112
v_add_f32 v83, v83, v112
v_mfma_f32_16x16x32_bf16 v[180:183], a[204:207], v[100:103], 0
v_add_f32 v84, v84, v112
v_add_f32 v85, v85, v112
v_add_f32 v86, v86, v112
v_add_f32 v87, v87, v112
v_mfma_f32_16x16x32_bf16 v[196:199], a[208:211], v[100:103], 0
v_exp_f32 v80, v80
v_exp_f32 v81, v81
v_mfma_f32_16x16x32_bf16 v[212:215], a[212:215], v[100:103], 0
v_exp_f32 v82, v82
v_exp_f32 v83, v83
v_mfma_f32_16x16x32_bf16 v[228:231], a[216:219], v[100:103], 0
v_cvt_pk_bf16_f32 v96, v80, v81
v_exp_f32 v84, v84
v_mfma_f32_16x16x32_bf16 v[244:247], a[220:223], v[100:103], 0
v_exp_f32 v85, v85
v_cvt_pk_bf16_f32 v97, v82, v83
v_exp_f32 v86, v86
v_mfma_f32_16x16x32_bf16 a[4:7], a[16:19], v[100:103], 0
v_exp_f32 v87, v87
v_cvt_pk_bf16_f32 v98, v84, v85
v_cvt_pk_bf16_f32 v99, v86, v87
s_waitcnt vmcnt(11) lgkmcnt(4)
s_barrier
v_mfma_f32_16x16x32_bf16 v[64:67], a[160:163], a[64:67], v[104:107]
ds_read_b128 a[128:131], v32 offset:16384
ds_read_b128 a[144:147], v32 offset:20480
v_add_f32 v88, v88, v116
v_mfma_f32_16x16x32_bf16 v[68:71], a[176:179], a[64:67], v[104:107]
ds_read_b64_tr_b16 a[240:241], v40 offset:8192
ds_read_b64_tr_b16 a[242:243], v40 offset:12288
v_add_f32 v89, v89, v116
v_mfma_f32_16x16x32_bf16 v[64:67], a[164:167], a[80:83], v[64:67]
ds_read_b64_tr_b16 a[244:245], v41 offset:8192
ds_read_b64_tr_b16 a[246:247], v41 offset:12288
s_add_u32 m0, s80, 73728
v_mfma_f32_16x16x32_bf16 v[68:71], a[180:183], a[80:83], v[68:71]
s_mov_b32 s61, 40960
v_add_f32 v90, v90, v116
v_add_f32 v91, v91, v116
v_mfma_f32_16x16x32_bf16 v[64:67], a[168:171], a[96:99], v[64:67]
buffer_load_dwordx4 v44, s[8:11], s61 offen lds
v_mfma_f32_16x16x32_bf16 v[68:71], a[184:187], a[96:99], v[68:71]
buffer_load_dwordx4 v45, s[8:11], s61 offen offset:1024 lds
v_mfma_f32_16x16x32_bf16 v[64:67], a[172:175], a[112:115], v[64:67]
s_add_u32 m0, s80, 98304
v_add_f32 v92, v92, v116
v_add_f32 v93, v93, v116
v_mfma_f32_16x16x32_bf16 v[68:71], a[188:191], a[112:115], v[68:71]
buffer_load_dwordx4 v46, s[12:15], s61 offen lds
v_mfma_f32_16x16x32_bf16 v[136:139], a[192:195], v[96:99], 0
buffer_load_dwordx4 v47, s[12:15], s61 offen offset:1024 lds
v_mfma_f32_16x16x32_bf16 v[152:155], a[196:199], v[96:99], 0
v_add_f32 v94, v94, v116
v_add_f32 v95, v95, v116
v_mfma_f32_16x16x32_bf16 v[168:171], a[200:203], v[96:99], 0
v_exp_f32 v88, v88
v_mfma_f32_16x16x32_bf16 v[184:187], a[204:207], v[96:99], 0
v_exp_f32 v89, v89
v_mfma_f32_16x16x32_bf16 v[200:203], a[208:211], v[96:99], 0
v_exp_f32 v90, v90
v_mfma_f32_16x16x32_bf16 v[216:219], a[212:215], v[96:99], 0
v_exp_f32 v91, v91
v_cvt_pk_bf16_f32 v100, v88, v89
v_mfma_f32_16x16x32_bf16 v[232:235], a[216:219], v[96:99], 0
v_exp_f32 v92, v92
v_exp_f32 v93, v93
v_mfma_f32_16x16x32_bf16 v[248:251], a[220:223], v[96:99], 0
v_cvt_pk_bf16_f32 v101, v90, v91
v_exp_f32 v94, v94
v_mfma_f32_16x16x32_bf16 a[8:11], a[16:19], v[96:99], 0
v_exp_f32 v95, v95
v_cvt_pk_bf16_f32 v102, v92, v93
v_cvt_pk_bf16_f32 v103, v94, v95
v_mfma_f32_16x16x32_bf16 v[72:75], a[160:163], a[68:71], v[108:111]
ds_read_b128 a[132:135], v33 offset:16384
v_mfma_f32_16x16x32_bf16 v[76:79], a[176:179], a[68:71], v[108:111]
ds_read_b128 a[148:151], v33 offset:20480
v_mfma_f32_16x16x32_bf16 v[72:75], a[164:167], a[84:87], v[72:75]
v_exp_f32 v64, v64
v_mfma_f32_16x16x32_bf16 v[76:79], a[180:183], a[84:87], v[76:79]
v_exp_f32 v65, v65
v_mfma_f32_16x16x32_bf16 v[72:75], a[168:171], a[100:103], v[72:75]
ds_read_b64_tr_b16 a[248:249], v42 offset:8192
v_mfma_f32_16x16x32_bf16 v[76:79], a[184:187], a[100:103], v[76:79]
v_exp_f32 v66, v66
v_mfma_f32_16x16x32_bf16 v[72:75], a[172:175], a[116:119], v[72:75]
v_exp_f32 v67, v67
v_mfma_f32_16x16x32_bf16 v[76:79], a[188:191], a[116:119], v[76:79]
ds_read_b64_tr_b16 a[250:251], v42 offset:12288
v_cvt_pk_bf16_f32 v96, v64, v65
v_mfma_f32_16x16x32_bf16 v[140:143], a[192:195], v[100:103], 0
v_exp_f32 v68, v68
v_mfma_f32_16x16x32_bf16 v[156:159], a[196:199], v[100:103], 0
ds_read_b64_tr_b16 a[252:253], v43 offset:8192
v_mfma_f32_16x16x32_bf16 v[172:175], a[200:203], v[100:103], 0
v_exp_f32 v69, v69
v_mfma_f32_16x16x32_bf16 v[188:191], a[204:207], v[100:103], 0
v_cvt_pk_bf16_f32 v97, v66, v67
v_mfma_f32_16x16x32_bf16 v[204:207], a[208:211], v[100:103], 0
ds_read_b64_tr_b16 a[254:255], v43 offset:12288
v_mfma_f32_16x16x32_bf16 v[220:223], a[212:215], v[100:103], 0
v_exp_f32 v70, v70
v_mfma_f32_16x16x32_bf16 v[236:239], a[216:219], v[100:103], 0
v_exp_f32 v71, v71
v_mfma_f32_16x16x32_bf16 v[252:255], a[220:223], v[100:103], 0
v_cvt_pk_bf16_f32 v98, v68, v69
v_cvt_pk_bf16_f32 v99, v70, v71
v_mfma_f32_16x16x32_bf16 a[12:15], a[16:19], v[100:103], 0
v_mfma_f32_16x16x32_bf16 v[64:67], a[160:163], a[72:75], v[112:115]
ds_read_b128 a[136:139], v34 offset:16384
v_mfma_f32_16x16x32_bf16 v[68:71], a[176:179], a[72:75], v[112:115]
ds_read_b128 a[152:155], v34 offset:20480
v_mfma_f32_16x16x32_bf16 v[64:67], a[164:167], a[88:91], v[64:67]
v_exp_f32 v72, v72
v_mfma_f32_16x16x32_bf16 v[68:71], a[180:183], a[88:91], v[68:71]
v_exp_f32 v73, v73
v_mfma_f32_16x16x32_bf16 v[64:67], a[168:171], a[104:107], v[64:67]
ds_read_b64_tr_b16 a[192:193], v36 offset:16384
v_mfma_f32_16x16x32_bf16 v[68:71], a[184:187], a[104:107], v[68:71]
v_exp_f32 v74, v74
v_mfma_f32_16x16x32_bf16 v[64:67], a[172:175], a[120:123], v[64:67]
v_exp_f32 v75, v75
v_mfma_f32_16x16x32_bf16 v[68:71], a[188:191], a[120:123], v[68:71]
ds_read_b64_tr_b16 a[194:195], v36 offset:20480
v_cvt_pk_bf16_f32 v100, v72, v73
s_waitcnt lgkmcnt(4)
v_mfma_f32_16x16x32_bf16 v[128:131], a[224:227], v[96:99], v[128:131]
v_exp_f32 v76, v76
v_mfma_f32_16x16x32_bf16 v[144:147], a[228:231], v[96:99], v[144:147]
ds_read_b64_tr_b16 a[196:197], v37 offset:16384
v_mfma_f32_16x16x32_bf16 v[160:163], a[232:235], v[96:99], v[160:163]
v_exp_f32 v77, v77
v_mfma_f32_16x16x32_bf16 v[176:179], a[236:239], v[96:99], v[176:179]
v_cvt_pk_bf16_f32 v101, v74, v75
v_mfma_f32_16x16x32_bf16 v[192:195], a[240:243], v[96:99], v[192:195]
ds_read_b64_tr_b16 a[198:199], v37 offset:20480
v_mfma_f32_16x16x32_bf16 v[208:211], a[244:247], v[96:99], v[208:211]
v_exp_f32 v78, v78
v_mfma_f32_16x16x32_bf16 v[224:227], a[248:251], v[96:99], v[224:227]
v_exp_f32 v79, v79
v_mfma_f32_16x16x32_bf16 v[240:243], a[252:255], v[96:99], v[240:243]
v_cvt_pk_bf16_f32 v102, v76, v77
v_cvt_pk_bf16_f32 v103, v78, v79
v_mfma_f32_16x16x32_bf16 a[0:3], a[16:19], v[96:99], a[0:3]
v_mfma_f32_16x16x32_bf16 v[72:75], a[160:163], a[76:79], v[116:119]
ds_read_b128 a[140:143], v35 offset:16384
ds_read_b128 a[156:159], v35 offset:20480
v_mfma_f32_16x16x32_bf16 v[76:79], a[176:179], a[76:79], v[116:119]
ds_read_b64_tr_b16 a[200:201], v38 offset:16384
ds_read_b64_tr_b16 a[202:203], v38 offset:20480
v_mfma_f32_16x16x32_bf16 v[72:75], a[164:167], a[92:95], v[72:75]
ds_read_b64_tr_b16 a[204:205], v39 offset:16384
ds_read_b64_tr_b16 a[206:207], v39 offset:20480
v_mfma_f32_16x16x32_bf16 v[76:79], a[180:183], a[92:95], v[76:79]
s_mul_i32 s63, s57, 128
s_lshl_b32 s62, s56, 2
v_mfma_f32_16x16x32_bf16 v[72:75], a[168:171], a[108:111], v[72:75]
s_add_u32 s63, s63, s62
s_add_u32 s63, s63, s90
v_mfma_f32_16x16x32_bf16 v[76:79], a[184:187], a[108:111], v[76:79]
s_add_u32 s63, s63, 32768
v_mfma_f32_16x16x32_bf16 v[72:75], a[172:175], a[124:127], v[72:75]
s_waitcnt vmcnt(8)
buffer_store_dword v14, v15, s[44:47], s63 offen sc1
v_mfma_f32_16x16x32_bf16 v[76:79], a[188:191], a[124:127], v[76:79]
v_exp_f32 v64, v64
v_mfma_f32_16x16x32_bf16 v[132:135], a[224:227], v[100:103], v[132:135]
v_exp_f32 v65, v65
v_mfma_f32_16x16x32_bf16 v[148:151], a[228:231], v[100:103], v[148:151]
v_exp_f32 v66, v66
v_mfma_f32_16x16x32_bf16 v[164:167], a[232:235], v[100:103], v[164:167]
v_exp_f32 v67, v67
v_mfma_f32_16x16x32_bf16 v[180:183], a[236:239], v[100:103], v[180:183]
v_cvt_pk_bf16_f32 v96, v64, v65
v_mfma_f32_16x16x32_bf16 v[196:199], a[240:243], v[100:103], v[196:199]
v_exp_f32 v68, v68
v_mfma_f32_16x16x32_bf16 v[212:215], a[244:247], v[100:103], v[212:215]
v_exp_f32 v69, v69
v_mfma_f32_16x16x32_bf16 v[228:231], a[248:251], v[100:103], v[228:231]
v_cvt_pk_bf16_f32 v97, v66, v67
v_mfma_f32_16x16x32_bf16 v[244:247], a[252:255], v[100:103], v[244:247]
v_exp_f32 v70, v70
v_mfma_f32_16x16x32_bf16 a[4:7], a[16:19], v[100:103], a[4:7]
v_exp_f32 v71, v71
v_cvt_pk_bf16_f32 v98, v68, v69
v_cvt_pk_bf16_f32 v99, v70, v71
s_waitcnt lgkmcnt(4)
s_barrier
v_mfma_f32_16x16x32_bf16 v[64:67], a[128:131], a[64:67], v[104:107]
ds_read_b128 a[160:163], v32 offset:24576
ds_read_b128 a[176:179], v32 offset:28672
v_mfma_f32_16x16x32_bf16 v[68:71], a[144:147], a[64:67], v[104:107]
ds_read_b64_tr_b16 a[208:209], v40 offset:16384
ds_read_b64_tr_b16 a[210:211], v40 offset:20480
v_mfma_f32_16x16x32_bf16 v[64:67], a[132:135], a[80:83], v[64:67]
ds_read_b64_tr_b16 a[212:213], v41 offset:16384
ds_read_b64_tr_b16 a[214:215], v41 offset:20480
v_mfma_f32_16x16x32_bf16 v[68:71], a[148:151], a[80:83], v[68:71]
s_add_u32 m0, s80, 81920
s_mov_b32 s61, 49152
v_mfma_f32_16x16x32_bf16 v[64:67], a[136:139], a[96:99], v[64:67]
buffer_load_dwordx4 v44, s[8:11], s61 offen lds
v_mfma_f32_16x16x32_bf16 v[68:71], a[152:155], a[96:99], v[68:71]
buffer_load_dwordx4 v45, s[8:11], s61 offen offset:1024 lds
v_mfma_f32_16x16x32_bf16 v[64:67], a[140:143], a[112:115], v[64:67]
s_add_u32 m0, s80, 106496
v_mfma_f32_16x16x32_bf16 v[68:71], a[156:159], a[112:115], v[68:71]
buffer_load_dwordx4 v46, s[12:15], s61 offen lds
v_mfma_f32_16x16x32_bf16 v[136:139], a[224:227], v[96:99], v[136:139]
buffer_load_dwordx4 v47, s[12:15], s61 offen offset:1024 lds
v_mfma_f32_16x16x32_bf16 v[152:155], a[228:231], v[96:99], v[152:155]
v_exp_f32 v72, v72
v_mfma_f32_16x16x32_bf16 v[168:171], a[232:235], v[96:99], v[168:171]
v_exp_f32 v73, v73
v_mfma_f32_16x16x32_bf16 v[184:187], a[236:239], v[96:99], v[184:187]
v_exp_f32 v74, v74
v_mfma_f32_16x16x32_bf16 v[200:203], a[240:243], v[96:99], v[200:203]
v_exp_f32 v75, v75
v_cvt_pk_bf16_f32 v100, v72, v73
v_mfma_f32_16x16x32_bf16 v[216:219], a[244:247], v[96:99], v[216:219]
v_exp_f32 v76, v76
v_mfma_f32_16x16x32_bf16 v[232:235], a[248:251], v[96:99], v[232:235]
v_exp_f32 v77, v77
v_cvt_pk_bf16_f32 v101, v74, v75
v_mfma_f32_16x16x32_bf16 v[248:251], a[252:255], v[96:99], v[248:251]
v_exp_f32 v78, v78
v_mfma_f32_16x16x32_bf16 a[8:11], a[16:19], v[96:99], a[8:11]
v_exp_f32 v79, v79
v_cvt_pk_bf16_f32 v102, v76, v77
v_cvt_pk_bf16_f32 v103, v78, v79
v_mfma_f32_16x16x32_bf16 v[72:75], a[128:131], a[68:71], v[108:111]
ds_read_b128 a[164:167], v33 offset:24576
v_mfma_f32_16x16x32_bf16 v[76:79], a[144:147], a[68:71], v[108:111]
ds_read_b128 a[180:183], v33 offset:28672
v_mfma_f32_16x16x32_bf16 v[72:75], a[132:135], a[84:87], v[72:75]
v_exp_f32 v64, v64
v_mfma_f32_16x16x32_bf16 v[76:79], a[148:151], a[84:87], v[76:79]
v_exp_f32 v65, v65
v_mfma_f32_16x16x32_bf16 v[72:75], a[136:139], a[100:103], v[72:75]
ds_read_b64_tr_b16 a[216:217], v42 offset:16384
v_mfma_f32_16x16x32_bf16 v[76:79], a[152:155], a[100:103], v[76:79]
v_exp_f32 v66, v66
v_mfma_f32_16x16x32_bf16 v[72:75], a[140:143], a[116:119], v[72:75]
v_exp_f32 v67, v67
v_mfma_f32_16x16x32_bf16 v[76:79], a[156:159], a[116:119], v[76:79]
ds_read_b64_tr_b16 a[218:219], v42 offset:20480
v_cvt_pk_bf16_f32 v96, v64, v65
v_mfma_f32_16x16x32_bf16 v[140:143], a[224:227], v[100:103], v[140:143]
v_exp_f32 v68, v68
v_mfma_f32_16x16x32_bf16 v[156:159], a[228:231], v[100:103], v[156:159]
ds_read_b64_tr_b16 a[220:221], v43 offset:16384
v_mfma_f32_16x16x32_bf16 v[172:175], a[232:235], v[100:103], v[172:175]
v_exp_f32 v69, v69
v_mfma_f32_16x16x32_bf16 v[188:191], a[236:239], v[100:103], v[188:191]
v_cvt_pk_bf16_f32 v97, v66, v67
v_mfma_f32_16x16x32_bf16 v[204:207], a[240:243], v[100:103], v[204:207]
ds_read_b64_tr_b16 a[222:223], v43 offset:20480
v_mfma_f32_16x16x32_bf16 v[220:223], a[244:247], v[100:103], v[220:223]
v_exp_f32 v70, v70
v_mfma_f32_16x16x32_bf16 v[236:239], a[248:251], v[100:103], v[236:239]
v_exp_f32 v71, v71
v_mfma_f32_16x16x32_bf16 v[252:255], a[252:255], v[100:103], v[252:255]
v_cvt_pk_bf16_f32 v98, v68, v69
v_cvt_pk_bf16_f32 v99, v70, v71
v_mfma_f32_16x16x32_bf16 a[12:15], a[16:19], v[100:103], a[12:15]
v_mfma_f32_16x16x32_bf16 v[64:67], a[128:131], a[72:75], v[112:115]
ds_read_b128 a[168:171], v34 offset:24576
v_mfma_f32_16x16x32_bf16 v[68:71], a[144:147], a[72:75], v[112:115]
ds_read_b128 a[184:187], v34 offset:28672
v_mfma_f32_16x16x32_bf16 v[64:67], a[132:135], a[88:91], v[64:67]
v_exp_f32 v72, v72
v_mfma_f32_16x16x32_bf16 v[68:71], a[148:151], a[88:91], v[68:71]
v_exp_f32 v73, v73
v_mfma_f32_16x16x32_bf16 v[64:67], a[136:139], a[104:107], v[64:67]
ds_read_b64_tr_b16 a[224:225], v36 offset:24576
v_mfma_f32_16x16x32_bf16 v[68:71], a[152:155], a[104:107], v[68:71]
v_exp_f32 v74, v74
v_mfma_f32_16x16x32_bf16 v[64:67], a[140:143], a[120:123], v[64:67]
v_exp_f32 v75, v75
v_mfma_f32_16x16x32_bf16 v[68:71], a[156:159], a[120:123], v[68:71]
ds_read_b64_tr_b16 a[226:227], v36 offset:28672
v_cvt_pk_bf16_f32 v100, v72, v73
s_waitcnt lgkmcnt(4)
v_mfma_f32_16x16x32_bf16 v[128:131], a[192:195], v[96:99], v[128:131]
v_exp_f32 v76, v76
v_mfma_f32_16x16x32_bf16 v[144:147], a[196:199], v[96:99], v[144:147]
ds_read_b64_tr_b16 a[228:229], v37 offset:24576
v_mfma_f32_16x16x32_bf16 v[160:163], a[200:203], v[96:99], v[160:163]
v_exp_f32 v77, v77
v_mfma_f32_16x16x32_bf16 v[176:179], a[204:207], v[96:99], v[176:179]
v_cvt_pk_bf16_f32 v101, v74, v75
v_mfma_f32_16x16x32_bf16 v[192:195], a[208:211], v[96:99], v[192:195]
ds_read_b64_tr_b16 a[230:231], v37 offset:28672
v_mfma_f32_16x16x32_bf16 v[208:211], a[212:215], v[96:99], v[208:211]
v_exp_f32 v78, v78
v_mfma_f32_16x16x32_bf16 v[224:227], a[216:219], v[96:99], v[224:227]
v_exp_f32 v79, v79
v_mfma_f32_16x16x32_bf16 v[240:243], a[220:223], v[96:99], v[240:243]
v_cvt_pk_bf16_f32 v102, v76, v77
v_cvt_pk_bf16_f32 v103, v78, v79
v_mfma_f32_16x16x32_bf16 a[0:3], a[16:19], v[96:99], a[0:3]
v_mfma_f32_16x16x32_bf16 v[72:75], a[128:131], a[76:79], v[116:119]
ds_read_b128 a[172:175], v35 offset:24576
v_mfma_f32_16x16x32_bf16 v[76:79], a[144:147], a[76:79], v[116:119]
ds_read_b128 a[188:191], v35 offset:28672
v_mfma_f32_16x16x32_bf16 v[72:75], a[132:135], a[92:95], v[72:75]
v_exp_f32 v64, v64
v_mfma_f32_16x16x32_bf16 v[76:79], a[148:151], a[92:95], v[76:79]
v_exp_f32 v65, v65
v_mfma_f32_16x16x32_bf16 v[72:75], a[136:139], a[108:111], v[72:75]
ds_read_b64_tr_b16 a[232:233], v38 offset:24576
v_mfma_f32_16x16x32_bf16 v[76:79], a[152:155], a[108:111], v[76:79]
v_exp_f32 v66, v66
v_mfma_f32_16x16x32_bf16 v[72:75], a[140:143], a[124:127], v[72:75]
v_exp_f32 v67, v67
v_mfma_f32_16x16x32_bf16 v[76:79], a[156:159], a[124:127], v[76:79]
ds_read_b64_tr_b16 a[234:235], v38 offset:28672
v_cvt_pk_bf16_f32 v96, v64, v65
v_mfma_f32_16x16x32_bf16 v[132:135], a[192:195], v[100:103], v[132:135]
v_exp_f32 v68, v68
v_mfma_f32_16x16x32_bf16 v[148:151], a[196:199], v[100:103], v[148:151]
ds_read_b64_tr_b16 a[236:237], v39 offset:24576
v_mfma_f32_16x16x32_bf16 v[164:167], a[200:203], v[100:103], v[164:167]
v_exp_f32 v69, v69
v_mfma_f32_16x16x32_bf16 v[180:183], a[204:207], v[100:103], v[180:183]
v_cvt_pk_bf16_f32 v97, v66, v67
v_mfma_f32_16x16x32_bf16 v[196:199], a[208:211], v[100:103], v[196:199]
ds_read_b64_tr_b16 a[238:239], v39 offset:28672
v_mfma_f32_16x16x32_bf16 v[212:215], a[212:215], v[100:103], v[212:215]
v_exp_f32 v70, v70
v_mfma_f32_16x16x32_bf16 v[228:231], a[216:219], v[100:103], v[228:231]
v_exp_f32 v71, v71
v_mfma_f32_16x16x32_bf16 v[244:247], a[220:223], v[100:103], v[244:247]
v_cvt_pk_bf16_f32 v98, v68, v69
v_cvt_pk_bf16_f32 v99, v70, v71
v_mfma_f32_16x16x32_bf16 a[4:7], a[16:19], v[100:103], a[4:7]
s_waitcnt vmcnt(9) lgkmcnt(4)
s_barrier
v_mfma_f32_16x16x32_bf16 v[64:67], a[160:163], a[64:67], v[104:107]
ds_read_b128 a[128:131], v32 offset:0
ds_read_b128 a[144:147], v32 offset:4096
v_mfma_f32_16x16x32_bf16 v[68:71], a[176:179], a[64:67], v[104:107]
ds_read_b64_tr_b16 a[240:241], v40 offset:24576
ds_read_b64_tr_b16 a[242:243], v40 offset:28672
v_mfma_f32_16x16x32_bf16 v[64:67], a[164:167], a[80:83], v[64:67]
ds_read_b64_tr_b16 a[244:245], v41 offset:24576
ds_read_b64_tr_b16 a[246:247], v41 offset:28672
v_mfma_f32_16x16x32_bf16 v[68:71], a[180:183], a[80:83], v[68:71]
s_add_u32 m0, s80, 90112
s_mov_b32 s61, 57344
v_mfma_f32_16x16x32_bf16 v[64:67], a[168:171], a[96:99], v[64:67]
buffer_load_dwordx4 v44, s[8:11], s61 offen lds
v_mfma_f32_16x16x32_bf16 v[68:71], a[184:187], a[96:99], v[68:71]
buffer_load_dwordx4 v45, s[8:11], s61 offen offset:1024 lds
v_mfma_f32_16x16x32_bf16 v[64:67], a[172:175], a[112:115], v[64:67]
s_add_u32 m0, s80, 114688
v_mfma_f32_16x16x32_bf16 v[68:71], a[188:191], a[112:115], v[68:71]
buffer_load_dwordx4 v46, s[12:15], s61 offen lds
v_mfma_f32_16x16x32_bf16 v[136:139], a[192:195], v[96:99], v[136:139]
buffer_load_dwordx4 v47, s[12:15], s61 offen offset:1024 lds
v_mfma_f32_16x16x32_bf16 v[152:155], a[196:199], v[96:99], v[152:155]
v_exp_f32 v72, v72
v_mfma_f32_16x16x32_bf16 v[168:171], a[200:203], v[96:99], v[168:171]
v_exp_f32 v73, v73
v_mfma_f32_16x16x32_bf16 v[184:187], a[204:207], v[96:99], v[184:187]
v_exp_f32 v74, v74
v_mfma_f32_16x16x32_bf16 v[200:203], a[208:211], v[96:99], v[200:203]
v_exp_f32 v75, v75
v_cvt_pk_bf16_f32 v100, v72, v73
v_mfma_f32_16x16x32_bf16 v[216:219], a[212:215], v[96:99], v[216:219]
v_exp_f32 v76, v76
v_mfma_f32_16x16x32_bf16 v[232:235], a[216:219], v[96:99], v[232:235]
v_exp_f32 v77, v77
v_cvt_pk_bf16_f32 v101, v74, v75
v_mfma_f32_16x16x32_bf16 v[248:251], a[220:223], v[96:99], v[248:251]
v_exp_f32 v78, v78
v_mfma_f32_16x16x32_bf16 a[8:11], a[16:19], v[96:99], a[8:11]
v_exp_f32 v79, v79
v_cvt_pk_bf16_f32 v102, v76, v77
v_cvt_pk_bf16_f32 v103, v78, v79
v_mfma_f32_16x16x32_bf16 v[72:75], a[160:163], a[68:71], v[108:111]
ds_read_b128 a[132:135], v33 offset:0
v_mfma_f32_16x16x32_bf16 v[76:79], a[176:179], a[68:71], v[108:111]
ds_read_b128 a[148:151], v33 offset:4096
v_mfma_f32_16x16x32_bf16 v[72:75], a[164:167], a[84:87], v[72:75]
v_exp_f32 v64, v64
v_mfma_f32_16x16x32_bf16 v[76:79], a[180:183], a[84:87], v[76:79]
v_exp_f32 v65, v65
v_mfma_f32_16x16x32_bf16 v[72:75], a[168:171], a[100:103], v[72:75]
ds_read_b64_tr_b16 a[248:249], v42 offset:24576
v_mfma_f32_16x16x32_bf16 v[76:79], a[184:187], a[100:103], v[76:79]
v_exp_f32 v66, v66
v_mfma_f32_16x16x32_bf16 v[72:75], a[172:175], a[116:119], v[72:75]
v_exp_f32 v67, v67
v_mfma_f32_16x16x32_bf16 v[76:79], a[188:191], a[116:119], v[76:79]
ds_read_b64_tr_b16 a[250:251], v42 offset:28672
v_cvt_pk_bf16_f32 v96, v64, v65
v_mfma_f32_16x16x32_bf16 v[140:143], a[192:195], v[100:103], v[140:143]
v_exp_f32 v68, v68
v_mfma_f32_16x16x32_bf16 v[156:159], a[196:199], v[100:103], v[156:159]
ds_read_b64_tr_b16 a[252:253], v43 offset:24576
v_mfma_f32_16x16x32_bf16 v[172:175], a[200:203], v[100:103], v[172:175]
v_exp_f32 v69, v69
v_mfma_f32_16x16x32_bf16 v[188:191], a[204:207], v[100:103], v[188:191]
v_cvt_pk_bf16_f32 v97, v66, v67
v_mfma_f32_16x16x32_bf16 v[204:207], a[208:211], v[100:103], v[204:207]
ds_read_b64_tr_b16 a[254:255], v43 offset:28672
v_mfma_f32_16x16x32_bf16 v[220:223], a[212:215], v[100:103], v[220:223]
v_exp_f32 v70, v70
v_mfma_f32_16x16x32_bf16 v[236:239], a[216:219], v[100:103], v[236:239]
v_exp_f32 v71, v71
v_mfma_f32_16x16x32_bf16 v[252:255], a[220:223], v[100:103], v[252:255]
v_cvt_pk_bf16_f32 v98, v68, v69
v_cvt_pk_bf16_f32 v99, v70, v71
v_mfma_f32_16x16x32_bf16 a[12:15], a[16:19], v[100:103], a[12:15]
v_mfma_f32_16x16x32_bf16 v[64:67], a[160:163], a[72:75], v[112:115]
ds_read_b128 a[136:139], v34 offset:0
ds_read_b128 a[152:155], v34 offset:4096
v_mfma_f32_16x16x32_bf16 v[68:71], a[176:179], a[72:75], v[112:115]
ds_read_b64_tr_b16 a[192:193], v36 offset:32768
ds_read_b64_tr_b16 a[194:195], v36 offset:36864
v_mfma_f32_16x16x32_bf16 v[64:67], a[164:167], a[88:91], v[64:67]
ds_read_b64_tr_b16 a[196:197], v37 offset:32768
ds_read_b64_tr_b16 a[198:199], v37 offset:36864
v_mfma_f32_16x16x32_bf16 v[68:71], a[180:183], a[88:91], v[68:71]
s_or_b32 s63, s56, s70
s_cmp_eq_u32 s63, 0
s_cselect_b32 s63, 0, 0x40000000
v_mfma_f32_16x16x32_bf16 v[64:67], a[168:171], a[104:107], v[64:67]
v_or_b32 v30, s63, v15
v_mov_b32 v31, 1
v_mfma_f32_16x16x32_bf16 v[68:71], a[184:187], a[104:107], v[68:71]
buffer_atomic_add v31, v30, s[52:55], 0 offen sc1
v_mfma_f32_16x16x32_bf16 v[64:67], a[172:175], a[120:123], v[64:67]
v_exp_f32 v72, v72
v_mfma_f32_16x16x32_bf16 v[68:71], a[188:191], a[120:123], v[68:71]
v_exp_f32 v73, v73
s_waitcnt lgkmcnt(6)
v_mfma_f32_16x16x32_bf16 v[128:131], a[224:227], v[96:99], v[128:131]
v_exp_f32 v74, v74
v_mfma_f32_16x16x32_bf16 v[144:147], a[228:231], v[96:99], v[144:147]
v_exp_f32 v75, v75
v_mfma_f32_16x16x32_bf16 v[160:163], a[232:235], v[96:99], v[160:163]
v_cvt_pk_bf16_f32 v100, v72, v73
v_mfma_f32_16x16x32_bf16 v[176:179], a[236:239], v[96:99], v[176:179]
v_exp_f32 v76, v76
v_mfma_f32_16x16x32_bf16 v[192:195], a[240:243], v[96:99], v[192:195]
v_exp_f32 v77, v77
v_mfma_f32_16x16x32_bf16 v[208:211], a[244:247], v[96:99], v[208:211]
v_cvt_pk_bf16_f32 v101, v74, v75
v_mfma_f32_16x16x32_bf16 v[224:227], a[248:251], v[96:99], v[224:227]
v_exp_f32 v78, v78
v_mfma_f32_16x16x32_bf16 v[240:243], a[252:255], v[96:99], v[240:243]
v_exp_f32 v79, v79
v_mfma_f32_16x16x32_bf16 a[0:3], a[16:19], v[96:99], a[0:3]
v_cvt_pk_bf16_f32 v102, v76, v77
v_cvt_pk_bf16_f32 v103, v78, v79
v_mfma_f32_16x16x32_bf16 v[72:75], a[160:163], a[76:79], v[116:119]
ds_read_b128 a[140:143], v35 offset:0
v_mfma_f32_16x16x32_bf16 v[76:79], a[176:179], a[76:79], v[116:119]
ds_read_b128 a[156:159], v35 offset:4096
v_mfma_f32_16x16x32_bf16 v[72:75], a[164:167], a[92:95], v[72:75]
v_exp_f32 v64, v64
v_mfma_f32_16x16x32_bf16 v[76:79], a[180:183], a[92:95], v[76:79]
v_exp_f32 v65, v65
v_mfma_f32_16x16x32_bf16 v[72:75], a[168:171], a[108:111], v[72:75]
ds_read_b64_tr_b16 a[200:201], v38 offset:32768
v_mfma_f32_16x16x32_bf16 v[76:79], a[184:187], a[108:111], v[76:79]
v_exp_f32 v66, v66
v_mfma_f32_16x16x32_bf16 v[72:75], a[172:175], a[124:127], v[72:75]
v_exp_f32 v67, v67
v_mfma_f32_16x16x32_bf16 v[76:79], a[188:191], a[124:127], v[76:79]
ds_read_b64_tr_b16 a[202:203], v38 offset:36864
v_cvt_pk_bf16_f32 v96, v64, v65
v_mfma_f32_16x16x32_bf16 v[132:135], a[224:227], v[100:103], v[132:135]
v_exp_f32 v68, v68
v_mfma_f32_16x16x32_bf16 v[148:151], a[228:231], v[100:103], v[148:151]
ds_read_b64_tr_b16 a[204:205], v39 offset:32768
v_mfma_f32_16x16x32_bf16 v[164:167], a[232:235], v[100:103], v[164:167]
v_exp_f32 v69, v69
v_mfma_f32_16x16x32_bf16 v[180:183], a[236:239], v[100:103], v[180:183]
v_cvt_pk_bf16_f32 v97, v66, v67
v_mfma_f32_16x16x32_bf16 v[196:199], a[240:243], v[100:103], v[196:199]
ds_read_b64_tr_b16 a[206:207], v39 offset:36864
v_mfma_f32_16x16x32_bf16 v[212:215], a[244:247], v[100:103], v[212:215]
v_exp_f32 v70, v70
v_mfma_f32_16x16x32_bf16 v[228:231], a[248:251], v[100:103], v[228:231]
v_exp_f32 v71, v71
v_mfma_f32_16x16x32_bf16 v[244:247], a[252:255], v[100:103], v[244:247]
v_cvt_pk_bf16_f32 v98, v68, v69
v_cvt_pk_bf16_f32 v99, v70, v71
v_mfma_f32_16x16x32_bf16 a[4:7], a[16:19], v[100:103], a[4:7]
s_waitcnt vmcnt(10) lgkmcnt(4)
s_barrier
v_mfma_f32_16x16x32_bf16 v[64:67], a[128:131], a[64:67], v[104:107]
ds_read_b128 a[160:163], v32 offset:8192
ds_read_b128 a[176:179], v32 offset:12288
v_mfma_f32_16x16x32_bf16 v[68:71], a[144:147], a[64:67], v[104:107]
ds_read_b64_tr_b16 a[208:209], v40 offset:32768
ds_read_b64_tr_b16 a[210:211], v40 offset:36864
v_mfma_f32_16x16x32_bf16 v[64:67], a[132:135], a[80:83], v[64:67]
ds_read_b64_tr_b16 a[212:213], v41 offset:32768
ds_read_b64_tr_b16 a[214:215], v41 offset:36864
v_mfma_f32_16x16x32_bf16 v[68:71], a[148:151], a[80:83], v[68:71]
s_add_u32 m0, s80, 65536
s_mov_b32 s61, 65536
v_mfma_f32_16x16x32_bf16 v[64:67], a[136:139], a[96:99], v[64:67]
buffer_load_dwordx4 v44, s[8:11], s61 offen lds
v_mfma_f32_16x16x32_bf16 v[68:71], a[152:155], a[96:99], v[68:71]
buffer_load_dwordx4 v45, s[8:11], s61 offen offset:1024 lds
v_mfma_f32_16x16x32_bf16 v[64:67], a[140:143], a[112:115], v[64:67]
s_add_u32 m0, s80, 122880
v_mfma_f32_16x16x32_bf16 v[68:71], a[156:159], a[112:115], v[68:71]
buffer_load_dwordx4 v46, s[12:15], s61 offen lds
v_mfma_f32_16x16x32_bf16 v[136:139], a[224:227], v[96:99], v[136:139]
buffer_load_dwordx4 v47, s[12:15], s61 offen offset:1024 lds
v_mfma_f32_16x16x32_bf16 v[152:155], a[228:231], v[96:99], v[152:155]
v_exp_f32 v72, v72
v_mfma_f32_16x16x32_bf16 v[168:171], a[232:235], v[96:99], v[168:171]
v_exp_f32 v73, v73
v_mfma_f32_16x16x32_bf16 v[184:187], a[236:239], v[96:99], v[184:187]
v_exp_f32 v74, v74
v_mfma_f32_16x16x32_bf16 v[200:203], a[240:243], v[96:99], v[200:203]
v_exp_f32 v75, v75
v_cvt_pk_bf16_f32 v100, v72, v73
v_mfma_f32_16x16x32_bf16 v[216:219], a[244:247], v[96:99], v[216:219]
v_exp_f32 v76, v76
v_mfma_f32_16x16x32_bf16 v[232:235], a[248:251], v[96:99], v[232:235]
v_exp_f32 v77, v77
v_cvt_pk_bf16_f32 v101, v74, v75
v_mfma_f32_16x16x32_bf16 v[248:251], a[252:255], v[96:99], v[248:251]
v_exp_f32 v78, v78
v_mfma_f32_16x16x32_bf16 a[8:11], a[16:19], v[96:99], a[8:11]
v_exp_f32 v79, v79
v_cvt_pk_bf16_f32 v102, v76, v77
v_cvt_pk_bf16_f32 v103, v78, v79
v_mfma_f32_16x16x32_bf16 v[72:75], a[128:131], a[68:71], v[108:111]
ds_read_b128 a[164:167], v33 offset:8192
v_mfma_f32_16x16x32_bf16 v[76:79], a[144:147], a[68:71], v[108:111]
ds_read_b128 a[180:183], v33 offset:12288
v_mfma_f32_16x16x32_bf16 v[72:75], a[132:135], a[84:87], v[72:75]
v_exp_f32 v64, v64
v_mfma_f32_16x16x32_bf16 v[76:79], a[148:151], a[84:87], v[76:79]
v_exp_f32 v65, v65
v_mfma_f32_16x16x32_bf16 v[72:75], a[136:139], a[100:103], v[72:75]
ds_read_b64_tr_b16 a[216:217], v42 offset:32768
v_mfma_f32_16x16x32_bf16 v[76:79], a[152:155], a[100:103], v[76:79]
v_exp_f32 v66, v66
v_mfma_f32_16x16x32_bf16 v[72:75], a[140:143], a[116:119], v[72:75]
v_exp_f32 v67, v67
v_mfma_f32_16x16x32_bf16 v[76:79], a[156:159], a[116:119], v[76:79]
ds_read_b64_tr_b16 a[218:219], v42 offset:36864
v_cvt_pk_bf16_f32 v96, v64, v65
v_mfma_f32_16x16x32_bf16 v[140:143], a[224:227], v[100:103], v[140:143]
v_exp_f32 v68, v68
v_mfma_f32_16x16x32_bf16 v[156:159], a[228:231], v[100:103], v[156:159]
ds_read_b64_tr_b16 a[220:221], v43 offset:32768
v_mfma_f32_16x16x32_bf16 v[172:175], a[232:235], v[100:103], v[172:175]
v_exp_f32 v69, v69
v_mfma_f32_16x16x32_bf16 v[188:191], a[236:239], v[100:103], v[188:191]
v_cvt_pk_bf16_f32 v97, v66, v67
v_mfma_f32_16x16x32_bf16 v[204:207], a[240:243], v[100:103], v[204:207]
ds_read_b64_tr_b16 a[222:223], v43 offset:36864
v_mfma_f32_16x16x32_bf16 v[220:223], a[244:247], v[100:103], v[220:223]
v_exp_f32 v70, v70
v_mfma_f32_16x16x32_bf16 v[236:239], a[248:251], v[100:103], v[236:239]
v_exp_f32 v71, v71
v_mfma_f32_16x16x32_bf16 v[252:255], a[252:255], v[100:103], v[252:255]
v_cvt_pk_bf16_f32 v98, v68, v69
v_cvt_pk_bf16_f32 v99, v70, v71
v_mfma_f32_16x16x32_bf16 a[12:15], a[16:19], v[100:103], a[12:15]
v_mfma_f32_16x16x32_bf16 v[64:67], a[128:131], a[72:75], v[112:115]
ds_read_b128 a[168:171], v34 offset:8192
v_mfma_f32_16x16x32_bf16 v[68:71], a[144:147], a[72:75], v[112:115]
ds_read_b128 a[184:187], v34 offset:12288
v_mfma_f32_16x16x32_bf16 v[64:67], a[132:135], a[88:91], v[64:67]
v_exp_f32 v72, v72
v_mfma_f32_16x16x32_bf16 v[68:71], a[148:151], a[88:91], v[68:71]
v_exp_f32 v73, v73
v_mfma_f32_16x16x32_bf16 v[64:67], a[136:139], a[104:107], v[64:67]
ds_read_b64_tr_b16 a[224:225], v36 offset:0
v_mfma_f32_16x16x32_bf16 v[68:71], a[152:155], a[104:107], v[68:71]
v_exp_f32 v74, v74
v_mfma_f32_16x16x32_bf16 v[64:67], a[140:143], a[120:123], v[64:67]
v_exp_f32 v75, v75
v_mfma_f32_16x16x32_bf16 v[68:71], a[156:159], a[120:123], v[68:71]
ds_read_b64_tr_b16 a[226:227], v36 offset:4096
v_cvt_pk_bf16_f32 v100, v72, v73
s_waitcnt lgkmcnt(4)
v_mfma_f32_16x16x32_bf16 v[128:131], a[192:195], v[96:99], v[128:131]
v_exp_f32 v76, v76
v_mfma_f32_16x16x32_bf16 v[144:147], a[196:199], v[96:99], v[144:147]
ds_read_b64_tr_b16 a[228:229], v37 offset:0
v_mfma_f32_16x16x32_bf16 v[160:163], a[200:203], v[96:99], v[160:163]
v_exp_f32 v77, v77
v_mfma_f32_16x16x32_bf16 v[176:179], a[204:207], v[96:99], v[176:179]
v_cvt_pk_bf16_f32 v101, v74, v75
v_mfma_f32_16x16x32_bf16 v[192:195], a[208:211], v[96:99], v[192:195]
ds_read_b64_tr_b16 a[230:231], v37 offset:4096
v_mfma_f32_16x16x32_bf16 v[208:211], a[212:215], v[96:99], v[208:211]
v_exp_f32 v78, v78
v_mfma_f32_16x16x32_bf16 v[224:227], a[216:219], v[96:99], v[224:227]
v_exp_f32 v79, v79
v_mfma_f32_16x16x32_bf16 v[240:243], a[220:223], v[96:99], v[240:243]
v_cvt_pk_bf16_f32 v102, v76, v77
v_cvt_pk_bf16_f32 v103, v78, v79
v_mfma_f32_16x16x32_bf16 a[0:3], a[16:19], v[96:99], a[0:3]
v_mfma_f32_16x16x32_bf16 v[72:75], a[128:131], a[76:79], v[116:119]
ds_read_b128 a[172:175], v35 offset:8192
v_mfma_f32_16x16x32_bf16 v[76:79], a[144:147], a[76:79], v[116:119]
ds_read_b128 a[188:191], v35 offset:12288
v_mfma_f32_16x16x32_bf16 v[72:75], a[132:135], a[92:95], v[72:75]
v_exp_f32 v64, v64
v_mfma_f32_16x16x32_bf16 v[76:79], a[148:151], a[92:95], v[76:79]
v_exp_f32 v65, v65
v_mfma_f32_16x16x32_bf16 v[72:75], a[136:139], a[108:111], v[72:75]
ds_read_b64_tr_b16 a[232:233], v38 offset:0
v_mfma_f32_16x16x32_bf16 v[76:79], a[152:155], a[108:111], v[76:79]
v_exp_f32 v66, v66
v_mfma_f32_16x16x32_bf16 v[72:75], a[140:143], a[124:127], v[72:75]
v_exp_f32 v67, v67
v_mfma_f32_16x16x32_bf16 v[76:79], a[156:159], a[124:127], v[76:79]
ds_read_b64_tr_b16 a[234:235], v38 offset:4096
v_cvt_pk_bf16_f32 v96, v64, v65
v_mfma_f32_16x16x32_bf16 v[132:135], a[192:195], v[100:103], v[132:135]
v_exp_f32 v68, v68
v_mfma_f32_16x16x32_bf16 v[148:151], a[196:199], v[100:103], v[148:151]
ds_read_b64_tr_b16 a[236:237], v39 offset:0
v_mfma_f32_16x16x32_bf16 v[164:167], a[200:203], v[100:103], v[164:167]
v_exp_f32 v69, v69
v_mfma_f32_16x16x32_bf16 v[180:183], a[204:207], v[100:103], v[180:183]
v_cvt_pk_bf16_f32 v97, v66, v67
v_mfma_f32_16x16x32_bf16 v[196:199], a[208:211], v[100:103], v[196:199]
ds_read_b64_tr_b16 a[238:239], v39 offset:4096
v_mfma_f32_16x16x32_bf16 v[212:215], a[212:215], v[100:103], v[212:215]
v_exp_f32 v70, v70
v_mfma_f32_16x16x32_bf16 v[228:231], a[216:219], v[100:103], v[228:231]
v_exp_f32 v71, v71
v_mfma_f32_16x16x32_bf16 v[244:247], a[220:223], v[100:103], v[244:247]
v_cvt_pk_bf16_f32 v98, v68, v69
v_cvt_pk_bf16_f32 v99, v70, v71
v_mfma_f32_16x16x32_bf16 a[4:7], a[16:19], v[100:103], a[4:7]
s_waitcnt vmcnt(9) lgkmcnt(4)
s_barrier
v_mfma_f32_16x16x32_bf16 v[64:67], a[160:163], a[64:67], v[104:107]
ds_read_b128 a[128:131], v32 offset:16384
ds_read_b128 a[144:147], v32 offset:20480
v_mfma_f32_16x16x32_bf16 v[68:71], a[176:179], a[64:67], v[104:107]
ds_read_b64_tr_b16 a[240:241], v40 offset:0
ds_read_b64_tr_b16 a[242:243], v40 offset:4096
v_mfma_f32_16x16x32_bf16 v[64:67], a[164:167], a[80:83], v[64:67]
ds_read_b64_tr_b16 a[244:245], v41 offset:0
ds_read_b64_tr_b16 a[246:247], v41 offset:4096
v_mfma_f32_16x16x32_bf16 v[68:71], a[180:183], a[80:83], v[68:71]
s_add_u32 m0, s80, 73728
s_mov_b32 s61, 73728
v_mfma_f32_16x16x32_bf16 v[64:67], a[168:171], a[96:99], v[64:67]
buffer_load_dwordx4 v44, s[8:11], s61 offen lds
v_mfma_f32_16x16x32_bf16 v[68:71], a[184:187], a[96:99], v[68:71]
buffer_load_dwordx4 v45, s[8:11], s61 offen offset:1024 lds
v_mfma_f32_16x16x32_bf16 v[64:67], a[172:175], a[112:115], v[64:67]
s_add_u32 m0, s80, 131072
v_mfma_f32_16x16x32_bf16 v[68:71], a[188:191], a[112:115], v[68:71]
buffer_load_dwordx4 v46, s[12:15], s61 offen lds
v_mfma_f32_16x16x32_bf16 v[136:139], a[192:195], v[96:99], v[136:139]
buffer_load_dwordx4 v47, s[12:15], s61 offen offset:1024 lds
v_mfma_f32_16x16x32_bf16 v[152:155], a[196:199], v[96:99], v[152:155]
v_exp_f32 v72, v72
v_mfma_f32_16x16x32_bf16 v[168:171], a[200:203], v[96:99], v[168:171]
v_exp_f32 v73, v73
v_mfma_f32_16x16x32_bf16 v[184:187], a[204:207], v[96:99], v[184:187]
v_exp_f32 v74, v74
v_mfma_f32_16x16x32_bf16 v[200:203], a[208:211], v[96:99], v[200:203]
v_exp_f32 v75, v75
v_cvt_pk_bf16_f32 v100, v72, v73
v_mfma_f32_16x16x32_bf16 v[216:219], a[212:215], v[96:99], v[216:219]
v_exp_f32 v76, v76
v_mfma_f32_16x16x32_bf16 v[232:235], a[216:219], v[96:99], v[232:235]
v_exp_f32 v77, v77
v_cvt_pk_bf16_f32 v101, v74, v75
v_mfma_f32_16x16x32_bf16 v[248:251], a[220:223], v[96:99], v[248:251]
v_exp_f32 v78, v78
v_mfma_f32_16x16x32_bf16 a[8:11], a[16:19], v[96:99], a[8:11]
v_exp_f32 v79, v79
v_cvt_pk_bf16_f32 v102, v76, v77
v_cvt_pk_bf16_f32 v103, v78, v79
v_mfma_f32_16x16x32_bf16 v[72:75], a[160:163], a[68:71], v[108:111]
ds_read_b128 a[132:135], v33 offset:16384
v_mfma_f32_16x16x32_bf16 v[76:79], a[176:179], a[68:71], v[108:111]
ds_read_b128 a[148:151], v33 offset:20480
v_mfma_f32_16x16x32_bf16 v[72:75], a[164:167], a[84:87], v[72:75]
v_exp_f32 v64, v64
v_mfma_f32_16x16x32_bf16 v[76:79], a[180:183], a[84:87], v[76:79]
v_exp_f32 v65, v65
v_mfma_f32_16x16x32_bf16 v[72:75], a[168:171], a[100:103], v[72:75]
ds_read_b64_tr_b16 a[248:249], v42 offset:0
v_mfma_f32_16x16x32_bf16 v[76:79], a[184:187], a[100:103], v[76:79]
v_exp_f32 v66, v66
v_mfma_f32_16x16x32_bf16 v[72:75], a[172:175], a[116:119], v[72:75]
v_exp_f32 v67, v67
v_mfma_f32_16x16x32_bf16 v[76:79], a[188:191], a[116:119], v[76:79]
ds_read_b64_tr_b16 a[250:251], v42 offset:4096
v_cvt_pk_bf16_f32 v96, v64, v65
v_mfma_f32_16x16x32_bf16 v[140:143], a[192:195], v[100:103], v[140:143]
v_exp_f32 v68, v68
v_mfma_f32_16x16x32_bf16 v[156:159], a[196:199], v[100:103], v[156:159]
ds_read_b64_tr_b16 a[252:253], v43 offset:0
v_mfma_f32_16x16x32_bf16 v[172:175], a[200:203], v[100:103], v[172:175]
v_exp_f32 v69, v69
v_mfma_f32_16x16x32_bf16 v[188:191], a[204:207], v[100:103], v[188:191]
v_cvt_pk_bf16_f32 v97, v66, v67
v_mfma_f32_16x16x32_bf16 v[204:207], a[208:211], v[100:103], v[204:207]
ds_read_b64_tr_b16 a[254:255], v43 offset:4096
v_mfma_f32_16x16x32_bf16 v[220:223], a[212:215], v[100:103], v[220:223]
v_exp_f32 v70, v70
v_mfma_f32_16x16x32_bf16 v[236:239], a[216:219], v[100:103], v[236:239]
v_exp_f32 v71, v71
v_mfma_f32_16x16x32_bf16 v[252:255], a[220:223], v[100:103], v[252:255]
v_cvt_pk_bf16_f32 v98, v68, v69
v_cvt_pk_bf16_f32 v99, v70, v71
v_mfma_f32_16x16x32_bf16 a[12:15], a[16:19], v[100:103], a[12:15]
v_mfma_f32_16x16x32_bf16 v[64:67], a[160:163], a[72:75], v[112:115]
ds_read_b128 a[136:139], v34 offset:16384
v_mfma_f32_16x16x32_bf16 v[68:71], a[176:179], a[72:75], v[112:115]
ds_read_b128 a[152:155], v34 offset:20480
v_mfma_f32_16x16x32_bf16 v[64:67], a[164:167], a[88:91], v[64:67]
v_exp_f32 v72, v72
v_mfma_f32_16x16x32_bf16 v[68:71], a[180:183], a[88:91], v[68:71]
v_exp_f32 v73, v73
v_mfma_f32_16x16x32_bf16 v[64:67], a[168:171], a[104:107], v[64:67]
ds_read_b64_tr_b16 a[192:193], v36 offset:8192
v_mfma_f32_16x16x32_bf16 v[68:71], a[184:187], a[104:107], v[68:71]
v_exp_f32 v74, v74
v_mfma_f32_16x16x32_bf16 v[64:67], a[172:175], a[120:123], v[64:67]
v_exp_f32 v75, v75
v_mfma_f32_16x16x32_bf16 v[68:71], a[188:191], a[120:123], v[68:71]
ds_read_b64_tr_b16 a[194:195], v36 offset:12288
v_cvt_pk_bf16_f32 v100, v72, v73
s_waitcnt lgkmcnt(4)
v_mfma_f32_16x16x32_bf16 v[128:131], a[224:227], v[96:99], v[128:131]
v_exp_f32 v76, v76
v_mfma_f32_16x16x32_bf16 v[144:147], a[228:231], v[96:99], v[144:147]
ds_read_b64_tr_b16 a[196:197], v37 offset:8192
v_mfma_f32_16x16x32_bf16 v[160:163], a[232:235], v[96:99], v[160:163]
v_exp_f32 v77, v77
v_mfma_f32_16x16x32_bf16 v[176:179], a[236:239], v[96:99], v[176:179]
v_cvt_pk_bf16_f32 v101, v74, v75
v_mfma_f32_16x16x32_bf16 v[192:195], a[240:243], v[96:99], v[192:195]
ds_read_b64_tr_b16 a[198:199], v37 offset:12288
v_mfma_f32_16x16x32_bf16 v[208:211], a[244:247], v[96:99], v[208:211]
v_exp_f32 v78, v78
v_mfma_f32_16x16x32_bf16 v[224:227], a[248:251], v[96:99], v[224:227]
v_exp_f32 v79, v79
v_mfma_f32_16x16x32_bf16 v[240:243], a[252:255], v[96:99], v[240:243]
v_cvt_pk_bf16_f32 v102, v76, v77
v_cvt_pk_bf16_f32 v103, v78, v79
v_mfma_f32_16x16x32_bf16 a[0:3], a[16:19], v[96:99], a[0:3]
v_mfma_f32_16x16x32_bf16 v[72:75], a[160:163], a[76:79], v[116:119]
ds_read_b128 a[140:143], v35 offset:16384
v_mfma_f32_16x16x32_bf16 v[76:79], a[176:179], a[76:79], v[116:119]
ds_read_b128 a[156:159], v35 offset:20480
v_mfma_f32_16x16x32_bf16 v[72:75], a[164:167], a[92:95], v[72:75]
v_exp_f32 v64, v64
v_mfma_f32_16x16x32_bf16 v[76:79], a[180:183], a[92:95], v[76:79]
v_exp_f32 v65, v65
v_mfma_f32_16x16x32_bf16 v[72:75], a[168:171], a[108:111], v[72:75]
ds_read_b64_tr_b16 a[200:201], v38 offset:8192
v_mfma_f32_16x16x32_bf16 v[76:79], a[184:187], a[108:111], v[76:79]
v_exp_f32 v66, v66
v_mfma_f32_16x16x32_bf16 v[72:75], a[172:175], a[124:127], v[72:75]
v_exp_f32 v67, v67
v_mfma_f32_16x16x32_bf16 v[76:79], a[188:191], a[124:127], v[76:79]
ds_read_b64_tr_b16 a[202:203], v38 offset:12288
v_cvt_pk_bf16_f32 v96, v64, v65
v_mfma_f32_16x16x32_bf16 v[132:135], a[224:227], v[100:103], v[132:135]
v_exp_f32 v68, v68
v_mfma_f32_16x16x32_bf16 v[148:151], a[228:231], v[100:103], v[148:151]
ds_read_b64_tr_b16 a[204:205], v39 offset:8192
v_mfma_f32_16x16x32_bf16 v[164:167], a[232:235], v[100:103], v[164:167]
v_exp_f32 v69, v69
v_mfma_f32_16x16x32_bf16 v[180:183], a[236:239], v[100:103], v[180:183]
v_cvt_pk_bf16_f32 v97, v66, v67
v_mfma_f32_16x16x32_bf16 v[196:199], a[240:243], v[100:103], v[196:199]
ds_read_b64_tr_b16 a[206:207], v39 offset:12288
v_mfma_f32_16x16x32_bf16 v[212:215], a[244:247], v[100:103], v[212:215]
v_exp_f32 v70, v70
v_mfma_f32_16x16x32_bf16 v[228:231], a[248:251], v[100:103], v[228:231]
v_exp_f32 v71, v71
v_mfma_f32_16x16x32_bf16 v[244:247], a[252:255], v[100:103], v[244:247]
v_cvt_pk_bf16_f32 v98, v68, v69
v_cvt_pk_bf16_f32 v99, v70, v71
v_mfma_f32_16x16x32_bf16 a[4:7], a[16:19], v[100:103], a[4:7]
s_waitcnt vmcnt(9) lgkmcnt(4)
s_barrier
v_mfma_f32_16x16x32_bf16 v[64:67], a[128:131], a[64:67], v[104:107]
ds_read_b128 a[160:163], v32 offset:24576
ds_read_b128 a[176:179], v32 offset:28672
v_mfma_f32_16x16x32_bf16 v[68:71], a[144:147], a[64:67], v[104:107]
ds_read_b64_tr_b16 a[208:209], v40 offset:8192
ds_read_b64_tr_b16 a[210:211], v40 offset:12288
v_mfma_f32_16x16x32_bf16 v[64:67], a[132:135], a[80:83], v[64:67]
ds_read_b64_tr_b16 a[212:213], v41 offset:8192
ds_read_b64_tr_b16 a[214:215], v41 offset:12288
v_mfma_f32_16x16x32_bf16 v[68:71], a[148:151], a[80:83], v[68:71]
s_add_u32 m0, s80, 81920
s_mov_b32 s61, 81920
v_mfma_f32_16x16x32_bf16 v[64:67], a[136:139], a[96:99], v[64:67]
buffer_load_dwordx4 v44, s[8:11], s61 offen lds
v_mfma_f32_16x16x32_bf16 v[68:71], a[152:155], a[96:99], v[68:71]
buffer_load_dwordx4 v45, s[8:11], s61 offen offset:1024 lds
v_mfma_f32_16x16x32_bf16 v[64:67], a[140:143], a[112:115], v[64:67]
s_add_u32 m0, s80, 98304
v_mfma_f32_16x16x32_bf16 v[68:71], a[156:159], a[112:115], v[68:71]
buffer_load_dwordx4 v46, s[12:15], s61 offen lds
v_mfma_f32_16x16x32_bf16 v[136:139], a[224:227], v[96:99], v[136:139]
buffer_load_dwordx4 v47, s[12:15], s61 offen offset:1024 lds
v_mfma_f32_16x16x32_bf16 v[152:155], a[228:231], v[96:99], v[152:155]
v_exp_f32 v72, v72
v_mfma_f32_16x16x32_bf16 v[168:171], a[232:235], v[96:99], v[168:171]
v_exp_f32 v73, v73
v_mfma_f32_16x16x32_bf16 v[184:187], a[236:239], v[96:99], v[184:187]
v_exp_f32 v74, v74
v_mfma_f32_16x16x32_bf16 v[200:203], a[240:243], v[96:99], v[200:203]
v_exp_f32 v75, v75
v_cvt_pk_bf16_f32 v100, v72, v73
v_mfma_f32_16x16x32_bf16 v[216:219], a[244:247], v[96:99], v[216:219]
v_exp_f32 v76, v76
v_mfma_f32_16x16x32_bf16 v[232:235], a[248:251], v[96:99], v[232:235]
v_exp_f32 v77, v77
v_cvt_pk_bf16_f32 v101, v74, v75
v_mfma_f32_16x16x32_bf16 v[248:251], a[252:255], v[96:99], v[248:251]
v_exp_f32 v78, v78
v_mfma_f32_16x16x32_bf16 a[8:11], a[16:19], v[96:99], a[8:11]
v_exp_f32 v79, v79
v_cvt_pk_bf16_f32 v102, v76, v77
v_cvt_pk_bf16_f32 v103, v78, v79
v_mfma_f32_16x16x32_bf16 v[72:75], a[128:131], a[68:71], v[108:111]
ds_read_b128 a[164:167], v33 offset:24576
v_mfma_f32_16x16x32_bf16 v[76:79], a[144:147], a[68:71], v[108:111]
ds_read_b128 a[180:183], v33 offset:28672
v_mfma_f32_16x16x32_bf16 v[72:75], a[132:135], a[84:87], v[72:75]
v_exp_f32 v64, v64
v_mfma_f32_16x16x32_bf16 v[76:79], a[148:151], a[84:87], v[76:79]
v_exp_f32 v65, v65
v_mfma_f32_16x16x32_bf16 v[72:75], a[136:139], a[100:103], v[72:75]
ds_read_b64_tr_b16 a[216:217], v42 offset:8192
v_mfma_f32_16x16x32_bf16 v[76:79], a[152:155], a[100:103], v[76:79]
v_exp_f32 v66, v66
v_mfma_f32_16x16x32_bf16 v[72:75], a[140:143], a[116:119], v[72:75]
v_exp_f32 v67, v67
v_mfma_f32_16x16x32_bf16 v[76:79], a[156:159], a[116:119], v[76:79]
ds_read_b64_tr_b16 a[218:219], v42 offset:12288
v_cvt_pk_bf16_f32 v96, v64, v65
v_mfma_f32_16x16x32_bf16 v[140:143], a[224:227], v[100:103], v[140:143]
v_exp_f32 v68, v68
v_mfma_f32_16x16x32_bf16 v[156:159], a[228:231], v[100:103], v[156:159]
ds_read_b64_tr_b16 a[220:221], v43 offset:8192
v_mfma_f32_16x16x32_bf16 v[172:175], a[232:235], v[100:103], v[172:175]
v_exp_f32 v69, v69
v_mfma_f32_16x16x32_bf16 v[188:191], a[236:239], v[100:103], v[188:191]
v_cvt_pk_bf16_f32 v97, v66, v67
v_mfma_f32_16x16x32_bf16 v[204:207], a[240:243], v[100:103], v[204:207]
ds_read_b64_tr_b16 a[222:223], v43 offset:12288
v_mfma_f32_16x16x32_bf16 v[220:223], a[244:247], v[100:103], v[220:223]
v_exp_f32 v70, v70
v_mfma_f32_16x16x32_bf16 v[236:239], a[248:251], v[100:103], v[236:239]
v_exp_f32 v71, v71
v_mfma_f32_16x16x32_bf16 v[252:255], a[252:255], v[100:103], v[252:255]
v_cvt_pk_bf16_f32 v98, v68, v69
v_cvt_pk_bf16_f32 v99, v70, v71
v_mfma_f32_16x16x32_bf16 a[12:15], a[16:19], v[100:103], a[12:15]
v_mfma_f32_16x16x32_bf16 v[64:67], a[128:131], a[72:75], v[112:115]
ds_read_b128 a[168:171], v34 offset:24576
v_mfma_f32_16x16x32_bf16 v[68:71], a[144:147], a[72:75], v[112:115]
ds_read_b128 a[184:187], v34 offset:28672
v_mfma_f32_16x16x32_bf16 v[64:67], a[132:135], a[88:91], v[64:67]
v_exp_f32 v72, v72
v_mfma_f32_16x16x32_bf16 v[68:71], a[148:151], a[88:91], v[68:71]
v_exp_f32 v73, v73
v_mfma_f32_16x16x32_bf16 v[64:67], a[136:139], a[104:107], v[64:67]
ds_read_b64_tr_b16 a[224:225], v36 offset:16384
v_mfma_f32_16x16x32_bf16 v[68:71], a[152:155], a[104:107], v[68:71]
v_exp_f32 v74, v74
v_mfma_f32_16x16x32_bf16 v[64:67], a[140:143], a[120:123], v[64:67]
v_exp_f32 v75, v75
v_mfma_f32_16x16x32_bf16 v[68:71], a[156:159], a[120:123], v[68:71]
ds_read_b64_tr_b16 a[226:227], v36 offset:20480
v_cvt_pk_bf16_f32 v100, v72, v73
s_waitcnt lgkmcnt(4)
v_mfma_f32_16x16x32_bf16 v[128:131], a[192:195], v[96:99], v[128:131]
v_exp_f32 v76, v76
v_mfma_f32_16x16x32_bf16 v[144:147], a[196:199], v[96:99], v[144:147]
ds_read_b64_tr_b16 a[228:229], v37 offset:16384
v_mfma_f32_16x16x32_bf16 v[160:163], a[200:203], v[96:99], v[160:163]
v_exp_f32 v77, v77
v_mfma_f32_16x16x32_bf16 v[176:179], a[204:207], v[96:99], v[176:179]
v_cvt_pk_bf16_f32 v101, v74, v75
v_mfma_f32_16x16x32_bf16 v[192:195], a[208:211], v[96:99], v[192:195]
ds_read_b64_tr_b16 a[230:231], v37 offset:20480
v_mfma_f32_16x16x32_bf16 v[208:211], a[212:215], v[96:99], v[208:211]
v_exp_f32 v78, v78
v_mfma_f32_16x16x32_bf16 v[224:227], a[216:219], v[96:99], v[224:227]
v_exp_f32 v79, v79
v_mfma_f32_16x16x32_bf16 v[240:243], a[220:223], v[96:99], v[240:243]
v_cvt_pk_bf16_f32 v102, v76, v77
v_cvt_pk_bf16_f32 v103, v78, v79
v_mfma_f32_16x16x32_bf16 a[0:3], a[16:19], v[96:99], a[0:3]
v_mfma_f32_16x16x32_bf16 v[72:75], a[128:131], a[76:79], v[116:119]
ds_read_b128 a[172:175], v35 offset:24576
v_mfma_f32_16x16x32_bf16 v[76:79], a[144:147], a[76:79], v[116:119]
ds_read_b128 a[188:191], v35 offset:28672
v_mfma_f32_16x16x32_bf16 v[72:75], a[132:135], a[92:95], v[72:75]
v_exp_f32 v64, v64
v_mfma_f32_16x16x32_bf16 v[76:79], a[148:151], a[92:95], v[76:79]
v_exp_f32 v65, v65
v_mfma_f32_16x16x32_bf16 v[72:75], a[136:139], a[108:111], v[72:75]
ds_read_b64_tr_b16 a[232:233], v38 offset:16384
v_mfma_f32_16x16x32_bf16 v[76:79], a[152:155], a[108:111], v[76:79]
v_exp_f32 v66, v66
v_mfma_f32_16x16x32_bf16 v[72:75], a[140:143], a[124:127], v[72:75]
v_exp_f32 v67, v67
v_mfma_f32_16x16x32_bf16 v[76:79], a[156:159], a[124:127], v[76:79]
ds_read_b64_tr_b16 a[234:235], v38 offset:20480
v_cvt_pk_bf16_f32 v96, v64, v65
v_mfma_f32_16x16x32_bf16 v[132:135], a[192:195], v[100:103], v[132:135]
v_exp_f32 v68, v68
v_mfma_f32_16x16x32_bf16 v[148:151], a[196:199], v[100:103], v[148:151]
ds_read_b64_tr_b16 a[236:237], v39 offset:16384
v_mfma_f32_16x16x32_bf16 v[164:167], a[200:203], v[100:103], v[164:167]
v_exp_f32 v69, v69
v_mfma_f32_16x16x32_bf16 v[180:183], a[204:207], v[100:103], v[180:183]
v_cvt_pk_bf16_f32 v97, v66, v67
v_mfma_f32_16x16x32_bf16 v[196:199], a[208:211], v[100:103], v[196:199]
ds_read_b64_tr_b16 a[238:239], v39 offset:20480
v_mfma_f32_16x16x32_bf16 v[212:215], a[212:215], v[100:103], v[212:215]
v_exp_f32 v70, v70
v_mfma_f32_16x16x32_bf16 v[228:231], a[216:219], v[100:103], v[228:231]
v_exp_f32 v71, v71
v_mfma_f32_16x16x32_bf16 v[244:247], a[220:223], v[100:103], v[244:247]
v_cvt_pk_bf16_f32 v98, v68, v69
v_cvt_pk_bf16_f32 v99, v70, v71
v_mfma_f32_16x16x32_bf16 a[4:7], a[16:19], v[100:103], a[4:7]
s_waitcnt vmcnt(8) lgkmcnt(4)
s_barrier
v_mfma_f32_16x16x32_bf16 v[64:67], a[160:163], a[64:67], v[104:107]
ds_read_b128 a[128:131], v32 offset:0
ds_read_b128 a[144:147], v32 offset:4096
v_mfma_f32_16x16x32_bf16 v[68:71], a[176:179], a[64:67], v[104:107]
ds_read_b64_tr_b16 a[240:241], v40 offset:16384
ds_read_b64_tr_b16 a[242:243], v40 offset:20480
v_mfma_f32_16x16x32_bf16 v[64:67], a[164:167], a[80:83], v[64:67]
ds_read_b64_tr_b16 a[244:245], v41 offset:16384
ds_read_b64_tr_b16 a[246:247], v41 offset:20480
v_mfma_f32_16x16x32_bf16 v[68:71], a[180:183], a[80:83], v[68:71]
s_add_u32 m0, s80, 90112
s_mov_b32 s61, 90112
v_mfma_f32_16x16x32_bf16 v[64:67], a[168:171], a[96:99], v[64:67]
buffer_load_dwordx4 v44, s[8:11], s61 offen lds
v_mfma_f32_16x16x32_bf16 v[68:71], a[184:187], a[96:99], v[68:71]
buffer_load_dwordx4 v45, s[8:11], s61 offen offset:1024 lds
v_mfma_f32_16x16x32_bf16 v[64:67], a[172:175], a[112:115], v[64:67]
s_add_u32 m0, s80, 106496
v_mfma_f32_16x16x32_bf16 v[68:71], a[188:191], a[112:115], v[68:71]
buffer_load_dwordx4 v46, s[12:15], s61 offen lds
v_mfma_f32_16x16x32_bf16 v[136:139], a[192:195], v[96:99], v[136:139]
buffer_load_dwordx4 v47, s[12:15], s61 offen offset:1024 lds
v_mfma_f32_16x16x32_bf16 v[152:155], a[196:199], v[96:99], v[152:155]
v_exp_f32 v72, v72
v_mfma_f32_16x16x32_bf16 v[168:171], a[200:203], v[96:99], v[168:171]
v_exp_f32 v73, v73
v_mfma_f32_16x16x32_bf16 v[184:187], a[204:207], v[96:99], v[184:187]
v_exp_f32 v74, v74
v_mfma_f32_16x16x32_bf16 v[200:203], a[208:211], v[96:99], v[200:203]
v_exp_f32 v75, v75
v_cvt_pk_bf16_f32 v100, v72, v73
v_mfma_f32_16x16x32_bf16 v[216:219], a[212:215], v[96:99], v[216:219]
v_exp_f32 v76, v76
v_mfma_f32_16x16x32_bf16 v[232:235], a[216:219], v[96:99], v[232:235]
v_exp_f32 v77, v77
v_cvt_pk_bf16_f32 v101, v74, v75
v_mfma_f32_16x16x32_bf16 v[248:251], a[220:223], v[96:99], v[248:251]
v_exp_f32 v78, v78
v_mfma_f32_16x16x32_bf16 a[8:11], a[16:19], v[96:99], a[8:11]
v_exp_f32 v79, v79
v_cvt_pk_bf16_f32 v102, v76, v77
v_cvt_pk_bf16_f32 v103, v78, v79
v_mfma_f32_16x16x32_bf16 v[72:75], a[160:163], a[68:71], v[108:111]
ds_read_b128 a[132:135], v33 offset:0
v_mfma_f32_16x16x32_bf16 v[76:79], a[176:179], a[68:71], v[108:111]
ds_read_b128 a[148:151], v33 offset:4096
v_mfma_f32_16x16x32_bf16 v[72:75], a[164:167], a[84:87], v[72:75]
v_exp_f32 v64, v64
v_mfma_f32_16x16x32_bf16 v[76:79], a[180:183], a[84:87], v[76:79]
v_exp_f32 v65, v65
v_mfma_f32_16x16x32_bf16 v[72:75], a[168:171], a[100:103], v[72:75]
ds_read_b64_tr_b16 a[248:249], v42 offset:16384
v_mfma_f32_16x16x32_bf16 v[76:79], a[184:187], a[100:103], v[76:79]
v_exp_f32 v66, v66
v_mfma_f32_16x16x32_bf16 v[72:75], a[172:175], a[116:119], v[72:75]
v_exp_f32 v67, v67
v_mfma_f32_16x16x32_bf16 v[76:79], a[188:191], a[116:119], v[76:79]
ds_read_b64_tr_b16 a[250:251], v42 offset:20480
v_cvt_pk_bf16_f32 v96, v64, v65
v_mfma_f32_16x16x32_bf16 v[140:143], a[192:195], v[100:103], v[140:143]
v_exp_f32 v68, v68
v_mfma_f32_16x16x32_bf16 v[156:159], a[196:199], v[100:103], v[156:159]
ds_read_b64_tr_b16 a[252:253], v43 offset:16384
v_mfma_f32_16x16x32_bf16 v[172:175], a[200:203], v[100:103], v[172:175]
v_exp_f32 v69, v69
v_mfma_f32_16x16x32_bf16 v[188:191], a[204:207], v[100:103], v[188:191]
v_cvt_pk_bf16_f32 v97, v66, v67
v_mfma_f32_16x16x32_bf16 v[204:207], a[208:211], v[100:103], v[204:207]
ds_read_b64_tr_b16 a[254:255], v43 offset:20480
v_mfma_f32_16x16x32_bf16 v[220:223], a[212:215], v[100:103], v[220:223]
v_exp_f32 v70, v70
v_mfma_f32_16x16x32_bf16 v[236:239], a[216:219], v[100:103], v[236:239]
v_exp_f32 v71, v71
v_mfma_f32_16x16x32_bf16 v[252:255], a[220:223], v[100:103], v[252:255]
v_cvt_pk_bf16_f32 v98, v68, v69
v_cvt_pk_bf16_f32 v99, v70, v71
v_mfma_f32_16x16x32_bf16 a[12:15], a[16:19], v[100:103], a[12:15]
v_mfma_f32_16x16x32_bf16 v[64:67], a[160:163], a[72:75], v[112:115]
ds_read_b128 a[136:139], v34 offset:0
v_mfma_f32_16x16x32_bf16 v[68:71], a[176:179], a[72:75], v[112:115]
ds_read_b128 a[152:155], v34 offset:4096
v_mfma_f32_16x16x32_bf16 v[64:67], a[164:167], a[88:91], v[64:67]
v_exp_f32 v72, v72
v_mfma_f32_16x16x32_bf16 v[68:71], a[180:183], a[88:91], v[68:71]
v_exp_f32 v73, v73
v_mfma_f32_16x16x32_bf16 v[64:67], a[168:171], a[104:107], v[64:67]
ds_read_b64_tr_b16 a[192:193], v36 offset:24576
v_mfma_f32_16x16x32_bf16 v[68:71], a[184:187], a[104:107], v[68:71]
v_exp_f32 v74, v74
v_mfma_f32_16x16x32_bf16 v[64:67], a[172:175], a[120:123], v[64:67]
v_exp_f32 v75, v75
v_mfma_f32_16x16x32_bf16 v[68:71], a[188:191], a[120:123], v[68:71]
ds_read_b64_tr_b16 a[194:195], v36 offset:28672
v_cvt_pk_bf16_f32 v100, v72, v73
s_waitcnt lgkmcnt(4)
v_mfma_f32_16x16x32_bf16 v[128:131], a[224:227], v[96:99], v[128:131]
v_exp_f32 v76, v76
v_mfma_f32_16x16x32_bf16 v[144:147], a[228:231], v[96:99], v[144:147]
ds_read_b64_tr_b16 a[196:197], v37 offset:24576
v_mfma_f32_16x16x32_bf16 v[160:163], a[232:235], v[96:99], v[160:163]
v_exp_f32 v77, v77
v_mfma_f32_16x16x32_bf16 v[176:179], a[236:239], v[96:99], v[176:179]
v_cvt_pk_bf16_f32 v101, v74, v75
v_mfma_f32_16x16x32_bf16 v[192:195], a[240:243], v[96:99], v[192:195]
ds_read_b64_tr_b16 a[198:199], v37 offset:28672
v_mfma_f32_16x16x32_bf16 v[208:211], a[244:247], v[96:99], v[208:211]
v_exp_f32 v78, v78
v_mfma_f32_16x16x32_bf16 v[224:227], a[248:251], v[96:99], v[224:227]
v_exp_f32 v79, v79
v_mfma_f32_16x16x32_bf16 v[240:243], a[252:255], v[96:99], v[240:243]
v_cvt_pk_bf16_f32 v102, v76, v77
v_cvt_pk_bf16_f32 v103, v78, v79
v_mfma_f32_16x16x32_bf16 a[0:3], a[16:19], v[96:99], a[0:3]
v_mfma_f32_16x16x32_bf16 v[72:75], a[160:163], a[76:79], v[116:119]
ds_read_b128 a[140:143], v35 offset:0
v_mfma_f32_16x16x32_bf16 v[76:79], a[176:179], a[76:79], v[116:119]
ds_read_b128 a[156:159], v35 offset:4096
v_mfma_f32_16x16x32_bf16 v[72:75], a[164:167], a[92:95], v[72:75]
v_exp_f32 v64, v64
v_mfma_f32_16x16x32_bf16 v[76:79], a[180:183], a[92:95], v[76:79]
v_exp_f32 v65, v65
v_mfma_f32_16x16x32_bf16 v[72:75], a[168:171], a[108:111], v[72:75]
ds_read_b64_tr_b16 a[200:201], v38 offset:24576
v_mfma_f32_16x16x32_bf16 v[76:79], a[184:187], a[108:111], v[76:79]
v_exp_f32 v66, v66
v_mfma_f32_16x16x32_bf16 v[72:75], a[172:175], a[124:127], v[72:75]
v_exp_f32 v67, v67
v_mfma_f32_16x16x32_bf16 v[76:79], a[188:191], a[124:127], v[76:79]
ds_read_b64_tr_b16 a[202:203], v38 offset:28672
v_cvt_pk_bf16_f32 v96, v64, v65
v_mfma_f32_16x16x32_bf16 v[132:135], a[224:227], v[100:103], v[132:135]
v_exp_f32 v68, v68
v_mfma_f32_16x16x32_bf16 v[148:151], a[228:231], v[100:103], v[148:151]
ds_read_b64_tr_b16 a[204:205], v39 offset:24576
v_mfma_f32_16x16x32_bf16 v[164:167], a[232:235], v[100:103], v[164:167]
v_exp_f32 v69, v69
v_mfma_f32_16x16x32_bf16 v[180:183], a[236:239], v[100:103], v[180:183]
v_cvt_pk_bf16_f32 v97, v66, v67
v_mfma_f32_16x16x32_bf16 v[196:199], a[240:243], v[100:103], v[196:199]
ds_read_b64_tr_b16 a[206:207], v39 offset:28672
v_mfma_f32_16x16x32_bf16 v[212:215], a[244:247], v[100:103], v[212:215]
v_exp_f32 v70, v70
v_mfma_f32_16x16x32_bf16 v[228:231], a[248:251], v[100:103], v[228:231]
v_exp_f32 v71, v71
v_mfma_f32_16x16x32_bf16 v[244:247], a[252:255], v[100:103], v[244:247]
v_cvt_pk_bf16_f32 v98, v68, v69
v_cvt_pk_bf16_f32 v99, v70, v71
v_mfma_f32_16x16x32_bf16 a[4:7], a[16:19], v[100:103], a[4:7]
s_waitcnt vmcnt(8) lgkmcnt(4)
s_barrier
v_mfma_f32_16x16x32_bf16 v[64:67], a[128:131], a[64:67], v[104:107]
ds_read_b128 a[160:163], v32 offset:8192
ds_read_b128 a[176:179], v32 offset:12288
v_mfma_f32_16x16x32_bf16 v[68:71], a[144:147], a[64:67], v[104:107]
ds_read_b64_tr_b16 a[208:209], v40 offset:24576
ds_read_b64_tr_b16 a[210:211], v40 offset:28672
v_mfma_f32_16x16x32_bf16 v[64:67], a[132:135], a[80:83], v[64:67]
ds_read_b64_tr_b16 a[212:213], v41 offset:24576
ds_read_b64_tr_b16 a[214:215], v41 offset:28672
v_mfma_f32_16x16x32_bf16 v[68:71], a[148:151], a[80:83], v[68:71]
s_add_u32 m0, s80, 65536
s_mov_b32 s61, 98304
v_mfma_f32_16x16x32_bf16 v[64:67], a[136:139], a[96:99], v[64:67]
buffer_load_dwordx4 v44, s[8:11], s61 offen lds
v_mfma_f32_16x16x32_bf16 v[68:71], a[152:155], a[96:99], v[68:71]
buffer_load_dwordx4 v45, s[8:11], s61 offen offset:1024 lds
v_mfma_f32_16x16x32_bf16 v[64:67], a[140:143], a[112:115], v[64:67]
s_add_u32 m0, s80, 114688
v_mfma_f32_16x16x32_bf16 v[68:71], a[156:159], a[112:115], v[68:71]
buffer_load_dwordx4 v46, s[12:15], s61 offen lds
v_mfma_f32_16x16x32_bf16 v[136:139], a[224:227], v[96:99], v[136:139]
buffer_load_dwordx4 v47, s[12:15], s61 offen offset:1024 lds
v_mfma_f32_16x16x32_bf16 v[152:155], a[228:231], v[96:99], v[152:155]
v_exp_f32 v72, v72
v_mfma_f32_16x16x32_bf16 v[168:171], a[232:235], v[96:99], v[168:171]
v_exp_f32 v73, v73
v_mfma_f32_16x16x32_bf16 v[184:187], a[236:239], v[96:99], v[184:187]
v_exp_f32 v74, v74
v_mfma_f32_16x16x32_bf16 v[200:203], a[240:243], v[96:99], v[200:203]
v_exp_f32 v75, v75
v_cvt_pk_bf16_f32 v100, v72, v73
v_mfma_f32_16x16x32_bf16 v[216:219], a[244:247], v[96:99], v[216:219]
v_exp_f32 v76, v76
v_mfma_f32_16x16x32_bf16 v[232:235], a[248:251], v[96:99], v[232:235]
v_exp_f32 v77, v77
v_cvt_pk_bf16_f32 v101, v74, v75
v_mfma_f32_16x16x32_bf16 v[248:251], a[252:255], v[96:99], v[248:251]
v_exp_f32 v78, v78
v_mfma_f32_16x16x32_bf16 a[8:11], a[16:19], v[96:99], a[8:11]
v_exp_f32 v79, v79
v_cvt_pk_bf16_f32 v102, v76, v77
v_cvt_pk_bf16_f32 v103, v78, v79
v_mfma_f32_16x16x32_bf16 v[72:75], a[128:131], a[68:71], v[108:111]
ds_read_b128 a[164:167], v33 offset:8192
v_mfma_f32_16x16x32_bf16 v[76:79], a[144:147], a[68:71], v[108:111]
ds_read_b128 a[180:183], v33 offset:12288
v_mfma_f32_16x16x32_bf16 v[72:75], a[132:135], a[84:87], v[72:75]
v_exp_f32 v64, v64
v_mfma_f32_16x16x32_bf16 v[76:79], a[148:151], a[84:87], v[76:79]
v_exp_f32 v65, v65
v_mfma_f32_16x16x32_bf16 v[72:75], a[136:139], a[100:103], v[72:75]
ds_read_b64_tr_b16 a[216:217], v42 offset:24576
v_mfma_f32_16x16x32_bf16 v[76:79], a[152:155], a[100:103], v[76:79]
v_exp_f32 v66, v66
v_mfma_f32_16x16x32_bf16 v[72:75], a[140:143], a[116:119], v[72:75]
v_exp_f32 v67, v67
v_mfma_f32_16x16x32_bf16 v[76:79], a[156:159], a[116:119], v[76:79]
ds_read_b64_tr_b16 a[218:219], v42 offset:28672
v_cvt_pk_bf16_f32 v96, v64, v65
v_mfma_f32_16x16x32_bf16 v[140:143], a[224:227], v[100:103], v[140:143]
v_exp_f32 v68, v68
v_mfma_f32_16x16x32_bf16 v[156:159], a[228:231], v[100:103], v[156:159]
ds_read_b64_tr_b16 a[220:221], v43 offset:24576
v_mfma_f32_16x16x32_bf16 v[172:175], a[232:235], v[100:103], v[172:175]
v_exp_f32 v69, v69
v_mfma_f32_16x16x32_bf16 v[188:191], a[236:239], v[100:103], v[188:191]
v_cvt_pk_bf16_f32 v97, v66, v67
v_mfma_f32_16x16x32_bf16 v[204:207], a[240:243], v[100:103], v[204:207]
ds_read_b64_tr_b16 a[222:223], v43 offset:28672
v_mfma_f32_16x16x32_bf16 v[220:223], a[244:247], v[100:103], v[220:223]
v_exp_f32 v70, v70
v_mfma_f32_16x16x32_bf16 v[236:239], a[248:251], v[100:103], v[236:239]
v_exp_f32 v71, v71
v_mfma_f32_16x16x32_bf16 v[252:255], a[252:255], v[100:103], v[252:255]
v_cvt_pk_bf16_f32 v98, v68, v69
v_cvt_pk_bf16_f32 v99, v70, v71
v_mfma_f32_16x16x32_bf16 a[12:15], a[16:19], v[100:103], a[12:15]
v_mfma_f32_16x16x32_bf16 v[64:67], a[128:131], a[72:75], v[112:115]
ds_read_b128 a[168:171], v34 offset:8192
v_mfma_f32_16x16x32_bf16 v[68:71], a[144:147], a[72:75], v[112:115]
ds_read_b128 a[184:187], v34 offset:12288
v_mfma_f32_16x16x32_bf16 v[64:67], a[132:135], a[88:91], v[64:67]
v_exp_f32 v72, v72
v_mfma_f32_16x16x32_bf16 v[68:71], a[148:151], a[88:91], v[68:71]
v_exp_f32 v73, v73
v_mfma_f32_16x16x32_bf16 v[64:67], a[136:139], a[104:107], v[64:67]
ds_read_b64_tr_b16 a[224:225], v36 offset:32768
v_mfma_f32_16x16x32_bf16 v[68:71], a[152:155], a[104:107], v[68:71]
v_exp_f32 v74, v74
v_mfma_f32_16x16x32_bf16 v[64:67], a[140:143], a[120:123], v[64:67]
v_exp_f32 v75, v75
v_mfma_f32_16x16x32_bf16 v[68:71], a[156:159], a[120:123], v[68:71]
ds_read_b64_tr_b16 a[226:227], v36 offset:36864
v_cvt_pk_bf16_f32 v100, v72, v73
s_waitcnt lgkmcnt(4)
v_mfma_f32_16x16x32_bf16 v[128:131], a[192:195], v[96:99], v[128:131]
v_exp_f32 v76, v76
v_mfma_f32_16x16x32_bf16 v[144:147], a[196:199], v[96:99], v[144:147]
ds_read_b64_tr_b16 a[228:229], v37 offset:32768
v_mfma_f32_16x16x32_bf16 v[160:163], a[200:203], v[96:99], v[160:163]
v_exp_f32 v77, v77
v_mfma_f32_16x16x32_bf16 v[176:179], a[204:207], v[96:99], v[176:179]
v_cvt_pk_bf16_f32 v101, v74, v75
v_mfma_f32_16x16x32_bf16 v[192:195], a[208:211], v[96:99], v[192:195]
ds_read_b64_tr_b16 a[230:231], v37 offset:36864
v_mfma_f32_16x16x32_bf16 v[208:211], a[212:215], v[96:99], v[208:211]
v_exp_f32 v78, v78
v_mfma_f32_16x16x32_bf16 v[224:227], a[216:219], v[96:99], v[224:227]
v_exp_f32 v79, v79
v_mfma_f32_16x16x32_bf16 v[240:243], a[220:223], v[96:99], v[240:243]
v_cvt_pk_bf16_f32 v102, v76, v77
v_cvt_pk_bf16_f32 v103, v78, v79
v_mfma_f32_16x16x32_bf16 a[0:3], a[16:19], v[96:99], a[0:3]
v_mfma_f32_16x16x32_bf16 v[72:75], a[128:131], a[76:79], v[116:119]
ds_read_b128 a[172:175], v35 offset:8192
v_mfma_f32_16x16x32_bf16 v[76:79], a[144:147], a[76:79], v[116:119]
ds_read_b128 a[188:191], v35 offset:12288
v_mfma_f32_16x16x32_bf16 v[72:75], a[132:135], a[92:95], v[72:75]
v_exp_f32 v64, v64
v_mfma_f32_16x16x32_bf16 v[76:79], a[148:151], a[92:95], v[76:79]
v_exp_f32 v65, v65
v_mfma_f32_16x16x32_bf16 v[72:75], a[136:139], a[108:111], v[72:75]
ds_read_b64_tr_b16 a[232:233], v38 offset:32768
v_mfma_f32_16x16x32_bf16 v[76:79], a[152:155], a[108:111], v[76:79]
v_exp_f32 v66, v66
v_mfma_f32_16x16x32_bf16 v[72:75], a[140:143], a[124:127], v[72:75]
v_exp_f32 v67, v67
v_mfma_f32_16x16x32_bf16 v[76:79], a[156:159], a[124:127], v[76:79]
ds_read_b64_tr_b16 a[234:235], v38 offset:36864
v_cvt_pk_bf16_f32 v96, v64, v65
v_mfma_f32_16x16x32_bf16 v[132:135], a[192:195], v[100:103], v[132:135]
v_exp_f32 v68, v68
v_mfma_f32_16x16x32_bf16 v[148:151], a[196:199], v[100:103], v[148:151]
ds_read_b64_tr_b16 a[236:237], v39 offset:32768
v_mfma_f32_16x16x32_bf16 v[164:167], a[200:203], v[100:103], v[164:167]
v_exp_f32 v69, v69
v_mfma_f32_16x16x32_bf16 v[180:183], a[204:207], v[100:103], v[180:183]
v_cvt_pk_bf16_f32 v97, v66, v67
v_mfma_f32_16x16x32_bf16 v[196:199], a[208:211], v[100:103], v[196:199]
ds_read_b64_tr_b16 a[238:239], v39 offset:36864
v_mfma_f32_16x16x32_bf16 v[212:215], a[212:215], v[100:103], v[212:215]
v_exp_f32 v70, v70
v_mfma_f32_16x16x32_bf16 v[228:231], a[216:219], v[100:103], v[228:231]
v_exp_f32 v71, v71
v_mfma_f32_16x16x32_bf16 v[244:247], a[220:223], v[100:103], v[244:247]
v_cvt_pk_bf16_f32 v98, v68, v69
v_cvt_pk_bf16_f32 v99, v70, v71
v_mfma_f32_16x16x32_bf16 a[4:7], a[16:19], v[100:103], a[4:7]
s_waitcnt vmcnt(8) lgkmcnt(4)
s_barrier
v_mfma_f32_16x16x32_bf16 v[64:67], a[160:163], a[64:67], v[104:107]
ds_read_b128 a[128:131], v32 offset:16384
ds_read_b128 a[144:147], v32 offset:20480
v_mfma_f32_16x16x32_bf16 v[68:71], a[176:179], a[64:67], v[104:107]
ds_read_b64_tr_b16 a[240:241], v40 offset:32768
ds_read_b64_tr_b16 a[242:243], v40 offset:36864
v_mfma_f32_16x16x32_bf16 v[64:67], a[164:167], a[80:83], v[64:67]
ds_read_b64_tr_b16 a[244:245], v41 offset:32768
ds_read_b64_tr_b16 a[246:247], v41 offset:36864
v_mfma_f32_16x16x32_bf16 v[68:71], a[180:183], a[80:83], v[68:71]
s_add_u32 m0, s80, 73728
s_mov_b32 s61, 106496
v_mfma_f32_16x16x32_bf16 v[64:67], a[168:171], a[96:99], v[64:67]
buffer_load_dwordx4 v44, s[8:11], s61 offen lds
v_mfma_f32_16x16x32_bf16 v[68:71], a[184:187], a[96:99], v[68:71]
buffer_load_dwordx4 v45, s[8:11], s61 offen offset:1024 lds
v_mfma_f32_16x16x32_bf16 v[64:67], a[172:175], a[112:115], v[64:67]
s_add_u32 m0, s80, 122880
v_mfma_f32_16x16x32_bf16 v[68:71], a[188:191], a[112:115], v[68:71]
buffer_load_dwordx4 v46, s[12:15], s61 offen lds
v_mfma_f32_16x16x32_bf16 v[136:139], a[192:195], v[96:99], v[136:139]
buffer_load_dwordx4 v47, s[12:15], s61 offen offset:1024 lds
v_mfma_f32_16x16x32_bf16 v[152:155], a[196:199], v[96:99], v[152:155]
v_exp_f32 v72, v72
v_mfma_f32_16x16x32_bf16 v[168:171], a[200:203], v[96:99], v[168:171]
v_exp_f32 v73, v73
v_mfma_f32_16x16x32_bf16 v[184:187], a[204:207], v[96:99], v[184:187]
v_exp_f32 v74, v74
v_mfma_f32_16x16x32_bf16 v[200:203], a[208:211], v[96:99], v[200:203]
v_exp_f32 v75, v75
v_cvt_pk_bf16_f32 v100, v72, v73
v_mfma_f32_16x16x32_bf16 v[216:219], a[212:215], v[96:99], v[216:219]
v_exp_f32 v76, v76
v_mfma_f32_16x16x32_bf16 v[232:235], a[216:219], v[96:99], v[232:235]
v_exp_f32 v77, v77
v_cvt_pk_bf16_f32 v101, v74, v75
v_mfma_f32_16x16x32_bf16 v[248:251], a[220:223], v[96:99], v[248:251]
v_exp_f32 v78, v78
v_mfma_f32_16x16x32_bf16 a[8:11], a[16:19], v[96:99], a[8:11]
v_exp_f32 v79, v79
v_cvt_pk_bf16_f32 v102, v76, v77
v_cvt_pk_bf16_f32 v103, v78, v79
v_mfma_f32_16x16x32_bf16 v[72:75], a[160:163], a[68:71], v[108:111]
ds_read_b128 a[132:135], v33 offset:16384
v_mfma_f32_16x16x32_bf16 v[76:79], a[176:179], a[68:71], v[108:111]
ds_read_b128 a[148:151], v33 offset:20480
v_mfma_f32_16x16x32_bf16 v[72:75], a[164:167], a[84:87], v[72:75]
v_exp_f32 v64, v64
v_mfma_f32_16x16x32_bf16 v[76:79], a[180:183], a[84:87], v[76:79]
v_exp_f32 v65, v65
v_mfma_f32_16x16x32_bf16 v[72:75], a[168:171], a[100:103], v[72:75]
ds_read_b64_tr_b16 a[248:249], v42 offset:32768
v_mfma_f32_16x16x32_bf16 v[76:79], a[184:187], a[100:103], v[76:79]
v_exp_f32 v66, v66
v_mfma_f32_16x16x32_bf16 v[72:75], a[172:175], a[116:119], v[72:75]
v_exp_f32 v67, v67
v_mfma_f32_16x16x32_bf16 v[76:79], a[188:191], a[116:119], v[76:79]
ds_read_b64_tr_b16 a[250:251], v42 offset:36864
v_cvt_pk_bf16_f32 v96, v64, v65
v_mfma_f32_16x16x32_bf16 v[140:143], a[192:195], v[100:103], v[140:143]
v_exp_f32 v68, v68
v_mfma_f32_16x16x32_bf16 v[156:159], a[196:199], v[100:103], v[156:159]
ds_read_b64_tr_b16 a[252:253], v43 offset:32768
v_mfma_f32_16x16x32_bf16 v[172:175], a[200:203], v[100:103], v[172:175]
v_exp_f32 v69, v69
v_mfma_f32_16x16x32_bf16 v[188:191], a[204:207], v[100:103], v[188:191]
v_cvt_pk_bf16_f32 v97, v66, v67
v_mfma_f32_16x16x32_bf16 v[204:207], a[208:211], v[100:103], v[204:207]
ds_read_b64_tr_b16 a[254:255], v43 offset:36864
v_mfma_f32_16x16x32_bf16 v[220:223], a[212:215], v[100:103], v[220:223]
v_exp_f32 v70, v70
v_mfma_f32_16x16x32_bf16 v[236:239], a[216:219], v[100:103], v[236:239]
v_exp_f32 v71, v71
v_mfma_f32_16x16x32_bf16 v[252:255], a[220:223], v[100:103], v[252:255]
v_cvt_pk_bf16_f32 v98, v68, v69
v_cvt_pk_bf16_f32 v99, v70, v71
v_mfma_f32_16x16x32_bf16 a[12:15], a[16:19], v[100:103], a[12:15]
v_mfma_f32_16x16x32_bf16 v[64:67], a[160:163], a[72:75], v[112:115]
ds_read_b128 a[136:139], v34 offset:16384
ds_read_b128 a[152:155], v34 offset:20480
v_mfma_f32_16x16x32_bf16 v[68:71], a[176:179], a[72:75], v[112:115]
v_exp_f32 v72, v72
v_mfma_f32_16x16x32_bf16 v[64:67], a[164:167], a[88:91], v[64:67]
ds_read_b64_tr_b16 a[192:193], v36 offset:0
v_mfma_f32_16x16x32_bf16 v[68:71], a[180:183], a[88:91], v[68:71]
v_exp_f32 v73, v73
v_mfma_f32_16x16x32_bf16 v[64:67], a[168:171], a[104:107], v[64:67]
ds_read_b64_tr_b16 a[194:195], v36 offset:4096
v_mfma_f32_16x16x32_bf16 v[68:71], a[184:187], a[104:107], v[68:71]
ds_read_b64_tr_b16 a[196:197], v37 offset:0
v_mfma_f32_16x16x32_bf16 v[64:67], a[172:175], a[120:123], v[64:67]
ds_read_b64_tr_b16 a[198:199], v37 offset:4096
s_lshl_b32 s62, s89, 2
v_mfma_f32_16x16x32_bf16 v[68:71], a[188:191], a[120:123], v[68:71]
s_add_u32 s62, s62, s56
s_lshl_b32 s63, s62, 5
s_waitcnt lgkmcnt(6)
v_mfma_f32_16x16x32_bf16 v[128:131], a[224:227], v[96:99], v[128:131]
v_and_b32 v26, 31, v0
v_mfma_f32_16x16x32_bf16 v[144:147], a[228:231], v[96:99], v[144:147]
v_exp_f32 v74, v74
v_mfma_f32_16x16x32_bf16 v[160:163], a[232:235], v[96:99], v[160:163]
v_exp_f32 v75, v75
v_mfma_f32_16x16x32_bf16 v[176:179], a[236:239], v[96:99], v[176:179]
v_cvt_pk_bf16_f32 v100, v72, v73
v_mfma_f32_16x16x32_bf16 v[192:195], a[240:243], v[96:99], v[192:195]
v_exp_f32 v76, v76
v_mfma_f32_16x16x32_bf16 v[208:211], a[244:247], v[96:99], v[208:211]
v_exp_f32 v77, v77
v_mfma_f32_16x16x32_bf16 v[224:227], a[248:251], v[96:99], v[224:227]
v_cvt_pk_bf16_f32 v101, v74, v75
v_mfma_f32_16x16x32_bf16 v[240:243], a[252:255], v[96:99], v[240:243]
v_exp_f32 v78, v78
v_mfma_f32_16x16x32_bf16 a[0:3], a[16:19], v[96:99], a[0:3]
v_exp_f32 v79, v79
v_cvt_pk_bf16_f32 v102, v76, v77
v_cvt_pk_bf16_f32 v103, v78, v79
v_mfma_f32_16x16x32_bf16 v[72:75], a[160:163], a[76:79], v[116:119]
ds_read_b128 a[140:143], v35 offset:16384
ds_read_b128 a[156:159], v35 offset:20480
v_mfma_f32_16x16x32_bf16 v[76:79], a[176:179], a[76:79], v[116:119]
v_exp_f32 v64, v64
v_mfma_f32_16x16x32_bf16 v[72:75], a[164:167], a[92:95], v[72:75]
ds_read_b64_tr_b16 a[200:201], v38 offset:0
v_mfma_f32_16x16x32_bf16 v[76:79], a[180:183], a[92:95], v[76:79]
ds_read_b64_tr_b16 a[202:203], v38 offset:4096
v_mfma_f32_16x16x32_bf16 v[72:75], a[168:171], a[108:111], v[72:75]
ds_read_b64_tr_b16 a[204:205], v39 offset:0
ds_read_b64_tr_b16 a[206:207], v39 offset:4096
v_mfma_f32_16x16x32_bf16 v[76:79], a[184:187], a[108:111], v[76:79]
v_add_u32 v26, s63, v26
v_lshlrev_b32 v26, 8, v26
v_mfma_f32_16x16x32_bf16 v[72:75], a[172:175], a[124:127], v[72:75]
buffer_load_dword v124, v26, s[20:23], 0 offen offset:0
v_mfma_f32_16x16x32_bf16 v[76:79], a[188:191], a[124:127], v[76:79]
v_exp_f32 v65, v65
v_mfma_f32_16x16x32_bf16 v[132:135], a[224:227], v[100:103], v[132:135]
v_exp_f32 v66, v66
v_mfma_f32_16x16x32_bf16 v[148:151], a[228:231], v[100:103], v[148:151]
v_exp_f32 v67, v67
v_mfma_f32_16x16x32_bf16 v[164:167], a[232:235], v[100:103], v[164:167]
v_cvt_pk_bf16_f32 v96, v64, v65
v_mfma_f32_16x16x32_bf16 v[180:183], a[236:239], v[100:103], v[180:183]
v_exp_f32 v68, v68
v_mfma_f32_16x16x32_bf16 v[196:199], a[240:243], v[100:103], v[196:199]
v_exp_f32 v69, v69
v_mfma_f32_16x16x32_bf16 v[212:215], a[244:247], v[100:103], v[212:215]
v_cvt_pk_bf16_f32 v97, v66, v67
v_mfma_f32_16x16x32_bf16 v[228:231], a[248:251], v[100:103], v[228:231]
v_exp_f32 v70, v70
v_mfma_f32_16x16x32_bf16 v[244:247], a[252:255], v[100:103], v[244:247]
v_exp_f32 v71, v71
v_mfma_f32_16x16x32_bf16 a[4:7], a[16:19], v[100:103], a[4:7]
v_cvt_pk_bf16_f32 v98, v68, v69
v_cvt_pk_bf16_f32 v99, v70, v71
s_waitcnt vmcnt(9) lgkmcnt(4)
s_barrier
v_mfma_f32_16x16x32_bf16 v[64:67], a[128:131], a[64:67], v[104:107]
ds_read_b128 a[160:163], v32 offset:24576
ds_read_b128 a[176:179], v32 offset:28672
v_mfma_f32_16x16x32_bf16 v[68:71], a[144:147], a[64:67], v[104:107]
ds_read_b64_tr_b16 a[208:209], v40 offset:0
ds_read_b64_tr_b16 a[210:211], v40 offset:4096
v_mfma_f32_16x16x32_bf16 v[64:67], a[132:135], a[80:83], v[64:67]
ds_read_b64_tr_b16 a[212:213], v41 offset:0
ds_read_b64_tr_b16 a[214:215], v41 offset:4096
v_mfma_f32_16x16x32_bf16 v[68:71], a[148:151], a[80:83], v[68:71]
s_add_u32 m0, s80, 81920
s_mov_b32 s61, 114688
v_mfma_f32_16x16x32_bf16 v[64:67], a[136:139], a[96:99], v[64:67]
buffer_load_dwordx4 v44, s[8:11], s61 offen lds
v_mfma_f32_16x16x32_bf16 v[68:71], a[152:155], a[96:99], v[68:71]
buffer_load_dwordx4 v45, s[8:11], s61 offen offset:1024 lds
v_mfma_f32_16x16x32_bf16 v[64:67], a[140:143], a[112:115], v[64:67]
s_add_u32 m0, s80, 131072
v_mfma_f32_16x16x32_bf16 v[68:71], a[156:159], a[112:115], v[68:71]
buffer_load_dwordx4 v46, s[12:15], s61 offen lds
v_mfma_f32_16x16x32_bf16 v[136:139], a[224:227], v[96:99], v[136:139]
buffer_load_dwordx4 v47, s[12:15], s61 offen offset:1024 lds
v_mfma_f32_16x16x32_bf16 v[152:155], a[228:231], v[96:99], v[152:155]
v_exp_f32 v72, v72
v_mfma_f32_16x16x32_bf16 v[168:171], a[232:235], v[96:99], v[168:171]
v_exp_f32 v73, v73
v_mfma_f32_16x16x32_bf16 v[184:187], a[236:239], v[96:99], v[184:187]
v_exp_f32 v74, v74
v_mfma_f32_16x16x32_bf16 v[200:203], a[240:243], v[96:99], v[200:203]
v_exp_f32 v75, v75
v_cvt_pk_bf16_f32 v100, v72, v73
v_mfma_f32_16x16x32_bf16 v[216:219], a[244:247], v[96:99], v[216:219]
v_exp_f32 v76, v76
v_mfma_f32_16x16x32_bf16 v[232:235], a[248:251], v[96:99], v[232:235]
v_exp_f32 v77, v77
v_cvt_pk_bf16_f32 v101, v74, v75
v_mfma_f32_16x16x32_bf16 v[248:251], a[252:255], v[96:99], v[248:251]
v_exp_f32 v78, v78
v_mfma_f32_16x16x32_bf16 a[8:11], a[16:19], v[96:99], a[8:11]
v_exp_f32 v79, v79
v_cvt_pk_bf16_f32 v102, v76, v77
v_cvt_pk_bf16_f32 v103, v78, v79
v_mfma_f32_16x16x32_bf16 v[72:75], a[128:131], a[68:71], v[108:111]
ds_read_b128 a[164:167], v33 offset:24576
v_mfma_f32_16x16x32_bf16 v[76:79], a[144:147], a[68:71], v[108:111]
ds_read_b128 a[180:183], v33 offset:28672
v_mfma_f32_16x16x32_bf16 v[72:75], a[132:135], a[84:87], v[72:75]
v_exp_f32 v64, v64
v_mfma_f32_16x16x32_bf16 v[76:79], a[148:151], a[84:87], v[76:79]
v_exp_f32 v65, v65
v_mfma_f32_16x16x32_bf16 v[72:75], a[136:139], a[100:103], v[72:75]
ds_read_b64_tr_b16 a[216:217], v42 offset:0
v_mfma_f32_16x16x32_bf16 v[76:79], a[152:155], a[100:103], v[76:79]
v_exp_f32 v66, v66
v_mfma_f32_16x16x32_bf16 v[72:75], a[140:143], a[116:119], v[72:75]
v_exp_f32 v67, v67
v_mfma_f32_16x16x32_bf16 v[76:79], a[156:159], a[116:119], v[76:79]
ds_read_b64_tr_b16 a[218:219], v42 offset:4096
v_cvt_pk_bf16_f32 v96, v64, v65
v_mfma_f32_16x16x32_bf16 v[140:143], a[224:227], v[100:103], v[140:143]
v_exp_f32 v68, v68
v_mfma_f32_16x16x32_bf16 v[156:159], a[228:231], v[100:103], v[156:159]
ds_read_b64_tr_b16 a[220:221], v43 offset:0
v_mfma_f32_16x16x32_bf16 v[172:175], a[232:235], v[100:103], v[172:175]
v_exp_f32 v69, v69
v_mfma_f32_16x16x32_bf16 v[188:191], a[236:239], v[100:103], v[188:191]
v_cvt_pk_bf16_f32 v97, v66, v67
v_mfma_f32_16x16x32_bf16 v[204:207], a[240:243], v[100:103], v[204:207]
ds_read_b64_tr_b16 a[222:223], v43 offset:4096
v_mfma_f32_16x16x32_bf16 v[220:223], a[244:247], v[100:103], v[220:223]
v_exp_f32 v70, v70
v_mfma_f32_16x16x32_bf16 v[236:239], a[248:251], v[100:103], v[236:239]
v_exp_f32 v71, v71
v_mfma_f32_16x16x32_bf16 v[252:255], a[252:255], v[100:103], v[252:255]
v_cvt_pk_bf16_f32 v98, v68, v69
v_cvt_pk_bf16_f32 v99, v70, v71
v_mfma_f32_16x16x32_bf16 a[12:15], a[16:19], v[100:103], a[12:15]
v_mfma_f32_16x16x32_bf16 v[64:67], a[128:131], a[72:75], v[112:115]
ds_read_b128 a[168:171], v34 offset:24576
v_mfma_f32_16x16x32_bf16 v[68:71], a[144:147], a[72:75], v[112:115]
ds_read_b128 a[184:187], v34 offset:28672
v_mfma_f32_16x16x32_bf16 v[64:67], a[132:135], a[88:91], v[64:67]
v_exp_f32 v72, v72
v_mfma_f32_16x16x32_bf16 v[68:71], a[148:151], a[88:91], v[68:71]
v_exp_f32 v73, v73
v_mfma_f32_16x16x32_bf16 v[64:67], a[136:139], a[104:107], v[64:67]
ds_read_b64_tr_b16 a[224:225], v36 offset:8192
v_mfma_f32_16x16x32_bf16 v[68:71], a[152:155], a[104:107], v[68:71]
v_exp_f32 v74, v74
v_mfma_f32_16x16x32_bf16 v[64:67], a[140:143], a[120:123], v[64:67]
v_exp_f32 v75, v75
v_mfma_f32_16x16x32_bf16 v[68:71], a[156:159], a[120:123], v[68:71]
ds_read_b64_tr_b16 a[226:227], v36 offset:12288
v_cvt_pk_bf16_f32 v100, v72, v73
s_waitcnt lgkmcnt(4)
v_mfma_f32_16x16x32_bf16 v[128:131], a[192:195], v[96:99], v[128:131]
v_exp_f32 v76, v76
v_mfma_f32_16x16x32_bf16 v[144:147], a[196:199], v[96:99], v[144:147]
ds_read_b64_tr_b16 a[228:229], v37 offset:8192
v_mfma_f32_16x16x32_bf16 v[160:163], a[200:203], v[96:99], v[160:163]
v_exp_f32 v77, v77
v_mfma_f32_16x16x32_bf16 v[176:179], a[204:207], v[96:99], v[176:179]
v_cvt_pk_bf16_f32 v101, v74, v75
v_mfma_f32_16x16x32_bf16 v[192:195], a[208:211], v[96:99], v[192:195]
ds_read_b64_tr_b16 a[230:231], v37 offset:12288
v_mfma_f32_16x16x32_bf16 v[208:211], a[212:215], v[96:99], v[208:211]
v_exp_f32 v78, v78
v_mfma_f32_16x16x32_bf16 v[224:227], a[216:219], v[96:99], v[224:227]
v_exp_f32 v79, v79
v_mfma_f32_16x16x32_bf16 v[240:243], a[220:223], v[96:99], v[240:243]
v_cvt_pk_bf16_f32 v102, v76, v77
v_cvt_pk_bf16_f32 v103, v78, v79
v_mfma_f32_16x16x32_bf16 a[0:3], a[16:19], v[96:99], a[0:3]
v_mfma_f32_16x16x32_bf16 v[72:75], a[128:131], a[76:79], v[116:119]
ds_read_b128 a[172:175], v35 offset:24576
v_mfma_f32_16x16x32_bf16 v[76:79], a[144:147], a[76:79], v[116:119]
ds_read_b128 a[188:191], v35 offset:28672
v_mfma_f32_16x16x32_bf16 v[72:75], a[132:135], a[92:95], v[72:75]
v_exp_f32 v64, v64
v_mfma_f32_16x16x32_bf16 v[76:79], a[148:151], a[92:95], v[76:79]
v_exp_f32 v65, v65
v_mfma_f32_16x16x32_bf16 v[72:75], a[136:139], a[108:111], v[72:75]
ds_read_b64_tr_b16 a[232:233], v38 offset:8192
v_mfma_f32_16x16x32_bf16 v[76:79], a[152:155], a[108:111], v[76:79]
v_exp_f32 v66, v66
v_mfma_f32_16x16x32_bf16 v[72:75], a[140:143], a[124:127], v[72:75]
v_exp_f32 v67, v67
v_mfma_f32_16x16x32_bf16 v[76:79], a[156:159], a[124:127], v[76:79]
ds_read_b64_tr_b16 a[234:235], v38 offset:12288
v_cvt_pk_bf16_f32 v96, v64, v65
v_mfma_f32_16x16x32_bf16 v[132:135], a[192:195], v[100:103], v[132:135]
v_exp_f32 v68, v68
v_mfma_f32_16x16x32_bf16 v[148:151], a[196:199], v[100:103], v[148:151]
ds_read_b64_tr_b16 a[236:237], v39 offset:8192
v_mfma_f32_16x16x32_bf16 v[164:167], a[200:203], v[100:103], v[164:167]
v_exp_f32 v69, v69
v_mfma_f32_16x16x32_bf16 v[180:183], a[204:207], v[100:103], v[180:183]
v_cvt_pk_bf16_f32 v97, v66, v67
v_mfma_f32_16x16x32_bf16 v[196:199], a[208:211], v[100:103], v[196:199]
ds_read_b64_tr_b16 a[238:239], v39 offset:12288
v_mfma_f32_16x16x32_bf16 v[212:215], a[212:215], v[100:103], v[212:215]
v_exp_f32 v70, v70
v_mfma_f32_16x16x32_bf16 v[228:231], a[216:219], v[100:103], v[228:231]
v_exp_f32 v71, v71
v_mfma_f32_16x16x32_bf16 v[244:247], a[220:223], v[100:103], v[244:247]
v_cvt_pk_bf16_f32 v98, v68, v69
v_cvt_pk_bf16_f32 v99, v70, v71
v_mfma_f32_16x16x32_bf16 a[4:7], a[16:19], v[100:103], a[4:7]
s_waitcnt vmcnt(9) lgkmcnt(4)
s_barrier
v_mfma_f32_16x16x32_bf16 v[64:67], a[160:163], a[64:67], v[104:107]
ds_read_b128 a[128:131], v32 offset:0
ds_read_b128 a[144:147], v32 offset:4096
v_mfma_f32_16x16x32_bf16 v[68:71], a[176:179], a[64:67], v[104:107]
ds_read_b64_tr_b16 a[240:241], v40 offset:8192
ds_read_b64_tr_b16 a[242:243], v40 offset:12288
v_mfma_f32_16x16x32_bf16 v[64:67], a[164:167], a[80:83], v[64:67]
ds_read_b64_tr_b16 a[244:245], v41 offset:8192
ds_read_b64_tr_b16 a[246:247], v41 offset:12288
v_mfma_f32_16x16x32_bf16 v[68:71], a[180:183], a[80:83], v[68:71]
s_add_u32 m0, s80, 90112
s_mov_b32 s61, 122880
v_mfma_f32_16x16x32_bf16 v[64:67], a[168:171], a[96:99], v[64:67]
buffer_load_dwordx4 v44, s[8:11], s61 offen lds
v_mfma_f32_16x16x32_bf16 v[68:71], a[184:187], a[96:99], v[68:71]
buffer_load_dwordx4 v45, s[8:11], s61 offen offset:1024 lds
v_mfma_f32_16x16x32_bf16 v[64:67], a[172:175], a[112:115], v[64:67]
s_add_u32 m0, s80, 98304
v_mfma_f32_16x16x32_bf16 v[68:71], a[188:191], a[112:115], v[68:71]
buffer_load_dwordx4 v46, s[12:15], s61 offen lds
v_mfma_f32_16x16x32_bf16 v[136:139], a[192:195], v[96:99], v[136:139]
buffer_load_dwordx4 v47, s[12:15], s61 offen offset:1024 lds
v_mfma_f32_16x16x32_bf16 v[152:155], a[196:199], v[96:99], v[152:155]
v_exp_f32 v72, v72
v_mfma_f32_16x16x32_bf16 v[168:171], a[200:203], v[96:99], v[168:171]
v_exp_f32 v73, v73
v_mfma_f32_16x16x32_bf16 v[184:187], a[204:207], v[96:99], v[184:187]
v_exp_f32 v74, v74
v_mfma_f32_16x16x32_bf16 v[200:203], a[208:211], v[96:99], v[200:203]
v_exp_f32 v75, v75
v_cvt_pk_bf16_f32 v100, v72, v73
v_mfma_f32_16x16x32_bf16 v[216:219], a[212:215], v[96:99], v[216:219]
v_exp_f32 v76, v76
v_mfma_f32_16x16x32_bf16 v[232:235], a[216:219], v[96:99], v[232:235]
v_exp_f32 v77, v77
v_cvt_pk_bf16_f32 v101, v74, v75
v_mfma_f32_16x16x32_bf16 v[248:251], a[220:223], v[96:99], v[248:251]
v_exp_f32 v78, v78
v_mfma_f32_16x16x32_bf16 a[8:11], a[16:19], v[96:99], a[8:11]
v_exp_f32 v79, v79
v_cvt_pk_bf16_f32 v102, v76, v77
v_cvt_pk_bf16_f32 v103, v78, v79
v_mfma_f32_16x16x32_bf16 v[72:75], a[160:163], a[68:71], v[108:111]
ds_read_b128 a[132:135], v33 offset:0
v_mfma_f32_16x16x32_bf16 v[76:79], a[176:179], a[68:71], v[108:111]
ds_read_b128 a[148:151], v33 offset:4096
v_mfma_f32_16x16x32_bf16 v[72:75], a[164:167], a[84:87], v[72:75]
v_exp_f32 v64, v64
v_mfma_f32_16x16x32_bf16 v[76:79], a[180:183], a[84:87], v[76:79]
v_exp_f32 v65, v65
v_mfma_f32_16x16x32_bf16 v[72:75], a[168:171], a[100:103], v[72:75]
ds_read_b64_tr_b16 a[248:249], v42 offset:8192
v_mfma_f32_16x16x32_bf16 v[76:79], a[184:187], a[100:103], v[76:79]
v_exp_f32 v66, v66
v_mfma_f32_16x16x32_bf16 v[72:75], a[172:175], a[116:119], v[72:75]
v_exp_f32 v67, v67
v_mfma_f32_16x16x32_bf16 v[76:79], a[188:191], a[116:119], v[76:79]
ds_read_b64_tr_b16 a[250:251], v42 offset:12288
v_cvt_pk_bf16_f32 v96, v64, v65
v_mfma_f32_16x16x32_bf16 v[140:143], a[192:195], v[100:103], v[140:143]
v_exp_f32 v68, v68
v_mfma_f32_16x16x32_bf16 v[156:159], a[196:199], v[100:103], v[156:159]
ds_read_b64_tr_b16 a[252:253], v43 offset:8192
v_mfma_f32_16x16x32_bf16 v[172:175], a[200:203], v[100:103], v[172:175]
v_exp_f32 v69, v69
v_mfma_f32_16x16x32_bf16 v[188:191], a[204:207], v[100:103], v[188:191]
v_cvt_pk_bf16_f32 v97, v66, v67
v_mfma_f32_16x16x32_bf16 v[204:207], a[208:211], v[100:103], v[204:207]
ds_read_b64_tr_b16 a[254:255], v43 offset:12288
v_mfma_f32_16x16x32_bf16 v[220:223], a[212:215], v[100:103], v[220:223]
v_exp_f32 v70, v70
v_mfma_f32_16x16x32_bf16 v[236:239], a[216:219], v[100:103], v[236:239]
v_exp_f32 v71, v71
v_mfma_f32_16x16x32_bf16 v[252:255], a[220:223], v[100:103], v[252:255]
v_cvt_pk_bf16_f32 v98, v68, v69
v_cvt_pk_bf16_f32 v99, v70, v71
v_mfma_f32_16x16x32_bf16 a[12:15], a[16:19], v[100:103], a[12:15]
v_mfma_f32_16x16x32_bf16 v[64:67], a[160:163], a[72:75], v[112:115]
ds_read_b128 a[136:139], v34 offset:0
ds_read_b128 a[152:155], v34 offset:4096
v_mfma_f32_16x16x32_bf16 v[68:71], a[176:179], a[72:75], v[112:115]
v_exp_f32 v72, v72
v_mfma_f32_16x16x32_bf16 v[64:67], a[164:167], a[88:91], v[64:67]
ds_read_b64_tr_b16 a[192:193], v36 offset:16384
v_mfma_f32_16x16x32_bf16 v[68:71], a[180:183], a[88:91], v[68:71]
v_exp_f32 v73, v73
v_mfma_f32_16x16x32_bf16 v[64:67], a[168:171], a[104:107], v[64:67]
ds_read_b64_tr_b16 a[194:195], v36 offset:20480
v_mfma_f32_16x16x32_bf16 v[68:71], a[184:187], a[104:107], v[68:71]
ds_read_b64_tr_b16 a[196:197], v37 offset:16384
v_mfma_f32_16x16x32_bf16 v[64:67], a[172:175], a[120:123], v[64:67]
ds_read_b64_tr_b16 a[198:199], v37 offset:20480
s_lshl_b32 s62, s89, 2
v_mfma_f32_16x16x32_bf16 v[68:71], a[188:191], a[120:123], v[68:71]
s_add_u32 s62, s62, s56
s_lshl_b32 s63, s62, 5
s_waitcnt lgkmcnt(6)
v_mfma_f32_16x16x32_bf16 v[128:131], a[224:227], v[96:99], v[128:131]
v_and_b32 v26, 31, v0
v_mfma_f32_16x16x32_bf16 v[144:147], a[228:231], v[96:99], v[144:147]
v_exp_f32 v74, v74
v_mfma_f32_16x16x32_bf16 v[160:163], a[232:235], v[96:99], v[160:163]
v_exp_f32 v75, v75
v_mfma_f32_16x16x32_bf16 v[176:179], a[236:239], v[96:99], v[176:179]
v_cvt_pk_bf16_f32 v100, v72, v73
v_mfma_f32_16x16x32_bf16 v[192:195], a[240:243], v[96:99], v[192:195]
v_exp_f32 v76, v76
v_mfma_f32_16x16x32_bf16 v[208:211], a[244:247], v[96:99], v[208:211]
v_exp_f32 v77, v77
v_mfma_f32_16x16x32_bf16 v[224:227], a[248:251], v[96:99], v[224:227]
v_cvt_pk_bf16_f32 v101, v74, v75
v_mfma_f32_16x16x32_bf16 v[240:243], a[252:255], v[96:99], v[240:243]
v_exp_f32 v78, v78
v_mfma_f32_16x16x32_bf16 a[0:3], a[16:19], v[96:99], a[0:3]
v_exp_f32 v79, v79
v_cvt_pk_bf16_f32 v102, v76, v77
v_cvt_pk_bf16_f32 v103, v78, v79
v_mfma_f32_16x16x32_bf16 v[72:75], a[160:163], a[76:79], v[116:119]
ds_read_b128 a[140:143], v35 offset:0
ds_read_b128 a[156:159], v35 offset:4096
v_mfma_f32_16x16x32_bf16 v[76:79], a[176:179], a[76:79], v[116:119]
v_exp_f32 v64, v64
v_mfma_f32_16x16x32_bf16 v[72:75], a[164:167], a[92:95], v[72:75]
ds_read_b64_tr_b16 a[200:201], v38 offset:16384
v_mfma_f32_16x16x32_bf16 v[76:79], a[180:183], a[92:95], v[76:79]
ds_read_b64_tr_b16 a[202:203], v38 offset:20480
v_mfma_f32_16x16x32_bf16 v[72:75], a[168:171], a[108:111], v[72:75]
ds_read_b64_tr_b16 a[204:205], v39 offset:16384
ds_read_b64_tr_b16 a[206:207], v39 offset:20480
v_mfma_f32_16x16x32_bf16 v[76:79], a[184:187], a[108:111], v[76:79]
v_add_u32 v26, s63, v26
v_lshlrev_b32 v26, 8, v26
v_mfma_f32_16x16x32_bf16 v[72:75], a[172:175], a[124:127], v[72:75]
buffer_load_dword v125, v26, s[20:23], 0 offen offset:128
v_mfma_f32_16x16x32_bf16 v[76:79], a[188:191], a[124:127], v[76:79]
v_exp_f32 v65, v65
v_mfma_f32_16x16x32_bf16 v[132:135], a[224:227], v[100:103], v[132:135]
v_exp_f32 v66, v66
v_mfma_f32_16x16x32_bf16 v[148:151], a[228:231], v[100:103], v[148:151]
v_exp_f32 v67, v67
v_mfma_f32_16x16x32_bf16 v[164:167], a[232:235], v[100:103], v[164:167]
v_cvt_pk_bf16_f32 v96, v64, v65
v_mfma_f32_16x16x32_bf16 v[180:183], a[236:239], v[100:103], v[180:183]
v_exp_f32 v68, v68
v_mfma_f32_16x16x32_bf16 v[196:199], a[240:243], v[100:103], v[196:199]
v_exp_f32 v69, v69
v_mfma_f32_16x16x32_bf16 v[212:215], a[244:247], v[100:103], v[212:215]
v_cvt_pk_bf16_f32 v97, v66, v67
v_mfma_f32_16x16x32_bf16 v[228:231], a[248:251], v[100:103], v[228:231]
v_exp_f32 v70, v70
v_mfma_f32_16x16x32_bf16 v[244:247], a[252:255], v[100:103], v[244:247]
v_exp_f32 v71, v71
v_mfma_f32_16x16x32_bf16 a[4:7], a[16:19], v[100:103], a[4:7]
v_cvt_pk_bf16_f32 v98, v68, v69
v_cvt_pk_bf16_f32 v99, v70, v71
s_waitcnt vmcnt(10) lgkmcnt(4)
s_barrier
v_mfma_f32_16x16x32_bf16 v[64:67], a[128:131], a[64:67], v[104:107]
ds_read_b128 a[160:163], v32 offset:8192
v_mfma_f32_16x16x32_bf16 v[68:71], a[144:147], a[64:67], v[104:107]
ds_read_b128 a[176:179], v32 offset:12288
v_mfma_f32_16x16x32_bf16 v[64:67], a[132:135], a[80:83], v[64:67]
v_exp_f32 v72, v72
v_mfma_f32_16x16x32_bf16 v[68:71], a[148:151], a[80:83], v[68:71]
v_exp_f32 v73, v73
v_mfma_f32_16x16x32_bf16 v[64:67], a[136:139], a[96:99], v[64:67]
ds_read_b64_tr_b16 a[208:209], v40 offset:16384
v_mfma_f32_16x16x32_bf16 v[68:71], a[152:155], a[96:99], v[68:71]
v_exp_f32 v74, v74
v_mfma_f32_16x16x32_bf16 v[64:67], a[140:143], a[112:115], v[64:67]
v_exp_f32 v75, v75
v_mfma_f32_16x16x32_bf16 v[68:71], a[156:159], a[112:115], v[68:71]
ds_read_b64_tr_b16 a[210:211], v40 offset:20480
v_cvt_pk_bf16_f32 v100, v72, v73
v_mfma_f32_16x16x32_bf16 v[136:139], a[224:227], v[96:99], v[136:139]
v_exp_f32 v76, v76
v_mfma_f32_16x16x32_bf16 v[152:155], a[228:231], v[96:99], v[152:155]
ds_read_b64_tr_b16 a[212:213], v41 offset:16384
v_mfma_f32_16x16x32_bf16 v[168:171], a[232:235], v[96:99], v[168:171]
v_exp_f32 v77, v77
v_mfma_f32_16x16x32_bf16 v[184:187], a[236:239], v[96:99], v[184:187]
v_cvt_pk_bf16_f32 v101, v74, v75
v_mfma_f32_16x16x32_bf16 v[200:203], a[240:243], v[96:99], v[200:203]
ds_read_b64_tr_b16 a[214:215], v41 offset:20480
v_mfma_f32_16x16x32_bf16 v[216:219], a[244:247], v[96:99], v[216:219]
v_exp_f32 v78, v78
v_mfma_f32_16x16x32_bf16 v[232:235], a[248:251], v[96:99], v[232:235]
v_exp_f32 v79, v79
v_mfma_f32_16x16x32_bf16 v[248:251], a[252:255], v[96:99], v[248:251]
v_cvt_pk_bf16_f32 v102, v76, v77
v_cvt_pk_bf16_f32 v103, v78, v79
v_mfma_f32_16x16x32_bf16 a[8:11], a[16:19], v[96:99], a[8:11]
v_mfma_f32_16x16x32_bf16 v[72:75], a[128:131], a[68:71], v[108:111]
ds_read_b128 a[164:167], v33 offset:8192
v_mfma_f32_16x16x32_bf16 v[76:79], a[144:147], a[68:71], v[108:111]
ds_read_b128 a[180:183], v33 offset:12288
v_mfma_f32_16x16x32_bf16 v[72:75], a[132:135], a[84:87], v[72:75]
v_exp_f32 v64, v64
v_mfma_f32_16x16x32_bf16 v[76:79], a[148:151], a[84:87], v[76:79]
v_exp_f32 v65, v65
v_mfma_f32_16x16x32_bf16 v[72:75], a[136:139], a[100:103], v[72:75]
ds_read_b64_tr_b16 a[216:217], v42 offset:16384
v_mfma_f32_16x16x32_bf16 v[76:79], a[152:155], a[100:103], v[76:79]
v_exp_f32 v66, v66
v_mfma_f32_16x16x32_bf16 v[72:75], a[140:143], a[116:119], v[72:75]
v_exp_f32 v67, v67
v_mfma_f32_16x16x32_bf16 v[76:79], a[156:159], a[116:119], v[76:79]
ds_read_b64_tr_b16 a[218:219], v42 offset:20480
v_cvt_pk_bf16_f32 v96, v64, v65
v_mfma_f32_16x16x32_bf16 v[140:143], a[224:227], v[100:103], v[140:143]
v_exp_f32 v68, v68
v_mfma_f32_16x16x32_bf16 v[156:159], a[228:231], v[100:103], v[156:159]
ds_read_b64_tr_b16 a[220:221], v43 offset:16384
v_mfma_f32_16x16x32_bf16 v[172:175], a[232:235], v[100:103], v[172:175]
v_exp_f32 v69, v69
v_mfma_f32_16x16x32_bf16 v[188:191], a[236:239], v[100:103], v[188:191]
v_cvt_pk_bf16_f32 v97, v66, v67
v_mfma_f32_16x16x32_bf16 v[204:207], a[240:243], v[100:103], v[204:207]
ds_read_b64_tr_b16 a[222:223], v43 offset:20480
v_mfma_f32_16x16x32_bf16 v[220:223], a[244:247], v[100:103], v[220:223]
v_exp_f32 v70, v70
v_mfma_f32_16x16x32_bf16 v[236:239], a[248:251], v[100:103], v[236:239]
v_exp_f32 v71, v71
v_mfma_f32_16x16x32_bf16 v[252:255], a[252:255], v[100:103], v[252:255]
v_cvt_pk_bf16_f32 v98, v68, v69
v_cvt_pk_bf16_f32 v99, v70, v71
v_mfma_f32_16x16x32_bf16 a[12:15], a[16:19], v[100:103], a[12:15]
v_mfma_f32_16x16x32_bf16 v[64:67], a[128:131], a[72:75], v[112:115]
ds_read_b128 a[168:171], v34 offset:8192
v_mfma_f32_16x16x32_bf16 v[68:71], a[144:147], a[72:75], v[112:115]
ds_read_b128 a[184:187], v34 offset:12288
v_mfma_f32_16x16x32_bf16 v[64:67], a[132:135], a[88:91], v[64:67]
v_exp_f32 v72, v72
v_mfma_f32_16x16x32_bf16 v[68:71], a[148:151], a[88:91], v[68:71]
v_exp_f32 v73, v73
v_mfma_f32_16x16x32_bf16 v[64:67], a[136:139], a[104:107], v[64:67]
ds_read_b64_tr_b16 a[224:225], v36 offset:24576
v_mfma_f32_16x16x32_bf16 v[68:71], a[152:155], a[104:107], v[68:71]
v_exp_f32 v74, v74
v_mfma_f32_16x16x32_bf16 v[64:67], a[140:143], a[120:123], v[64:67]
v_exp_f32 v75, v75
v_mfma_f32_16x16x32_bf16 v[68:71], a[156:159], a[120:123], v[68:71]
ds_read_b64_tr_b16 a[226:227], v36 offset:28672
v_cvt_pk_bf16_f32 v100, v72, v73
s_waitcnt lgkmcnt(4)
v_mfma_f32_16x16x32_bf16 v[128:131], a[192:195], v[96:99], v[128:131]
v_exp_f32 v76, v76
v_mfma_f32_16x16x32_bf16 v[144:147], a[196:199], v[96:99], v[144:147]
ds_read_b64_tr_b16 a[228:229], v37 offset:24576
v_mfma_f32_16x16x32_bf16 v[160:163], a[200:203], v[96:99], v[160:163]
v_exp_f32 v77, v77
v_mfma_f32_16x16x32_bf16 v[176:179], a[204:207], v[96:99], v[176:179]
v_cvt_pk_bf16_f32 v101, v74, v75
v_mfma_f32_16x16x32_bf16 v[192:195], a[208:211], v[96:99], v[192:195]
ds_read_b64_tr_b16 a[230:231], v37 offset:28672
v_mfma_f32_16x16x32_bf16 v[208:211], a[212:215], v[96:99], v[208:211]
v_exp_f32 v78, v78
v_mfma_f32_16x16x32_bf16 v[224:227], a[216:219], v[96:99], v[224:227]
v_exp_f32 v79, v79
v_mfma_f32_16x16x32_bf16 v[240:243], a[220:223], v[96:99], v[240:243]
v_cvt_pk_bf16_f32 v102, v76, v77
v_cvt_pk_bf16_f32 v103, v78, v79
v_mfma_f32_16x16x32_bf16 a[0:3], a[16:19], v[96:99], a[0:3]
v_mfma_f32_16x16x32_bf16 v[72:75], a[128:131], a[76:79], v[116:119]
ds_read_b128 a[172:175], v35 offset:8192
v_mfma_f32_16x16x32_bf16 v[76:79], a[144:147], a[76:79], v[116:119]
ds_read_b128 a[188:191], v35 offset:12288
v_mfma_f32_16x16x32_bf16 v[72:75], a[132:135], a[92:95], v[72:75]
v_exp_f32 v64, v64
v_mfma_f32_16x16x32_bf16 v[76:79], a[148:151], a[92:95], v[76:79]
v_exp_f32 v65, v65
v_mfma_f32_16x16x32_bf16 v[72:75], a[136:139], a[108:111], v[72:75]
ds_read_b64_tr_b16 a[232:233], v38 offset:24576
v_mfma_f32_16x16x32_bf16 v[76:79], a[152:155], a[108:111], v[76:79]
v_exp_f32 v66, v66
v_mfma_f32_16x16x32_bf16 v[72:75], a[140:143], a[124:127], v[72:75]
v_exp_f32 v67, v67
v_mfma_f32_16x16x32_bf16 v[76:79], a[156:159], a[124:127], v[76:79]
ds_read_b64_tr_b16 a[234:235], v38 offset:28672
v_cvt_pk_bf16_f32 v96, v64, v65
v_mfma_f32_16x16x32_bf16 v[132:135], a[192:195], v[100:103], v[132:135]
v_exp_f32 v68, v68
v_mfma_f32_16x16x32_bf16 v[148:151], a[196:199], v[100:103], v[148:151]
ds_read_b64_tr_b16 a[236:237], v39 offset:24576
v_mfma_f32_16x16x32_bf16 v[164:167], a[200:203], v[100:103], v[164:167]
v_exp_f32 v69, v69
v_mfma_f32_16x16x32_bf16 v[180:183], a[204:207], v[100:103], v[180:183]
v_cvt_pk_bf16_f32 v97, v66, v67
v_mfma_f32_16x16x32_bf16 v[196:199], a[208:211], v[100:103], v[196:199]
ds_read_b64_tr_b16 a[238:239], v39 offset:28672
v_mfma_f32_16x16x32_bf16 v[212:215], a[212:215], v[100:103], v[212:215]
v_exp_f32 v70, v70
v_mfma_f32_16x16x32_bf16 v[228:231], a[216:219], v[100:103], v[228:231]
v_exp_f32 v71, v71
v_mfma_f32_16x16x32_bf16 v[244:247], a[220:223], v[100:103], v[244:247]
v_cvt_pk_bf16_f32 v98, v68, v69
v_cvt_pk_bf16_f32 v99, v70, v71
v_mfma_f32_16x16x32_bf16 a[4:7], a[16:19], v[100:103], a[4:7]
s_waitcnt vmcnt(5) lgkmcnt(4)
s_barrier
v_mfma_f32_16x16x32_bf16 v[64:67], a[160:163], a[64:67], v[104:107]
ds_read_b128 a[128:131], v32 offset:16384
ds_read_b128 a[144:147], v32 offset:20480
v_mfma_f32_16x16x32_bf16 v[68:71], a[176:179], a[64:67], v[104:107]
v_exp_f32 v72, v72
v_mfma_f32_16x16x32_bf16 v[64:67], a[164:167], a[80:83], v[64:67]
ds_read_b64_tr_b16 a[240:241], v40 offset:24576
v_mfma_f32_16x16x32_bf16 v[68:71], a[180:183], a[80:83], v[68:71]
ds_read_b64_tr_b16 a[242:243], v40 offset:28672
v_mfma_f32_16x16x32_bf16 v[64:67], a[168:171], a[96:99], v[64:67]
ds_read_b64_tr_b16 a[244:245], v41 offset:24576
ds_read_b64_tr_b16 a[246:247], v41 offset:28672
v_mfma_f32_16x16x32_bf16 v[68:71], a[184:187], a[96:99], v[68:71]
s_lshl_b32 s62, s89, 2
s_add_u32 s62, s62, s56
v_mfma_f32_16x16x32_bf16 v[64:67], a[172:175], a[112:115], v[64:67]
s_lshl_b32 s63, s62, 5
v_and_b32 v26, 31, v0
v_mfma_f32_16x16x32_bf16 v[68:71], a[188:191], a[112:115], v[68:71]
v_add_u32 v26, s63, v26
v_mfma_f32_16x16x32_bf16 v[136:139], a[192:195], v[96:99], v[136:139]
v_exp_f32 v73, v73
v_mfma_f32_16x16x32_bf16 v[152:155], a[196:199], v[96:99], v[152:155]
v_exp_f32 v74, v74
v_mfma_f32_16x16x32_bf16 v[168:171], a[200:203], v[96:99], v[168:171]
v_exp_f32 v75, v75
v_mfma_f32_16x16x32_bf16 v[184:187], a[204:207], v[96:99], v[184:187]
v_cvt_pk_bf16_f32 v100, v72, v73
v_mfma_f32_16x16x32_bf16 v[200:203], a[208:211], v[96:99], v[200:203]
v_exp_f32 v76, v76
v_mfma_f32_16x16x32_bf16 v[216:219], a[212:215], v[96:99], v[216:219]
v_exp_f32 v77, v77
v_mfma_f32_16x16x32_bf16 v[232:235], a[216:219], v[96:99], v[232:235]
v_cvt_pk_bf16_f32 v101, v74, v75
v_mfma_f32_16x16x32_bf16 v[248:251], a[220:223], v[96:99], v[248:251]
v_exp_f32 v78, v78
v_mfma_f32_16x16x32_bf16 a[8:11], a[16:19], v[96:99], a[8:11]
v_exp_f32 v79, v79
v_cvt_pk_bf16_f32 v102, v76, v77
v_cvt_pk_bf16_f32 v103, v78, v79
v_mfma_f32_16x16x32_bf16 v[72:75], a[160:163], a[68:71], v[108:111]
ds_read_b128 a[132:135], v33 offset:16384
ds_read_b128 a[148:151], v33 offset:20480
v_mfma_f32_16x16x32_bf16 v[76:79], a[176:179], a[68:71], v[108:111]
ds_read_b64_tr_b16 a[248:249], v42 offset:24576
ds_read_b64_tr_b16 a[250:251], v42 offset:28672
v_mfma_f32_16x16x32_bf16 v[72:75], a[164:167], a[84:87], v[72:75]
ds_read_b64_tr_b16 a[252:253], v43 offset:24576
ds_read_b64_tr_b16 a[254:255], v43 offset:28672
v_mfma_f32_16x16x32_bf16 v[76:79], a[180:183], a[84:87], v[76:79]
v_and_b32 v28, 3, v26
v_lshrrev_b32 v26, 2, v26
v_mfma_f32_16x16x32_bf16 v[72:75], a[168:171], a[100:103], v[72:75]
v_mul_u32_u24 v26, 3584, v26
v_lshl_add_u32 v26, v28, 7, v26
v_mfma_f32_16x16x32_bf16 v[76:79], a[184:187], a[100:103], v[76:79]
buffer_load_dword v126, v26, s[32:35], 0 offen
v_mfma_f32_16x16x32_bf16 v[72:75], a[172:175], a[116:119], v[72:75]
v_exp_f32 v64, v64
v_mfma_f32_16x16x32_bf16 v[76:79], a[188:191], a[116:119], v[76:79]
v_exp_f32 v65, v65
v_mfma_f32_16x16x32_bf16 v[140:143], a[192:195], v[100:103], v[140:143]
v_exp_f32 v66, v66
v_mfma_f32_16x16x32_bf16 v[156:159], a[196:199], v[100:103], v[156:159]
v_exp_f32 v67, v67
v_mfma_f32_16x16x32_bf16 v[172:175], a[200:203], v[100:103], v[172:175]
v_cvt_pk_bf16_f32 v96, v64, v65
v_mfma_f32_16x16x32_bf16 v[188:191], a[204:207], v[100:103], v[188:191]
v_exp_f32 v68, v68
v_mfma_f32_16x16x32_bf16 v[204:207], a[208:211], v[100:103], v[204:207]
v_exp_f32 v69, v69
v_mfma_f32_16x16x32_bf16 v[220:223], a[212:215], v[100:103], v[220:223]
v_cvt_pk_bf16_f32 v97, v66, v67
v_mfma_f32_16x16x32_bf16 v[236:239], a[216:219], v[100:103], v[236:239]
v_exp_f32 v70, v70
v_mfma_f32_16x16x32_bf16 v[252:255], a[220:223], v[100:103], v[252:255]
v_exp_f32 v71, v71
v_mfma_f32_16x16x32_bf16 a[12:15], a[16:19], v[100:103], a[12:15]
v_cvt_pk_bf16_f32 v98, v68, v69
v_cvt_pk_bf16_f32 v99, v70, v71
v_mfma_f32_16x16x32_bf16 v[64:67], a[160:163], a[72:75], v[112:115]
ds_read_b128 a[136:139], v34 offset:16384
v_mfma_f32_16x16x32_bf16 v[68:71], a[176:179], a[72:75], v[112:115]
ds_read_b128 a[152:155], v34 offset:20480
v_mfma_f32_16x16x32_bf16 v[64:67], a[164:167], a[88:91], v[64:67]
v_exp_f32 v72, v72
v_mfma_f32_16x16x32_bf16 v[68:71], a[180:183], a[88:91], v[68:71]
v_exp_f32 v73, v73
v_mfma_f32_16x16x32_bf16 v[64:67], a[168:171], a[104:107], v[64:67]
ds_read_b64_tr_b16 a[192:193], v36 offset:32768
v_mfma_f32_16x16x32_bf16 v[68:71], a[184:187], a[104:107], v[68:71]
v_exp_f32 v74, v74
v_mfma_f32_16x16x32_bf16 v[64:67], a[172:175], a[120:123], v[64:67]
v_exp_f32 v75, v75
v_mfma_f32_16x16x32_bf16 v[68:71], a[188:191], a[120:123], v[68:71]
ds_read_b64_tr_b16 a[194:195], v36 offset:36864
v_cvt_pk_bf16_f32 v100, v72, v73
s_waitcnt lgkmcnt(4)
v_mfma_f32_16x16x32_bf16 v[128:131], a[224:227], v[96:99], v[128:131]
v_exp_f32 v76, v76
v_mfma_f32_16x16x32_bf16 v[144:147], a[228:231], v[96:99], v[144:147]
ds_read_b64_tr_b16 a[196:197], v37 offset:32768
v_mfma_f32_16x16x32_bf16 v[160:163], a[232:235], v[96:99], v[160:163]
v_exp_f32 v77, v77
v_mfma_f32_16x16x32_bf16 v[176:179], a[236:239], v[96:99], v[176:179]
v_cvt_pk_bf16_f32 v101, v74, v75
v_mfma_f32_16x16x32_bf16 v[192:195], a[240:243], v[96:99], v[192:195]
ds_read_b64_tr_b16 a[198:199], v37 offset:36864
v_mfma_f32_16x16x32_bf16 v[208:211], a[244:247], v[96:99], v[208:211]
v_exp_f32 v78, v78
v_mfma_f32_16x16x32_bf16 v[224:227], a[248:251], v[96:99], v[224:227]
v_exp_f32 v79, v79
v_mfma_f32_16x16x32_bf16 v[240:243], a[252:255], v[96:99], v[240:243]
v_cvt_pk_bf16_f32 v102, v76, v77
v_cvt_pk_bf16_f32 v103, v78, v79
v_mfma_f32_16x16x32_bf16 a[0:3], a[16:19], v[96:99], a[0:3]
v_mfma_f32_16x16x32_bf16 v[72:75], a[160:163], a[76:79], v[116:119]
ds_read_b128 a[140:143], v35 offset:16384
v_mfma_f32_16x16x32_bf16 v[76:79], a[176:179], a[76:79], v[116:119]
ds_read_b128 a[156:159], v35 offset:20480
v_mfma_f32_16x16x32_bf16 v[72:75], a[164:167], a[92:95], v[72:75]
v_exp_f32 v64, v64
v_mfma_f32_16x16x32_bf16 v[76:79], a[180:183], a[92:95], v[76:79]
v_exp_f32 v65, v65
v_mfma_f32_16x16x32_bf16 v[72:75], a[168:171], a[108:111], v[72:75]
ds_read_b64_tr_b16 a[200:201], v38 offset:32768
v_mfma_f32_16x16x32_bf16 v[76:79], a[184:187], a[108:111], v[76:79]
v_exp_f32 v66, v66
v_mfma_f32_16x16x32_bf16 v[72:75], a[172:175], a[124:127], v[72:75]
v_exp_f32 v67, v67
v_mfma_f32_16x16x32_bf16 v[76:79], a[188:191], a[124:127], v[76:79]
ds_read_b64_tr_b16 a[202:203], v38 offset:36864
v_cvt_pk_bf16_f32 v96, v64, v65
v_mfma_f32_16x16x32_bf16 v[132:135], a[224:227], v[100:103], v[132:135]
v_exp_f32 v68, v68
v_mfma_f32_16x16x32_bf16 v[148:151], a[228:231], v[100:103], v[148:151]
ds_read_b64_tr_b16 a[204:205], v39 offset:32768
v_mfma_f32_16x16x32_bf16 v[164:167], a[232:235], v[100:103], v[164:167]
v_exp_f32 v69, v69
v_mfma_f32_16x16x32_bf16 v[180:183], a[236:239], v[100:103], v[180:183]
v_cvt_pk_bf16_f32 v97, v66, v67
v_mfma_f32_16x16x32_bf16 v[196:199], a[240:243], v[100:103], v[196:199]
ds_read_b64_tr_b16 a[206:207], v39 offset:36864
v_mfma_f32_16x16x32_bf16 v[212:215], a[244:247], v[100:103], v[212:215]
v_exp_f32 v70, v70
v_mfma_f32_16x16x32_bf16 v[228:231], a[248:251], v[100:103], v[228:231]
v_exp_f32 v71, v71
v_mfma_f32_16x16x32_bf16 v[244:247], a[252:255], v[100:103], v[244:247]
v_cvt_pk_bf16_f32 v98, v68, v69
v_cvt_pk_bf16_f32 v99, v70, v71
v_mfma_f32_16x16x32_bf16 a[4:7], a[16:19], v[100:103], a[4:7]
s_waitcnt vmcnt(2) lgkmcnt(4)
s_barrier
v_mfma_f32_16x16x32_bf16 v[64:67], a[128:131], a[64:67], v[104:107]
ds_read_b128 a[160:163], v32 offset:24576
v_mfma_f32_16x16x32_bf16 v[68:71], a[144:147], a[64:67], v[104:107]
ds_read_b128 a[176:179], v32 offset:28672
v_mfma_f32_16x16x32_bf16 v[64:67], a[132:135], a[80:83], v[64:67]
v_exp_f32 v72, v72
v_mfma_f32_16x16x32_bf16 v[68:71], a[148:151], a[80:83], v[68:71]
v_exp_f32 v73, v73
v_mfma_f32_16x16x32_bf16 v[64:67], a[136:139], a[96:99], v[64:67]
ds_read_b64_tr_b16 a[208:209], v40 offset:32768
v_mfma_f32_16x16x32_bf16 v[68:71], a[152:155], a[96:99], v[68:71]
v_exp_f32 v74, v74
v_mfma_f32_16x16x32_bf16 v[64:67], a[140:143], a[112:115], v[64:67]
v_exp_f32 v75, v75
v_mfma_f32_16x16x32_bf16 v[68:71], a[156:159], a[112:115], v[68:71]
ds_read_b64_tr_b16 a[210:211], v40 offset:36864
v_cvt_pk_bf16_f32 v100, v72, v73
v_mfma_f32_16x16x32_bf16 v[136:139], a[224:227], v[96:99], v[136:139]
v_exp_f32 v76, v76
v_mfma_f32_16x16x32_bf16 v[152:155], a[228:231], v[96:99], v[152:155]
ds_read_b64_tr_b16 a[212:213], v41 offset:32768
v_mfma_f32_16x16x32_bf16 v[168:171], a[232:235], v[96:99], v[168:171]
v_exp_f32 v77, v77
v_mfma_f32_16x16x32_bf16 v[184:187], a[236:239], v[96:99], v[184:187]
v_cvt_pk_bf16_f32 v101, v74, v75
v_mfma_f32_16x16x32_bf16 v[200:203], a[240:243], v[96:99], v[200:203]
ds_read_b64_tr_b16 a[214:215], v41 offset:36864
v_mfma_f32_16x16x32_bf16 v[216:219], a[244:247], v[96:99], v[216:219]
v_exp_f32 v78, v78
v_mfma_f32_16x16x32_bf16 v[232:235], a[248:251], v[96:99], v[232:235]
v_exp_f32 v79, v79
v_mfma_f32_16x16x32_bf16 v[248:251], a[252:255], v[96:99], v[248:251]
v_cvt_pk_bf16_f32 v102, v76, v77
v_cvt_pk_bf16_f32 v103, v78, v79
v_mfma_f32_16x16x32_bf16 a[8:11], a[16:19], v[96:99], a[8:11]
v_mfma_f32_16x16x32_bf16 v[72:75], a[128:131], a[68:71], v[108:111]
ds_read_b128 a[164:167], v33 offset:24576
v_mfma_f32_16x16x32_bf16 v[76:79], a[144:147], a[68:71], v[108:111]
ds_read_b128 a[180:183], v33 offset:28672
v_mfma_f32_16x16x32_bf16 v[72:75], a[132:135], a[84:87], v[72:75]
v_exp_f32 v64, v64
v_mfma_f32_16x16x32_bf16 v[76:79], a[148:151], a[84:87], v[76:79]
v_exp_f32 v65, v65
v_mfma_f32_16x16x32_bf16 v[72:75], a[136:139], a[100:103], v[72:75]
ds_read_b64_tr_b16 a[216:217], v42 offset:32768
v_mfma_f32_16x16x32_bf16 v[76:79], a[152:155], a[100:103], v[76:79]
v_exp_f32 v66, v66
v_mfma_f32_16x16x32_bf16 v[72:75], a[140:143], a[116:119], v[72:75]
v_exp_f32 v67, v67
v_mfma_f32_16x16x32_bf16 v[76:79], a[156:159], a[116:119], v[76:79]
ds_read_b64_tr_b16 a[218:219], v42 offset:36864
v_cvt_pk_bf16_f32 v96, v64, v65
v_mfma_f32_16x16x32_bf16 v[140:143], a[224:227], v[100:103], v[140:143]
v_exp_f32 v68, v68
v_mfma_f32_16x16x32_bf16 v[156:159], a[228:231], v[100:103], v[156:159]
ds_read_b64_tr_b16 a[220:221], v43 offset:32768
v_mfma_f32_16x16x32_bf16 v[172:175], a[232:235], v[100:103], v[172:175]
v_exp_f32 v69, v69
v_mfma_f32_16x16x32_bf16 v[188:191], a[236:239], v[100:103], v[188:191]
v_cvt_pk_bf16_f32 v97, v66, v67
v_mfma_f32_16x16x32_bf16 v[204:207], a[240:243], v[100:103], v[204:207]
ds_read_b64_tr_b16 a[222:223], v43 offset:36864
v_mfma_f32_16x16x32_bf16 v[220:223], a[244:247], v[100:103], v[220:223]
v_exp_f32 v70, v70
v_mfma_f32_16x16x32_bf16 v[236:239], a[248:251], v[100:103], v[236:239]
v_exp_f32 v71, v71
v_mfma_f32_16x16x32_bf16 v[252:255], a[252:255], v[100:103], v[252:255]
v_cvt_pk_bf16_f32 v98, v68, v69
v_cvt_pk_bf16_f32 v99, v70, v71
v_mfma_f32_16x16x32_bf16 a[12:15], a[16:19], v[100:103], a[12:15]
v_mfma_f32_16x16x32_bf16 v[64:67], a[128:131], a[72:75], v[112:115]
ds_read_b128 a[168:171], v34 offset:24576
ds_read_b128 a[184:187], v34 offset:28672
v_mfma_f32_16x16x32_bf16 v[68:71], a[144:147], a[72:75], v[112:115]
v_exp_f32 v72, v72
v_mfma_f32_16x16x32_bf16 v[64:67], a[132:135], a[88:91], v[64:67]
ds_read_b64_tr_b16 a[224:225], v36 offset:0
v_mfma_f32_16x16x32_bf16 v[68:71], a[148:151], a[88:91], v[68:71]
v_exp_f32 v73, v73
v_mfma_f32_16x16x32_bf16 v[64:67], a[136:139], a[104:107], v[64:67]
ds_read_b64_tr_b16 a[226:227], v36 offset:4096
v_mfma_f32_16x16x32_bf16 v[68:71], a[152:155], a[104:107], v[68:71]
ds_read_b64_tr_b16 a[228:229], v37 offset:0
v_mfma_f32_16x16x32_bf16 v[64:67], a[140:143], a[120:123], v[64:67]
ds_read_b64_tr_b16 a[230:231], v37 offset:4096
s_lshl_b32 s62, s89, 2
v_mfma_f32_16x16x32_bf16 v[68:71], a[156:159], a[120:123], v[68:71]
s_add_u32 s62, s62, s56
s_lshl_b32 s63, s62, 5
s_waitcnt lgkmcnt(6)
v_mfma_f32_16x16x32_bf16 v[128:131], a[192:195], v[96:99], v[128:131]
v_and_b32 v26, 31, v0
v_mfma_f32_16x16x32_bf16 v[144:147], a[196:199], v[96:99], v[144:147]
v_exp_f32 v74, v74
v_mfma_f32_16x16x32_bf16 v[160:163], a[200:203], v[96:99], v[160:163]
v_exp_f32 v75, v75
v_mfma_f32_16x16x32_bf16 v[176:179], a[204:207], v[96:99], v[176:179]
v_cvt_pk_bf16_f32 v100, v72, v73
v_mfma_f32_16x16x32_bf16 v[192:195], a[208:211], v[96:99], v[192:195]
v_exp_f32 v76, v76
v_mfma_f32_16x16x32_bf16 v[208:211], a[212:215], v[96:99], v[208:211]
v_exp_f32 v77, v77
v_mfma_f32_16x16x32_bf16 v[224:227], a[216:219], v[96:99], v[224:227]
v_cvt_pk_bf16_f32 v101, v74, v75
v_mfma_f32_16x16x32_bf16 v[240:243], a[220:223], v[96:99], v[240:243]
v_exp_f32 v78, v78
v_mfma_f32_16x16x32_bf16 a[0:3], a[16:19], v[96:99], a[0:3]
v_exp_f32 v79, v79
v_cvt_pk_bf16_f32 v102, v76, v77
v_cvt_pk_bf16_f32 v103, v78, v79
v_mfma_f32_16x16x32_bf16 v[72:75], a[128:131], a[76:79], v[116:119]
ds_read_b128 a[172:175], v35 offset:24576
ds_read_b128 a[188:191], v35 offset:28672
v_mfma_f32_16x16x32_bf16 v[76:79], a[144:147], a[76:79], v[116:119]
v_exp_f32 v64, v64
v_mfma_f32_16x16x32_bf16 v[72:75], a[132:135], a[92:95], v[72:75]
ds_read_b64_tr_b16 a[232:233], v38 offset:0
v_mfma_f32_16x16x32_bf16 v[76:79], a[148:151], a[92:95], v[76:79]
ds_read_b64_tr_b16 a[234:235], v38 offset:4096
v_mfma_f32_16x16x32_bf16 v[72:75], a[136:139], a[108:111], v[72:75]
ds_read_b64_tr_b16 a[236:237], v39 offset:0
ds_read_b64_tr_b16 a[238:239], v39 offset:4096
v_mfma_f32_16x16x32_bf16 v[76:79], a[152:155], a[108:111], v[76:79]
v_add_u32 v26, s63, v26
v_lshlrev_b32 v26, 7, v26
v_mfma_f32_16x16x32_bf16 v[72:75], a[140:143], a[124:127], v[72:75]
buffer_load_dword v124, v26, s[36:39], 0 offen
v_mfma_f32_16x16x32_bf16 v[76:79], a[156:159], a[124:127], v[76:79]
v_exp_f32 v65, v65
v_mfma_f32_16x16x32_bf16 v[132:135], a[192:195], v[100:103], v[132:135]
v_exp_f32 v66, v66
v_mfma_f32_16x16x32_bf16 v[148:151], a[196:199], v[100:103], v[148:151]
v_exp_f32 v67, v67
v_mfma_f32_16x16x32_bf16 v[164:167], a[200:203], v[100:103], v[164:167]
v_cvt_pk_bf16_f32 v96, v64, v65
v_mfma_f32_16x16x32_bf16 v[180:183], a[204:207], v[100:103], v[180:183]
v_exp_f32 v68, v68
v_mfma_f32_16x16x32_bf16 v[196:199], a[208:211], v[100:103], v[196:199]
v_exp_f32 v69, v69
v_mfma_f32_16x16x32_bf16 v[212:215], a[212:215], v[100:103], v[212:215]
v_cvt_pk_bf16_f32 v97, v66, v67
v_mfma_f32_16x16x32_bf16 v[228:231], a[216:219], v[100:103], v[228:231]
v_exp_f32 v70, v70
v_mfma_f32_16x16x32_bf16 v[244:247], a[220:223], v[100:103], v[244:247]
v_exp_f32 v71, v71
v_mfma_f32_16x16x32_bf16 a[4:7], a[16:19], v[100:103], a[4:7]
v_cvt_pk_bf16_f32 v98, v68, v69
v_cvt_pk_bf16_f32 v99, v70, v71
s_waitcnt lgkmcnt(4)
s_barrier
v_mfma_f32_16x16x32_bf16 v[64:67], a[160:163], a[64:67], v[104:107]
ds_read_b64_tr_b16 a[240:241], v40 offset:0
v_mfma_f32_16x16x32_bf16 v[68:71], a[176:179], a[64:67], v[104:107]
v_exp_f32 v72, v72
v_mfma_f32_16x16x32_bf16 v[64:67], a[164:167], a[80:83], v[64:67]
ds_read_b64_tr_b16 a[242:243], v40 offset:4096
v_mfma_f32_16x16x32_bf16 v[68:71], a[180:183], a[80:83], v[68:71]
v_exp_f32 v73, v73
v_mfma_f32_16x16x32_bf16 v[64:67], a[168:171], a[96:99], v[64:67]
v_exp_f32 v74, v74
v_mfma_f32_16x16x32_bf16 v[68:71], a[184:187], a[96:99], v[68:71]
v_exp_f32 v75, v75
v_mfma_f32_16x16x32_bf16 v[64:67], a[172:175], a[112:115], v[64:67]
ds_read_b64_tr_b16 a[244:245], v41 offset:0
v_cvt_pk_bf16_f32 v100, v72, v73
v_mfma_f32_16x16x32_bf16 v[68:71], a[188:191], a[112:115], v[68:71]
v_exp_f32 v76, v76
v_mfma_f32_16x16x32_bf16 v[136:139], a[192:195], v[96:99], v[136:139]
v_exp_f32 v77, v77
v_mfma_f32_16x16x32_bf16 v[152:155], a[196:199], v[96:99], v[152:155]
v_mfma_f32_16x16x32_bf16 v[168:171], a[200:203], v[96:99], v[168:171]
ds_read_b64_tr_b16 a[246:247], v41 offset:4096
v_cvt_pk_bf16_f32 v101, v74, v75
v_mfma_f32_16x16x32_bf16 v[184:187], a[204:207], v[96:99], v[184:187]
v_exp_f32 v78, v78
v_mfma_f32_16x16x32_bf16 v[200:203], a[208:211], v[96:99], v[200:203]
v_mfma_f32_16x16x32_bf16 v[216:219], a[212:215], v[96:99], v[216:219]
v_exp_f32 v79, v79
v_mfma_f32_16x16x32_bf16 v[232:235], a[216:219], v[96:99], v[232:235]
v_cvt_pk_bf16_f32 v102, v76, v77
v_mfma_f32_16x16x32_bf16 v[248:251], a[220:223], v[96:99], v[248:251]
v_cvt_pk_bf16_f32 v103, v78, v79
v_mfma_f32_16x16x32_bf16 a[8:11], a[16:19], v[96:99], a[8:11]
v_mfma_f32_16x16x32_bf16 v[72:75], a[160:163], a[68:71], v[108:111]
ds_read_b64_tr_b16 a[248:249], v42 offset:0
v_mfma_f32_16x16x32_bf16 v[76:79], a[176:179], a[68:71], v[108:111]
v_exp_f32 v64, v64
v_mfma_f32_16x16x32_bf16 v[72:75], a[164:167], a[84:87], v[72:75]
ds_read_b64_tr_b16 a[250:251], v42 offset:4096
v_mfma_f32_16x16x32_bf16 v[76:79], a[180:183], a[84:87], v[76:79]
v_exp_f32 v65, v65
v_mfma_f32_16x16x32_bf16 v[72:75], a[168:171], a[100:103], v[72:75]
v_exp_f32 v66, v66
v_mfma_f32_16x16x32_bf16 v[76:79], a[184:187], a[100:103], v[76:79]
v_exp_f32 v67, v67
v_mfma_f32_16x16x32_bf16 v[72:75], a[172:175], a[116:119], v[72:75]
ds_read_b64_tr_b16 a[252:253], v43 offset:0
v_cvt_pk_bf16_f32 v96, v64, v65
v_mfma_f32_16x16x32_bf16 v[76:79], a[188:191], a[116:119], v[76:79]
v_exp_f32 v68, v68
v_mfma_f32_16x16x32_bf16 v[140:143], a[192:195], v[100:103], v[140:143]
v_exp_f32 v69, v69
v_mfma_f32_16x16x32_bf16 v[156:159], a[196:199], v[100:103], v[156:159]
v_mfma_f32_16x16x32_bf16 v[172:175], a[200:203], v[100:103], v[172:175]
ds_read_b64_tr_b16 a[254:255], v43 offset:4096
v_cvt_pk_bf16_f32 v97, v66, v67
v_mfma_f32_16x16x32_bf16 v[188:191], a[204:207], v[100:103], v[188:191]
v_exp_f32 v70, v70
v_mfma_f32_16x16x32_bf16 v[204:207], a[208:211], v[100:103], v[204:207]
v_mfma_f32_16x16x32_bf16 v[220:223], a[212:215], v[100:103], v[220:223]
v_exp_f32 v71, v71
v_mfma_f32_16x16x32_bf16 v[236:239], a[216:219], v[100:103], v[236:239]
v_cvt_pk_bf16_f32 v98, v68, v69
v_mfma_f32_16x16x32_bf16 v[252:255], a[220:223], v[100:103], v[252:255]
v_cvt_pk_bf16_f32 v99, v70, v71
v_mfma_f32_16x16x32_bf16 a[12:15], a[16:19], v[100:103], a[12:15]
v_mfma_f32_16x16x32_bf16 v[64:67], a[160:163], a[72:75], v[112:115]
v_exp_f32 v72, v72
v_mfma_f32_16x16x32_bf16 v[68:71], a[176:179], a[72:75], v[112:115]
v_exp_f32 v73, v73
v_mfma_f32_16x16x32_bf16 v[64:67], a[164:167], a[88:91], v[64:67]
v_exp_f32 v74, v74
v_mfma_f32_16x16x32_bf16 v[68:71], a[180:183], a[88:91], v[68:71]
v_mfma_f32_16x16x32_bf16 v[64:67], a[168:171], a[104:107], v[64:67]
v_exp_f32 v75, v75
v_mfma_f32_16x16x32_bf16 v[68:71], a[184:187], a[104:107], v[68:71]
v_mfma_f32_16x16x32_bf16 v[64:67], a[172:175], a[120:123], v[64:67]
v_cvt_pk_bf16_f32 v100, v72, v73
v_mfma_f32_16x16x32_bf16 v[68:71], a[188:191], a[120:123], v[68:71]
v_exp_f32 v76, v76
s_waitcnt lgkmcnt(0)
v_mfma_f32_16x16x32_bf16 v[128:131], a[224:227], v[96:99], v[128:131]
v_exp_f32 v77, v77
v_mfma_f32_16x16x32_bf16 v[144:147], a[228:231], v[96:99], v[144:147]
v_mfma_f32_16x16x32_bf16 v[160:163], a[232:235], v[96:99], v[160:163]
v_cvt_pk_bf16_f32 v101, v74, v75
v_mfma_f32_16x16x32_bf16 v[176:179], a[236:239], v[96:99], v[176:179]
v_exp_f32 v78, v78
v_mfma_f32_16x16x32_bf16 v[192:195], a[240:243], v[96:99], v[192:195]
v_mfma_f32_16x16x32_bf16 v[208:211], a[244:247], v[96:99], v[208:211]
v_exp_f32 v79, v79
v_mfma_f32_16x16x32_bf16 v[224:227], a[248:251], v[96:99], v[224:227]
v_cvt_pk_bf16_f32 v102, v76, v77
v_mfma_f32_16x16x32_bf16 v[240:243], a[252:255], v[96:99], v[240:243]
v_cvt_pk_bf16_f32 v103, v78, v79
v_mfma_f32_16x16x32_bf16 a[0:3], a[16:19], v[96:99], a[0:3]
v_mfma_f32_16x16x32_bf16 v[72:75], a[160:163], a[76:79], v[116:119]
v_exp_f32 v64, v64
v_mfma_f32_16x16x32_bf16 v[76:79], a[176:179], a[76:79], v[116:119]
v_exp_f32 v65, v65
v_mfma_f32_16x16x32_bf16 v[72:75], a[164:167], a[92:95], v[72:75]
v_exp_f32 v66, v66
v_mfma_f32_16x16x32_bf16 v[76:79], a[180:183], a[92:95], v[76:79]
v_mfma_f32_16x16x32_bf16 v[72:75], a[168:171], a[108:111], v[72:75]
v_exp_f32 v67, v67
v_mfma_f32_16x16x32_bf16 v[76:79], a[184:187], a[108:111], v[76:79]
v_mfma_f32_16x16x32_bf16 v[72:75], a[172:175], a[124:127], v[72:75]
v_cvt_pk_bf16_f32 v96, v64, v65
v_mfma_f32_16x16x32_bf16 v[76:79], a[188:191], a[124:127], v[76:79]
v_exp_f32 v68, v68
v_mfma_f32_16x16x32_bf16 v[132:135], a[224:227], v[100:103], v[132:135]
v_exp_f32 v69, v69
v_mfma_f32_16x16x32_bf16 v[148:151], a[228:231], v[100:103], v[148:151]
v_mfma_f32_16x16x32_bf16 v[164:167], a[232:235], v[100:103], v[164:167]
v_cvt_pk_bf16_f32 v97, v66, v67
v_mfma_f32_16x16x32_bf16 v[180:183], a[236:239], v[100:103], v[180:183]
v_exp_f32 v70, v70
v_mfma_f32_16x16x32_bf16 v[196:199], a[240:243], v[100:103], v[196:199]
v_mfma_f32_16x16x32_bf16 v[212:215], a[244:247], v[100:103], v[212:215]
v_exp_f32 v71, v71
v_mfma_f32_16x16x32_bf16 v[228:231], a[248:251], v[100:103], v[228:231]
v_cvt_pk_bf16_f32 v98, v68, v69
v_mfma_f32_16x16x32_bf16 v[244:247], a[252:255], v[100:103], v[244:247]
v_cvt_pk_bf16_f32 v99, v70, v71
v_mfma_f32_16x16x32_bf16 a[4:7], a[16:19], v[100:103], a[4:7]
s_barrier
v_mfma_f32_16x16x32_bf16 v[136:139], a[224:227], v[96:99], v[136:139]
s_add_u32 m0, s60, 0
s_add_u32 s61, s69, 0
v_exp_f32 v72, v72
v_mfma_f32_16x16x32_bf16 v[152:155], a[228:231], v[96:99], v[152:155]
buffer_load_dwordx4 v2, s[20:23], s61 offen offset:0 lds
v_exp_f32 v73, v73
v_mfma_f32_16x16x32_bf16 v[168:171], a[232:235], v[96:99], v[168:171]
buffer_load_dwordx4 v3, s[20:23], s61 offen offset:1024 lds
v_exp_f32 v74, v74
v_mfma_f32_16x16x32_bf16 v[184:187], a[236:239], v[96:99], v[184:187]
buffer_load_dwordx4 v4, s[20:23], s61 offen offset:2048 lds
v_exp_f32 v75, v75
v_cvt_pk_bf16_f32 v100, v72, v73
v_mfma_f32_16x16x32_bf16 v[200:203], a[240:243], v[96:99], v[200:203]
buffer_load_dwordx4 v5, s[20:23], s61 offen offset:3072 lds
s_add_u32 m0, s60, 4096
s_add_u32 s61, s69, 32768
v_mfma_f32_16x16x32_bf16 v[216:219], a[244:247], v[96:99], v[216:219]
buffer_load_dwordx4 v2, s[20:23], s61 offen offset:0 lds
v_exp_f32 v76, v76
v_mfma_f32_16x16x32_bf16 v[232:235], a[248:251], v[96:99], v[232:235]
buffer_load_dwordx4 v3, s[20:23], s61 offen offset:1024 lds
buffer_load_dwordx4 v4, s[20:23], s61 offen offset:2048 lds
v_mfma_f32_16x16x32_bf16 v[248:251], a[252:255], v[96:99], v[248:251]
buffer_load_dwordx4 v5, s[20:23], s61 offen offset:3072 lds
v_exp_f32 v77, v77
v_cvt_pk_bf16_f32 v101, v74, v75
v_mfma_f32_16x16x32_bf16 a[8:11], a[16:19], v[96:99], a[8:11]
v_exp_f32 v78, v78
v_exp_f32 v79, v79
v_cvt_pk_bf16_f32 v102, v76, v77
v_cvt_pk_bf16_f32 v103, v78, v79
s_nop 1
v_mfma_f32_16x16x32_bf16 v[140:143], a[224:227], v[100:103], v[140:143]
s_add_u32 m0, s60, 8192
s_add_u32 s61, s69, 65536
v_mfma_f32_16x16x32_bf16 v[156:159], a[228:231], v[100:103], v[156:159]
buffer_load_dwordx4 v2, s[20:23], s61 offen offset:0 lds
v_mfma_f32_16x16x32_bf16 v[172:175], a[232:235], v[100:103], v[172:175]
buffer_load_dwordx4 v3, s[20:23], s61 offen offset:1024 lds
v_mfma_f32_16x16x32_bf16 v[188:191], a[236:239], v[100:103], v[188:191]
v_mfma_f32_16x16x32_bf16 v[204:207], a[240:243], v[100:103], v[204:207]
buffer_load_dwordx4 v4, s[20:23], s61 offen offset:2048 lds
v_mfma_f32_16x16x32_bf16 v[220:223], a[244:247], v[100:103], v[220:223]
v_mfma_f32_16x16x32_bf16 v[236:239], a[248:251], v[100:103], v[236:239]
buffer_load_dwordx4 v5, s[20:23], s61 offen offset:3072 lds
v_mfma_f32_16x16x32_bf16 v[252:255], a[252:255], v[100:103], v[252:255]
v_mfma_f32_16x16x32_bf16 a[12:15], a[16:19], v[100:103], a[12:15]
L_back:
s_add_u32 m0, s60, 12288
s_add_u32 s61, s69, 98304
buffer_load_dwordx4 v2, s[20:23], s61 offen offset:0 lds
buffer_load_dwordx4 v3, s[20:23], s61 offen offset:1024 lds
buffer_load_dwordx4 v4, s[20:23], s61 offen offset:2048 lds
buffer_load_dwordx4 v5, s[20:23], s61 offen offset:3072 lds
v_accvgpr_read_b32 v120, a0
v_accvgpr_read_b32 v121, a4
v_accvgpr_read_b32 v122, a8
v_accvgpr_read_b32 v123, a12
v_max3_f32 v26, v120, v121, v122
v_max_f32 v26, v26, v123
v_mov_b32 v27, 0x4b800000
v_cmp_nlt_f32 vcc, v26, v27
v_rcp_f32 v120, v120
v_rcp_f32 v121, v121
v_rcp_f32 v122, v122
v_rcp_f32 v123, v123
s_cmp_lg_u64 vcc, 0
s_cselect_b32 s63, 1, 0
v_mov_b32 v26, s63
s_lshl_b32 s63, s56, 2
s_add_u32 s63, s63, 159744
v_mov_b32 v27, s63
ds_write_b32 v27, v26
s_add_u32 s63, s56, 0
s_and_b32 s63, s63, 3
s_lshl_b32 s63, s63, 10
s_add_u32 s63, s63, s59
v_add_u32 v64, s63, v1
s_add_u32 s63, s56, 1
s_and_b32 s63, s63, 3
s_lshl_b32 s63, s63, 10
s_add_u32 s63, s63, s59
v_add_u32 v65, s63, v1
s_add_u32 s63, s56, 2
s_and_b32 s63, s63, 3
s_lshl_b32 s63, s63, 10
s_add_u32 s63, s63, s59
v_add_u32 v66, s63, v1
s_add_u32 s63, s56, 3
s_and_b32 s63, s63, 3
s_lshl_b32 s63, s63, 10
s_add_u32 s63, s63, s59
v_add_u32 v67, s63, v1
v_pk_mul_f32 v[128:129], v[128:129], v[120:121] op_sel:[0,0] op_sel_hi:[1,0]
v_pk_mul_f32 v[130:131], v[130:131], v[120:121] op_sel:[0,0] op_sel_hi:[1,0]
v_pk_mul_f32 v[144:145], v[144:145], v[120:121] op_sel:[0,0] op_sel_hi:[1,0]
v_pk_mul_f32 v[146:147], v[146:147], v[120:121] op_sel:[0,0] op_sel_hi:[1,0]
v_cvt_pk_bf16_f32 v128, v128, v129
v_cvt_pk_bf16_f32 v129, v130, v131
v_cvt_pk_bf16_f32 v130, v144, v145
v_cvt_pk_bf16_f32 v131, v146, v147
v_pk_mul_f32 v[160:161], v[160:161], v[120:121] op_sel:[0,0] op_sel_hi:[1,0]
v_pk_mul_f32 v[162:163], v[162:163], v[120:121] op_sel:[0,0] op_sel_hi:[1,0]
v_pk_mul_f32 v[176:177], v[176:177], v[120:121] op_sel:[0,0] op_sel_hi:[1,0]
v_pk_mul_f32 v[178:179], v[178:179], v[120:121] op_sel:[0,0] op_sel_hi:[1,0]
v_cvt_pk_bf16_f32 v160, v160, v161
v_cvt_pk_bf16_f32 v161, v162, v163
v_cvt_pk_bf16_f32 v162, v176, v177
v_cvt_pk_bf16_f32 v163, v178, v179
ds_write_b128 v64, v[128:131] offset:0
v_pk_mul_f32 v[192:193], v[192:193], v[120:121] op_sel:[0,0] op_sel_hi:[1,0]
v_pk_mul_f32 v[194:195], v[194:195], v[120:121] op_sel:[0,0] op_sel_hi:[1,0]
v_pk_mul_f32 v[208:209], v[208:209], v[120:121] op_sel:[0,0] op_sel_hi:[1,0]
v_pk_mul_f32 v[210:211], v[210:211], v[120:121] op_sel:[0,0] op_sel_hi:[1,0]
v_cvt_pk_bf16_f32 v192, v192, v193
v_cvt_pk_bf16_f32 v193, v194, v195
v_cvt_pk_bf16_f32 v194, v208, v209
v_cvt_pk_bf16_f32 v195, v210, v211
ds_write_b128 v64, v[160:163] offset:4096
v_pk_mul_f32 v[224:225], v[224:225], v[120:121] op_sel:[0,0] op_sel_hi:[1,0]
v_pk_mul_f32 v[226:227], v[226:227], v[120:121] op_sel:[0,0] op_sel_hi:[1,0]
v_pk_mul_f32 v[240:241], v[240:241], v[120:121] op_sel:[0,0] op_sel_hi:[1,0]
v_pk_mul_f32 v[242:243], v[242:243], v[120:121] op_sel:[0,0] op_sel_hi:[1,0]
v_cvt_pk_bf16_f32 v224, v224, v225
v_cvt_pk_bf16_f32 v225, v226, v227
v_cvt_pk_bf16_f32 v226, v240, v241
v_cvt_pk_bf16_f32 v227, v242, v243
ds_write_b128 v64, v[192:195] offset:8192
ds_write_b128 v64, v[224:227] offset:12288
v_pk_mul_f32 v[132:133], v[132:133], v[120:121] op_sel:[0,1] op_sel_hi:[1,1]
v_pk_mul_f32 v[134:135], v[134:135], v[120:121] op_sel:[0,1] op_sel_hi:[1,1]
v_pk_mul_f32 v[148:149], v[148:149], v[120:121] op_sel:[0,1] op_sel_hi:[1,1]
v_pk_mul_f32 v[150:151], v[150:151], v[120:121] op_sel:[0,1] op_sel_hi:[1,1]
v_cvt_pk_bf16_f32 v132, v132, v133
v_cvt_pk_bf16_f32 v133, v134, v135
v_cvt_pk_bf16_f32 v134, v148, v149
v_cvt_pk_bf16_f32 v135, v150, v151
v_pk_mul_f32 v[164:165], v[164:165], v[120:121] op_sel:[0,1] op_sel_hi:[1,1]
v_pk_mul_f32 v[166:167], v[166:167], v[120:121] op_sel:[0,1] op_sel_hi:[1,1]
v_pk_mul_f32 v[180:181], v[180:181], v[120:121] op_sel:[0,1] op_sel_hi:[1,1]
v_pk_mul_f32 v[182:183], v[182:183], v[120:121] op_sel:[0,1] op_sel_hi:[1,1]
v_cvt_pk_bf16_f32 v164, v164, v165
v_cvt_pk_bf16_f32 v165, v166, v167
v_cvt_pk_bf16_f32 v166, v180, v181
v_cvt_pk_bf16_f32 v167, v182, v183
ds_write_b128 v65, v[132:135] offset:0
v_pk_mul_f32 v[196:197], v[196:197], v[120:121] op_sel:[0,1] op_sel_hi:[1,1]
v_pk_mul_f32 v[198:199], v[198:199], v[120:121] op_sel:[0,1] op_sel_hi:[1,1]
v_pk_mul_f32 v[212:213], v[212:213], v[120:121] op_sel:[0,1] op_sel_hi:[1,1]
v_pk_mul_f32 v[214:215], v[214:215], v[120:121] op_sel:[0,1] op_sel_hi:[1,1]
v_cvt_pk_bf16_f32 v196, v196, v197
v_cvt_pk_bf16_f32 v197, v198, v199
v_cvt_pk_bf16_f32 v198, v212, v213
v_cvt_pk_bf16_f32 v199, v214, v215
ds_write_b128 v65, v[164:167] offset:4096
v_pk_mul_f32 v[228:229], v[228:229], v[120:121] op_sel:[0,1] op_sel_hi:[1,1]
v_pk_mul_f32 v[230:231], v[230:231], v[120:121] op_sel:[0,1] op_sel_hi:[1,1]
v_pk_mul_f32 v[244:245], v[244:245], v[120:121] op_sel:[0,1] op_sel_hi:[1,1]
v_pk_mul_f32 v[246:247], v[246:247], v[120:121] op_sel:[0,1] op_sel_hi:[1,1]
v_cvt_pk_bf16_f32 v228, v228, v229
v_cvt_pk_bf16_f32 v229, v230, v231
v_cvt_pk_bf16_f32 v230, v244, v245
v_cvt_pk_bf16_f32 v231, v246, v247
ds_write_b128 v65, v[196:199] offset:8192
ds_write_b128 v65, v[228:231] offset:12288
v_pk_mul_f32 v[136:137], v[136:137], v[122:123] op_sel:[0,0] op_sel_hi:[1,0]
v_pk_mul_f32 v[138:139], v[138:139], v[122:123] op_sel:[0,0] op_sel_hi:[1,0]
v_pk_mul_f32 v[152:153], v[152:153], v[122:123] op_sel:[0,0] op_sel_hi:[1,0]
v_pk_mul_f32 v[154:155], v[154:155], v[122:123] op_sel:[0,0] op_sel_hi:[1,0]
v_cvt_pk_bf16_f32 v136, v136, v137
v_cvt_pk_bf16_f32 v137, v138, v139
v_cvt_pk_bf16_f32 v138, v152, v153
v_cvt_pk_bf16_f32 v139, v154, v155
v_pk_mul_f32 v[168:169], v[168:169], v[122:123] op_sel:[0,0] op_sel_hi:[1,0]
v_pk_mul_f32 v[170:171], v[170:171], v[122:123] op_sel:[0,0] op_sel_hi:[1,0]
v_pk_mul_f32 v[184:185], v[184:185], v[122:123] op_sel:[0,0] op_sel_hi:[1,0]
v_pk_mul_f32 v[186:187], v[186:187], v[122:123] op_sel:[0,0] op_sel_hi:[1,0]
v_cvt_pk_bf16_f32 v168, v168, v169
v_cvt_pk_bf16_f32 v169, v170, v171
v_cvt_pk_bf16_f32 v170, v184, v185
v_cvt_pk_bf16_f32 v171, v186, v187
ds_write_b128 v66, v[136:139] offset:0
v_pk_mul_f32 v[200:201], v[200:201], v[122:123] op_sel:[0,0] op_sel_hi:[1,0]
v_pk_mul_f32 v[202:203], v[202:203], v[122:123] op_sel:[0,0] op_sel_hi:[1,0]
v_pk_mul_f32 v[216:217], v[216:217], v[122:123] op_sel:[0,0] op_sel_hi:[1,0]
v_pk_mul_f32 v[218:219], v[218:219], v[122:123] op_sel:[0,0] op_sel_hi:[1,0]
v_cvt_pk_bf16_f32 v200, v200, v201
v_cvt_pk_bf16_f32 v201, v202, v203
v_cvt_pk_bf16_f32 v202, v216, v217
v_cvt_pk_bf16_f32 v203, v218, v219
ds_write_b128 v66, v[168:171] offset:4096
v_pk_mul_f32 v[232:233], v[232:233], v[122:123] op_sel:[0,0] op_sel_hi:[1,0]
v_pk_mul_f32 v[234:235], v[234:235], v[122:123] op_sel:[0,0] op_sel_hi:[1,0]
v_pk_mul_f32 v[248:249], v[248:249], v[122:123] op_sel:[0,0] op_sel_hi:[1,0]
v_pk_mul_f32 v[250:251], v[250:251], v[122:123] op_sel:[0,0] op_sel_hi:[1,0]
v_cvt_pk_bf16_f32 v232, v232, v233
v_cvt_pk_bf16_f32 v233, v234, v235
v_cvt_pk_bf16_f32 v234, v248, v249
v_cvt_pk_bf16_f32 v235, v250, v251
ds_write_b128 v66, v[200:203] offset:8192
ds_write_b128 v66, v[232:235] offset:12288
v_pk_mul_f32 v[140:141], v[140:141], v[122:123] op_sel:[0,1] op_sel_hi:[1,1]
v_pk_mul_f32 v[142:143], v[142:143], v[122:123] op_sel:[0,1] op_sel_hi:[1,1]
v_pk_mul_f32 v[156:157], v[156:157], v[122:123] op_sel:[0,1] op_sel_hi:[1,1]
v_pk_mul_f32 v[158:159], v[158:159], v[122:123] op_sel:[0,1] op_sel_hi:[1,1]
v_cvt_pk_bf16_f32 v140, v140, v141
v_cvt_pk_bf16_f32 v141, v142, v143
v_cvt_pk_bf16_f32 v142, v156, v157
v_cvt_pk_bf16_f32 v143, v158, v159
v_pk_mul_f32 v[172:173], v[172:173], v[122:123] op_sel:[0,1] op_sel_hi:[1,1]
v_pk_mul_f32 v[174:175], v[174:175], v[122:123] op_sel:[0,1] op_sel_hi:[1,1]
v_pk_mul_f32 v[188:189], v[188:189], v[122:123] op_sel:[0,1] op_sel_hi:[1,1]
v_pk_mul_f32 v[190:191], v[190:191], v[122:123] op_sel:[0,1] op_sel_hi:[1,1]
v_cvt_pk_bf16_f32 v172, v172, v173
v_cvt_pk_bf16_f32 v173, v174, v175
v_cvt_pk_bf16_f32 v174, v188, v189
v_cvt_pk_bf16_f32 v175, v190, v191
ds_write_b128 v67, v[140:143] offset:0
v_pk_mul_f32 v[204:205], v[204:205], v[122:123] op_sel:[0,1] op_sel_hi:[1,1]
v_pk_mul_f32 v[206:207], v[206:207], v[122:123] op_sel:[0,1] op_sel_hi:[1,1]
v_pk_mul_f32 v[220:221], v[220:221], v[122:123] op_sel:[0,1] op_sel_hi:[1,1]
v_pk_mul_f32 v[222:223], v[222:223], v[122:123] op_sel:[0,1] op_sel_hi:[1,1]
v_cvt_pk_bf16_f32 v204, v204, v205
v_cvt_pk_bf16_f32 v205, v206, v207
v_cvt_pk_bf16_f32 v206, v220, v221
v_cvt_pk_bf16_f32 v207, v222, v223
ds_write_b128 v67, v[172:175] offset:4096
v_pk_mul_f32 v[236:237], v[236:237], v[122:123] op_sel:[0,1] op_sel_hi:[1,1]
v_pk_mul_f32 v[238:239], v[238:239], v[122:123] op_sel:[0,1] op_sel_hi:[1,1]
v_pk_mul_f32 v[252:253], v[252:253], v[122:123] op_sel:[0,1] op_sel_hi:[1,1]
v_pk_mul_f32 v[254:255], v[254:255], v[122:123] op_sel:[0,1] op_sel_hi:[1,1]
v_cvt_pk_bf16_f32 v236, v236, v237
v_cvt_pk_bf16_f32 v237, v238, v239
v_cvt_pk_bf16_f32 v238, v252, v253
v_cvt_pk_bf16_f32 v239, v254, v255
ds_write_b128 v67, v[204:207] offset:8192
ds_write_b128 v67, v[236:239] offset:12288
s_waitcnt lgkmcnt(0)
s_barrier
v_mov_b32 v27, 159744
ds_read_b128 v[64:67], v27
s_waitcnt vmcnt(12)
ds_read_b64_tr_b16 v[32:33], v10 offset:0
ds_read_b64_tr_b16 v[34:35], v10 offset:2048
ds_read_b64_tr_b16 v[36:37], v11 offset:0
ds_read_b64_tr_b16 v[38:39], v11 offset:2048
ds_read_b64_tr_b16 v[40:41], v12 offset:0
ds_read_b64_tr_b16 v[42:43], v12 offset:2048
ds_read_b64_tr_b16 v[44:45], v13 offset:0
ds_read_b64_tr_b16 v[46:47], v13 offset:2048
ds_read_b128 a[0:3], v1 offset:0
ds_read_b128 a[4:7], v1 offset:1024
ds_read_b128 a[8:11], v1 offset:2048
ds_read_b128 a[12:15], v1 offset:3072
s_waitcnt lgkmcnt(12)
v_or3_b32 v64, v64, v65, v66
v_or_b32 v64, v64, v67
s_nop 0
v_readfirstlane_b32 s63, v64
s_nop 3
s_cmp_gt_u32 s63, s70
s_cbranch_scc1 L_fallback
s_waitcnt lgkmcnt(3)
v_mfma_f32_16x16x32_bf16 v[192:195], v[32:35], a[0:3], 0
s_waitcnt vmcnt(8)
ds_read_b64_tr_b16 v[48:49], v10 offset:4096
s_waitcnt lgkmcnt(3)
v_mfma_f32_16x16x32_bf16 v[196:199], v[32:35], a[4:7], 0
ds_read_b64_tr_b16 v[50:51], v10 offset:6144
ds_read_b128 a[16:19], v1 offset:4096
s_waitcnt lgkmcnt(4)
v_mfma_f32_16x16x32_bf16 v[200:203], v[32:35], a[8:11], 0
ds_read_b128 a[20:23], v1 offset:5120
s_add_u32 m0, s60, 0
s_waitcnt lgkmcnt(4)
v_mfma_f32_16x16x32_bf16 v[204:207], v[32:35], a[12:15], 0
s_add_u32 s61, s69, 131072
v_mfma_f32_16x16x32_bf16 v[208:211], v[36:39], a[0:3], 0
ds_read_b64_tr_b16 v[52:53], v11 offset:4096
ds_read_b64_tr_b16 v[54:55], v11 offset:6144
v_mfma_f32_16x16x32_bf16 v[212:215], v[36:39], a[4:7], 0
buffer_load_dwordx4 v2, s[20:23], s61 offen offset:0 lds
v_mfma_f32_16x16x32_bf16 v[216:219], v[36:39], a[8:11], 0
ds_read_b128 a[24:27], v1 offset:6144
v_mfma_f32_16x16x32_bf16 v[220:223], v[36:39], a[12:15], 0
ds_read_b64_tr_b16 v[56:57], v12 offset:4096
ds_read_b64_tr_b16 v[58:59], v12 offset:6144
v_mfma_f32_16x16x32_bf16 v[224:227], v[40:43], a[0:3], 0
buffer_load_dwordx4 v3, s[20:23], s61 offen offset:1024 lds
v_mfma_f32_16x16x32_bf16 v[228:231], v[40:43], a[4:7], 0
v_mfma_f32_16x16x32_bf16 v[232:235], v[40:43], a[8:11], 0
ds_read_b64_tr_b16 v[60:61], v13 offset:4096
ds_read_b128 a[28:31], v1 offset:7168
v_mfma_f32_16x16x32_bf16 v[236:239], v[40:43], a[12:15], 0
ds_read_b64_tr_b16 v[62:63], v13 offset:6144
v_mfma_f32_16x16x32_bf16 v[240:243], v[44:47], a[0:3], 0
buffer_load_dwordx4 v4, s[20:23], s61 offen offset:2048 lds
v_mfma_f32_16x16x32_bf16 v[244:247], v[44:47], a[4:7], 0
buffer_load_dwordx4 v5, s[20:23], s61 offen offset:3072 lds
v_mfma_f32_16x16x32_bf16 v[248:251], v[44:47], a[8:11], 0
v_mfma_f32_16x16x32_bf16 v[252:255], v[44:47], a[12:15], 0
s_waitcnt lgkmcnt(0)
v_mfma_f32_16x16x32_bf16 v[192:195], v[48:51], a[16:19], v[192:195]
s_waitcnt vmcnt(8)
ds_read_b64_tr_b16 v[32:33], v10 offset:8192
v_mfma_f32_16x16x32_bf16 v[196:199], v[48:51], a[20:23], v[196:199]
ds_read_b64_tr_b16 v[34:35], v10 offset:10240
ds_read_b128 a[32:35], v1 offset:8192
v_mfma_f32_16x16x32_bf16 v[200:203], v[48:51], a[24:27], v[200:203]
ds_read_b128 a[36:39], v1 offset:9216
s_add_u32 m0, s60, 4096
v_mfma_f32_16x16x32_bf16 v[204:207], v[48:51], a[28:31], v[204:207]
s_add_u32 s61, s69, 163840
v_mfma_f32_16x16x32_bf16 v[208:211], v[52:55], a[16:19], v[208:211]
ds_read_b64_tr_b16 v[36:37], v11 offset:8192
ds_read_b64_tr_b16 v[38:39], v11 offset:10240
v_mfma_f32_16x16x32_bf16 v[212:215], v[52:55], a[20:23], v[212:215]
buffer_load_dwordx4 v2, s[20:23], s61 offen offset:0 lds
v_mfma_f32_16x16x32_bf16 v[216:219], v[52:55], a[24:27], v[216:219]
ds_read_b128 a[40:43], v1 offset:10240
v_mfma_f32_16x16x32_bf16 v[220:223], v[52:55], a[28:31], v[220:223]
ds_read_b64_tr_b16 v[40:41], v12 offset:8192
ds_read_b64_tr_b16 v[42:43], v12 offset:10240
v_mfma_f32_16x16x32_bf16 v[224:227], v[56:59], a[16:19], v[224:227]
buffer_load_dwordx4 v3, s[20:23], s61 offen offset:1024 lds
v_mfma_f32_16x16x32_bf16 v[228:231], v[56:59], a[20:23], v[228:231]
v_mfma_f32_16x16x32_bf16 v[232:235], v[56:59], a[24:27], v[232:235]
ds_read_b64_tr_b16 v[44:45], v13 offset:8192
ds_read_b128 a[44:47], v1 offset:11264
v_mfma_f32_16x16x32_bf16 v[236:239], v[56:59], a[28:31], v[236:239]
ds_read_b64_tr_b16 v[46:47], v13 offset:10240
v_mfma_f32_16x16x32_bf16 v[240:243], v[60:63], a[16:19], v[240:243]
buffer_load_dwordx4 v4, s[20:23], s61 offen offset:2048 lds
v_mfma_f32_16x16x32_bf16 v[244:247], v[60:63], a[20:23], v[244:247]
buffer_load_dwordx4 v5, s[20:23], s61 offen offset:3072 lds
v_mfma_f32_16x16x32_bf16 v[248:251], v[60:63], a[24:27], v[248:251]
v_mfma_f32_16x16x32_bf16 v[252:255], v[60:63], a[28:31], v[252:255]
s_waitcnt lgkmcnt(0)
v_mfma_f32_16x16x32_bf16 v[192:195], v[32:35], a[32:35], v[192:195]
s_waitcnt vmcnt(8)
ds_read_b64_tr_b16 v[48:49], v10 offset:12288
v_mfma_f32_16x16x32_bf16 v[196:199], v[32:35], a[36:39], v[196:199]
ds_read_b128 a[48:51], v1 offset:12288
ds_read_b64_tr_b16 v[50:51], v10 offset:14336
v_mfma_f32_16x16x32_bf16 v[200:203], v[32:35], a[40:43], v[200:203]
ds_read_b128 a[52:55], v1 offset:13312
ds_read_b128 a[56:59], v1 offset:14336
v_mfma_f32_16x16x32_bf16 v[204:207], v[32:35], a[44:47], v[204:207]
ds_read_b128 a[60:63], v1 offset:15360
s_add_u32 m0, s60, 8192
v_mfma_f32_16x16x32_bf16 v[208:211], v[36:39], a[32:35], v[208:211]
s_add_u32 s61, s69, 196608
s_sub_u32 s63, s91, s60
v_mfma_f32_16x16x32_bf16 v[212:215], v[36:39], a[36:39], v[212:215]
ds_read_b64_tr_b16 v[52:53], v11 offset:12288
ds_read_b64_tr_b16 v[54:55], v11 offset:14336
v_mfma_f32_16x16x32_bf16 v[216:219], v[36:39], a[40:43], v[216:219]
buffer_load_dwordx4 v2, s[20:23], s61 offen offset:0 lds
v_mfma_f32_16x16x32_bf16 v[220:223], v[36:39], a[44:47], v[220:223]
ds_read_b64_tr_b16 v[56:57], v12 offset:12288
ds_read_b64_tr_b16 v[58:59], v12 offset:14336
v_mfma_f32_16x16x32_bf16 v[224:227], v[40:43], a[32:35], v[224:227]
buffer_load_dwordx4 v3, s[20:23], s61 offen offset:1024 lds
v_mfma_f32_16x16x32_bf16 v[228:231], v[40:43], a[36:39], v[228:231]
v_add_u32 v20, s63, v10
v_add_u32 v21, s63, v11
v_mfma_f32_16x16x32_bf16 v[232:235], v[40:43], a[40:43], v[232:235]
ds_read_b64_tr_b16 v[60:61], v13 offset:12288
v_mfma_f32_16x16x32_bf16 v[236:239], v[40:43], a[44:47], v[236:239]
ds_read_b64_tr_b16 v[62:63], v13 offset:14336
v_add_u32 v22, s63, v12
v_mfma_f32_16x16x32_bf16 v[240:243], v[44:47], a[32:35], v[240:243]
buffer_load_dwordx4 v4, s[20:23], s61 offen offset:2048 lds
v_mfma_f32_16x16x32_bf16 v[244:247], v[44:47], a[36:39], v[244:247]
buffer_load_dwordx4 v5, s[20:23], s61 offen offset:3072 lds
v_mfma_f32_16x16x32_bf16 v[248:251], v[44:47], a[40:43], v[248:251]
v_add_u32 v23, s63, v13
v_mfma_f32_16x16x32_bf16 v[252:255], v[44:47], a[44:47], v[252:255]
s_waitcnt lgkmcnt(0)
v_mfma_f32_16x16x32_bf16 v[192:195], v[48:51], a[48:51], v[192:195]
s_waitcnt vmcnt(8)
ds_read_b64_tr_b16 v[32:33], v10 offset:0
v_mfma_f32_16x16x32_bf16 v[196:199], v[48:51], a[52:55], v[196:199]
ds_read_b64_tr_b16 v[34:35], v10 offset:2048
ds_read_b128 a[64:67], v1 offset:16384
v_mfma_f32_16x16x32_bf16 v[200:203], v[48:51], a[56:59], v[200:203]
ds_read_b128 a[68:71], v1 offset:17408
s_add_u32 m0, s60, 12288
v_mfma_f32_16x16x32_bf16 v[204:207], v[48:51], a[60:63], v[204:207]
s_add_u32 s61, s69, 229376
v_mfma_f32_16x16x32_bf16 v[208:211], v[52:55], a[48:51], v[208:211]
ds_read_b64_tr_b16 v[36:37], v11 offset:0
ds_read_b64_tr_b16 v[38:39], v11 offset:2048
v_mfma_f32_16x16x32_bf16 v[212:215], v[52:55], a[52:55], v[212:215]
buffer_load_dwordx4 v2, s[20:23], s61 offen offset:0 lds
v_mfma_f32_16x16x32_bf16 v[216:219], v[52:55], a[56:59], v[216:219]
ds_read_b128 a[72:75], v1 offset:18432
v_mfma_f32_16x16x32_bf16 v[220:223], v[52:55], a[60:63], v[220:223]
ds_read_b64_tr_b16 v[40:41], v12 offset:0
ds_read_b64_tr_b16 v[42:43], v12 offset:2048
v_mfma_f32_16x16x32_bf16 v[224:227], v[56:59], a[48:51], v[224:227]
buffer_load_dwordx4 v3, s[20:23], s61 offen offset:1024 lds
v_mfma_f32_16x16x32_bf16 v[228:231], v[56:59], a[52:55], v[228:231]
v_mfma_f32_16x16x32_bf16 v[232:235], v[56:59], a[56:59], v[232:235]
ds_read_b64_tr_b16 v[44:45], v13 offset:0
ds_read_b128 a[76:79], v1 offset:19456
v_mfma_f32_16x16x32_bf16 v[236:239], v[56:59], a[60:63], v[236:239]
ds_read_b64_tr_b16 v[46:47], v13 offset:2048
v_mfma_f32_16x16x32_bf16 v[240:243], v[60:63], a[48:51], v[240:243]
buffer_load_dwordx4 v4, s[20:23], s61 offen offset:2048 lds
v_mfma_f32_16x16x32_bf16 v[244:247], v[60:63], a[52:55], v[244:247]
buffer_load_dwordx4 v5, s[20:23], s61 offen offset:3072 lds
v_mfma_f32_16x16x32_bf16 v[248:251], v[60:63], a[56:59], v[248:251]
v_mfma_f32_16x16x32_bf16 v[252:255], v[60:63], a[60:63], v[252:255]
s_waitcnt lgkmcnt(0)
v_mfma_f32_16x16x32_bf16 v[192:195], v[32:35], a[64:67], v[192:195]
s_waitcnt vmcnt(8)
ds_read_b64_tr_b16 v[48:49], v10 offset:4096
v_mfma_f32_16x16x32_bf16 v[196:199], v[32:35], a[68:71], v[196:199]
ds_read_b64_tr_b16 v[50:51], v10 offset:6144
ds_read_b128 a[80:83], v1 offset:20480
v_mfma_f32_16x16x32_bf16 v[200:203], v[32:35], a[72:75], v[200:203]
ds_read_b128 a[84:87], v1 offset:21504
s_add_u32 m0, s60, 0
v_mfma_f32_16x16x32_bf16 v[204:207], v[32:35], a[76:79], v[204:207]
s_add_u32 s61, s69, 262144
v_mfma_f32_16x16x32_bf16 v[208:211], v[36:39], a[64:67], v[208:211]
ds_read_b64_tr_b16 v[52:53], v11 offset:4096
ds_read_b64_tr_b16 v[54:55], v11 offset:6144
v_mfma_f32_16x16x32_bf16 v[212:215], v[36:39], a[68:71], v[212:215]
buffer_load_dwordx4 v2, s[20:23], s61 offen offset:0 lds
v_mfma_f32_16x16x32_bf16 v[216:219], v[36:39], a[72:75], v[216:219]
ds_read_b128 a[88:91], v1 offset:22528
v_mfma_f32_16x16x32_bf16 v[220:223], v[36:39], a[76:79], v[220:223]
ds_read_b64_tr_b16 v[56:57], v12 offset:4096
ds_read_b64_tr_b16 v[58:59], v12 offset:6144
v_mfma_f32_16x16x32_bf16 v[224:227], v[40:43], a[64:67], v[224:227]
buffer_load_dwordx4 v3, s[20:23], s61 offen offset:1024 lds
v_mfma_f32_16x16x32_bf16 v[228:231], v[40:43], a[68:71], v[228:231]
v_mfma_f32_16x16x32_bf16 v[232:235], v[40:43], a[72:75], v[232:235]
ds_read_b64_tr_b16 v[60:61], v13 offset:4096
ds_read_b128 a[92:95], v1 offset:23552
v_mfma_f32_16x16x32_bf16 v[236:239], v[40:43], a[76:79], v[236:239]
ds_read_b64_tr_b16 v[62:63], v13 offset:6144
v_mfma_f32_16x16x32_bf16 v[240:243], v[44:47], a[64:67], v[240:243]
buffer_load_dwordx4 v4, s[20:23], s61 offen offset:2048 lds
v_mfma_f32_16x16x32_bf16 v[244:247], v[44:47], a[68:71], v[244:247]
buffer_load_dwordx4 v5, s[20:23], s61 offen offset:3072 lds
v_mfma_f32_16x16x32_bf16 v[248:251], v[44:47], a[72:75], v[248:251]
v_mfma_f32_16x16x32_bf16 v[252:255], v[44:47], a[76:79], v[252:255]
s_waitcnt lgkmcnt(0)
v_mfma_f32_16x16x32_bf16 v[192:195], v[48:51], a[80:83], v[192:195]
s_waitcnt vmcnt(8)
ds_read_b64_tr_b16 v[32:33], v10 offset:8192
v_mfma_f32_16x16x32_bf16 v[196:199], v[48:51], a[84:87], v[196:199]
ds_read_b64_tr_b16 v[34:35], v10 offset:10240
ds_read_b128 a[96:99], v1 offset:24576
v_mfma_f32_16x16x32_bf16 v[200:203], v[48:51], a[88:91], v[200:203]
ds_read_b128 a[100:103], v1 offset:25600
s_add_u32 m0, s60, 4096
v_mfma_f32_16x16x32_bf16 v[204:207], v[48:51], a[92:95], v[204:207]
s_add_u32 s61, s69, 294912
v_mfma_f32_16x16x32_bf16 v[208:211], v[52:55], a[80:83], v[208:211]
ds_read_b64_tr_b16 v[36:37], v11 offset:8192
ds_read_b64_tr_b16 v[38:39], v11 offset:10240
v_mfma_f32_16x16x32_bf16 v[212:215], v[52:55], a[84:87], v[212:215]
buffer_load_dwordx4 v2, s[20:23], s61 offen offset:0 lds
v_mfma_f32_16x16x32_bf16 v[216:219], v[52:55], a[88:91], v[216:219]
ds_read_b128 a[104:107], v1 offset:26624
v_mfma_f32_16x16x32_bf16 v[220:223], v[52:55], a[92:95], v[220:223]
ds_read_b64_tr_b16 v[40:41], v12 offset:8192
ds_read_b64_tr_b16 v[42:43], v12 offset:10240
v_mfma_f32_16x16x32_bf16 v[224:227], v[56:59], a[80:83], v[224:227]
buffer_load_dwordx4 v3, s[20:23], s61 offen offset:1024 lds
v_mfma_f32_16x16x32_bf16 v[228:231], v[56:59], a[84:87], v[228:231]
v_mfma_f32_16x16x32_bf16 v[232:235], v[56:59], a[88:91], v[232:235]
ds_read_b64_tr_b16 v[44:45], v13 offset:8192
ds_read_b128 a[108:111], v1 offset:27648
v_mfma_f32_16x16x32_bf16 v[236:239], v[56:59], a[92:95], v[236:239]
ds_read_b64_tr_b16 v[46:47], v13 offset:10240
v_mfma_f32_16x16x32_bf16 v[240:243], v[60:63], a[80:83], v[240:243]
buffer_load_dwordx4 v4, s[20:23], s61 offen offset:2048 lds
v_mfma_f32_16x16x32_bf16 v[244:247], v[60:63], a[84:87], v[244:247]
buffer_load_dwordx4 v5, s[20:23], s61 offen offset:3072 lds
v_mfma_f32_16x16x32_bf16 v[248:251], v[60:63], a[88:91], v[248:251]
v_mfma_f32_16x16x32_bf16 v[252:255], v[60:63], a[92:95], v[252:255]
s_waitcnt lgkmcnt(0)
v_mfma_f32_16x16x32_bf16 v[192:195], v[32:35], a[96:99], v[192:195]
s_waitcnt vmcnt(8)
ds_read_b64_tr_b16 v[48:49], v10 offset:12288
v_mfma_f32_16x16x32_bf16 v[196:199], v[32:35], a[100:103], v[196:199]
ds_read_b128 a[112:115], v1 offset:28672
ds_read_b64_tr_b16 v[50:51], v10 offset:14336
v_mfma_f32_16x16x32_bf16 v[200:203], v[32:35], a[104:107], v[200:203]
ds_read_b128 a[116:119], v1 offset:29696
ds_read_b128 a[120:123], v1 offset:30720
v_mfma_f32_16x16x32_bf16 v[204:207], v[32:35], a[108:111], v[204:207]
ds_read_b128 a[124:127], v1 offset:31744
s_add_u32 m0, s60, 8192
s_add_u32 s61, s69, 327680
v_mfma_f32_16x16x32_bf16 v[208:211], v[36:39], a[96:99], v[208:211]
ds_read_b64_tr_b16 v[52:53], v11 offset:12288
ds_read_b64_tr_b16 v[54:55], v11 offset:14336
v_mfma_f32_16x16x32_bf16 v[212:215], v[36:39], a[100:103], v[212:215]
buffer_load_dwordx4 v2, s[20:23], s61 offen offset:0 lds
v_mfma_f32_16x16x32_bf16 v[216:219], v[36:39], a[104:107], v[216:219]
ds_read_b64_tr_b16 v[56:57], v12 offset:12288
ds_read_b64_tr_b16 v[58:59], v12 offset:14336
v_mfma_f32_16x16x32_bf16 v[220:223], v[36:39], a[108:111], v[220:223]
buffer_load_dwordx4 v3, s[20:23], s61 offen offset:1024 lds
v_mfma_f32_16x16x32_bf16 v[224:227], v[40:43], a[96:99], v[224:227]
ds_read_b64_tr_b16 v[60:61], v13 offset:12288
ds_read_b64_tr_b16 v[62:63], v13 offset:14336
v_mfma_f32_16x16x32_bf16 v[228:231], v[40:43], a[100:103], v[228:231]
buffer_load_dwordx4 v4, s[20:23], s61 offen offset:2048 lds
v_mfma_f32_16x16x32_bf16 v[232:235], v[40:43], a[104:107], v[232:235]
buffer_load_dwordx4 v5, s[20:23], s61 offen offset:3072 lds
v_mfma_f32_16x16x32_bf16 v[236:239], v[40:43], a[108:111], v[236:239]
v_and_b32 v127, 7, v0
v_lshlrev_b32 v127, 7, v127
v_mfma_f32_16x16x32_bf16 v[240:243], v[44:47], a[96:99], v[240:243]
s_lshl_b32 s63, s56, 2
v_add_u32 v127, s63, v127
v_mfma_f32_16x16x32_bf16 v[244:247], v[44:47], a[100:103], v[244:247]
s_add_u32 s63, s90, 32768
v_mfma_f32_16x16x32_bf16 v[248:251], v[44:47], a[104:107], v[248:251]
buffer_load_dword v126, v127, s[44:47], s63 offen sc1
v_mfma_f32_16x16x32_bf16 v[252:255], v[44:47], a[108:111], v[252:255]
buffer_load_dword v125, off, s[52:55], 0 sc1
s_waitcnt lgkmcnt(0)
v_mfma_f32_16x16x32_bf16 v[192:195], v[48:51], a[112:115], v[192:195]
s_waitcnt vmcnt(10)
ds_read_b64_tr_b16 v[32:33], v10 offset:0
v_mfma_f32_16x16x32_bf16 v[196:199], v[48:51], a[116:119], v[196:199]
ds_read_b64_tr_b16 v[34:35], v10 offset:2048
ds_read_b128 a[128:131], v1 offset:32768
v_mfma_f32_16x16x32_bf16 v[200:203], v[48:51], a[120:123], v[200:203]
ds_read_b128 a[132:135], v1 offset:33792
s_add_u32 m0, s60, 12288
v_mfma_f32_16x16x32_bf16 v[204:207], v[48:51], a[124:127], v[204:207]
s_add_u32 s61, s69, 360448
v_mfma_f32_16x16x32_bf16 v[208:211], v[52:55], a[112:115], v[208:211]
ds_read_b64_tr_b16 v[36:37], v11 offset:0
ds_read_b64_tr_b16 v[38:39], v11 offset:2048
v_mfma_f32_16x16x32_bf16 v[212:215], v[52:55], a[116:119], v[212:215]
buffer_load_dwordx4 v2, s[20:23], s61 offen offset:0 lds
v_mfma_f32_16x16x32_bf16 v[216:219], v[52:55], a[120:123], v[216:219]
ds_read_b128 a[136:139], v1 offset:34816
v_mfma_f32_16x16x32_bf16 v[220:223], v[52:55], a[124:127], v[220:223]
ds_read_b64_tr_b16 v[40:41], v12 offset:0
ds_read_b64_tr_b16 v[42:43], v12 offset:2048
v_mfma_f32_16x16x32_bf16 v[224:227], v[56:59], a[112:115], v[224:227]
buffer_load_dwordx4 v3, s[20:23], s61 offen offset:1024 lds
v_mfma_f32_16x16x32_bf16 v[228:231], v[56:59], a[116:119], v[228:231]
v_mfma_f32_16x16x32_bf16 v[232:235], v[56:59], a[120:123], v[232:235]
ds_read_b64_tr_b16 v[44:45], v13 offset:0
ds_read_b128 a[140:143], v1 offset:35840
v_mfma_f32_16x16x32_bf16 v[236:239], v[56:59], a[124:127], v[236:239]
ds_read_b64_tr_b16 v[46:47], v13 offset:2048
v_mfma_f32_16x16x32_bf16 v[240:243], v[60:63], a[112:115], v[240:243]
buffer_load_dwordx4 v4, s[20:23], s61 offen offset:2048 lds
v_mfma_f32_16x16x32_bf16 v[244:247], v[60:63], a[116:119], v[244:247]
buffer_load_dwordx4 v5, s[20:23], s61 offen offset:3072 lds
v_mfma_f32_16x16x32_bf16 v[248:251], v[60:63], a[120:123], v[248:251]
v_mfma_f32_16x16x32_bf16 v[252:255], v[60:63], a[124:127], v[252:255]
s_waitcnt lgkmcnt(0)
v_mfma_f32_16x16x32_bf16 v[192:195], v[32:35], a[128:131], v[192:195]
s_waitcnt vmcnt(10)
ds_read_b64_tr_b16 v[48:49], v10 offset:4096
v_mfma_f32_16x16x32_bf16 v[196:199], v[32:35], a[132:135], v[196:199]
ds_read_b64_tr_b16 v[50:51], v10 offset:6144
ds_read_b128 a[144:147], v1 offset:36864
v_mfma_f32_16x16x32_bf16 v[200:203], v[32:35], a[136:139], v[200:203]
ds_read_b128 a[148:151], v1 offset:37888
s_add_u32 m0, s60, 0
v_mfma_f32_16x16x32_bf16 v[204:207], v[32:35], a[140:143], v[204:207]
s_add_u32 s61, s69, 393216
v_mfma_f32_16x16x32_bf16 v[208:211], v[36:39], a[128:131], v[208:211]
ds_read_b64_tr_b16 v[52:53], v11 offset:4096
ds_read_b64_tr_b16 v[54:55], v11 offset:6144
v_mfma_f32_16x16x32_bf16 v[212:215], v[36:39], a[132:135], v[212:215]
buffer_load_dwordx4 v2, s[20:23], s61 offen offset:0 lds
v_mfma_f32_16x16x32_bf16 v[216:219], v[36:39], a[136:139], v[216:219]
ds_read_b128 a[152:155], v1 offset:38912
v_mfma_f32_16x16x32_bf16 v[220:223], v[36:39], a[140:143], v[220:223]
ds_read_b64_tr_b16 v[56:57], v12 offset:4096
ds_read_b64_tr_b16 v[58:59], v12 offset:6144
v_mfma_f32_16x16x32_bf16 v[224:227], v[40:43], a[128:131], v[224:227]
buffer_load_dwordx4 v3, s[20:23], s61 offen offset:1024 lds
v_mfma_f32_16x16x32_bf16 v[228:231], v[40:43], a[132:135], v[228:231]
v_mfma_f32_16x16x32_bf16 v[232:235], v[40:43], a[136:139], v[232:235]
ds_read_b64_tr_b16 v[60:61], v13 offset:4096
ds_read_b128 a[156:159], v1 offset:39936
v_mfma_f32_16x16x32_bf16 v[236:239], v[40:43], a[140:143], v[236:239]
ds_read_b64_tr_b16 v[62:63], v13 offset:6144
v_mfma_f32_16x16x32_bf16 v[240:243], v[44:47], a[128:131], v[240:243]
buffer_load_dwordx4 v4, s[20:23], s61 offen offset:2048 lds
v_mfma_f32_16x16x32_bf16 v[244:247], v[44:47], a[132:135], v[244:247]
buffer_load_dwordx4 v5, s[20:23], s61 offen offset:3072 lds
v_mfma_f32_16x16x32_bf16 v[248:251], v[44:47], a[136:139], v[248:251]
v_mfma_f32_16x16x32_bf16 v[252:255], v[44:47], a[140:143], v[252:255]
s_waitcnt lgkmcnt(0)
v_mfma_f32_16x16x32_bf16 v[192:195], v[48:51], a[144:147], v[192:195]
s_waitcnt vmcnt(10)
ds_read_b64_tr_b16 v[32:33], v10 offset:8192
v_mfma_f32_16x16x32_bf16 v[196:199], v[48:51], a[148:151], v[196:199]
ds_read_b64_tr_b16 v[34:35], v10 offset:10240
ds_read_b128 a[160:163], v1 offset:40960
v_mfma_f32_16x16x32_bf16 v[200:203], v[48:51], a[152:155], v[200:203]
ds_read_b128 a[164:167], v1 offset:41984
s_add_u32 m0, s60, 4096
v_mfma_f32_16x16x32_bf16 v[204:207], v[48:51], a[156:159], v[204:207]
s_add_u32 s61, s69, 425984
v_mfma_f32_16x16x32_bf16 v[208:211], v[52:55], a[144:147], v[208:211]
ds_read_b64_tr_b16 v[36:37], v11 offset:8192
ds_read_b64_tr_b16 v[38:39], v11 offset:10240
v_mfma_f32_16x16x32_bf16 v[212:215], v[52:55], a[148:151], v[212:215]
buffer_load_dwordx4 v2, s[20:23], s61 offen offset:0 lds
v_mfma_f32_16x16x32_bf16 v[216:219], v[52:55], a[152:155], v[216:219]
ds_read_b128 a[168:171], v1 offset:43008
v_mfma_f32_16x16x32_bf16 v[220:223], v[52:55], a[156:159], v[220:223]
ds_read_b64_tr_b16 v[40:41], v12 offset:8192
ds_read_b64_tr_b16 v[42:43], v12 offset:10240
v_mfma_f32_16x16x32_bf16 v[224:227], v[56:59], a[144:147], v[224:227]
buffer_load_dwordx4 v3, s[20:23], s61 offen offset:1024 lds
v_mfma_f32_16x16x32_bf16 v[228:231], v[56:59], a[148:151], v[228:231]
v_mfma_f32_16x16x32_bf16 v[232:235], v[56:59], a[152:155], v[232:235]
ds_read_b64_tr_b16 v[44:45], v13 offset:8192
ds_read_b128 a[172:175], v1 offset:44032
v_mfma_f32_16x16x32_bf16 v[236:239], v[56:59], a[156:159], v[236:239]
ds_read_b64_tr_b16 v[46:47], v13 offset:10240
v_mfma_f32_16x16x32_bf16 v[240:243], v[60:63], a[144:147], v[240:243]
buffer_load_dwordx4 v4, s[20:23], s61 offen offset:2048 lds
v_mfma_f32_16x16x32_bf16 v[244:247], v[60:63], a[148:151], v[244:247]
buffer_load_dwordx4 v5, s[20:23], s61 offen offset:3072 lds
v_mfma_f32_16x16x32_bf16 v[248:251], v[60:63], a[152:155], v[248:251]
v_mfma_f32_16x16x32_bf16 v[252:255], v[60:63], a[156:159], v[252:255]
s_waitcnt lgkmcnt(0)
v_mfma_f32_16x16x32_bf16 v[192:195], v[32:35], a[160:163], v[192:195]
s_waitcnt vmcnt(8)
ds_read_b64_tr_b16 v[48:49], v10 offset:12288
v_mfma_f32_16x16x32_bf16 v[196:199], v[32:35], a[164:167], v[196:199]
ds_read_b64_tr_b16 v[50:51], v10 offset:14336
ds_read_b128 a[176:179], v1 offset:45056
v_mfma_f32_16x16x32_bf16 v[200:203], v[32:35], a[168:171], v[200:203]
ds_read_b128 a[180:183], v1 offset:46080
s_add_u32 m0, s60, 8192
v_mfma_f32_16x16x32_bf16 v[204:207], v[32:35], a[172:175], v[204:207]
s_add_u32 s61, s69, 458752
v_mfma_f32_16x16x32_bf16 v[208:211], v[36:39], a[160:163], v[208:211]
ds_read_b64_tr_b16 v[52:53], v11 offset:12288
ds_read_b64_tr_b16 v[54:55], v11 offset:14336
v_mfma_f32_16x16x32_bf16 v[212:215], v[36:39], a[164:167], v[212:215]
buffer_load_dwordx4 v2, s[20:23], s61 offen offset:0 lds
v_mfma_f32_16x16x32_bf16 v[216:219], v[36:39], a[168:171], v[216:219]
ds_read_b128 a[184:187], v1 offset:47104
v_mfma_f32_16x16x32_bf16 v[220:223], v[36:39], a[172:175], v[220:223]
ds_read_b64_tr_b16 v[56:57], v12 offset:12288
ds_read_b64_tr_b16 v[58:59], v12 offset:14336
v_mfma_f32_16x16x32_bf16 v[224:227], v[40:43], a[160:163], v[224:227]
buffer_load_dwordx4 v3, s[20:23], s61 offen offset:1024 lds
v_mfma_f32_16x16x32_bf16 v[228:231], v[40:43], a[164:167], v[228:231]
v_mfma_f32_16x16x32_bf16 v[232:235], v[40:43], a[168:171], v[232:235]
ds_read_b64_tr_b16 v[60:61], v13 offset:12288
ds_read_b128 a[188:191], v1 offset:48128
v_mfma_f32_16x16x32_bf16 v[236:239], v[40:43], a[172:175], v[236:239]
ds_read_b64_tr_b16 v[62:63], v13 offset:14336
v_mfma_f32_16x16x32_bf16 v[240:243], v[44:47], a[160:163], v[240:243]
buffer_load_dwordx4 v4, s[20:23], s61 offen offset:2048 lds
v_mfma_f32_16x16x32_bf16 v[244:247], v[44:47], a[164:167], v[244:247]
buffer_load_dwordx4 v5, s[20:23], s61 offen offset:3072 lds
v_mfma_f32_16x16x32_bf16 v[248:251], v[44:47], a[168:171], v[248:251]
v_mfma_f32_16x16x32_bf16 v[252:255], v[44:47], a[172:175], v[252:255]
s_waitcnt lgkmcnt(0)
v_mfma_f32_16x16x32_bf16 v[192:195], v[48:51], a[176:179], v[192:195]
s_waitcnt vmcnt(8)
ds_read_b64_tr_b16 v[32:33], v10 offset:0
v_mfma_f32_16x16x32_bf16 v[196:199], v[48:51], a[180:183], v[196:199]
ds_read_b64_tr_b16 v[34:35], v10 offset:2048
ds_read_b128 a[192:195], v1 offset:49152
v_mfma_f32_16x16x32_bf16 v[200:203], v[48:51], a[184:187], v[200:203]
ds_read_b128 a[196:199], v1 offset:50176
s_add_u32 m0, s60, 12288
v_mfma_f32_16x16x32_bf16 v[204:207], v[48:51], a[188:191], v[204:207]
s_add_u32 s61, s69, 491520
v_mfma_f32_16x16x32_bf16 v[208:211], v[52:55], a[176:179], v[208:211]
ds_read_b64_tr_b16 v[36:37], v11 offset:0
ds_read_b64_tr_b16 v[38:39], v11 offset:2048
v_mfma_f32_16x16x32_bf16 v[212:215], v[52:55], a[180:183], v[212:215]
buffer_load_dwordx4 v2, s[20:23], s61 offen offset:0 lds
v_mfma_f32_16x16x32_bf16 v[216:219], v[52:55], a[184:187], v[216:219]
ds_read_b128 a[200:203], v1 offset:51200
v_mfma_f32_16x16x32_bf16 v[220:223], v[52:55], a[188:191], v[220:223]
ds_read_b64_tr_b16 v[40:41], v12 offset:0
ds_read_b64_tr_b16 v[42:43], v12 offset:2048
v_mfma_f32_16x16x32_bf16 v[224:227], v[56:59], a[176:179], v[224:227]
buffer_load_dwordx4 v3, s[20:23], s61 offen offset:1024 lds
v_mfma_f32_16x16x32_bf16 v[228:231], v[56:59], a[180:183], v[228:231]
v_mfma_f32_16x16x32_bf16 v[232:235], v[56:59], a[184:187], v[232:235]
ds_read_b64_tr_b16 v[44:45], v13 offset:0
ds_read_b128 a[204:207], v1 offset:52224
v_mfma_f32_16x16x32_bf16 v[236:239], v[56:59], a[188:191], v[236:239]
ds_read_b64_tr_b16 v[46:47], v13 offset:2048
v_mfma_f32_16x16x32_bf16 v[240:243], v[60:63], a[176:179], v[240:243]
buffer_load_dwordx4 v4, s[20:23], s61 offen offset:2048 lds
v_mfma_f32_16x16x32_bf16 v[244:247], v[60:63], a[180:183], v[244:247]
buffer_load_dwordx4 v5, s[20:23], s61 offen offset:3072 lds
v_mfma_f32_16x16x32_bf16 v[248:251], v[60:63], a[184:187], v[248:251]
v_mfma_f32_16x16x32_bf16 v[252:255], v[60:63], a[188:191], v[252:255]
s_waitcnt lgkmcnt(0)
v_mfma_f32_16x16x32_bf16 v[192:195], v[32:35], a[192:195], v[192:195]
s_waitcnt vmcnt(8)
ds_read_b64_tr_b16 v[48:49], v10 offset:4096
v_mfma_f32_16x16x32_bf16 v[196:199], v[32:35], a[196:199], v[196:199]
ds_read_b64_tr_b16 v[50:51], v10 offset:6144
ds_read_b128 a[208:211], v1 offset:53248
v_mfma_f32_16x16x32_bf16 v[200:203], v[32:35], a[200:203], v[200:203]
ds_read_b128 a[212:215], v1 offset:54272
s_add_u32 m0, s60, 0
v_mfma_f32_16x16x32_bf16 v[204:207], v[32:35], a[204:207], v[204:207]
s_add_u32 s61, s69, 128
v_mfma_f32_16x16x32_bf16 v[208:211], v[36:39], a[192:195], v[208:211]
ds_read_b64_tr_b16 v[52:53], v11 offset:4096
ds_read_b64_tr_b16 v[54:55], v11 offset:6144
v_mfma_f32_16x16x32_bf16 v[212:215], v[36:39], a[196:199], v[212:215]
buffer_load_dwordx4 v2, s[20:23], s61 offen offset:0 lds
v_mfma_f32_16x16x32_bf16 v[216:219], v[36:39], a[200:203], v[216:219]
ds_read_b128 a[216:219], v1 offset:55296
v_mfma_f32_16x16x32_bf16 v[220:223], v[36:39], a[204:207], v[220:223]
ds_read_b64_tr_b16 v[56:57], v12 offset:4096
ds_read_b64_tr_b16 v[58:59], v12 offset:6144
v_mfma_f32_16x16x32_bf16 v[224:227], v[40:43], a[192:195], v[224:227]
buffer_load_dwordx4 v3, s[20:23], s61 offen offset:1024 lds
v_mfma_f32_16x16x32_bf16 v[228:231], v[40:43], a[196:199], v[228:231]
v_mfma_f32_16x16x32_bf16 v[232:235], v[40:43], a[200:203], v[232:235]
ds_read_b64_tr_b16 v[60:61], v13 offset:4096
ds_read_b128 a[220:223], v1 offset:56320
v_mfma_f32_16x16x32_bf16 v[236:239], v[40:43], a[204:207], v[236:239]
ds_read_b64_tr_b16 v[62:63], v13 offset:6144
v_mfma_f32_16x16x32_bf16 v[240:243], v[44:47], a[192:195], v[240:243]
buffer_load_dwordx4 v4, s[20:23], s61 offen offset:2048 lds
v_mfma_f32_16x16x32_bf16 v[244:247], v[44:47], a[196:199], v[244:247]
buffer_load_dwordx4 v5, s[20:23], s61 offen offset:3072 lds
v_mfma_f32_16x16x32_bf16 v[248:251], v[44:47], a[200:203], v[248:251]
v_mfma_f32_16x16x32_bf16 v[252:255], v[44:47], a[204:207], v[252:255]
s_waitcnt lgkmcnt(0)
v_mfma_f32_16x16x32_bf16 v[192:195], v[48:51], a[208:211], v[192:195]
s_waitcnt vmcnt(8)
ds_read_b64_tr_b16 v[32:33], v10 offset:8192
v_mfma_f32_16x16x32_bf16 v[196:199], v[48:51], a[212:215], v[196:199]
ds_read_b64_tr_b16 v[34:35], v10 offset:10240
ds_read_b128 a[224:227], v1 offset:57344
v_mfma_f32_16x16x32_bf16 v[200:203], v[48:51], a[216:219], v[200:203]
ds_read_b128 a[228:231], v1 offset:58368
s_add_u32 m0, s60, 4096
v_mfma_f32_16x16x32_bf16 v[204:207], v[48:51], a[220:223], v[204:207]
s_add_u32 s61, s69, 32896
v_mfma_f32_16x16x32_bf16 v[208:211], v[52:55], a[208:211], v[208:211]
ds_read_b64_tr_b16 v[36:37], v11 offset:8192
ds_read_b64_tr_b16 v[38:39], v11 offset:10240
v_mfma_f32_16x16x32_bf16 v[212:215], v[52:55], a[212:215], v[212:215]
buffer_load_dwordx4 v2, s[20:23], s61 offen offset:0 lds
v_mfma_f32_16x16x32_bf16 v[216:219], v[52:55], a[216:219], v[216:219]
ds_read_b128 a[232:235], v1 offset:59392
v_mfma_f32_16x16x32_bf16 v[220:223], v[52:55], a[220:223], v[220:223]
ds_read_b64_tr_b16 v[40:41], v12 offset:8192
ds_read_b64_tr_b16 v[42:43], v12 offset:10240
v_mfma_f32_16x16x32_bf16 v[224:227], v[56:59], a[208:211], v[224:227]
buffer_load_dwordx4 v3, s[20:23], s61 offen offset:1024 lds
v_mfma_f32_16x16x32_bf16 v[228:231], v[56:59], a[212:215], v[228:231]
v_mfma_f32_16x16x32_bf16 v[232:235], v[56:59], a[216:219], v[232:235]
ds_read_b64_tr_b16 v[44:45], v13 offset:8192
ds_read_b128 a[236:239], v1 offset:60416
v_mfma_f32_16x16x32_bf16 v[236:239], v[56:59], a[220:223], v[236:239]
ds_read_b64_tr_b16 v[46:47], v13 offset:10240
v_mfma_f32_16x16x32_bf16 v[240:243], v[60:63], a[208:211], v[240:243]
buffer_load_dwordx4 v4, s[20:23], s61 offen offset:2048 lds
v_mfma_f32_16x16x32_bf16 v[244:247], v[60:63], a[212:215], v[244:247]
buffer_load_dwordx4 v5, s[20:23], s61 offen offset:3072 lds
v_mfma_f32_16x16x32_bf16 v[248:251], v[60:63], a[216:219], v[248:251]
v_mfma_f32_16x16x32_bf16 v[252:255], v[60:63], a[220:223], v[252:255]
s_waitcnt lgkmcnt(0)
v_mfma_f32_16x16x32_bf16 v[192:195], v[32:35], a[224:227], v[192:195]
s_waitcnt vmcnt(8)
ds_read_b64_tr_b16 v[48:49], v10 offset:12288
v_mfma_f32_16x16x32_bf16 v[196:199], v[32:35], a[228:231], v[196:199]
ds_read_b64_tr_b16 v[50:51], v10 offset:14336
ds_read_b128 a[240:243], v1 offset:61440
v_mfma_f32_16x16x32_bf16 v[200:203], v[32:35], a[232:235], v[200:203]
ds_read_b128 a[244:247], v1 offset:62464
s_add_u32 m0, s60, 8192
v_mfma_f32_16x16x32_bf16 v[204:207], v[32:35], a[236:239], v[204:207]
s_add_u32 s61, s69, 65664
v_mfma_f32_16x16x32_bf16 v[208:211], v[36:39], a[224:227], v[208:211]
ds_read_b64_tr_b16 v[52:53], v11 offset:12288
ds_read_b64_tr_b16 v[54:55], v11 offset:14336
v_mfma_f32_16x16x32_bf16 v[212:215], v[36:39], a[228:231], v[212:215]
buffer_load_dwordx4 v2, s[20:23], s61 offen offset:0 lds
v_mfma_f32_16x16x32_bf16 v[216:219], v[36:39], a[232:235], v[216:219]
ds_read_b128 a[248:251], v1 offset:63488
v_mfma_f32_16x16x32_bf16 v[220:223], v[36:39], a[236:239], v[220:223]
ds_read_b64_tr_b16 v[56:57], v12 offset:12288
ds_read_b64_tr_b16 v[58:59], v12 offset:14336
v_mfma_f32_16x16x32_bf16 v[224:227], v[40:43], a[224:227], v[224:227]
buffer_load_dwordx4 v3, s[20:23], s61 offen offset:1024 lds
v_mfma_f32_16x16x32_bf16 v[228:231], v[40:43], a[228:231], v[228:231]
v_mfma_f32_16x16x32_bf16 v[232:235], v[40:43], a[232:235], v[232:235]
ds_read_b64_tr_b16 v[60:61], v13 offset:12288
ds_read_b128 a[252:255], v1 offset:64512
v_mfma_f32_16x16x32_bf16 v[236:239], v[40:43], a[236:239], v[236:239]
ds_read_b64_tr_b16 v[62:63], v13 offset:14336
v_mfma_f32_16x16x32_bf16 v[240:243], v[44:47], a[224:227], v[240:243]
buffer_load_dwordx4 v4, s[20:23], s61 offen offset:2048 lds
v_mfma_f32_16x16x32_bf16 v[244:247], v[44:47], a[228:231], v[244:247]
buffer_load_dwordx4 v5, s[20:23], s61 offen offset:3072 lds
v_mfma_f32_16x16x32_bf16 v[248:251], v[44:47], a[232:235], v[248:251]
v_mfma_f32_16x16x32_bf16 v[252:255], v[44:47], a[236:239], v[252:255]
s_waitcnt lgkmcnt(0)
v_mfma_f32_16x16x32_bf16 v[192:195], v[48:51], a[240:243], v[192:195]
s_waitcnt vmcnt(8)
ds_read_b64_tr_b16 v[32:33], v10 offset:0
v_mfma_f32_16x16x32_bf16 v[196:199], v[48:51], a[244:247], v[196:199]
ds_read_b64_tr_b16 v[34:35], v10 offset:2048
s_add_u32 m0, s60, 12288
v_mfma_f32_16x16x32_bf16 v[200:203], v[48:51], a[248:251], v[200:203]
s_add_u32 s61, s69, 98432
v_mfma_f32_16x16x32_bf16 v[204:207], v[48:51], a[252:255], v[204:207]
ds_read_b64_tr_b16 v[36:37], v11 offset:0
ds_read_b64_tr_b16 v[38:39], v11 offset:2048
v_mfma_f32_16x16x32_bf16 v[208:211], v[52:55], a[240:243], v[208:211]
buffer_load_dwordx4 v2, s[20:23], s61 offen offset:0 lds
v_mfma_f32_16x16x32_bf16 v[212:215], v[52:55], a[244:247], v[212:215]
v_mfma_f32_16x16x32_bf16 v[216:219], v[52:55], a[248:251], v[216:219]
v_mfma_f32_16x16x32_bf16 v[220:223], v[52:55], a[252:255], v[220:223]
ds_read_b64_tr_b16 v[40:41], v12 offset:0
ds_read_b64_tr_b16 v[42:43], v12 offset:2048
v_mfma_f32_16x16x32_bf16 v[224:227], v[56:59], a[240:243], v[224:227]
buffer_load_dwordx4 v3, s[20:23], s61 offen offset:1024 lds
v_mfma_f32_16x16x32_bf16 v[228:231], v[56:59], a[244:247], v[228:231]
v_mfma_f32_16x16x32_bf16 v[232:235], v[56:59], a[248:251], v[232:235]
ds_read_b64_tr_b16 v[44:45], v13 offset:0
v_mfma_f32_16x16x32_bf16 v[236:239], v[56:59], a[252:255], v[236:239]
ds_read_b64_tr_b16 v[46:47], v13 offset:2048
v_mfma_f32_16x16x32_bf16 v[240:243], v[60:63], a[240:243], v[240:243]
buffer_load_dwordx4 v4, s[20:23], s61 offen offset:2048 lds
v_mfma_f32_16x16x32_bf16 v[244:247], v[60:63], a[244:247], v[244:247]
buffer_load_dwordx4 v5, s[20:23], s61 offen offset:3072 lds
v_mfma_f32_16x16x32_bf16 v[248:251], v[60:63], a[248:251], v[248:251]
v_mfma_f32_16x16x32_bf16 v[252:255], v[60:63], a[252:255], v[252:255]
v_cmp_ne_u32 vcc, v126, v14
s_nop 3
s_cbranch_vccnz L_spin6
L_back5:
v_and_b32 v125, 0xff, v125
v_cmp_ne_u32 vcc, 0, v125
s_or_b32 s63, s2, s56
s_cmp_eq_u32 s63, 0
s_nop 1
s_cselect_b64 vcc, vcc, 0
s_cbranch_vccnz L_spin4
L_back3:
s_or_b32 s63, s2, s56
s_cmp_eq_u32 s63, 0
s_cselect_b32 s63, 0, 0x40000000
v_or_b32 v124, s63, v15
buffer_store_dword v14, v124, s[44:47], 0 offen sc1
s_waitcnt lgkmcnt(0)
s_barrier
s_lshl_b32 s85, s56, 10
s_lshl_b32 s62, s58, 16
s_add_u32 s62, s62, s85
s_add_u32 s84, s62, 3145728
v_mfma_f32_16x16x32_bf16 v[128:131], v[32:35], a[0:3], 0
s_waitcnt vmcnt(9)
ds_read_b64_tr_b16 v[48:49], v10 offset:4096
v_mfma_f32_16x16x32_bf16 v[132:135], v[32:35], a[4:7], 0
ds_read_b64_tr_b16 v[50:51], v10 offset:6144
s_add_u32 m0, s91, 0
s_add_u32 s61, s69, 131200
v_mfma_f32_16x16x32_bf16 v[136:139], v[32:35], a[8:11], 0
ds_read_b64_tr_b16 v[52:53], v11 offset:4096
ds_read_b64_tr_b16 v[54:55], v11 offset:6144
v_mfma_f32_16x16x32_bf16 v[140:143], v[32:35], a[12:15], 0
buffer_load_dwordx4 v2, s[20:23], s61 offen offset:0 lds
v_mfma_f32_16x16x32_bf16 v[144:147], v[36:39], a[0:3], 0
ds_read_b64_tr_b16 v[56:57], v12 offset:4096
ds_read_b64_tr_b16 v[58:59], v12 offset:6144
v_mfma_f32_16x16x32_bf16 v[148:151], v[36:39], a[4:7], 0
buffer_load_dwordx4 v3, s[20:23], s61 offen offset:1024 lds
v_mfma_f32_16x16x32_bf16 v[152:155], v[36:39], a[8:11], 0
ds_read_b64_tr_b16 v[60:61], v13 offset:4096
ds_read_b64_tr_b16 v[62:63], v13 offset:6144
v_mfma_f32_16x16x32_bf16 v[156:159], v[36:39], a[12:15], 0
buffer_load_dwordx4 v4, s[20:23], s61 offen offset:2048 lds
v_mfma_f32_16x16x32_bf16 v[160:163], v[40:43], a[0:3], 0
buffer_load_dwordx4 v5, s[20:23], s61 offen offset:3072 lds
v_mfma_f32_16x16x32_bf16 v[164:167], v[40:43], a[4:7], 0
s_add_u32 m0, s91, 4096
s_add_u32 s61, s69, 163968
v_mfma_f32_16x16x32_bf16 v[168:171], v[40:43], a[8:11], 0
buffer_load_dwordx4 v2, s[20:23], s61 offen offset:0 lds
v_mfma_f32_16x16x32_bf16 v[172:175], v[40:43], a[12:15], 0
buffer_load_dwordx4 v3, s[20:23], s61 offen offset:1024 lds
v_mfma_f32_16x16x32_bf16 v[176:179], v[44:47], a[0:3], 0
buffer_load_dwordx4 v4, s[20:23], s61 offen offset:2048 lds
v_mfma_f32_16x16x32_bf16 v[180:183], v[44:47], a[4:7], 0
buffer_load_dwordx4 v5, s[20:23], s61 offen offset:3072 lds
s_add_u32 m0, s85, 0
v_mfma_f32_16x16x32_bf16 v[184:187], v[44:47], a[8:11], 0
buffer_load_dwordx4 v1, s[44:47], s84 offen sc1 lds
s_add_u32 s84, s84, 4096
v_mfma_f32_16x16x32_bf16 v[188:191], v[44:47], a[12:15], 0
s_add_u32 m0, s85, 4096
s_nop 0
buffer_load_dwordx4 v1, s[44:47], s84 offen sc1 lds
s_waitcnt lgkmcnt(0)
v_mfma_f32_16x16x32_bf16 v[128:131], v[48:51], a[16:19], v[128:131]
s_waitcnt vmcnt(15)
ds_read_b64_tr_b16 v[32:33], v10 offset:8192
v_mfma_f32_16x16x32_bf16 v[132:135], v[48:51], a[20:23], v[132:135]
ds_read_b64_tr_b16 v[34:35], v10 offset:10240
s_add_u32 m0, s60, 0
s_add_u32 s61, s69, 196736
v_mfma_f32_16x16x32_bf16 v[136:139], v[48:51], a[24:27], v[136:139]
ds_read_b64_tr_b16 v[36:37], v11 offset:8192
ds_read_b64_tr_b16 v[38:39], v11 offset:10240
v_mfma_f32_16x16x32_bf16 v[140:143], v[48:51], a[28:31], v[140:143]
buffer_load_dwordx4 v2, s[20:23], s61 offen offset:0 lds
v_mfma_f32_16x16x32_bf16 v[144:147], v[52:55], a[16:19], v[144:147]
ds_read_b64_tr_b16 v[40:41], v12 offset:8192
ds_read_b64_tr_b16 v[42:43], v12 offset:10240
v_mfma_f32_16x16x32_bf16 v[148:151], v[52:55], a[20:23], v[148:151]
buffer_load_dwordx4 v3, s[20:23], s61 offen offset:1024 lds
v_mfma_f32_16x16x32_bf16 v[152:155], v[52:55], a[24:27], v[152:155]
ds_read_b64_tr_b16 v[44:45], v13 offset:8192
ds_read_b64_tr_b16 v[46:47], v13 offset:10240
v_mfma_f32_16x16x32_bf16 v[156:159], v[52:55], a[28:31], v[156:159]
buffer_load_dwordx4 v4, s[20:23], s61 offen offset:2048 lds
v_mfma_f32_16x16x32_bf16 v[160:163], v[56:59], a[16:19], v[160:163]
buffer_load_dwordx4 v5, s[20:23], s61 offen offset:3072 lds
v_mfma_f32_16x16x32_bf16 v[164:167], v[56:59], a[20:23], v[164:167]
s_add_u32 m0, s60, 4096
s_add_u32 s61, s69, 229504
v_mfma_f32_16x16x32_bf16 v[168:171], v[56:59], a[24:27], v[168:171]
buffer_load_dwordx4 v2, s[20:23], s61 offen offset:0 lds
v_mfma_f32_16x16x32_bf16 v[172:175], v[56:59], a[28:31], v[172:175]
buffer_load_dwordx4 v3, s[20:23], s61 offen offset:1024 lds
v_mfma_f32_16x16x32_bf16 v[176:179], v[60:63], a[16:19], v[176:179]
buffer_load_dwordx4 v4, s[20:23], s61 offen offset:2048 lds
v_mfma_f32_16x16x32_bf16 v[180:183], v[60:63], a[20:23], v[180:183]
buffer_load_dwordx4 v5, s[20:23], s61 offen offset:3072 lds
v_mfma_f32_16x16x32_bf16 v[184:187], v[60:63], a[24:27], v[184:187]
s_add_u32 s84, s84, 4096
s_add_u32 m0, s85, 8192
v_mfma_f32_16x16x32_bf16 v[188:191], v[60:63], a[28:31], v[188:191]
buffer_load_dwordx4 v1, s[44:47], s84 offen sc1 lds
s_waitcnt lgkmcnt(0)
v_mfma_f32_16x16x32_bf16 v[128:131], v[32:35], a[32:35], v[128:131]
s_waitcnt vmcnt(20)
ds_read_b64_tr_b16 v[48:49], v10 offset:12288
v_mfma_f32_16x16x32_bf16 v[132:135], v[32:35], a[36:39], v[132:135]
ds_read_b64_tr_b16 v[50:51], v10 offset:14336
s_add_u32 m0, s60, 8192
v_mfma_f32_16x16x32_bf16 v[136:139], v[32:35], a[40:43], v[136:139]
s_add_u32 s61, s69, 262272
v_mfma_f32_16x16x32_bf16 v[140:143], v[32:35], a[44:47], v[140:143]
ds_read_b64_tr_b16 v[52:53], v11 offset:12288
ds_read_b64_tr_b16 v[54:55], v11 offset:14336
v_mfma_f32_16x16x32_bf16 v[144:147], v[36:39], a[32:35], v[144:147]
buffer_load_dwordx4 v2, s[20:23], s61 offen offset:0 lds
v_mfma_f32_16x16x32_bf16 v[148:151], v[36:39], a[36:39], v[148:151]
ds_read_b64_tr_b16 v[56:57], v12 offset:12288
v_mfma_f32_16x16x32_bf16 v[152:155], v[36:39], a[40:43], v[152:155]
ds_read_b64_tr_b16 v[58:59], v12 offset:14336
v_mfma_f32_16x16x32_bf16 v[156:159], v[36:39], a[44:47], v[156:159]
buffer_load_dwordx4 v3, s[20:23], s61 offen offset:1024 lds
v_mfma_f32_16x16x32_bf16 v[160:163], v[40:43], a[32:35], v[160:163]
ds_read_b64_tr_b16 v[60:61], v13 offset:12288
v_mfma_f32_16x16x32_bf16 v[164:167], v[40:43], a[36:39], v[164:167]
ds_read_b64_tr_b16 v[62:63], v13 offset:14336
v_mfma_f32_16x16x32_bf16 v[168:171], v[40:43], a[40:43], v[168:171]
buffer_load_dwordx4 v4, s[20:23], s61 offen offset:2048 lds
v_mfma_f32_16x16x32_bf16 v[172:175], v[40:43], a[44:47], v[172:175]
buffer_load_dwordx4 v5, s[20:23], s61 offen offset:3072 lds
v_mfma_f32_16x16x32_bf16 v[176:179], v[44:47], a[32:35], v[176:179]
s_add_u32 s84, s84, 4096
s_add_u32 m0, s85, 12288
v_mfma_f32_16x16x32_bf16 v[180:183], v[44:47], a[36:39], v[180:183]
v_mfma_f32_16x16x32_bf16 v[184:187], v[44:47], a[40:43], v[184:187]
buffer_load_dwordx4 v1, s[44:47], s84 offen sc1 lds
v_mfma_f32_16x16x32_bf16 v[188:191], v[44:47], a[44:47], v[188:191]
s_waitcnt lgkmcnt(0)
v_mfma_f32_16x16x32_bf16 v[128:131], v[48:51], a[48:51], v[128:131]
s_waitcnt vmcnt(20)
ds_read_b64_tr_b16 v[32:33], v20 offset:0
v_mfma_f32_16x16x32_bf16 v[132:135], v[48:51], a[52:55], v[132:135]
ds_read_b64_tr_b16 v[34:35], v20 offset:2048
s_add_u32 m0, s60, 12288
v_mfma_f32_16x16x32_bf16 v[136:139], v[48:51], a[56:59], v[136:139]
s_add_u32 s61, s69, 295040
v_mfma_f32_16x16x32_bf16 v[140:143], v[48:51], a[60:63], v[140:143]
ds_read_b64_tr_b16 v[36:37], v21 offset:0
ds_read_b64_tr_b16 v[38:39], v21 offset:2048
v_mfma_f32_16x16x32_bf16 v[144:147], v[52:55], a[48:51], v[144:147]
buffer_load_dwordx4 v2, s[20:23], s61 offen offset:0 lds
v_mfma_f32_16x16x32_bf16 v[148:151], v[52:55], a[52:55], v[148:151]
ds_read_b64_tr_b16 v[40:41], v22 offset:0
v_mfma_f32_16x16x32_bf16 v[152:155], v[52:55], a[56:59], v[152:155]
ds_read_b64_tr_b16 v[42:43], v22 offset:2048
v_mfma_f32_16x16x32_bf16 v[156:159], v[52:55], a[60:63], v[156:159]
buffer_load_dwordx4 v3, s[20:23], s61 offen offset:1024 lds
v_mfma_f32_16x16x32_bf16 v[160:163], v[56:59], a[48:51], v[160:163]
ds_read_b64_tr_b16 v[44:45], v23 offset:0
v_mfma_f32_16x16x32_bf16 v[164:167], v[56:59], a[52:55], v[164:167]
ds_read_b64_tr_b16 v[46:47], v23 offset:2048
v_mfma_f32_16x16x32_bf16 v[168:171], v[56:59], a[56:59], v[168:171]
buffer_load_dwordx4 v4, s[20:23], s61 offen offset:2048 lds
v_mfma_f32_16x16x32_bf16 v[172:175], v[56:59], a[60:63], v[172:175]
buffer_load_dwordx4 v5, s[20:23], s61 offen offset:3072 lds
v_mfma_f32_16x16x32_bf16 v[176:179], v[60:63], a[48:51], v[176:179]
s_add_u32 s84, s84, 4096
s_add_u32 m0, s85, 16384
v_mfma_f32_16x16x32_bf16 v[180:183], v[60:63], a[52:55], v[180:183]
v_mfma_f32_16x16x32_bf16 v[184:187], v[60:63], a[56:59], v[184:187]
buffer_load_dwordx4 v1, s[44:47], s84 offen sc1 lds
v_mfma_f32_16x16x32_bf16 v[188:191], v[60:63], a[60:63], v[188:191]
s_waitcnt lgkmcnt(0)
v_mfma_f32_16x16x32_bf16 v[128:131], v[32:35], a[64:67], v[128:131]
s_waitcnt vmcnt(21)
ds_read_b64_tr_b16 v[48:49], v20 offset:4096
v_mfma_f32_16x16x32_bf16 v[132:135], v[32:35], a[68:71], v[132:135]
ds_read_b64_tr_b16 v[50:51], v20 offset:6144
s_add_u32 m0, s91, 0
v_mfma_f32_16x16x32_bf16 v[136:139], v[32:35], a[72:75], v[136:139]
s_add_u32 s61, s69, 327808
v_mfma_f32_16x16x32_bf16 v[140:143], v[32:35], a[76:79], v[140:143]
ds_read_b64_tr_b16 v[52:53], v21 offset:4096
ds_read_b64_tr_b16 v[54:55], v21 offset:6144
v_mfma_f32_16x16x32_bf16 v[144:147], v[36:39], a[64:67], v[144:147]
buffer_load_dwordx4 v2, s[20:23], s61 offen offset:0 lds
v_mfma_f32_16x16x32_bf16 v[148:151], v[36:39], a[68:71], v[148:151]
ds_read_b64_tr_b16 v[56:57], v22 offset:4096
v_mfma_f32_16x16x32_bf16 v[152:155], v[36:39], a[72:75], v[152:155]
ds_read_b64_tr_b16 v[58:59], v22 offset:6144
v_mfma_f32_16x16x32_bf16 v[156:159], v[36:39], a[76:79], v[156:159]
buffer_load_dwordx4 v3, s[20:23], s61 offen offset:1024 lds
v_mfma_f32_16x16x32_bf16 v[160:163], v[40:43], a[64:67], v[160:163]
ds_read_b64_tr_b16 v[60:61], v23 offset:4096
v_mfma_f32_16x16x32_bf16 v[164:167], v[40:43], a[68:71], v[164:167]
ds_read_b64_tr_b16 v[62:63], v23 offset:6144
v_mfma_f32_16x16x32_bf16 v[168:171], v[40:43], a[72:75], v[168:171]
buffer_load_dwordx4 v4, s[20:23], s61 offen offset:2048 lds
v_mfma_f32_16x16x32_bf16 v[172:175], v[40:43], a[76:79], v[172:175]
buffer_load_dwordx4 v5, s[20:23], s61 offen offset:3072 lds
v_mfma_f32_16x16x32_bf16 v[176:179], v[44:47], a[64:67], v[176:179]
s_add_u32 s84, s84, 4096
s_add_u32 m0, s85, 20480
v_mfma_f32_16x16x32_bf16 v[180:183], v[44:47], a[68:71], v[180:183]
v_mfma_f32_16x16x32_bf16 v[184:187], v[44:47], a[72:75], v[184:187]
buffer_load_dwordx4 v1, s[44:47], s84 offen sc1 lds
v_mfma_f32_16x16x32_bf16 v[188:191], v[44:47], a[76:79], v[188:191]
s_waitcnt lgkmcnt(0)
v_mfma_f32_16x16x32_bf16 v[128:131], v[48:51], a[80:83], v[128:131]
s_waitcnt vmcnt(20)
ds_read_b64_tr_b16 v[32:33], v10 offset:0
v_mfma_f32_16x16x32_bf16 v[132:135], v[48:51], a[84:87], v[132:135]
ds_read_b64_tr_b16 v[34:35], v10 offset:2048
s_add_u32 m0, s91, 4096
v_mfma_f32_16x16x32_bf16 v[136:139], v[48:51], a[88:91], v[136:139]
s_add_u32 s61, s69, 360576
v_mfma_f32_16x16x32_bf16 v[140:143], v[48:51], a[92:95], v[140:143]
ds_read_b64_tr_b16 v[36:37], v11 offset:0
ds_read_b64_tr_b16 v[38:39], v11 offset:2048
v_mfma_f32_16x16x32_bf16 v[144:147], v[52:55], a[80:83], v[144:147]
buffer_load_dwordx4 v2, s[20:23], s61 offen offset:0 lds
v_mfma_f32_16x16x32_bf16 v[148:151], v[52:55], a[84:87], v[148:151]
ds_read_b64_tr_b16 v[40:41], v12 offset:0
v_mfma_f32_16x16x32_bf16 v[152:155], v[52:55], a[88:91], v[152:155]
ds_read_b64_tr_b16 v[42:43], v12 offset:2048
v_mfma_f32_16x16x32_bf16 v[156:159], v[52:55], a[92:95], v[156:159]
buffer_load_dwordx4 v3, s[20:23], s61 offen offset:1024 lds
v_mfma_f32_16x16x32_bf16 v[160:163], v[56:59], a[80:83], v[160:163]
ds_read_b64_tr_b16 v[44:45], v13 offset:0
v_mfma_f32_16x16x32_bf16 v[164:167], v[56:59], a[84:87], v[164:167]
ds_read_b64_tr_b16 v[46:47], v13 offset:2048
v_mfma_f32_16x16x32_bf16 v[168:171], v[56:59], a[88:91], v[168:171]
buffer_load_dwordx4 v4, s[20:23], s61 offen offset:2048 lds
v_mfma_f32_16x16x32_bf16 v[172:175], v[56:59], a[92:95], v[172:175]
buffer_load_dwordx4 v5, s[20:23], s61 offen offset:3072 lds
v_mfma_f32_16x16x32_bf16 v[176:179], v[60:63], a[80:83], v[176:179]
s_add_u32 s84, s84, 4096
s_add_u32 m0, s85, 24576
v_mfma_f32_16x16x32_bf16 v[180:183], v[60:63], a[84:87], v[180:183]
v_mfma_f32_16x16x32_bf16 v[184:187], v[60:63], a[88:91], v[184:187]
buffer_load_dwordx4 v1, s[44:47], s84 offen sc1 lds
v_mfma_f32_16x16x32_bf16 v[188:191], v[60:63], a[92:95], v[188:191]
s_waitcnt lgkmcnt(0)
v_mfma_f32_16x16x32_bf16 v[128:131], v[32:35], a[96:99], v[128:131]
s_waitcnt vmcnt(21)
ds_read_b64_tr_b16 v[48:49], v10 offset:4096
v_mfma_f32_16x16x32_bf16 v[132:135], v[32:35], a[100:103], v[132:135]
ds_read_b64_tr_b16 v[50:51], v10 offset:6144
s_add_u32 m0, s60, 0
v_mfma_f32_16x16x32_bf16 v[136:139], v[32:35], a[104:107], v[136:139]
s_add_u32 s61, s69, 393344
s_lshl_b32 s63, s58, 6
v_mfma_f32_16x16x32_bf16 v[140:143], v[32:35], a[108:111], v[140:143]
ds_read_b64_tr_b16 v[52:53], v11 offset:4096
ds_read_b64_tr_b16 v[54:55], v11 offset:6144
v_mfma_f32_16x16x32_bf16 v[144:147], v[36:39], a[96:99], v[144:147]
buffer_load_dwordx4 v2, s[20:23], s61 offen offset:0 lds
v_mfma_f32_16x16x32_bf16 v[148:151], v[36:39], a[100:103], v[148:151]
ds_read_b64_tr_b16 v[56:57], v12 offset:4096
ds_read_b64_tr_b16 v[58:59], v12 offset:6144
v_mfma_f32_16x16x32_bf16 v[152:155], v[36:39], a[104:107], v[152:155]
buffer_load_dwordx4 v3, s[20:23], s61 offen offset:1024 lds
v_mfma_f32_16x16x32_bf16 v[156:159], v[36:39], a[108:111], v[156:159]
ds_read_b64_tr_b16 v[60:61], v13 offset:4096
ds_read_b64_tr_b16 v[62:63], v13 offset:6144
v_mfma_f32_16x16x32_bf16 v[160:163], v[40:43], a[96:99], v[160:163]
buffer_load_dwordx4 v4, s[20:23], s61 offen offset:2048 lds
v_mfma_f32_16x16x32_bf16 v[164:167], v[40:43], a[100:103], v[164:167]
buffer_load_dwordx4 v5, s[20:23], s61 offen offset:3072 lds
v_mfma_f32_16x16x32_bf16 v[168:171], v[40:43], a[104:107], v[168:171]
s_add_u32 s84, s84, 4096
s_add_u32 m0, s85, 28672
v_mfma_f32_16x16x32_bf16 v[172:175], v[40:43], a[108:111], v[172:175]
buffer_load_dwordx4 v1, s[44:47], s84 offen sc1 lds
v_mfma_f32_16x16x32_bf16 v[176:179], v[44:47], a[96:99], v[176:179]
s_lshl_b32 s62, s56, 4
s_add_u32 s63, s63, s62
v_mfma_f32_16x16x32_bf16 v[180:183], v[44:47], a[100:103], v[180:183]
s_lshl_b32 s63, s63, 3
s_add_u32 s63, s63, s57
v_mfma_f32_16x16x32_bf16 v[184:187], v[44:47], a[104:107], v[184:187]
s_lshl_b32 s63, s63, 10
s_add_u32 s81, s63, 25165824
v_mfma_f32_16x16x32_bf16 v[188:191], v[44:47], a[108:111], v[188:191]
s_waitcnt lgkmcnt(0)
v_mfma_f32_16x16x32_bf16 v[128:131], v[48:51], a[112:115], v[128:131]
s_waitcnt vmcnt(21)
ds_read_b64_tr_b16 v[32:33], v10 offset:8192
v_cvt_pk_bf16_f32 v192, v192, v193
v_mfma_f32_16x16x32_bf16 v[132:135], v[48:51], a[116:119], v[132:135]
ds_read_b64_tr_b16 v[34:35], v10 offset:10240
s_add_u32 m0, s60, 4096
s_add_u32 s61, s69, 426112
v_mfma_f32_16x16x32_bf16 v[136:139], v[48:51], a[120:123], v[136:139]
ds_read_b64_tr_b16 v[36:37], v11 offset:8192
ds_read_b64_tr_b16 v[38:39], v11 offset:10240
v_cvt_pk_bf16_f32 v193, v194, v195
v_mfma_f32_16x16x32_bf16 v[140:143], v[48:51], a[124:127], v[140:143]
buffer_load_dwordx4 v2, s[20:23], s61 offen offset:0 lds
v_mfma_f32_16x16x32_bf16 v[144:147], v[52:55], a[112:115], v[144:147]
ds_read_b64_tr_b16 v[40:41], v12 offset:8192
ds_read_b64_tr_b16 v[42:43], v12 offset:10240
v_cvt_pk_bf16_f32 v194, v208, v209
v_mfma_f32_16x16x32_bf16 v[148:151], v[52:55], a[116:119], v[148:151]
buffer_load_dwordx4 v3, s[20:23], s61 offen offset:1024 lds
v_mfma_f32_16x16x32_bf16 v[152:155], v[52:55], a[120:123], v[152:155]
ds_read_b64_tr_b16 v[44:45], v13 offset:8192
ds_read_b64_tr_b16 v[46:47], v13 offset:10240
v_mfma_f32_16x16x32_bf16 v[156:159], v[52:55], a[124:127], v[156:159]
buffer_load_dwordx4 v4, s[20:23], s61 offen offset:2048 lds
v_mfma_f32_16x16x32_bf16 v[160:163], v[56:59], a[112:115], v[160:163]
buffer_load_dwordx4 v5, s[20:23], s61 offen offset:3072 lds
v_mfma_f32_16x16x32_bf16 v[164:167], v[56:59], a[116:119], v[164:167]
s_add_u32 s84, s84, 4096
s_add_u32 m0, s85, 32768
v_mfma_f32_16x16x32_bf16 v[168:171], v[56:59], a[120:123], v[168:171]
buffer_load_dwordx4 v1, s[44:47], s84 offen sc1 lds
v_mfma_f32_16x16x32_bf16 v[172:175], v[56:59], a[124:127], v[172:175]
s_add_u32 s84, s84, 4096
s_add_u32 m0, s85, 36864
v_mfma_f32_16x16x32_bf16 v[176:179], v[60:63], a[112:115], v[176:179]
buffer_load_dwordx4 v1, s[44:47], s84 offen sc1 lds
v_mfma_f32_16x16x32_bf16 v[180:183], v[60:63], a[116:119], v[180:183]
v_cvt_pk_bf16_f32 v195, v210, v211
v_mfma_f32_16x16x32_bf16 v[184:187], v[60:63], a[120:123], v[184:187]
buffer_store_dwordx4 v[192:195], v1, s[44:47], s81 offen sc1
v_mfma_f32_16x16x32_bf16 v[188:191], v[60:63], a[124:127], v[188:191]
s_add_u32 s81, s81, 8192
v_cvt_pk_bf16_f32 v196, v196, v197
s_waitcnt lgkmcnt(0)
v_mfma_f32_16x16x32_bf16 v[128:131], v[32:35], a[128:131], v[128:131]
s_waitcnt vmcnt(23)
ds_read_b64_tr_b16 v[48:49], v10 offset:12288
v_mfma_f32_16x16x32_bf16 v[132:135], v[32:35], a[132:135], v[132:135]
ds_read_b64_tr_b16 v[50:51], v10 offset:14336
s_add_u32 m0, s60, 8192
v_mfma_f32_16x16x32_bf16 v[136:139], v[32:35], a[136:139], v[136:139]
s_add_u32 s61, s69, 458880
v_cvt_pk_bf16_f32 v197, v198, v199
v_mfma_f32_16x16x32_bf16 v[140:143], v[32:35], a[140:143], v[140:143]
ds_read_b64_tr_b16 v[52:53], v11 offset:12288
ds_read_b64_tr_b16 v[54:55], v11 offset:14336
v_cvt_pk_bf16_f32 v198, v212, v213
v_mfma_f32_16x16x32_bf16 v[144:147], v[36:39], a[128:131], v[144:147]
buffer_load_dwordx4 v2, s[20:23], s61 offen offset:0 lds
v_mfma_f32_16x16x32_bf16 v[148:151], v[36:39], a[132:135], v[148:151]
ds_read_b64_tr_b16 v[56:57], v12 offset:12288
ds_read_b64_tr_b16 v[58:59], v12 offset:14336
v_mfma_f32_16x16x32_bf16 v[152:155], v[36:39], a[136:139], v[152:155]
buffer_load_dwordx4 v3, s[20:23], s61 offen offset:1024 lds
v_mfma_f32_16x16x32_bf16 v[156:159], v[36:39], a[140:143], v[156:159]
ds_read_b64_tr_b16 v[60:61], v13 offset:12288
ds_read_b64_tr_b16 v[62:63], v13 offset:14336
v_mfma_f32_16x16x32_bf16 v[160:163], v[40:43], a[128:131], v[160:163]
buffer_load_dwordx4 v4, s[20:23], s61 offen offset:2048 lds
v_mfma_f32_16x16x32_bf16 v[164:167], v[40:43], a[132:135], v[164:167]
buffer_load_dwordx4 v5, s[20:23], s61 offen offset:3072 lds
v_mfma_f32_16x16x32_bf16 v[168:171], v[40:43], a[136:139], v[168:171]
s_add_u32 s84, s84, 4096
s_add_u32 m0, s85, 40960
v_mfma_f32_16x16x32_bf16 v[172:175], v[40:43], a[140:143], v[172:175]
buffer_load_dwordx4 v1, s[44:47], s84 offen sc1 lds
v_mfma_f32_16x16x32_bf16 v[176:179], v[44:47], a[128:131], v[176:179]
v_cvt_pk_bf16_f32 v199, v214, v215
v_mfma_f32_16x16x32_bf16 v[180:183], v[44:47], a[132:135], v[180:183]
buffer_store_dwordx4 v[196:199], v1, s[44:47], s81 offen sc1
v_mfma_f32_16x16x32_bf16 v[184:187], v[44:47], a[136:139], v[184:187]
s_add_u32 s81, s81, 8192
v_cvt_pk_bf16_f32 v200, v200, v201
v_mfma_f32_16x16x32_bf16 v[188:191], v[44:47], a[140:143], v[188:191]
v_cvt_pk_bf16_f32 v201, v202, v203
s_waitcnt lgkmcnt(0)
v_mfma_f32_16x16x32_bf16 v[128:131], v[48:51], a[144:147], v[128:131]
s_waitcnt vmcnt(24)
ds_read_b64_tr_b16 v[32:33], v20 offset:0
v_mfma_f32_16x16x32_bf16 v[132:135], v[48:51], a[148:151], v[132:135]
ds_read_b64_tr_b16 v[34:35], v20 offset:2048
s_add_u32 m0, s60, 12288
v_mfma_f32_16x16x32_bf16 v[136:139], v[48:51], a[152:155], v[136:139]
s_add_u32 s61, s69, 491648
v_cvt_pk_bf16_f32 v202, v216, v217
v_mfma_f32_16x16x32_bf16 v[140:143], v[48:51], a[156:159], v[140:143]
ds_read_b64_tr_b16 v[36:37], v21 offset:0
ds_read_b64_tr_b16 v[38:39], v21 offset:2048
v_mfma_f32_16x16x32_bf16 v[144:147], v[52:55], a[144:147], v[144:147]
buffer_load_dwordx4 v2, s[20:23], s61 offen offset:0 lds
v_mfma_f32_16x16x32_bf16 v[148:151], v[52:55], a[148:151], v[148:151]
ds_read_b64_tr_b16 v[40:41], v22 offset:0
ds_read_b64_tr_b16 v[42:43], v22 offset:2048
v_mfma_f32_16x16x32_bf16 v[152:155], v[52:55], a[152:155], v[152:155]
buffer_load_dwordx4 v3, s[20:23], s61 offen offset:1024 lds
v_mfma_f32_16x16x32_bf16 v[156:159], v[52:55], a[156:159], v[156:159]
ds_read_b64_tr_b16 v[44:45], v23 offset:0
ds_read_b64_tr_b16 v[46:47], v23 offset:2048
v_mfma_f32_16x16x32_bf16 v[160:163], v[56:59], a[144:147], v[160:163]
buffer_load_dwordx4 v4, s[20:23], s61 offen offset:2048 lds
v_mfma_f32_16x16x32_bf16 v[164:167], v[56:59], a[148:151], v[164:167]
buffer_load_dwordx4 v5, s[20:23], s61 offen offset:3072 lds
v_mfma_f32_16x16x32_bf16 v[168:171], v[56:59], a[152:155], v[168:171]
s_add_u32 s84, s84, 4096
s_add_u32 m0, s85, 45056
v_mfma_f32_16x16x32_bf16 v[172:175], v[56:59], a[156:159], v[172:175]
buffer_load_dwordx4 v1, s[44:47], s84 offen sc1 lds
v_mfma_f32_16x16x32_bf16 v[176:179], v[60:63], a[144:147], v[176:179]
v_cvt_pk_bf16_f32 v203, v218, v219
v_mfma_f32_16x16x32_bf16 v[180:183], v[60:63], a[148:151], v[180:183]
buffer_store_dwordx4 v[200:203], v1, s[44:47], s81 offen sc1
v_mfma_f32_16x16x32_bf16 v[184:187], v[60:63], a[152:155], v[184:187]
s_add_u32 s81, s81, 8192
v_cvt_pk_bf16_f32 v204, v204, v205
v_mfma_f32_16x16x32_bf16 v[188:191], v[60:63], a[156:159], v[188:191]
v_cvt_pk_bf16_f32 v205, v206, v207
s_waitcnt lgkmcnt(0)
v_mfma_f32_16x16x32_bf16 v[128:131], v[32:35], a[160:163], v[128:131]
s_waitcnt vmcnt(25)
ds_read_b64_tr_b16 v[48:49], v20 offset:4096
v_mfma_f32_16x16x32_bf16 v[132:135], v[32:35], a[164:167], v[132:135]
ds_read_b64_tr_b16 v[50:51], v20 offset:6144
s_add_u32 m0, s91, 0
v_mfma_f32_16x16x32_bf16 v[136:139], v[32:35], a[168:171], v[136:139]
s_mov_b32 s61, 0
v_cvt_pk_bf16_f32 v206, v220, v221
v_mfma_f32_16x16x32_bf16 v[140:143], v[32:35], a[172:175], v[140:143]
ds_read_b64_tr_b16 v[52:53], v21 offset:4096
ds_read_b64_tr_b16 v[54:55], v21 offset:6144
v_cvt_pk_bf16_f32 v207, v222, v223
v_mfma_f32_16x16x32_bf16 v[144:147], v[36:39], a[160:163], v[144:147]
buffer_load_dwordx4 v6, s[32:35], s61 offen offset:0 lds
v_mfma_f32_16x16x32_bf16 v[148:151], v[36:39], a[164:167], v[148:151]
buffer_store_dwordx4 v[204:207], v1, s[44:47], s81 offen sc1
v_mfma_f32_16x16x32_bf16 v[152:155], v[36:39], a[168:171], v[152:155]
ds_read_b64_tr_b16 v[56:57], v22 offset:4096
ds_read_b64_tr_b16 v[58:59], v22 offset:6144
v_mfma_f32_16x16x32_bf16 v[156:159], v[36:39], a[172:175], v[156:159]
buffer_load_dwordx4 v7, s[32:35], s61 offen offset:1024 lds
v_mfma_f32_16x16x32_bf16 v[160:163], v[40:43], a[160:163], v[160:163]
ds_read_b64_tr_b16 v[60:61], v23 offset:4096
ds_read_b64_tr_b16 v[62:63], v23 offset:6144
v_mfma_f32_16x16x32_bf16 v[164:167], v[40:43], a[164:167], v[164:167]
buffer_load_dwordx4 v8, s[32:35], s61 offen offset:2048 lds
v_mfma_f32_16x16x32_bf16 v[168:171], v[40:43], a[168:171], v[168:171]
buffer_load_dwordx4 v9, s[32:35], s61 offen offset:3072 lds
v_mfma_f32_16x16x32_bf16 v[172:175], v[40:43], a[172:175], v[172:175]
s_add_u32 s84, s84, 4096
s_add_u32 m0, s85, 49152
v_mfma_f32_16x16x32_bf16 v[176:179], v[44:47], a[160:163], v[176:179]
buffer_load_dwordx4 v1, s[44:47], s84 offen sc1 lds
v_mfma_f32_16x16x32_bf16 v[180:183], v[44:47], a[164:167], v[180:183]
s_add_u32 s81, s81, 8192
v_cvt_pk_bf16_f32 v224, v224, v225
v_mfma_f32_16x16x32_bf16 v[184:187], v[44:47], a[168:171], v[184:187]
v_cvt_pk_bf16_f32 v225, v226, v227
v_cvt_pk_bf16_f32 v226, v240, v241
v_mfma_f32_16x16x32_bf16 v[188:191], v[44:47], a[172:175], v[188:191]
s_waitcnt lgkmcnt(0)
v_mfma_f32_16x16x32_bf16 v[128:131], v[48:51], a[176:179], v[128:131]
s_waitcnt vmcnt(26)
ds_read_b64_tr_b16 v[32:33], v10 offset:0
v_mfma_f32_16x16x32_bf16 v[132:135], v[48:51], a[180:183], v[132:135]
ds_read_b64_tr_b16 v[34:35], v10 offset:2048
s_add_u32 m0, s91, 4096
v_mfma_f32_16x16x32_bf16 v[136:139], v[48:51], a[184:187], v[136:139]
s_mov_b32 s61, 114688
v_cvt_pk_bf16_f32 v227, v242, v243
v_mfma_f32_16x16x32_bf16 v[140:143], v[48:51], a[188:191], v[140:143]
ds_read_b64_tr_b16 v[36:37], v11 offset:0
v_mfma_f32_16x16x32_bf16 v[144:147], v[52:55], a[176:179], v[144:147]
ds_read_b64_tr_b16 v[38:39], v11 offset:2048
v_mfma_f32_16x16x32_bf16 v[148:151], v[52:55], a[180:183], v[148:151]
buffer_load_dwordx4 v6, s[32:35], s61 offen offset:0 lds
v_mfma_f32_16x16x32_bf16 v[152:155], v[52:55], a[184:187], v[152:155]
buffer_store_dwordx4 v[224:227], v1, s[44:47], s81 offen sc1
v_mfma_f32_16x16x32_bf16 v[156:159], v[52:55], a[188:191], v[156:159]
ds_read_b64_tr_b16 v[40:41], v12 offset:0
ds_read_b64_tr_b16 v[42:43], v12 offset:2048
s_add_u32 s81, s81, 8192
v_mfma_f32_16x16x32_bf16 v[160:163], v[56:59], a[176:179], v[160:163]
buffer_load_dwordx4 v7, s[32:35], s61 offen offset:1024 lds
v_mfma_f32_16x16x32_bf16 v[164:167], v[56:59], a[180:183], v[164:167]
ds_read_b64_tr_b16 v[44:45], v13 offset:0
ds_read_b64_tr_b16 v[46:47], v13 offset:2048
v_mfma_f32_16x16x32_bf16 v[168:171], v[56:59], a[184:187], v[168:171]
buffer_load_dwordx4 v8, s[32:35], s61 offen offset:2048 lds
v_mfma_f32_16x16x32_bf16 v[172:175], v[56:59], a[188:191], v[172:175]
buffer_load_dwordx4 v9, s[32:35], s61 offen offset:3072 lds
v_mfma_f32_16x16x32_bf16 v[176:179], v[60:63], a[176:179], v[176:179]
s_add_u32 s84, s84, 4096
s_add_u32 m0, s85, 53248
v_mfma_f32_16x16x32_bf16 v[180:183], v[60:63], a[180:183], v[180:183]
buffer_load_dwordx4 v1, s[44:47], s84 offen sc1 lds
v_mfma_f32_16x16x32_bf16 v[184:187], v[60:63], a[184:187], v[184:187]
v_cvt_pk_bf16_f32 v228, v228, v229
v_cvt_pk_bf16_f32 v229, v230, v231
v_mfma_f32_16x16x32_bf16 v[188:191], v[60:63], a[188:191], v[188:191]
v_cvt_pk_bf16_f32 v230, v244, v245
v_cvt_pk_bf16_f32 v231, v246, v247
s_waitcnt lgkmcnt(0)
v_mfma_f32_16x16x32_bf16 v[128:131], v[32:35], a[192:195], v[128:131]
s_waitcnt vmcnt(27)
ds_read_b64_tr_b16 v[48:49], v10 offset:4096
v_mfma_f32_16x16x32_bf16 v[132:135], v[32:35], a[196:199], v[132:135]
buffer_store_dwordx4 v[228:231], v1, s[44:47], s81 offen sc1
v_mfma_f32_16x16x32_bf16 v[136:139], v[32:35], a[200:203], v[136:139]
ds_read_b64_tr_b16 v[50:51], v10 offset:6144
s_add_u32 m0, s60, 0
s_mov_b32 s61, 229376
v_mfma_f32_16x16x32_bf16 v[140:143], v[32:35], a[204:207], v[140:143]
ds_read_b64_tr_b16 v[52:53], v11 offset:4096
ds_read_b64_tr_b16 v[54:55], v11 offset:6144
s_add_u32 s81, s81, 8192
v_mfma_f32_16x16x32_bf16 v[144:147], v[36:39], a[192:195], v[144:147]
buffer_load_dwordx4 v6, s[32:35], s61 offen offset:0 lds
v_mfma_f32_16x16x32_bf16 v[148:151], v[36:39], a[196:199], v[148:151]
ds_read_b64_tr_b16 v[56:57], v12 offset:4096
ds_read_b64_tr_b16 v[58:59], v12 offset:6144
v_mfma_f32_16x16x32_bf16 v[152:155], v[36:39], a[200:203], v[152:155]
buffer_load_dwordx4 v7, s[32:35], s61 offen offset:1024 lds
v_mfma_f32_16x16x32_bf16 v[156:159], v[36:39], a[204:207], v[156:159]
ds_read_b64_tr_b16 v[60:61], v13 offset:4096
ds_read_b64_tr_b16 v[62:63], v13 offset:6144
v_mfma_f32_16x16x32_bf16 v[160:163], v[40:43], a[192:195], v[160:163]
buffer_load_dwordx4 v8, s[32:35], s61 offen offset:2048 lds
v_mfma_f32_16x16x32_bf16 v[164:167], v[40:43], a[196:199], v[164:167]
buffer_load_dwordx4 v9, s[32:35], s61 offen offset:3072 lds
v_mfma_f32_16x16x32_bf16 v[168:171], v[40:43], a[200:203], v[168:171]
s_add_u32 s84, s84, 4096
s_add_u32 m0, s85, 57344
v_mfma_f32_16x16x32_bf16 v[172:175], v[40:43], a[204:207], v[172:175]
buffer_load_dwordx4 v1, s[44:47], s84 offen sc1 lds
v_mfma_f32_16x16x32_bf16 v[176:179], v[44:47], a[192:195], v[176:179]
v_cvt_pk_bf16_f32 v232, v232, v233
v_cvt_pk_bf16_f32 v233, v234, v235
v_mfma_f32_16x16x32_bf16 v[180:183], v[44:47], a[196:199], v[180:183]
v_cvt_pk_bf16_f32 v234, v248, v249
v_cvt_pk_bf16_f32 v235, v250, v251
v_mfma_f32_16x16x32_bf16 v[184:187], v[44:47], a[200:203], v[184:187]
buffer_store_dwordx4 v[232:235], v1, s[44:47], s81 offen sc1
v_mfma_f32_16x16x32_bf16 v[188:191], v[44:47], a[204:207], v[188:191]
s_waitcnt lgkmcnt(0)
v_mfma_f32_16x16x32_bf16 v[128:131], v[48:51], a[208:211], v[128:131]
s_waitcnt vmcnt(27)
ds_read_b64_tr_b16 v[32:33], v10 offset:8192
v_mfma_f32_16x16x32_bf16 v[132:135], v[48:51], a[212:215], v[132:135]
ds_read_b64_tr_b16 v[34:35], v10 offset:10240
s_add_u32 m0, s60, 4096
v_mfma_f32_16x16x32_bf16 v[136:139], v[48:51], a[216:219], v[136:139]
s_mov_b32 s61, 344064
s_add_u32 s81, s81, 8192
v_mfma_f32_16x16x32_bf16 v[140:143], v[48:51], a[220:223], v[140:143]
ds_read_b64_tr_b16 v[36:37], v11 offset:8192
ds_read_b64_tr_b16 v[38:39], v11 offset:10240
v_mfma_f32_16x16x32_bf16 v[144:147], v[52:55], a[208:211], v[144:147]
buffer_load_dwordx4 v6, s[32:35], s61 offen offset:0 lds
v_mfma_f32_16x16x32_bf16 v[148:151], v[52:55], a[212:215], v[148:151]
ds_read_b64_tr_b16 v[40:41], v12 offset:8192
ds_read_b64_tr_b16 v[42:43], v12 offset:10240
v_mfma_f32_16x16x32_bf16 v[152:155], v[52:55], a[216:219], v[152:155]
buffer_load_dwordx4 v7, s[32:35], s61 offen offset:1024 lds
v_mfma_f32_16x16x32_bf16 v[156:159], v[52:55], a[220:223], v[156:159]
ds_read_b64_tr_b16 v[44:45], v13 offset:8192
ds_read_b64_tr_b16 v[46:47], v13 offset:10240
v_mfma_f32_16x16x32_bf16 v[160:163], v[56:59], a[208:211], v[160:163]
buffer_load_dwordx4 v8, s[32:35], s61 offen offset:2048 lds
v_mfma_f32_16x16x32_bf16 v[164:167], v[56:59], a[212:215], v[164:167]
buffer_load_dwordx4 v9, s[32:35], s61 offen offset:3072 lds
v_mfma_f32_16x16x32_bf16 v[168:171], v[56:59], a[216:219], v[168:171]
s_add_u32 s84, s84, 4096
s_add_u32 m0, s85, 61440
v_mfma_f32_16x16x32_bf16 v[172:175], v[56:59], a[220:223], v[172:175]
buffer_load_dwordx4 v1, s[44:47], s84 offen sc1 lds
v_mfma_f32_16x16x32_bf16 v[176:179], v[60:63], a[208:211], v[176:179]
v_cvt_pk_bf16_f32 v236, v236, v237
v_cvt_pk_bf16_f32 v237, v238, v239
v_mfma_f32_16x16x32_bf16 v[180:183], v[60:63], a[212:215], v[180:183]
v_cvt_pk_bf16_f32 v238, v252, v253
v_cvt_pk_bf16_f32 v239, v254, v255
v_mfma_f32_16x16x32_bf16 v[184:187], v[60:63], a[216:219], v[184:187]
buffer_store_dwordx4 v[236:239], v1, s[44:47], s81 offen sc1
v_mfma_f32_16x16x32_bf16 v[188:191], v[60:63], a[220:223], v[188:191]
s_waitcnt lgkmcnt(0)
v_mfma_f32_16x16x32_bf16 v[128:131], v[32:35], a[224:227], v[128:131]
s_waitcnt vmcnt(27)
ds_read_b64_tr_b16 v[48:49], v10 offset:12288
ds_read_b64_tr_b16 v[50:51], v10 offset:14336
s_add_u32 m0, s60, 8192
v_mfma_f32_16x16x32_bf16 v[132:135], v[32:35], a[228:231], v[132:135]
s_mov_b32 s61, 458752
v_mov_b32 v30, s72
v_accvgpr_write_b32 a16, v30
v_accvgpr_write_b32 a17, v30
v_mfma_f32_16x16x32_bf16 v[136:139], v[32:35], a[232:235], v[136:139]
ds_read_b64_tr_b16 v[52:53], v11 offset:12288
ds_read_b64_tr_b16 v[54:55], v11 offset:14336
v_accvgpr_write_b32 a18, v30
v_accvgpr_write_b32 a19, v30
v_mfma_f32_16x16x32_bf16 v[140:143], v[32:35], a[236:239], v[140:143]
buffer_load_dwordx4 v6, s[32:35], s61 offen offset:0 lds
v_mfma_f32_16x16x32_bf16 v[144:147], v[36:39], a[224:227], v[144:147]
ds_read_b64_tr_b16 v[56:57], v12 offset:12288
ds_read_b64_tr_b16 v[58:59], v12 offset:14336
v_lshrrev_b32 v30, 4, v0
v_mfma_f32_16x16x32_bf16 v[148:151], v[36:39], a[228:231], v[148:151]
buffer_load_dwordx4 v7, s[32:35], s61 offen offset:1024 lds
v_lshlrev_b32 v30, 8, v30
v_mfma_f32_16x16x32_bf16 v[152:155], v[36:39], a[232:235], v[152:155]
ds_read_b64_tr_b16 v[60:61], v13 offset:12288
ds_read_b64_tr_b16 v[62:63], v13 offset:14336
v_and_b32 v31, 15, v0
v_lshl_add_u32 v30, v31, 3, v30
v_mfma_f32_16x16x32_bf16 v[156:159], v[36:39], a[236:239], v[156:159]
buffer_load_dwordx4 v8, s[32:35], s61 offen offset:2048 lds
s_lshl_b32 s63, s58, 12
v_mfma_f32_16x16x32_bf16 v[160:163], v[40:43], a[224:227], v[160:163]
buffer_load_dwordx4 v9, s[32:35], s61 offen offset:3072 lds
s_add_u32 s63, s63, 5242880
v_mfma_f32_16x16x32_bf16 v[164:167], v[40:43], a[228:231], v[164:167]
buffer_load_dwordx2 v[192:193], v30, s[44:47], s63 offen offset:0 sc1
v_mfma_f32_16x16x32_bf16 v[168:171], v[40:43], a[232:235], v[168:171]
buffer_load_dwordx2 v[194:195], v30, s[44:47], s63 offen offset:128 sc1
v_mfma_f32_16x16x32_bf16 v[172:175], v[40:43], a[236:239], v[172:175]
buffer_load_dwordx2 v[196:197], v30, s[44:47], s63 offen offset:1024 sc1
v_mfma_f32_16x16x32_bf16 v[176:179], v[44:47], a[224:227], v[176:179]
buffer_load_dwordx2 v[198:199], v30, s[44:47], s63 offen offset:1152 sc1
v_mfma_f32_16x16x32_bf16 v[180:183], v[44:47], a[228:231], v[180:183]
buffer_load_dwordx2 v[200:201], v30, s[44:47], s63 offen offset:2048 sc1
v_mfma_f32_16x16x32_bf16 v[184:187], v[44:47], a[232:235], v[184:187]
buffer_load_dwordx2 v[202:203], v30, s[44:47], s63 offen offset:2176 sc1
v_mfma_f32_16x16x32_bf16 v[188:191], v[44:47], a[236:239], v[188:191]
buffer_load_dwordx2 v[204:205], v30, s[44:47], s63 offen offset:3072 sc1
buffer_load_dwordx2 v[206:207], v30, s[44:47], s63 offen offset:3200 sc1
s_barrier
s_waitcnt lgkmcnt(0)
v_mfma_f32_16x16x32_bf16 v[128:131], v[48:51], a[240:243], v[128:131]
s_waitcnt vmcnt(32)
ds_read_b64_tr_b16 v[32:33], v20 offset:0
v_mfma_f32_16x16x32_bf16 v[132:135], v[48:51], a[244:247], v[132:135]
ds_read_b64_tr_b16 v[34:35], v20 offset:2048
ds_read_b128 a[128:131], v1 offset:0
v_mfma_f32_16x16x32_bf16 v[136:139], v[48:51], a[248:251], v[136:139]
ds_read_b128 a[132:135], v1 offset:1024
s_add_u32 m0, s60, 12288
v_mfma_f32_16x16x32_bf16 v[140:143], v[48:51], a[252:255], v[140:143]
s_mov_b32 s61, 573440
v_mfma_f32_16x16x32_bf16 v[144:147], v[52:55], a[240:243], v[144:147]
ds_read_b64_tr_b16 v[36:37], v21 offset:0
ds_read_b64_tr_b16 v[38:39], v21 offset:2048
v_mfma_f32_16x16x32_bf16 v[148:151], v[52:55], a[244:247], v[148:151]
buffer_load_dwordx4 v6, s[32:35], s61 offen offset:0 lds
v_mfma_f32_16x16x32_bf16 v[152:155], v[52:55], a[248:251], v[152:155]
ds_read_b128 a[136:139], v1 offset:2048
v_mfma_f32_16x16x32_bf16 v[156:159], v[52:55], a[252:255], v[156:159]
ds_read_b64_tr_b16 v[40:41], v22 offset:0
ds_read_b64_tr_b16 v[42:43], v22 offset:2048
v_mfma_f32_16x16x32_bf16 v[160:163], v[56:59], a[240:243], v[160:163]
buffer_load_dwordx4 v7, s[32:35], s61 offen offset:1024 lds
v_mfma_f32_16x16x32_bf16 v[164:167], v[56:59], a[244:247], v[164:167]
v_mfma_f32_16x16x32_bf16 v[168:171], v[56:59], a[248:251], v[168:171]
ds_read_b64_tr_b16 v[44:45], v23 offset:0
ds_read_b128 a[140:143], v1 offset:3072
v_mfma_f32_16x16x32_bf16 v[172:175], v[56:59], a[252:255], v[172:175]
ds_read_b64_tr_b16 v[46:47], v23 offset:2048
v_mfma_f32_16x16x32_bf16 v[176:179], v[60:63], a[240:243], v[176:179]
buffer_load_dwordx4 v8, s[32:35], s61 offen offset:2048 lds
v_mfma_f32_16x16x32_bf16 v[180:183], v[60:63], a[244:247], v[180:183]
buffer_load_dwordx4 v9, s[32:35], s61 offen offset:3072 lds
v_mfma_f32_16x16x32_bf16 v[184:187], v[60:63], a[248:251], v[184:187]
v_mfma_f32_16x16x32_bf16 v[188:191], v[60:63], a[252:255], v[188:191]
s_waitcnt lgkmcnt(0)
v_mfma_f32_16x16x32_bf16 v[64:67], v[32:35], a[128:131], 0
s_waitcnt vmcnt(30)
ds_read_b64_tr_b16 v[48:49], v20 offset:4096
v_mfma_f32_16x16x32_bf16 v[68:71], v[32:35], a[132:135], 0
ds_read_b128 a[144:147], v1 offset:4096
ds_read_b64_tr_b16 v[50:51], v20 offset:6144
v_mfma_f32_16x16x32_bf16 v[72:75], v[32:35], a[136:139], 0
ds_read_b128 a[148:151], v1 offset:5120
ds_read_b128 a[152:155], v1 offset:6144
v_mfma_f32_16x16x32_bf16 v[76:79], v[32:35], a[140:143], 0
ds_read_b128 a[156:159], v1 offset:7168
s_add_u32 m0, s91, 0
v_mfma_f32_16x16x32_bf16 a[160:163], v[32:35], a[16:19], 0
s_mov_b32 s61, 688128
v_mfma_f32_16x16x32_bf16 v[80:83], v[36:39], a[128:131], 0
ds_read_b64_tr_b16 v[52:53], v21 offset:4096
ds_read_b64_tr_b16 v[54:55], v21 offset:6144
v_mfma_f32_16x16x32_bf16 v[84:87], v[36:39], a[132:135], 0
buffer_load_dwordx4 v6, s[32:35], s61 offen offset:0 lds
v_mfma_f32_16x16x32_bf16 v[88:91], v[36:39], a[136:139], 0
s_lshl_b32 s63, s58, 6
s_lshl_b32 s62, s56, 4
v_mfma_f32_16x16x32_bf16 v[92:95], v[36:39], a[140:143], 0
ds_read_b64_tr_b16 v[56:57], v22 offset:4096
s_add_u32 s63, s63, s62
v_mfma_f32_16x16x32_bf16 a[164:167], v[36:39], a[16:19], 0
ds_read_b64_tr_b16 v[58:59], v22 offset:6144
v_mfma_f32_16x16x32_bf16 v[96:99], v[40:43], a[128:131], 0
buffer_load_dwordx4 v7, s[32:35], s61 offen offset:1024 lds
v_mfma_f32_16x16x32_bf16 v[100:103], v[40:43], a[132:135], 0
s_lshl_b32 s63, s63, 3
s_add_u32 s63, s63, s57
v_mfma_f32_16x16x32_bf16 v[104:107], v[40:43], a[136:139], 0
ds_read_b64_tr_b16 v[60:61], v23 offset:4096
v_mfma_f32_16x16x32_bf16 v[108:111], v[40:43], a[140:143], 0
ds_read_b64_tr_b16 v[62:63], v23 offset:6144
s_lshl_b32 s63, s63, 10
v_mfma_f32_16x16x32_bf16 a[168:171], v[40:43], a[16:19], 0
buffer_load_dwordx4 v8, s[32:35], s61 offen offset:2048 lds
v_mfma_f32_16x16x32_bf16 v[112:115], v[44:47], a[128:131], 0
s_add_u32 s81, s63, 25231360
v_mfma_f32_16x16x32_bf16 v[116:119], v[44:47], a[132:135], 0
v_cvt_pk_bf16_f32 v128, v128, v129
v_mfma_f32_16x16x32_bf16 v[120:123], v[44:47], a[136:139], 0
buffer_load_dwordx4 v9, s[32:35], s61 offen offset:3072 lds
v_mfma_f32_16x16x32_bf16 v[124:127], v[44:47], a[140:143], 0
v_cvt_pk_bf16_f32 v129, v130, v131
v_mfma_f32_16x16x32_bf16 a[172:175], v[44:47], a[16:19], 0
s_waitcnt lgkmcnt(0)
v_mfma_f32_16x16x32_bf16 v[64:67], v[48:51], a[144:147], v[64:67]
s_waitcnt vmcnt(28)
ds_read_b64_tr_b16 v[32:33], v10 offset:0
v_mfma_f32_16x16x32_bf16 v[68:71], v[48:51], a[148:151], v[68:71]
ds_read_b128 a[128:131], v1 offset:8192
ds_read_b128 a[132:135], v1 offset:9216
v_mfma_f32_16x16x32_bf16 v[72:75], v[48:51], a[152:155], v[72:75]
ds_read_b64_tr_b16 v[34:35], v10 offset:2048
ds_read_b128 a[136:139], v1 offset:10240
v_mfma_f32_16x16x32_bf16 v[76:79], v[48:51], a[156:159], v[76:79]
ds_read_b128 a[140:143], v1 offset:11264
s_add_u32 m0, s91, 4096
v_mfma_f32_16x16x32_bf16 a[160:163], v[48:51], a[16:19], a[160:163]
s_mov_b32 s61, 802816
v_cvt_pk_bf16_f32 v130, v144, v145
v_mfma_f32_16x16x32_bf16 v[80:83], v[52:55], a[144:147], v[80:83]
ds_read_b64_tr_b16 v[36:37], v11 offset:0
ds_read_b64_tr_b16 v[38:39], v11 offset:2048
v_mfma_f32_16x16x32_bf16 v[84:87], v[52:55], a[148:151], v[84:87]
buffer_load_dwordx4 v6, s[32:35], s61 offen offset:0 lds
v_mfma_f32_16x16x32_bf16 v[88:91], v[52:55], a[152:155], v[88:91]
ds_read_b64_tr_b16 v[40:41], v12 offset:0
ds_read_b64_tr_b16 v[42:43], v12 offset:2048
v_mfma_f32_16x16x32_bf16 v[92:95], v[52:55], a[156:159], v[92:95]
buffer_load_dwordx4 v7, s[32:35], s61 offen offset:1024 lds
v_mfma_f32_16x16x32_bf16 a[164:167], v[52:55], a[16:19], a[164:167]
ds_read_b64_tr_b16 v[44:45], v13 offset:0
ds_read_b64_tr_b16 v[46:47], v13 offset:2048
v_mfma_f32_16x16x32_bf16 v[96:99], v[56:59], a[144:147], v[96:99]
buffer_load_dwordx4 v8, s[32:35], s61 offen offset:2048 lds
v_mfma_f32_16x16x32_bf16 v[100:103], v[56:59], a[148:151], v[100:103]
buffer_load_dwordx4 v9, s[32:35], s61 offen offset:3072 lds
v_mfma_f32_16x16x32_bf16 v[104:107], v[56:59], a[152:155], v[104:107]
v_cvt_pk_bf16_f32 v131, v146, v147
v_mfma_f32_16x16x32_bf16 v[108:111], v[56:59], a[156:159], v[108:111]
buffer_store_dwordx4 v[128:131], v1, s[44:47], s81 offen sc1
v_mfma_f32_16x16x32_bf16 a[168:171], v[56:59], a[16:19], a[168:171]
s_add_u32 s81, s81, 8192
v_cvt_pk_bf16_f32 v132, v132, v133
v_mfma_f32_16x16x32_bf16 v[112:115], v[60:63], a[144:147], v[112:115]
v_cvt_pk_bf16_f32 v133, v134, v135
v_cvt_pk_bf16_f32 v134, v148, v149
v_mfma_f32_16x16x32_bf16 v[116:119], v[60:63], a[148:151], v[116:119]
v_cvt_pk_bf16_f32 v135, v150, v151
v_mfma_f32_16x16x32_bf16 v[120:123], v[60:63], a[152:155], v[120:123]
buffer_store_dwordx4 v[132:135], v1, s[44:47], s81 offen sc1
v_mfma_f32_16x16x32_bf16 v[124:127], v[60:63], a[156:159], v[124:127]
v_mfma_f32_16x16x32_bf16 a[172:175], v[60:63], a[16:19], a[172:175]
s_waitcnt lgkmcnt(0)
v_mfma_f32_16x16x32_bf16 v[64:67], v[32:35], a[128:131], v[64:67]
s_waitcnt vmcnt(28)
ds_read_b64_tr_b16 v[48:49], v10 offset:4096
v_mfma_f32_16x16x32_bf16 v[68:71], v[32:35], a[132:135], v[68:71]
ds_read_b128 a[144:147], v1 offset:12288
ds_read_b128 a[148:151], v1 offset:13312
v_mfma_f32_16x16x32_bf16 v[72:75], v[32:35], a[136:139], v[72:75]
ds_read_b64_tr_b16 v[50:51], v10 offset:6144
ds_read_b128 a[152:155], v1 offset:14336
v_mfma_f32_16x16x32_bf16 v[76:79], v[32:35], a[140:143], v[76:79]
ds_read_b128 a[156:159], v1 offset:15360
s_add_u32 m0, s60, 0
v_mfma_f32_16x16x32_bf16 a[160:163], v[32:35], a[16:19], a[160:163]
s_mov_b32 s61, 917504
s_add_u32 s81, s81, 8192
v_mfma_f32_16x16x32_bf16 v[80:83], v[36:39], a[128:131], v[80:83]
ds_read_b64_tr_b16 v[52:53], v11 offset:4096
ds_read_b64_tr_b16 v[54:55], v11 offset:6144
v_mfma_f32_16x16x32_bf16 v[84:87], v[36:39], a[132:135], v[84:87]
buffer_load_dwordx4 v6, s[32:35], s61 offen offset:0 lds
v_mfma_f32_16x16x32_bf16 v[88:91], v[36:39], a[136:139], v[88:91]
v_cvt_pk_bf16_f32 v136, v136, v137
v_cvt_pk_bf16_f32 v137, v138, v139
v_mfma_f32_16x16x32_bf16 v[92:95], v[36:39], a[140:143], v[92:95]
ds_read_b64_tr_b16 v[56:57], v12 offset:4096
v_cvt_pk_bf16_f32 v138, v152, v153
v_mfma_f32_16x16x32_bf16 a[164:167], v[36:39], a[16:19], a[164:167]
ds_read_b64_tr_b16 v[58:59], v12 offset:6144
v_cvt_pk_bf16_f32 v139, v154, v155
v_mfma_f32_16x16x32_bf16 v[96:99], v[40:43], a[128:131], v[96:99]
buffer_load_dwordx4 v7, s[32:35], s61 offen offset:1024 lds
v_mfma_f32_16x16x32_bf16 v[100:103], v[40:43], a[132:135], v[100:103]
buffer_store_dwordx4 v[136:139], v1, s[44:47], s81 offen sc1
v_mfma_f32_16x16x32_bf16 v[104:107], v[40:43], a[136:139], v[104:107]
ds_read_b64_tr_b16 v[60:61], v13 offset:4096
v_mfma_f32_16x16x32_bf16 v[108:111], v[40:43], a[140:143], v[108:111]
ds_read_b64_tr_b16 v[62:63], v13 offset:6144
v_mfma_f32_16x16x32_bf16 a[168:171], v[40:43], a[16:19], a[168:171]
buffer_load_dwordx4 v8, s[32:35], s61 offen offset:2048 lds
v_mfma_f32_16x16x32_bf16 v[112:115], v[44:47], a[128:131], v[112:115]
s_add_u32 s81, s81, 8192
v_mfma_f32_16x16x32_bf16 v[116:119], v[44:47], a[132:135], v[116:119]
v_cvt_pk_bf16_f32 v140, v140, v141
v_mfma_f32_16x16x32_bf16 v[120:123], v[44:47], a[136:139], v[120:123]
buffer_load_dwordx4 v9, s[32:35], s61 offen offset:3072 lds
v_mfma_f32_16x16x32_bf16 v[124:127], v[44:47], a[140:143], v[124:127]
v_cvt_pk_bf16_f32 v141, v142, v143
v_mfma_f32_16x16x32_bf16 a[172:175], v[44:47], a[16:19], a[172:175]
s_waitcnt lgkmcnt(0)
v_mfma_f32_16x16x32_bf16 v[64:67], v[48:51], a[144:147], v[64:67]
s_waitcnt vmcnt(27)
ds_read_b64_tr_b16 v[32:33], v10 offset:8192
v_mfma_f32_16x16x32_bf16 v[68:71], v[48:51], a[148:151], v[68:71]
ds_read_b128 a[128:131], v1 offset:16384
ds_read_b128 a[132:135], v1 offset:17408
v_mfma_f32_16x16x32_bf16 v[72:75], v[48:51], a[152:155], v[72:75]
ds_read_b64_tr_b16 v[34:35], v10 offset:10240
ds_read_b128 a[136:139], v1 offset:18432
v_mfma_f32_16x16x32_bf16 v[76:79], v[48:51], a[156:159], v[76:79]
ds_read_b128 a[140:143], v1 offset:19456
s_add_u32 m0, s60, 4096
v_mfma_f32_16x16x32_bf16 a[160:163], v[48:51], a[16:19], a[160:163]
s_mov_b32 s61, 1032192
v_cvt_pk_bf16_f32 v142, v156, v157
v_mfma_f32_16x16x32_bf16 v[80:83], v[52:55], a[144:147], v[80:83]
ds_read_b64_tr_b16 v[36:37], v11 offset:8192
ds_read_b64_tr_b16 v[38:39], v11 offset:10240
v_mfma_f32_16x16x32_bf16 v[84:87], v[52:55], a[148:151], v[84:87]
buffer_load_dwordx4 v6, s[32:35], s61 offen offset:0 lds
v_mfma_f32_16x16x32_bf16 v[88:91], v[52:55], a[152:155], v[88:91]
ds_read_b64_tr_b16 v[40:41], v12 offset:8192
ds_read_b64_tr_b16 v[42:43], v12 offset:10240
v_mfma_f32_16x16x32_bf16 v[92:95], v[52:55], a[156:159], v[92:95]
buffer_load_dwordx4 v7, s[32:35], s61 offen offset:1024 lds
v_mfma_f32_16x16x32_bf16 a[164:167], v[52:55], a[16:19], a[164:167]
ds_read_b64_tr_b16 v[44:45], v13 offset:8192
ds_read_b64_tr_b16 v[46:47], v13 offset:10240
v_mfma_f32_16x16x32_bf16 v[96:99], v[56:59], a[144:147], v[96:99]
buffer_load_dwordx4 v8, s[32:35], s61 offen offset:2048 lds
v_mfma_f32_16x16x32_bf16 v[100:103], v[56:59], a[148:151], v[100:103]
buffer_load_dwordx4 v9, s[32:35], s61 offen offset:3072 lds
v_mfma_f32_16x16x32_bf16 v[104:107], v[56:59], a[152:155], v[104:107]
v_cvt_pk_bf16_f32 v143, v158, v159
v_mfma_f32_16x16x32_bf16 v[108:111], v[56:59], a[156:159], v[108:111]
buffer_store_dwordx4 v[140:143], v1, s[44:47], s81 offen sc1
v_mfma_f32_16x16x32_bf16 a[168:171], v[56:59], a[16:19], a[168:171]
s_add_u32 s81, s81, 8192
v_cvt_pk_bf16_f32 v160, v160, v161
v_mfma_f32_16x16x32_bf16 v[112:115], v[60:63], a[144:147], v[112:115]
v_cvt_pk_bf16_f32 v161, v162, v163
v_cvt_pk_bf16_f32 v162, v176, v177
v_mfma_f32_16x16x32_bf16 v[116:119], v[60:63], a[148:151], v[116:119]
v_cvt_pk_bf16_f32 v163, v178, v179
v_mfma_f32_16x16x32_bf16 v[120:123], v[60:63], a[152:155], v[120:123]
buffer_store_dwordx4 v[160:163], v1, s[44:47], s81 offen sc1
v_mfma_f32_16x16x32_bf16 v[124:127], v[60:63], a[156:159], v[124:127]
v_mfma_f32_16x16x32_bf16 a[172:175], v[60:63], a[16:19], a[172:175]
s_waitcnt lgkmcnt(0)
v_mfma_f32_16x16x32_bf16 v[64:67], v[32:35], a[128:131], v[64:67]
s_waitcnt vmcnt(21)
ds_read_b64_tr_b16 v[48:49], v10 offset:12288
v_mfma_f32_16x16x32_bf16 v[68:71], v[32:35], a[132:135], v[68:71]
ds_read_b128 a[144:147], v1 offset:20480
ds_read_b128 a[148:151], v1 offset:21504
v_mfma_f32_16x16x32_bf16 v[72:75], v[32:35], a[136:139], v[72:75]
ds_read_b64_tr_b16 v[50:51], v10 offset:14336
ds_read_b128 a[152:155], v1 offset:22528
v_mfma_f32_16x16x32_bf16 v[76:79], v[32:35], a[140:143], v[76:79]
ds_read_b128 a[156:159], v1 offset:23552
s_add_u32 m0, s60, 8192
v_mfma_f32_16x16x32_bf16 a[160:163], v[32:35], a[16:19], a[160:163]
s_mov_b32 s61, 1146880
s_add_u32 s81, s81, 8192
v_mfma_f32_16x16x32_bf16 v[80:83], v[36:39], a[128:131], v[80:83]
ds_read_b64_tr_b16 v[52:53], v11 offset:12288
ds_read_b64_tr_b16 v[54:55], v11 offset:14336
v_mfma_f32_16x16x32_bf16 v[84:87], v[36:39], a[132:135], v[84:87]
buffer_load_dwordx4 v6, s[32:35], s61 offen offset:0 lds
v_mfma_f32_16x16x32_bf16 v[88:91], v[36:39], a[136:139], v[88:91]
v_cvt_pk_bf16_f32 v164, v164, v165
v_cvt_pk_bf16_f32 v165, v166, v167
v_mfma_f32_16x16x32_bf16 v[92:95], v[36:39], a[140:143], v[92:95]
ds_read_b64_tr_b16 v[56:57], v12 offset:12288
v_cvt_pk_bf16_f32 v166, v180, v181
v_mfma_f32_16x16x32_bf16 a[164:167], v[36:39], a[16:19], a[164:167]
ds_read_b64_tr_b16 v[58:59], v12 offset:14336
v_cvt_pk_bf16_f32 v167, v182, v183
v_mfma_f32_16x16x32_bf16 v[96:99], v[40:43], a[128:131], v[96:99]
buffer_load_dwordx4 v7, s[32:35], s61 offen offset:1024 lds
v_mfma_f32_16x16x32_bf16 v[100:103], v[40:43], a[132:135], v[100:103]
buffer_store_dwordx4 v[164:167], v1, s[44:47], s81 offen sc1
v_mfma_f32_16x16x32_bf16 v[104:107], v[40:43], a[136:139], v[104:107]
ds_read_b64_tr_b16 v[60:61], v13 offset:12288
v_mfma_f32_16x16x32_bf16 v[108:111], v[40:43], a[140:143], v[108:111]
ds_read_b64_tr_b16 v[62:63], v13 offset:14336
v_mfma_f32_16x16x32_bf16 a[168:171], v[40:43], a[16:19], a[168:171]
buffer_load_dwordx4 v8, s[32:35], s61 offen offset:2048 lds
v_mfma_f32_16x16x32_bf16 v[112:115], v[44:47], a[128:131], v[112:115]
s_add_u32 s81, s81, 8192
v_mfma_f32_16x16x32_bf16 v[116:119], v[44:47], a[132:135], v[116:119]
v_cvt_pk_bf16_f32 v168, v168, v169
v_mfma_f32_16x16x32_bf16 v[120:123], v[44:47], a[136:139], v[120:123]
buffer_load_dwordx4 v9, s[32:35], s61 offen offset:3072 lds
v_mfma_f32_16x16x32_bf16 v[124:127], v[44:47], a[140:143], v[124:127]
v_cvt_pk_bf16_f32 v169, v170, v171
v_mfma_f32_16x16x32_bf16 a[172:175], v[44:47], a[16:19], a[172:175]
s_waitcnt lgkmcnt(0)
v_mfma_f32_16x16x32_bf16 v[64:67], v[48:51], a[144:147], v[64:67]
s_waitcnt vmcnt(22)
ds_read_b64_tr_b16 v[32:33], v20 offset:0
v_mfma_f32_16x16x32_bf16 v[68:71], v[48:51], a[148:151], v[68:71]
ds_read_b128 a[128:131], v1 offset:24576
ds_read_b128 a[132:135], v1 offset:25600
v_mfma_f32_16x16x32_bf16 v[72:75], v[48:51], a[152:155], v[72:75]
ds_read_b64_tr_b16 v[34:35], v20 offset:2048
ds_read_b128 a[136:139], v1 offset:26624
v_mfma_f32_16x16x32_bf16 v[76:79], v[48:51], a[156:159], v[76:79]
ds_read_b128 a[140:143], v1 offset:27648
s_add_u32 m0, s60, 12288
v_mfma_f32_16x16x32_bf16 a[160:163], v[48:51], a[16:19], a[160:163]
s_mov_b32 s61, 1261568
v_cvt_pk_bf16_f32 v170, v184, v185
v_mfma_f32_16x16x32_bf16 v[80:83], v[52:55], a[144:147], v[80:83]
ds_read_b64_tr_b16 v[36:37], v21 offset:0
ds_read_b64_tr_b16 v[38:39], v21 offset:2048
v_mfma_f32_16x16x32_bf16 v[84:87], v[52:55], a[148:151], v[84:87]
buffer_load_dwordx4 v6, s[32:35], s61 offen offset:0 lds
v_mfma_f32_16x16x32_bf16 v[88:91], v[52:55], a[152:155], v[88:91]
ds_read_b64_tr_b16 v[40:41], v22 offset:0
ds_read_b64_tr_b16 v[42:43], v22 offset:2048
v_mfma_f32_16x16x32_bf16 v[92:95], v[52:55], a[156:159], v[92:95]
buffer_load_dwordx4 v7, s[32:35], s61 offen offset:1024 lds
v_mfma_f32_16x16x32_bf16 a[164:167], v[52:55], a[16:19], a[164:167]
ds_read_b64_tr_b16 v[44:45], v23 offset:0
ds_read_b64_tr_b16 v[46:47], v23 offset:2048
v_mfma_f32_16x16x32_bf16 v[96:99], v[56:59], a[144:147], v[96:99]
buffer_load_dwordx4 v8, s[32:35], s61 offen offset:2048 lds
v_mfma_f32_16x16x32_bf16 v[100:103], v[56:59], a[148:151], v[100:103]
buffer_load_dwordx4 v9, s[32:35], s61 offen offset:3072 lds
v_mfma_f32_16x16x32_bf16 v[104:107], v[56:59], a[152:155], v[104:107]
v_cvt_pk_bf16_f32 v171, v186, v187
v_mfma_f32_16x16x32_bf16 v[108:111], v[56:59], a[156:159], v[108:111]
buffer_store_dwordx4 v[168:171], v1, s[44:47], s81 offen sc1
v_mfma_f32_16x16x32_bf16 a[168:171], v[56:59], a[16:19], a[168:171]
s_add_u32 s81, s81, 8192
v_cvt_pk_bf16_f32 v172, v172, v173
v_mfma_f32_16x16x32_bf16 v[112:115], v[60:63], a[144:147], v[112:115]
v_cvt_pk_bf16_f32 v173, v174, v175
v_cvt_pk_bf16_f32 v174, v188, v189
v_mfma_f32_16x16x32_bf16 v[116:119], v[60:63], a[148:151], v[116:119]
v_cvt_pk_bf16_f32 v175, v190, v191
v_mfma_f32_16x16x32_bf16 v[120:123], v[60:63], a[152:155], v[120:123]
buffer_store_dwordx4 v[172:175], v1, s[44:47], s81 offen sc1
v_mfma_f32_16x16x32_bf16 v[124:127], v[60:63], a[156:159], v[124:127]
v_mfma_f32_16x16x32_bf16 a[172:175], v[60:63], a[16:19], a[172:175]
s_waitcnt lgkmcnt(0)
v_mfma_f32_16x16x32_bf16 v[64:67], v[32:35], a[128:131], v[64:67]
s_waitcnt vmcnt(24)
ds_read_b64_tr_b16 v[48:49], v20 offset:4096
v_mfma_f32_16x16x32_bf16 v[68:71], v[32:35], a[132:135], v[68:71]
ds_read_b128 a[144:147], v1 offset:28672
ds_read_b64_tr_b16 v[50:51], v20 offset:6144
v_mfma_f32_16x16x32_bf16 v[72:75], v[32:35], a[136:139], v[72:75]
ds_read_b128 a[148:151], v1 offset:29696
s_add_u32 m0, s91, 0
v_mfma_f32_16x16x32_bf16 v[76:79], v[32:35], a[140:143], v[76:79]
s_mov_b32 s61, 1376256
v_mfma_f32_16x16x32_bf16 a[160:163], v[32:35], a[16:19], a[160:163]
ds_read_b64_tr_b16 v[52:53], v21 offset:4096
ds_read_b64_tr_b16 v[54:55], v21 offset:6144
v_mfma_f32_16x16x32_bf16 v[80:83], v[36:39], a[128:131], v[80:83]
buffer_load_dwordx4 v6, s[32:35], s61 offen offset:0 lds
v_mfma_f32_16x16x32_bf16 v[84:87], v[36:39], a[132:135], v[84:87]
v_mfma_f32_16x16x32_bf16 v[88:91], v[36:39], a[136:139], v[88:91]
ds_read_b128 a[152:155], v1 offset:30720
v_mfma_f32_16x16x32_bf16 v[92:95], v[36:39], a[140:143], v[92:95]
ds_read_b64_tr_b16 v[56:57], v22 offset:4096
v_mfma_f32_16x16x32_bf16 a[164:167], v[36:39], a[16:19], a[164:167]
ds_read_b64_tr_b16 v[58:59], v22 offset:6144
v_mfma_f32_16x16x32_bf16 v[96:99], v[40:43], a[128:131], v[96:99]
buffer_load_dwordx4 v7, s[32:35], s61 offen offset:1024 lds
v_mfma_f32_16x16x32_bf16 v[100:103], v[40:43], a[132:135], v[100:103]
v_mfma_f32_16x16x32_bf16 v[104:107], v[40:43], a[136:139], v[104:107]
ds_read_b128 a[156:159], v1 offset:31744
ds_read_b64_tr_b16 v[60:61], v23 offset:4096
v_mfma_f32_16x16x32_bf16 v[108:111], v[40:43], a[140:143], v[108:111]
ds_read_b64_tr_b16 v[62:63], v23 offset:6144
v_mfma_f32_16x16x32_bf16 a[168:171], v[40:43], a[16:19], a[168:171]
buffer_load_dwordx4 v8, s[32:35], s61 offen offset:2048 lds
v_mfma_f32_16x16x32_bf16 v[112:115], v[44:47], a[128:131], v[112:115]
v_mfma_f32_16x16x32_bf16 v[116:119], v[44:47], a[132:135], v[116:119]
v_mfma_f32_16x16x32_bf16 v[120:123], v[44:47], a[136:139], v[120:123]
buffer_load_dwordx4 v9, s[32:35], s61 offen offset:3072 lds
v_mfma_f32_16x16x32_bf16 v[124:127], v[44:47], a[140:143], v[124:127]
v_mfma_f32_16x16x32_bf16 a[172:175], v[44:47], a[16:19], a[172:175]
s_barrier
s_waitcnt lgkmcnt(0)
v_mfma_f32_16x16x32_bf16 v[64:67], v[48:51], a[144:147], v[64:67]
s_waitcnt vmcnt(21)
ds_read_b64_tr_b16 v[32:33], v10 offset:0
v_mfma_f32_16x16x32_bf16 v[68:71], v[48:51], a[148:151], v[68:71]
ds_read_b128 a[128:131], v1 offset:32768
ds_read_b64_tr_b16 v[34:35], v10 offset:2048
v_mfma_f32_16x16x32_bf16 v[72:75], v[48:51], a[152:155], v[72:75]
ds_read_b128 a[132:135], v1 offset:33792
s_add_u32 m0, s91, 4096
v_mfma_f32_16x16x32_bf16 v[76:79], v[48:51], a[156:159], v[76:79]
s_mov_b32 s61, 1490944
v_mfma_f32_16x16x32_bf16 a[160:163], v[48:51], a[16:19], a[160:163]
ds_read_b64_tr_b16 v[36:37], v11 offset:0
ds_read_b64_tr_b16 v[38:39], v11 offset:2048
v_mfma_f32_16x16x32_bf16 v[80:83], v[52:55], a[144:147], v[80:83]
buffer_load_dwordx4 v6, s[32:35], s61 offen offset:0 lds
v_mfma_f32_16x16x32_bf16 v[84:87], v[52:55], a[148:151], v[84:87]
v_mfma_f32_16x16x32_bf16 v[88:91], v[52:55], a[152:155], v[88:91]
ds_read_b128 a[136:139], v1 offset:34816
v_mfma_f32_16x16x32_bf16 v[92:95], v[52:55], a[156:159], v[92:95]
ds_read_b64_tr_b16 v[40:41], v12 offset:0
v_mfma_f32_16x16x32_bf16 a[164:167], v[52:55], a[16:19], a[164:167]
ds_read_b64_tr_b16 v[42:43], v12 offset:2048
v_mfma_f32_16x16x32_bf16 v[96:99], v[56:59], a[144:147], v[96:99]
buffer_load_dwordx4 v7, s[32:35], s61 offen offset:1024 lds
v_mfma_f32_16x16x32_bf16 v[100:103], v[56:59], a[148:151], v[100:103]
v_mfma_f32_16x16x32_bf16 v[104:107], v[56:59], a[152:155], v[104:107]
ds_read_b128 a[140:143], v1 offset:35840
ds_read_b64_tr_b16 v[44:45], v13 offset:0
v_mfma_f32_16x16x32_bf16 v[108:111], v[56:59], a[156:159], v[108:111]
ds_read_b64_tr_b16 v[46:47], v13 offset:2048
v_mfma_f32_16x16x32_bf16 a[168:171], v[56:59], a[16:19], a[168:171]
buffer_load_dwordx4 v8, s[32:35], s61 offen offset:2048 lds
v_mfma_f32_16x16x32_bf16 v[112:115], v[60:63], a[144:147], v[112:115]
v_mfma_f32_16x16x32_bf16 v[116:119], v[60:63], a[148:151], v[116:119]
v_mfma_f32_16x16x32_bf16 v[120:123], v[60:63], a[152:155], v[120:123]
buffer_load_dwordx4 v9, s[32:35], s61 offen offset:3072 lds
v_mfma_f32_16x16x32_bf16 v[124:127], v[60:63], a[156:159], v[124:127]
v_mfma_f32_16x16x32_bf16 a[172:175], v[60:63], a[16:19], a[172:175]
s_waitcnt lgkmcnt(0)
v_mfma_f32_16x16x32_bf16 v[64:67], v[32:35], a[128:131], v[64:67]
s_waitcnt vmcnt(21)
ds_read_b64_tr_b16 v[48:49], v10 offset:4096
v_mfma_f32_16x16x32_bf16 v[68:71], v[32:35], a[132:135], v[68:71]
ds_read_b128 a[144:147], v1 offset:36864
ds_read_b128 a[148:151], v1 offset:37888
v_mfma_f32_16x16x32_bf16 v[72:75], v[32:35], a[136:139], v[72:75]
ds_read_b64_tr_b16 v[50:51], v10 offset:6144
ds_read_b128 a[152:155], v1 offset:38912
v_mfma_f32_16x16x32_bf16 v[76:79], v[32:35], a[140:143], v[76:79]
ds_read_b128 a[156:159], v1 offset:39936
s_add_u32 m0, s60, 0
v_mfma_f32_16x16x32_bf16 a[160:163], v[32:35], a[16:19], a[160:163]
s_mov_b32 s61, 1605632
v_add_f32 v192, v192, v194
v_mfma_f32_16x16x32_bf16 v[80:83], v[36:39], a[128:131], v[80:83]
ds_read_b64_tr_b16 v[52:53], v11 offset:4096
ds_read_b64_tr_b16 v[54:55], v11 offset:6144
v_mfma_f32_16x16x32_bf16 v[84:87], v[36:39], a[132:135], v[84:87]
buffer_load_dwordx4 v6, s[32:35], s61 offen offset:0 lds
v_mfma_f32_16x16x32_bf16 v[88:91], v[36:39], a[136:139], v[88:91]
ds_read_b64_tr_b16 v[56:57], v12 offset:4096
ds_read_b64_tr_b16 v[58:59], v12 offset:6144
v_mfma_f32_16x16x32_bf16 v[92:95], v[36:39], a[140:143], v[92:95]
buffer_load_dwordx4 v7, s[32:35], s61 offen offset:1024 lds
v_mfma_f32_16x16x32_bf16 a[164:167], v[36:39], a[16:19], a[164:167]
ds_read_b64_tr_b16 v[60:61], v13 offset:4096
ds_read_b64_tr_b16 v[62:63], v13 offset:6144
v_mfma_f32_16x16x32_bf16 v[96:99], v[40:43], a[128:131], v[96:99]
buffer_load_dwordx4 v8, s[32:35], s61 offen offset:2048 lds
v_mfma_f32_16x16x32_bf16 v[100:103], v[40:43], a[132:135], v[100:103]
buffer_load_dwordx4 v9, s[32:35], s61 offen offset:3072 lds
v_mfma_f32_16x16x32_bf16 v[104:107], v[40:43], a[136:139], v[104:107]
v_add_f32 v193, v193, v195
v_add_f32 v196, v196, v198
v_mfma_f32_16x16x32_bf16 v[108:111], v[40:43], a[140:143], v[108:111]
v_add_f32 v197, v197, v199
v_add_f32 v200, v200, v202
v_mfma_f32_16x16x32_bf16 a[168:171], v[40:43], a[16:19], a[168:171]
v_add_f32 v201, v201, v203
v_add_f32 v204, v204, v206
v_mfma_f32_16x16x32_bf16 v[112:115], v[44:47], a[128:131], v[112:115]
v_add_f32 v205, v205, v207
v_mfma_f32_16x16x32_bf16 v[116:119], v[44:47], a[132:135], v[116:119]
v_permlane32_swap_b32 v192, v193
v_mfma_f32_16x16x32_bf16 v[120:123], v[44:47], a[136:139], v[120:123]
v_add_f32 v192, v192, v193
v_mov_b32 v193, v192
v_mfma_f32_16x16x32_bf16 v[124:127], v[44:47], a[140:143], v[124:127]
s_nop 0
v_permlane16_swap_b32 v192, v193
v_mfma_f32_16x16x32_bf16 a[172:175], v[44:47], a[16:19], a[172:175]
v_add_f32 v192, v192, v193
v_mov_b32 v193, v192
s_waitcnt lgkmcnt(0)
v_mfma_f32_16x16x32_bf16 v[64:67], v[48:51], a[144:147], v[64:67]
ds_read_b128 a[128:131], v1 offset:40960
v_mfma_f32_16x16x32_bf16 v[68:71], v[48:51], a[148:151], v[68:71]
s_waitcnt vmcnt(18)
ds_read_b64_tr_b16 v[32:33], v10 offset:8192
v_mfma_f32_16x16x32_bf16 v[72:75], v[48:51], a[152:155], v[72:75]
ds_read_b128 a[132:135], v1 offset:41984
ds_read_b128 a[136:139], v1 offset:43008
v_mfma_f32_16x16x32_bf16 v[76:79], v[48:51], a[156:159], v[76:79]
ds_read_b64_tr_b16 v[34:35], v10 offset:10240
ds_read_b128 a[140:143], v1 offset:44032
s_add_u32 m0, s60, 4096
v_mfma_f32_16x16x32_bf16 a[160:163], v[48:51], a[16:19], a[160:163]
s_mov_b32 s61, 1720320
v_mfma_f32_16x16x32_bf16 v[80:83], v[52:55], a[144:147], v[80:83]
ds_read_b64_tr_b16 v[36:37], v11 offset:8192
ds_read_b64_tr_b16 v[38:39], v11 offset:10240
v_mfma_f32_16x16x32_bf16 v[84:87], v[52:55], a[148:151], v[84:87]
buffer_load_dwordx4 v6, s[32:35], s61 offen offset:0 lds
v_mfma_f32_16x16x32_bf16 v[88:91], v[52:55], a[152:155], v[88:91]
ds_read_b64_tr_b16 v[40:41], v12 offset:8192
ds_read_b64_tr_b16 v[42:43], v12 offset:10240
v_mfma_f32_16x16x32_bf16 v[92:95], v[52:55], a[156:159], v[92:95]
buffer_load_dwordx4 v7, s[32:35], s61 offen offset:1024 lds
v_mfma_f32_16x16x32_bf16 a[164:167], v[52:55], a[16:19], a[164:167]
ds_read_b64_tr_b16 v[44:45], v13 offset:8192
ds_read_b64_tr_b16 v[46:47], v13 offset:10240
v_mfma_f32_16x16x32_bf16 v[96:99], v[56:59], a[144:147], v[96:99]
buffer_load_dwordx4 v8, s[32:35], s61 offen offset:2048 lds
v_mfma_f32_16x16x32_bf16 v[100:103], v[56:59], a[148:151], v[100:103]
buffer_load_dwordx4 v9, s[32:35], s61 offen offset:3072 lds
v_mfma_f32_16x16x32_bf16 v[104:107], v[56:59], a[152:155], v[104:107]
v_permlane32_swap_b32 v192, v193
v_mfma_f32_16x16x32_bf16 v[108:111], v[56:59], a[156:159], v[108:111]
v_permlane32_swap_b32 v196, v197
v_add_f32 v196, v196, v197
v_mfma_f32_16x16x32_bf16 a[168:171], v[56:59], a[16:19], a[168:171]
v_mov_b32 v197, v196
s_nop 1
v_permlane16_swap_b32 v196, v197
v_mfma_f32_16x16x32_bf16 v[112:115], v[60:63], a[144:147], v[112:115]
v_add_f32 v196, v196, v197
v_mov_b32 v197, v196
v_mfma_f32_16x16x32_bf16 v[116:119], v[60:63], a[148:151], v[116:119]
s_nop 0
v_permlane32_swap_b32 v196, v197
v_mfma_f32_16x16x32_bf16 v[120:123], v[60:63], a[152:155], v[120:123]
v_permlane32_swap_b32 v200, v201
v_add_f32 v200, v200, v201
v_mfma_f32_16x16x32_bf16 v[124:127], v[60:63], a[156:159], v[124:127]
v_mov_b32 v201, v200
s_nop 1
v_permlane16_swap_b32 v200, v201
v_mfma_f32_16x16x32_bf16 a[172:175], v[60:63], a[16:19], a[172:175]
v_add_f32 v200, v200, v201
v_mov_b32 v201, v200
s_waitcnt lgkmcnt(0)
v_mfma_f32_16x16x32_bf16 v[64:67], v[32:35], a[128:131], v[64:67]
ds_read_b128 a[144:147], v1 offset:45056
v_mfma_f32_16x16x32_bf16 v[68:71], v[32:35], a[132:135], v[68:71]
s_waitcnt vmcnt(18)
ds_read_b64_tr_b16 v[48:49], v10 offset:12288
v_mfma_f32_16x16x32_bf16 v[72:75], v[32:35], a[136:139], v[72:75]
ds_read_b128 a[148:151], v1 offset:46080
ds_read_b128 a[152:155], v1 offset:47104
v_mfma_f32_16x16x32_bf16 v[76:79], v[32:35], a[140:143], v[76:79]
ds_read_b128 a[156:159], v1 offset:48128
ds_read_b64_tr_b16 v[50:51], v10 offset:14336
s_add_u32 m0, s60, 8192
v_mfma_f32_16x16x32_bf16 a[160:163], v[32:35], a[16:19], a[160:163]
s_add_u32 s61, s69, 0
v_permlane32_swap_b32 v200, v201
v_mfma_f32_16x16x32_bf16 v[80:83], v[36:39], a[128:131], v[80:83]
ds_read_b64_tr_b16 v[52:53], v11 offset:12288
ds_read_b64_tr_b16 v[54:55], v11 offset:14336
v_mfma_f32_16x16x32_bf16 v[84:87], v[36:39], a[132:135], v[84:87]
buffer_load_dwordx4 v2, s[36:39], s61 offen offset:0 lds
v_mfma_f32_16x16x32_bf16 v[88:91], v[36:39], a[136:139], v[88:91]
ds_read_b64_tr_b16 v[56:57], v12 offset:12288
ds_read_b64_tr_b16 v[58:59], v12 offset:14336
v_mfma_f32_16x16x32_bf16 v[92:95], v[36:39], a[140:143], v[92:95]
buffer_load_dwordx4 v3, s[36:39], s61 offen offset:1024 lds
v_mfma_f32_16x16x32_bf16 a[164:167], v[36:39], a[16:19], a[164:167]
ds_read_b64_tr_b16 v[60:61], v13 offset:12288
ds_read_b64_tr_b16 v[62:63], v13 offset:14336
v_mfma_f32_16x16x32_bf16 v[96:99], v[40:43], a[128:131], v[96:99]
buffer_load_dwordx4 v4, s[36:39], s61 offen offset:2048 lds
v_mfma_f32_16x16x32_bf16 v[100:103], v[40:43], a[132:135], v[100:103]
buffer_load_dwordx4 v5, s[36:39], s61 offen offset:3072 lds
v_mfma_f32_16x16x32_bf16 v[104:107], v[40:43], a[136:139], v[104:107]
v_permlane32_swap_b32 v204, v205
v_add_f32 v204, v204, v205
v_mfma_f32_16x16x32_bf16 v[108:111], v[40:43], a[140:143], v[108:111]
v_mov_b32 v205, v204
s_nop 1
v_permlane16_swap_b32 v204, v205
v_mfma_f32_16x16x32_bf16 a[168:171], v[40:43], a[16:19], a[168:171]
v_add_f32 v204, v204, v205
v_mov_b32 v205, v204
v_mfma_f32_16x16x32_bf16 v[112:115], v[44:47], a[128:131], v[112:115]
s_nop 0
v_permlane32_swap_b32 v204, v205
v_mul_f32 v192, 0xbb000000, v192
v_mfma_f32_16x16x32_bf16 v[116:119], v[44:47], a[132:135], v[116:119]
v_mul_f32 v193, 0x3b000000, v193
v_fma_f32 v193, -v192, v192, v193
v_max_f32 v193, 0, v193
v_add_f32 v193, 0x3727c5ac, v193
v_mfma_f32_16x16x32_bf16 v[120:123], v[44:47], a[136:139], v[120:123]
s_mul_i32 s63, s57, 128
s_lshl_b32 s62, s56, 2
s_add_u32 s63, s63, s62
v_mfma_f32_16x16x32_bf16 v[124:127], v[44:47], a[140:143], v[124:127]
s_add_u32 s63, s63, s90
s_add_u32 s63, s63, 65536
v_mfma_f32_16x16x32_bf16 a[172:175], v[44:47], a[16:19], a[172:175]
s_waitcnt vmcnt(20)
buffer_store_dword v14, v15, s[44:47], s63 offen sc1
s_waitcnt lgkmcnt(0)
v_mfma_f32_16x16x32_bf16 v[64:67], v[48:51], a[144:147], v[64:67]
s_waitcnt vmcnt(17)
ds_read_b64_tr_b16 v[32:33], v20 offset:0
v_mfma_f32_16x16x32_bf16 v[68:71], v[48:51], a[148:151], v[68:71]
ds_read_b128 a[128:131], v1 offset:49152
ds_read_b128 a[132:135], v1 offset:50176
v_mfma_f32_16x16x32_bf16 v[72:75], v[48:51], a[152:155], v[72:75]
ds_read_b64_tr_b16 v[34:35], v20 offset:2048
ds_read_b128 a[136:139], v1 offset:51200
v_mfma_f32_16x16x32_bf16 v[76:79], v[48:51], a[156:159], v[76:79]
ds_read_b128 a[140:143], v1 offset:52224
s_add_u32 m0, s60, 12288
v_mfma_f32_16x16x32_bf16 a[160:163], v[48:51], a[16:19], a[160:163]
s_add_u32 s61, s69, 32768
v_mfma_f32_16x16x32_bf16 v[80:83], v[52:55], a[144:147], v[80:83]
ds_read_b64_tr_b16 v[36:37], v21 offset:0
ds_read_b64_tr_b16 v[38:39], v21 offset:2048
v_mfma_f32_16x16x32_bf16 v[84:87], v[52:55], a[148:151], v[84:87]
buffer_load_dwordx4 v2, s[36:39], s61 offen offset:0 lds
v_mfma_f32_16x16x32_bf16 v[88:91], v[52:55], a[152:155], v[88:91]
ds_read_b64_tr_b16 v[40:41], v22 offset:0
ds_read_b64_tr_b16 v[42:43], v22 offset:2048
v_mfma_f32_16x16x32_bf16 v[92:95], v[52:55], a[156:159], v[92:95]
buffer_load_dwordx4 v3, s[36:39], s61 offen offset:1024 lds
v_mfma_f32_16x16x32_bf16 a[164:167], v[52:55], a[16:19], a[164:167]
ds_read_b64_tr_b16 v[44:45], v23 offset:0
ds_read_b64_tr_b16 v[46:47], v23 offset:2048
v_mfma_f32_16x16x32_bf16 v[96:99], v[56:59], a[144:147], v[96:99]
buffer_load_dwordx4 v4, s[36:39], s61 offen offset:2048 lds
v_mfma_f32_16x16x32_bf16 v[100:103], v[56:59], a[148:151], v[100:103]
buffer_load_dwordx4 v5, s[36:39], s61 offen offset:3072 lds
v_mfma_f32_16x16x32_bf16 v[104:107], v[56:59], a[152:155], v[104:107]
v_rsq_f32 v16, v193
v_mfma_f32_16x16x32_bf16 v[108:111], v[56:59], a[156:159], v[108:111]
v_mul_f32 v24, v192, v16
v_mul_f32 v196, 0xbb000000, v196
v_mfma_f32_16x16x32_bf16 a[168:171], v[56:59], a[16:19], a[168:171]
v_mul_f32 v197, 0x3b000000, v197
v_fma_f32 v197, -v196, v196, v197
v_mfma_f32_16x16x32_bf16 v[112:115], v[60:63], a[144:147], v[112:115]
v_max_f32 v197, 0, v197
v_add_f32 v197, 0x3727c5ac, v197
v_mfma_f32_16x16x32_bf16 v[116:119], v[60:63], a[148:151], v[116:119]
v_rsq_f32 v17, v197
v_mfma_f32_16x16x32_bf16 v[120:123], v[60:63], a[152:155], v[120:123]
v_mul_f32 v25, v196, v17
v_mul_f32 v200, 0xbb000000, v200
v_mfma_f32_16x16x32_bf16 v[124:127], v[60:63], a[156:159], v[124:127]
v_mul_f32 v201, 0x3b000000, v201
v_fma_f32 v201, -v200, v200, v201
v_mfma_f32_16x16x32_bf16 a[172:175], v[60:63], a[16:19], a[172:175]
s_waitcnt lgkmcnt(0)
v_mfma_f32_16x16x32_bf16 v[64:67], v[32:35], a[128:131], v[64:67]
s_waitcnt vmcnt(17)
ds_read_b64_tr_b16 v[48:49], v20 offset:4096
v_mfma_f32_16x16x32_bf16 v[68:71], v[32:35], a[132:135], v[68:71]
ds_read_b128 a[144:147], v1 offset:53248
ds_read_b128 a[148:151], v1 offset:54272
v_mfma_f32_16x16x32_bf16 v[72:75], v[32:35], a[136:139], v[72:75]
ds_read_b64_tr_b16 v[50:51], v20 offset:6144
ds_read_b128 a[152:155], v1 offset:55296
v_mfma_f32_16x16x32_bf16 v[76:79], v[32:35], a[140:143], v[76:79]
ds_read_b128 a[156:159], v1 offset:56320
s_add_u32 m0, s91, 0
v_mfma_f32_16x16x32_bf16 a[160:163], v[32:35], a[16:19], a[160:163]
s_add_u32 s61, s69, 65536
v_max_f32 v201, 0, v201
v_mfma_f32_16x16x32_bf16 v[80:83], v[36:39], a[128:131], v[80:83]
ds_read_b64_tr_b16 v[52:53], v21 offset:4096
ds_read_b64_tr_b16 v[54:55], v21 offset:6144
v_mfma_f32_16x16x32_bf16 v[84:87], v[36:39], a[132:135], v[84:87]
buffer_load_dwordx4 v2, s[36:39], s61 offen offset:0 lds
v_mfma_f32_16x16x32_bf16 v[88:91], v[36:39], a[136:139], v[88:91]
ds_read_b64_tr_b16 v[56:57], v22 offset:4096
ds_read_b64_tr_b16 v[58:59], v22 offset:6144
v_mfma_f32_16x16x32_bf16 v[92:95], v[36:39], a[140:143], v[92:95]
buffer_load_dwordx4 v3, s[36:39], s61 offen offset:1024 lds
v_mfma_f32_16x16x32_bf16 a[164:167], v[36:39], a[16:19], a[164:167]
v_add_f32 v201, 0x3727c5ac, v201
v_mfma_f32_16x16x32_bf16 v[96:99], v[40:43], a[128:131], v[96:99]
ds_read_b64_tr_b16 v[60:61], v23 offset:4096
ds_read_b64_tr_b16 v[62:63], v23 offset:6144
v_mfma_f32_16x16x32_bf16 v[100:103], v[40:43], a[132:135], v[100:103]
buffer_load_dwordx4 v4, s[36:39], s61 offen offset:2048 lds
v_mfma_f32_16x16x32_bf16 v[104:107], v[40:43], a[136:139], v[104:107]
v_rsq_f32 v18, v201
v_mfma_f32_16x16x32_bf16 v[108:111], v[40:43], a[140:143], v[108:111]
v_mul_f32 v26, v200, v18
v_mul_f32 v204, 0xbb000000, v204
v_mfma_f32_16x16x32_bf16 a[168:171], v[40:43], a[16:19], a[168:171]
v_mul_f32 v205, 0x3b000000, v205
v_fma_f32 v205, -v204, v204, v205
v_mfma_f32_16x16x32_bf16 v[112:115], v[44:47], a[128:131], v[112:115]
v_max_f32 v205, 0, v205
v_add_f32 v205, 0x3727c5ac, v205
v_mfma_f32_16x16x32_bf16 v[116:119], v[44:47], a[132:135], v[116:119]
v_rsq_f32 v19, v205
v_mfma_f32_16x16x32_bf16 v[120:123], v[44:47], a[136:139], v[120:123]
buffer_load_dwordx4 v5, s[36:39], s61 offen offset:3072 lds
v_mfma_f32_16x16x32_bf16 v[124:127], v[44:47], a[140:143], v[124:127]
v_mul_f32 v27, v204, v19
v_mfma_f32_16x16x32_bf16 a[172:175], v[44:47], a[16:19], a[172:175]
s_waitcnt lgkmcnt(0)
v_mfma_f32_16x16x32_bf16 v[64:67], v[48:51], a[144:147], v[64:67]
s_waitcnt vmcnt(17)
ds_read_b64_tr_b16 v[32:33], v10 offset:0
v_mfma_f32_16x16x32_bf16 v[68:71], v[48:51], a[148:151], v[68:71]
ds_read_b128 a[128:131], v1 offset:57344
ds_read_b64_tr_b16 v[34:35], v10 offset:2048
v_mfma_f32_16x16x32_bf16 v[72:75], v[48:51], a[152:155], v[72:75]
ds_read_b128 a[132:135], v1 offset:58368
s_add_u32 m0, s91, 4096
v_mfma_f32_16x16x32_bf16 v[76:79], v[48:51], a[156:159], v[76:79]
s_add_u32 s61, s69, 98304
v_mfma_f32_16x16x32_bf16 a[160:163], v[48:51], a[16:19], a[160:163]
ds_read_b64_tr_b16 v[36:37], v11 offset:0
ds_read_b64_tr_b16 v[38:39], v11 offset:2048
v_mfma_f32_16x16x32_bf16 v[80:83], v[52:55], a[144:147], v[80:83]
buffer_load_dwordx4 v2, s[36:39], s61 offen offset:0 lds
v_mfma_f32_16x16x32_bf16 v[84:87], v[52:55], a[148:151], v[84:87]
v_mfma_f32_16x16x32_bf16 v[88:91], v[52:55], a[152:155], v[88:91]
ds_read_b128 a[136:139], v1 offset:59392
v_mfma_f32_16x16x32_bf16 v[92:95], v[52:55], a[156:159], v[92:95]
ds_read_b64_tr_b16 v[40:41], v12 offset:0
v_mfma_f32_16x16x32_bf16 a[164:167], v[52:55], a[16:19], a[164:167]
ds_read_b64_tr_b16 v[42:43], v12 offset:2048
v_mfma_f32_16x16x32_bf16 v[96:99], v[56:59], a[144:147], v[96:99]
buffer_load_dwordx4 v3, s[36:39], s61 offen offset:1024 lds
v_mfma_f32_16x16x32_bf16 v[100:103], v[56:59], a[148:151], v[100:103]
v_mfma_f32_16x16x32_bf16 v[104:107], v[56:59], a[152:155], v[104:107]
ds_read_b128 a[140:143], v1 offset:60416
ds_read_b64_tr_b16 v[44:45], v13 offset:0
v_mfma_f32_16x16x32_bf16 v[108:111], v[56:59], a[156:159], v[108:111]
ds_read_b64_tr_b16 v[46:47], v13 offset:2048
v_mfma_f32_16x16x32_bf16 a[168:171], v[56:59], a[16:19], a[168:171]
buffer_load_dwordx4 v4, s[36:39], s61 offen offset:2048 lds
v_mfma_f32_16x16x32_bf16 v[112:115], v[60:63], a[144:147], v[112:115]
v_mfma_f32_16x16x32_bf16 v[116:119], v[60:63], a[148:151], v[116:119]
v_mfma_f32_16x16x32_bf16 v[120:123], v[60:63], a[152:155], v[120:123]
buffer_load_dwordx4 v5, s[36:39], s61 offen offset:3072 lds
v_mfma_f32_16x16x32_bf16 v[124:127], v[60:63], a[156:159], v[124:127]
v_mfma_f32_16x16x32_bf16 a[172:175], v[60:63], a[16:19], a[172:175]
s_waitcnt lgkmcnt(0)
v_mfma_f32_16x16x32_bf16 v[64:67], v[32:35], a[128:131], v[64:67]
ds_read_b128 a[144:147], v1 offset:61440
v_mfma_f32_16x16x32_bf16 v[68:71], v[32:35], a[132:135], v[68:71]
s_waitcnt vmcnt(17)
ds_read_b64_tr_b16 v[48:49], v10 offset:4096
v_mfma_f32_16x16x32_bf16 v[72:75], v[32:35], a[136:139], v[72:75]
ds_read_b128 a[148:151], v1 offset:62464
ds_read_b128 a[152:155], v1 offset:63488
v_mfma_f32_16x16x32_bf16 v[76:79], v[32:35], a[140:143], v[76:79]
ds_read_b64_tr_b16 v[50:51], v10 offset:6144
ds_read_b128 a[156:159], v1 offset:64512
s_add_u32 m0, s60, 0
v_mfma_f32_16x16x32_bf16 a[160:163], v[32:35], a[16:19], a[160:163]
s_add_u32 s61, s69, 131072
s_lshr_b32 s63, s57, 1
s_lshl_b32 s63, s63, 4
v_mfma_f32_16x16x32_bf16 v[80:83], v[36:39], a[128:131], v[80:83]
ds_read_b64_tr_b16 v[52:53], v11 offset:4096
ds_read_b64_tr_b16 v[54:55], v11 offset:6144
s_lshl_b32 s62, s58, 6
v_mfma_f32_16x16x32_bf16 v[84:87], v[36:39], a[132:135], v[84:87]
buffer_load_dwordx4 v2, s[36:39], s61 offen offset:0 lds
v_mfma_f32_16x16x32_bf16 v[88:91], v[36:39], a[136:139], v[88:91]
ds_read_b64_tr_b16 v[56:57], v12 offset:4096
ds_read_b64_tr_b16 v[58:59], v12 offset:6144
v_mfma_f32_16x16x32_bf16 v[92:95], v[36:39], a[140:143], v[92:95]
buffer_load_dwordx4 v3, s[36:39], s61 offen offset:1024 lds
v_mfma_f32_16x16x32_bf16 a[164:167], v[36:39], a[16:19], a[164:167]
ds_read_b64_tr_b16 v[60:61], v13 offset:4096
ds_read_b64_tr_b16 v[62:63], v13 offset:6144
v_mfma_f32_16x16x32_bf16 v[96:99], v[40:43], a[128:131], v[96:99]
buffer_load_dwordx4 v4, s[36:39], s61 offen offset:2048 lds
v_mfma_f32_16x16x32_bf16 v[100:103], v[40:43], a[132:135], v[100:103]
buffer_load_dwordx4 v5, s[36:39], s61 offen offset:3072 lds
v_mfma_f32_16x16x32_bf16 v[104:107], v[40:43], a[136:139], v[104:107]
s_add_u32 s63, s63, s62
s_and_b32 s62, s57, 1
v_mfma_f32_16x16x32_bf16 v[108:111], v[40:43], a[140:143], v[108:111]
s_lshl_b32 s84, s62, 2
s_add_u32 s84, s84, s56
v_mfma_f32_16x16x32_bf16 a[168:171], v[40:43], a[16:19], a[168:171]
s_add_u32 s84, s84, s63
s_lshl_b32 s62, s62, 1
v_mfma_f32_16x16x32_bf16 v[112:115], v[44:47], a[128:131], v[112:115]
s_add_u32 s63, s63, s62
s_and_b32 s62, s56, 1
v_mfma_f32_16x16x32_bf16 v[116:119], v[44:47], a[132:135], v[116:119]
s_add_u32 s63, s63, s62
s_lshr_b32 s62, s56, 1
s_lshl_b32 s62, s62, 2
v_mfma_f32_16x16x32_bf16 v[120:123], v[44:47], a[136:139], v[120:123]
s_add_u32 s63, s63, s62
s_add_u32 s85, s63, 8
v_mfma_f32_16x16x32_bf16 v[124:127], v[44:47], a[140:143], v[124:127]
v_and_b32 v248, 7, v0
v_lshlrev_b32 v248, 7, v248
s_lshr_b32 s63, s57, 1
v_mfma_f32_16x16x32_bf16 a[172:175], v[44:47], a[16:19], a[172:175]
s_lshl_b32 s63, s63, 2
v_add_u32 v248, s63, v248
s_waitcnt lgkmcnt(0)
v_mfma_f32_16x16x32_bf16 v[64:67], v[48:51], a[144:147], v[64:67]
s_waitcnt vmcnt(17)
ds_read_b64_tr_b16 v[32:33], v10 offset:8192
v_mfma_f32_16x16x32_bf16 v[68:71], v[48:51], a[148:151], v[68:71]
ds_read_b64_tr_b16 v[34:35], v10 offset:10240
s_add_u32 m0, s60, 4096
v_mfma_f32_16x16x32_bf16 v[72:75], v[48:51], a[152:155], v[72:75]
s_add_u32 s61, s69, 163840
s_add_u32 s63, s90, 65536
v_mfma_f32_16x16x32_bf16 v[76:79], v[48:51], a[156:159], v[76:79]
buffer_load_dword v249, v248, s[44:47], s63 offen sc1
v_mfma_f32_16x16x32_bf16 a[160:163], v[48:51], a[16:19], a[160:163]
ds_read_b64_tr_b16 v[36:37], v11 offset:8192
v_mfma_f32_16x16x32_bf16 v[80:83], v[52:55], a[144:147], v[80:83]
ds_read_b64_tr_b16 v[38:39], v11 offset:10240
v_mfma_f32_16x16x32_bf16 v[84:87], v[52:55], a[148:151], v[84:87]
buffer_load_dwordx4 v2, s[36:39], s61 offen offset:0 lds
v_mfma_f32_16x16x32_bf16 v[88:91], v[52:55], a[152:155], v[88:91]
v_mfma_f32_16x16x32_bf16 v[92:95], v[52:55], a[156:159], v[92:95]
v_mfma_f32_16x16x32_bf16 a[164:167], v[52:55], a[16:19], a[164:167]
v_mfma_f32_16x16x32_bf16 v[96:99], v[56:59], a[144:147], v[96:99]
buffer_load_dwordx4 v3, s[36:39], s61 offen offset:1024 lds
v_mfma_f32_16x16x32_bf16 v[100:103], v[56:59], a[148:151], v[100:103]
v_mfma_f32_16x16x32_bf16 v[104:107], v[56:59], a[152:155], v[104:107]
v_mfma_f32_16x16x32_bf16 v[108:111], v[56:59], a[156:159], v[108:111]
buffer_load_dwordx4 v4, s[36:39], s61 offen offset:2048 lds
v_mfma_f32_16x16x32_bf16 a[168:171], v[56:59], a[16:19], a[168:171]
v_mfma_f32_16x16x32_bf16 v[112:115], v[60:63], a[144:147], v[112:115]
v_mfma_f32_16x16x32_bf16 v[116:119], v[60:63], a[148:151], v[116:119]
buffer_load_dwordx4 v5, s[36:39], s61 offen offset:3072 lds
v_mfma_f32_16x16x32_bf16 v[120:123], v[60:63], a[152:155], v[120:123]
v_mfma_f32_16x16x32_bf16 v[124:127], v[60:63], a[156:159], v[124:127]
v_mfma_f32_16x16x32_bf16 a[172:175], v[60:63], a[16:19], a[172:175]
s_waitcnt lgkmcnt(0)
s_barrier
s_lshl_b32 s100, s56, 12
s_add_u32 s100, s100, 32768
s_sub_u32 s63, s100, s60
v_add_u32 v6, s63, v10
v_add_u32 v7, s63, v11
v_add_u32 v8, s63, v12
v_add_u32 v9, s63, v13
s_add_u32 m0, s100, 0
s_add_u32 s61, s69, 196608
buffer_load_dwordx4 v2, s[36:39], s61 offen offset:0 lds
buffer_load_dwordx4 v3, s[36:39], s61 offen offset:1024 lds
buffer_load_dwordx4 v4, s[36:39], s61 offen offset:2048 lds
buffer_load_dwordx4 v5, s[36:39], s61 offen offset:3072 lds
v_accvgpr_read_b32 v208, a160
v_accvgpr_read_b32 v209, a161
v_accvgpr_read_b32 v210, a162
v_accvgpr_read_b32 v211, a163
v_accvgpr_read_b32 v212, a164
v_accvgpr_read_b32 v213, a165
v_accvgpr_read_b32 v214, a166
v_accvgpr_read_b32 v215, a167
v_accvgpr_read_b32 v216, a168
v_accvgpr_read_b32 v217, a169
v_accvgpr_read_b32 v218, a170
v_accvgpr_read_b32 v219, a171
v_accvgpr_read_b32 v220, a172
v_accvgpr_read_b32 v221, a173
v_accvgpr_read_b32 v222, a174
v_accvgpr_read_b32 v223, a175
v_mov_b32 v224, 0xc0135761
v_mov_b32 v225, 0xc0135761
s_mov_b32 s76, 0xbdd2d3e8
s_mov_b32 s77, 0xbdd2d3e8
s_and_b32 s62, s57, 1
s_min_u32 s63, s56, 1
s_and_b32 s63, s63, s62
s_lshl_b32 s81, s56, 1
s_sub_u32 s81, s81, s63
s_sub_u32 s62, s62, s63
s_add_u32 s63, s81, 1
s_cmp_eq_u32 s62, 1
s_cselect_b32 s63, 7, s63
s_lshl_b32 s81, s81, 12
s_lshl_b32 s63, s63, 12
v_add_u32 v28, s81, v1
v_add_u32 v29, s63, v1
s_waitcnt vmcnt(8)
v_cmp_ne_u32 vcc, v249, v14
s_nop 3
s_cbranch_vccnz L_spin8
L_back7:
v_pk_mul_f32 v[64:65], v[64:65], v[16:17] op_sel:[0,0] op_sel_hi:[1,0]
v_pk_mul_f32 v[66:67], v[66:67], v[16:17] op_sel:[0,0] op_sel_hi:[1,0]
v_pk_mul_f32 v[80:81], v[80:81], v[16:17] op_sel:[0,0] op_sel_hi:[1,0]
v_pk_mul_f32 v[82:83], v[82:83], v[16:17] op_sel:[0,0] op_sel_hi:[1,0]
v_pk_fma_f32 v[64:65], v[208:209], v[24:25], v[64:65] op_sel:[0,0,0] op_sel_hi:[1,0,1]
v_pk_fma_f32 v[66:67], v[210:211], v[24:25], v[66:67] op_sel:[0,0,0] op_sel_hi:[1,0,1]
v_pk_fma_f32 v[80:81], v[212:213], v[24:25], v[80:81] op_sel:[0,0,0] op_sel_hi:[1,0,1]
v_pk_fma_f32 v[82:83], v[214:215], v[24:25], v[82:83] op_sel:[0,0,0] op_sel_hi:[1,0,1]
v_pk_mul_f32 v[228:229], v[64:65], v[64:65]
v_pk_mul_f32 v[230:231], v[66:67], v[66:67]
v_pk_mul_f32 v[232:233], v[80:81], v[80:81]
v_pk_mul_f32 v[234:235], v[82:83], v[82:83]
v_pk_fma_f32 v[228:229], v[228:229], s[76:77], v[224:225]
v_pk_fma_f32 v[230:231], v[230:231], s[76:77], v[224:225]
v_pk_fma_f32 v[232:233], v[232:233], s[76:77], v[224:225]
v_pk_fma_f32 v[234:235], v[234:235], s[76:77], v[224:225]
v_pk_mul_f32 v[228:229], v[228:229], v[64:65]
v_pk_mul_f32 v[230:231], v[230:231], v[66:67]
v_pk_mul_f32 v[232:233], v[232:233], v[80:81]
v_pk_mul_f32 v[234:235], v[234:235], v[82:83]
v_exp_f32 v228, v228
v_exp_f32 v229, v229
v_exp_f32 v230, v230
v_exp_f32 v231, v231
v_exp_f32 v232, v232
v_exp_f32 v233, v233
v_exp_f32 v234, v234
v_exp_f32 v235, v235
v_pk_add_f32 v[228:229], v[228:229], 1.0 op_sel_hi:[1,0]
v_pk_add_f32 v[230:231], v[230:231], 1.0 op_sel_hi:[1,0]
v_pk_add_f32 v[232:233], v[232:233], 1.0 op_sel_hi:[1,0]
v_pk_add_f32 v[234:235], v[234:235], 1.0 op_sel_hi:[1,0]
v_rcp_f32 v228, v228
v_rcp_f32 v229, v229
v_rcp_f32 v230, v230
v_rcp_f32 v231, v231
v_rcp_f32 v232, v232
v_rcp_f32 v233, v233
v_rcp_f32 v234, v234
v_rcp_f32 v235, v235
v_pk_mul_f32 v[64:65], v[64:65], v[228:229]
v_pk_mul_f32 v[66:67], v[66:67], v[230:231]
v_pk_mul_f32 v[80:81], v[80:81], v[232:233]
v_pk_mul_f32 v[82:83], v[82:83], v[234:235]
v_cvt_pk_bf16_f32 v64, v64, v65
v_cvt_pk_bf16_f32 v65, v66, v67
v_cvt_pk_bf16_f32 v66, v80, v81
v_cvt_pk_bf16_f32 v67, v82, v83
ds_write_b128 v28, v[64:67] offset:0
s_lshl_b32 s63, s84, 13
s_add_u32 s63, s63, 25165824
s_add_u32 s62, s63, 4096
v_pk_mul_f32 v[68:69], v[68:69], v[16:17] op_sel:[0,1] op_sel_hi:[1,1]
v_pk_mul_f32 v[70:71], v[70:71], v[16:17] op_sel:[0,1] op_sel_hi:[1,1]
v_pk_mul_f32 v[84:85], v[84:85], v[16:17] op_sel:[0,1] op_sel_hi:[1,1]
v_pk_mul_f32 v[86:87], v[86:87], v[16:17] op_sel:[0,1] op_sel_hi:[1,1]
v_pk_fma_f32 v[68:69], v[208:209], v[24:25], v[68:69] op_sel:[0,1,0] op_sel_hi:[1,1,1]
v_pk_fma_f32 v[70:71], v[210:211], v[24:25], v[70:71] op_sel:[0,1,0] op_sel_hi:[1,1,1]
v_pk_fma_f32 v[84:85], v[212:213], v[24:25], v[84:85] op_sel:[0,1,0] op_sel_hi:[1,1,1]
v_pk_fma_f32 v[86:87], v[214:215], v[24:25], v[86:87] op_sel:[0,1,0] op_sel_hi:[1,1,1]
v_pk_mul_f32 v[228:229], v[68:69], v[68:69]
v_pk_mul_f32 v[230:231], v[70:71], v[70:71]
v_pk_mul_f32 v[232:233], v[84:85], v[84:85]
v_pk_mul_f32 v[234:235], v[86:87], v[86:87]
v_pk_fma_f32 v[228:229], v[228:229], s[76:77], v[224:225]
v_pk_fma_f32 v[230:231], v[230:231], s[76:77], v[224:225]
v_pk_fma_f32 v[232:233], v[232:233], s[76:77], v[224:225]
v_pk_fma_f32 v[234:235], v[234:235], s[76:77], v[224:225]
v_pk_mul_f32 v[228:229], v[228:229], v[68:69]
v_pk_mul_f32 v[230:231], v[230:231], v[70:71]
v_pk_mul_f32 v[232:233], v[232:233], v[84:85]
v_pk_mul_f32 v[234:235], v[234:235], v[86:87]
v_exp_f32 v228, v228
v_exp_f32 v229, v229
v_exp_f32 v230, v230
v_exp_f32 v231, v231
v_exp_f32 v232, v232
v_exp_f32 v233, v233
v_exp_f32 v234, v234
v_exp_f32 v235, v235
v_pk_add_f32 v[228:229], v[228:229], 1.0 op_sel_hi:[1,0]
v_pk_add_f32 v[230:231], v[230:231], 1.0 op_sel_hi:[1,0]
v_pk_add_f32 v[232:233], v[232:233], 1.0 op_sel_hi:[1,0]
v_pk_add_f32 v[234:235], v[234:235], 1.0 op_sel_hi:[1,0]
v_rcp_f32 v228, v228
v_rcp_f32 v229, v229
v_rcp_f32 v230, v230
v_rcp_f32 v231, v231
v_rcp_f32 v232, v232
v_rcp_f32 v233, v233
v_rcp_f32 v234, v234
v_rcp_f32 v235, v235
v_pk_mul_f32 v[68:69], v[68:69], v[228:229]
v_pk_mul_f32 v[70:71], v[70:71], v[230:231]
v_pk_mul_f32 v[84:85], v[84:85], v[232:233]
v_pk_mul_f32 v[86:87], v[86:87], v[234:235]
v_cvt_pk_bf16_f32 v68, v68, v69
v_cvt_pk_bf16_f32 v69, v70, v71
v_cvt_pk_bf16_f32 v70, v84, v85
v_cvt_pk_bf16_f32 v71, v86, v87
ds_write_b128 v28, v[68:71] offset:1024
buffer_load_dwordx4 v[128:131], v1, s[44:47], s63 offen offset:0 sc1
buffer_load_dwordx4 v[132:135], v1, s[44:47], s63 offen offset:1024 sc1
buffer_load_dwordx4 v[136:139], v1, s[44:47], s63 offen offset:2048 sc1
v_pk_mul_f32 v[72:73], v[72:73], v[18:19] op_sel:[0,0] op_sel_hi:[1,0]
v_pk_mul_f32 v[74:75], v[74:75], v[18:19] op_sel:[0,0] op_sel_hi:[1,0]
v_pk_mul_f32 v[88:89], v[88:89], v[18:19] op_sel:[0,0] op_sel_hi:[1,0]
v_pk_mul_f32 v[90:91], v[90:91], v[18:19] op_sel:[0,0] op_sel_hi:[1,0]
v_pk_fma_f32 v[72:73], v[208:209], v[26:27], v[72:73] op_sel:[0,0,0] op_sel_hi:[1,0,1]
v_pk_fma_f32 v[74:75], v[210:211], v[26:27], v[74:75] op_sel:[0,0,0] op_sel_hi:[1,0,1]
v_pk_fma_f32 v[88:89], v[212:213], v[26:27], v[88:89] op_sel:[0,0,0] op_sel_hi:[1,0,1]
v_pk_fma_f32 v[90:91], v[214:215], v[26:27], v[90:91] op_sel:[0,0,0] op_sel_hi:[1,0,1]
v_pk_mul_f32 v[228:229], v[72:73], v[72:73]
v_pk_mul_f32 v[230:231], v[74:75], v[74:75]
v_pk_mul_f32 v[232:233], v[88:89], v[88:89]
v_pk_mul_f32 v[234:235], v[90:91], v[90:91]
v_pk_fma_f32 v[228:229], v[228:229], s[76:77], v[224:225]
v_pk_fma_f32 v[230:231], v[230:231], s[76:77], v[224:225]
v_pk_fma_f32 v[232:233], v[232:233], s[76:77], v[224:225]
v_pk_fma_f32 v[234:235], v[234:235], s[76:77], v[224:225]
v_pk_mul_f32 v[228:229], v[228:229], v[72:73]
v_pk_mul_f32 v[230:231], v[230:231], v[74:75]
v_pk_mul_f32 v[232:233], v[232:233], v[88:89]
v_pk_mul_f32 v[234:235], v[234:235], v[90:91]
v_exp_f32 v228, v228
v_exp_f32 v229, v229
v_exp_f32 v230, v230
v_exp_f32 v231, v231
v_exp_f32 v232, v232
v_exp_f32 v233, v233
v_exp_f32 v234, v234
v_exp_f32 v235, v235
v_pk_add_f32 v[228:229], v[228:229], 1.0 op_sel_hi:[1,0]
v_pk_add_f32 v[230:231], v[230:231], 1.0 op_sel_hi:[1,0]
v_pk_add_f32 v[232:233], v[232:233], 1.0 op_sel_hi:[1,0]
v_pk_add_f32 v[234:235], v[234:235], 1.0 op_sel_hi:[1,0]
v_rcp_f32 v228, v228
v_rcp_f32 v229, v229
v_rcp_f32 v230, v230
v_rcp_f32 v231, v231
v_rcp_f32 v232, v232
v_rcp_f32 v233, v233
v_rcp_f32 v234, v234
v_rcp_f32 v235, v235
v_pk_mul_f32 v[72:73], v[72:73], v[228:229]
v_pk_mul_f32 v[74:75], v[74:75], v[230:231]
v_pk_mul_f32 v[88:89], v[88:89], v[232:233]
v_pk_mul_f32 v[90:91], v[90:91], v[234:235]
v_cvt_pk_bf16_f32 v72, v72, v73
v_cvt_pk_bf16_f32 v73, v74, v75
v_cvt_pk_bf16_f32 v74, v88, v89
v_cvt_pk_bf16_f32 v75, v90, v91
ds_write_b128 v28, v[72:75] offset:2048
buffer_load_dwordx4 v[140:143], v1, s[44:47], s63 offen offset:3072 sc1
buffer_load_dwordx4 v[144:147], v1, s[44:47], s62 offen offset:0 sc1
buffer_load_dwordx4 v[148:151], v1, s[44:47], s62 offen offset:1024 sc1
v_pk_mul_f32 v[76:77], v[76:77], v[18:19] op_sel:[0,1] op_sel_hi:[1,1]
v_pk_mul_f32 v[78:79], v[78:79], v[18:19] op_sel:[0,1] op_sel_hi:[1,1]
v_pk_mul_f32 v[92:93], v[92:93], v[18:19] op_sel:[0,1] op_sel_hi:[1,1]
v_pk_mul_f32 v[94:95], v[94:95], v[18:19] op_sel:[0,1] op_sel_hi:[1,1]
v_pk_fma_f32 v[76:77], v[208:209], v[26:27], v[76:77] op_sel:[0,1,0] op_sel_hi:[1,1,1]
v_pk_fma_f32 v[78:79], v[210:211], v[26:27], v[78:79] op_sel:[0,1,0] op_sel_hi:[1,1,1]
v_pk_fma_f32 v[92:93], v[212:213], v[26:27], v[92:93] op_sel:[0,1,0] op_sel_hi:[1,1,1]
v_pk_fma_f32 v[94:95], v[214:215], v[26:27], v[94:95] op_sel:[0,1,0] op_sel_hi:[1,1,1]
v_pk_mul_f32 v[228:229], v[76:77], v[76:77]
v_pk_mul_f32 v[230:231], v[78:79], v[78:79]
v_pk_mul_f32 v[232:233], v[92:93], v[92:93]
v_pk_mul_f32 v[234:235], v[94:95], v[94:95]
v_pk_fma_f32 v[228:229], v[228:229], s[76:77], v[224:225]
v_pk_fma_f32 v[230:231], v[230:231], s[76:77], v[224:225]
v_pk_fma_f32 v[232:233], v[232:233], s[76:77], v[224:225]
v_pk_fma_f32 v[234:235], v[234:235], s[76:77], v[224:225]
v_pk_mul_f32 v[228:229], v[228:229], v[76:77]
v_pk_mul_f32 v[230:231], v[230:231], v[78:79]
v_pk_mul_f32 v[232:233], v[232:233], v[92:93]
v_pk_mul_f32 v[234:235], v[234:235], v[94:95]
v_exp_f32 v228, v228
v_exp_f32 v229, v229
v_exp_f32 v230, v230
v_exp_f32 v231, v231
v_exp_f32 v232, v232
v_exp_f32 v233, v233
v_exp_f32 v234, v234
v_exp_f32 v235, v235
v_pk_add_f32 v[228:229], v[228:229], 1.0 op_sel_hi:[1,0]
v_pk_add_f32 v[230:231], v[230:231], 1.0 op_sel_hi:[1,0]
v_pk_add_f32 v[232:233], v[232:233], 1.0 op_sel_hi:[1,0]
v_pk_add_f32 v[234:235], v[234:235], 1.0 op_sel_hi:[1,0]
v_rcp_f32 v228, v228
v_rcp_f32 v229, v229
v_rcp_f32 v230, v230
v_rcp_f32 v231, v231
v_rcp_f32 v232, v232
v_rcp_f32 v233, v233
v_rcp_f32 v234, v234
v_rcp_f32 v235, v235
v_pk_mul_f32 v[76:77], v[76:77], v[228:229]
v_pk_mul_f32 v[78:79], v[78:79], v[230:231]
v_pk_mul_f32 v[92:93], v[92:93], v[232:233]
v_pk_mul_f32 v[94:95], v[94:95], v[234:235]
v_cvt_pk_bf16_f32 v76, v76, v77
v_cvt_pk_bf16_f32 v77, v78, v79
v_cvt_pk_bf16_f32 v78, v92, v93
v_cvt_pk_bf16_f32 v79, v94, v95
ds_write_b128 v28, v[76:79] offset:3072
buffer_load_dwordx4 v[152:155], v1, s[44:47], s62 offen offset:2048 sc1
buffer_load_dwordx4 v[156:159], v1, s[44:47], s62 offen offset:3072 sc1
v_pk_mul_f32 v[96:97], v[96:97], v[16:17] op_sel:[0,0] op_sel_hi:[1,0]
v_pk_mul_f32 v[98:99], v[98:99], v[16:17] op_sel:[0,0] op_sel_hi:[1,0]
v_pk_mul_f32 v[112:113], v[112:113], v[16:17] op_sel:[0,0] op_sel_hi:[1,0]
v_pk_mul_f32 v[114:115], v[114:115], v[16:17] op_sel:[0,0] op_sel_hi:[1,0]
v_pk_fma_f32 v[96:97], v[216:217], v[24:25], v[96:97] op_sel:[0,0,0] op_sel_hi:[1,0,1]
v_pk_fma_f32 v[98:99], v[218:219], v[24:25], v[98:99] op_sel:[0,0,0] op_sel_hi:[1,0,1]
v_pk_fma_f32 v[112:113], v[220:221], v[24:25], v[112:113] op_sel:[0,0,0] op_sel_hi:[1,0,1]
v_pk_fma_f32 v[114:115], v[222:223], v[24:25], v[114:115] op_sel:[0,0,0] op_sel_hi:[1,0,1]
v_pk_mul_f32 v[228:229], v[96:97], v[96:97]
v_pk_mul_f32 v[230:231], v[98:99], v[98:99]
v_pk_mul_f32 v[232:233], v[112:113], v[112:113]
v_pk_mul_f32 v[234:235], v[114:115], v[114:115]
v_pk_fma_f32 v[228:229], v[228:229], s[76:77], v[224:225]
v_pk_fma_f32 v[230:231], v[230:231], s[76:77], v[224:225]
v_pk_fma_f32 v[232:233], v[232:233], s[76:77], v[224:225]
v_pk_fma_f32 v[234:235], v[234:235], s[76:77], v[224:225]
v_pk_mul_f32 v[228:229], v[228:229], v[96:97]
v_pk_mul_f32 v[230:231], v[230:231], v[98:99]
v_pk_mul_f32 v[232:233], v[232:233], v[112:113]
v_pk_mul_f32 v[234:235], v[234:235], v[114:115]
v_exp_f32 v228, v228
v_exp_f32 v229, v229
v_exp_f32 v230, v230
v_exp_f32 v231, v231
v_exp_f32 v232, v232
v_exp_f32 v233, v233
v_exp_f32 v234, v234
v_exp_f32 v235, v235
v_pk_add_f32 v[228:229], v[228:229], 1.0 op_sel_hi:[1,0]
v_pk_add_f32 v[230:231], v[230:231], 1.0 op_sel_hi:[1,0]
v_pk_add_f32 v[232:233], v[232:233], 1.0 op_sel_hi:[1,0]
v_pk_add_f32 v[234:235], v[234:235], 1.0 op_sel_hi:[1,0]
v_rcp_f32 v228, v228
v_rcp_f32 v229, v229
v_rcp_f32 v230, v230
v_rcp_f32 v231, v231
v_rcp_f32 v232, v232
v_rcp_f32 v233, v233
v_rcp_f32 v234, v234
v_rcp_f32 v235, v235
v_pk_mul_f32 v[96:97], v[96:97], v[228:229]
v_pk_mul_f32 v[98:99], v[98:99], v[230:231]
v_pk_mul_f32 v[112:113], v[112:113], v[232:233]
v_pk_mul_f32 v[114:115], v[114:115], v[234:235]
v_cvt_pk_bf16_f32 v96, v96, v97
v_cvt_pk_bf16_f32 v97, v98, v99
v_cvt_pk_bf16_f32 v98, v112, v113
v_cvt_pk_bf16_f32 v99, v114, v115
ds_write_b128 v29, v[96:99] offset:0
s_lshl_b32 s63, s85, 13
s_add_u32 s63, s63, 25165824
s_add_u32 s62, s63, 4096
v_pk_mul_f32 v[100:101], v[100:101], v[16:17] op_sel:[0,1] op_sel_hi:[1,1]
v_pk_mul_f32 v[102:103], v[102:103], v[16:17] op_sel:[0,1] op_sel_hi:[1,1]
v_pk_mul_f32 v[116:117], v[116:117], v[16:17] op_sel:[0,1] op_sel_hi:[1,1]
v_pk_mul_f32 v[118:119], v[118:119], v[16:17] op_sel:[0,1] op_sel_hi:[1,1]
v_pk_fma_f32 v[100:101], v[216:217], v[24:25], v[100:101] op_sel:[0,1,0] op_sel_hi:[1,1,1]
v_pk_fma_f32 v[102:103], v[218:219], v[24:25], v[102:103] op_sel:[0,1,0] op_sel_hi:[1,1,1]
v_pk_fma_f32 v[116:117], v[220:221], v[24:25], v[116:117] op_sel:[0,1,0] op_sel_hi:[1,1,1]
v_pk_fma_f32 v[118:119], v[222:223], v[24:25], v[118:119] op_sel:[0,1,0] op_sel_hi:[1,1,1]
v_pk_mul_f32 v[228:229], v[100:101], v[100:101]
v_pk_mul_f32 v[230:231], v[102:103], v[102:103]
v_pk_mul_f32 v[232:233], v[116:117], v[116:117]
v_pk_mul_f32 v[234:235], v[118:119], v[118:119]
v_pk_fma_f32 v[228:229], v[228:229], s[76:77], v[224:225]
v_pk_fma_f32 v[230:231], v[230:231], s[76:77], v[224:225]
v_pk_fma_f32 v[232:233], v[232:233], s[76:77], v[224:225]
v_pk_fma_f32 v[234:235], v[234:235], s[76:77], v[224:225]
v_pk_mul_f32 v[228:229], v[228:229], v[100:101]
v_pk_mul_f32 v[230:231], v[230:231], v[102:103]
v_pk_mul_f32 v[232:233], v[232:233], v[116:117]
v_pk_mul_f32 v[234:235], v[234:235], v[118:119]
v_exp_f32 v228, v228
v_exp_f32 v229, v229
v_exp_f32 v230, v230
v_exp_f32 v231, v231
v_exp_f32 v232, v232
v_exp_f32 v233, v233
v_exp_f32 v234, v234
v_exp_f32 v235, v235
v_pk_add_f32 v[228:229], v[228:229], 1.0 op_sel_hi:[1,0]
v_pk_add_f32 v[230:231], v[230:231], 1.0 op_sel_hi:[1,0]
v_pk_add_f32 v[232:233], v[232:233], 1.0 op_sel_hi:[1,0]
v_pk_add_f32 v[234:235], v[234:235], 1.0 op_sel_hi:[1,0]
v_rcp_f32 v228, v228
v_rcp_f32 v229, v229
v_rcp_f32 v230, v230
v_rcp_f32 v231, v231
v_rcp_f32 v232, v232
v_rcp_f32 v233, v233
v_rcp_f32 v234, v234
v_rcp_f32 v235, v235
v_pk_mul_f32 v[100:101], v[100:101], v[228:229]
v_pk_mul_f32 v[102:103], v[102:103], v[230:231]
v_pk_mul_f32 v[116:117], v[116:117], v[232:233]
v_pk_mul_f32 v[118:119], v[118:119], v[234:235]
v_cvt_pk_bf16_f32 v100, v100, v101
v_cvt_pk_bf16_f32 v101, v102, v103
v_cvt_pk_bf16_f32 v102, v116, v117
v_cvt_pk_bf16_f32 v103, v118, v119
ds_write_b128 v29, v[100:103] offset:1024
buffer_load_dwordx4 v[160:163], v1, s[44:47], s63 offen offset:0 sc1
buffer_load_dwordx4 v[164:167], v1, s[44:47], s63 offen offset:1024 sc1
buffer_load_dwordx4 v[168:171], v1, s[44:47], s63 offen offset:2048 sc1
v_pk_mul_f32 v[104:105], v[104:105], v[18:19] op_sel:[0,0] op_sel_hi:[1,0]
v_pk_mul_f32 v[106:107], v[106:107], v[18:19] op_sel:[0,0] op_sel_hi:[1,0]
v_pk_mul_f32 v[120:121], v[120:121], v[18:19] op_sel:[0,0] op_sel_hi:[1,0]
v_pk_mul_f32 v[122:123], v[122:123], v[18:19] op_sel:[0,0] op_sel_hi:[1,0]
v_pk_fma_f32 v[104:105], v[216:217], v[26:27], v[104:105] op_sel:[0,0,0] op_sel_hi:[1,0,1]
v_pk_fma_f32 v[106:107], v[218:219], v[26:27], v[106:107] op_sel:[0,0,0] op_sel_hi:[1,0,1]
v_pk_fma_f32 v[120:121], v[220:221], v[26:27], v[120:121] op_sel:[0,0,0] op_sel_hi:[1,0,1]
v_pk_fma_f32 v[122:123], v[222:223], v[26:27], v[122:123] op_sel:[0,0,0] op_sel_hi:[1,0,1]
v_pk_mul_f32 v[228:229], v[104:105], v[104:105]
v_pk_mul_f32 v[230:231], v[106:107], v[106:107]
v_pk_mul_f32 v[232:233], v[120:121], v[120:121]
v_pk_mul_f32 v[234:235], v[122:123], v[122:123]
v_pk_fma_f32 v[228:229], v[228:229], s[76:77], v[224:225]
v_pk_fma_f32 v[230:231], v[230:231], s[76:77], v[224:225]
v_pk_fma_f32 v[232:233], v[232:233], s[76:77], v[224:225]
v_pk_fma_f32 v[234:235], v[234:235], s[76:77], v[224:225]
v_pk_mul_f32 v[228:229], v[228:229], v[104:105]
v_pk_mul_f32 v[230:231], v[230:231], v[106:107]
v_pk_mul_f32 v[232:233], v[232:233], v[120:121]
v_pk_mul_f32 v[234:235], v[234:235], v[122:123]
v_exp_f32 v228, v228
v_exp_f32 v229, v229
v_exp_f32 v230, v230
v_exp_f32 v231, v231
v_exp_f32 v232, v232
v_exp_f32 v233, v233
v_exp_f32 v234, v234
v_exp_f32 v235, v235
v_pk_add_f32 v[228:229], v[228:229], 1.0 op_sel_hi:[1,0]
v_pk_add_f32 v[230:231], v[230:231], 1.0 op_sel_hi:[1,0]
v_pk_add_f32 v[232:233], v[232:233], 1.0 op_sel_hi:[1,0]
v_pk_add_f32 v[234:235], v[234:235], 1.0 op_sel_hi:[1,0]
v_rcp_f32 v228, v228
v_rcp_f32 v229, v229
v_rcp_f32 v230, v230
v_rcp_f32 v231, v231
v_rcp_f32 v232, v232
v_rcp_f32 v233, v233
v_rcp_f32 v234, v234
v_rcp_f32 v235, v235
v_pk_mul_f32 v[104:105], v[104:105], v[228:229]
v_pk_mul_f32 v[106:107], v[106:107], v[230:231]
v_pk_mul_f32 v[120:121], v[120:121], v[232:233]
v_pk_mul_f32 v[122:123], v[122:123], v[234:235]
v_cvt_pk_bf16_f32 v104, v104, v105
v_cvt_pk_bf16_f32 v105, v106, v107
v_cvt_pk_bf16_f32 v106, v120, v121
v_cvt_pk_bf16_f32 v107, v122, v123
ds_write_b128 v29, v[104:107] offset:2048
buffer_load_dwordx4 v[172:175], v1, s[44:47], s63 offen offset:3072 sc1
buffer_load_dwordx4 v[176:179], v1, s[44:47], s62 offen offset:0 sc1
buffer_load_dwordx4 v[180:183], v1, s[44:47], s62 offen offset:1024 sc1
v_pk_mul_f32 v[108:109], v[108:109], v[18:19] op_sel:[0,1] op_sel_hi:[1,1]
v_pk_mul_f32 v[110:111], v[110:111], v[18:19] op_sel:[0,1] op_sel_hi:[1,1]
v_pk_mul_f32 v[124:125], v[124:125], v[18:19] op_sel:[0,1] op_sel_hi:[1,1]
v_pk_mul_f32 v[126:127], v[126:127], v[18:19] op_sel:[0,1] op_sel_hi:[1,1]
v_pk_fma_f32 v[108:109], v[216:217], v[26:27], v[108:109] op_sel:[0,1,0] op_sel_hi:[1,1,1]
v_pk_fma_f32 v[110:111], v[218:219], v[26:27], v[110:111] op_sel:[0,1,0] op_sel_hi:[1,1,1]
v_pk_fma_f32 v[124:125], v[220:221], v[26:27], v[124:125] op_sel:[0,1,0] op_sel_hi:[1,1,1]
v_pk_fma_f32 v[126:127], v[222:223], v[26:27], v[126:127] op_sel:[0,1,0] op_sel_hi:[1,1,1]
v_pk_mul_f32 v[228:229], v[108:109], v[108:109]
v_pk_mul_f32 v[230:231], v[110:111], v[110:111]
v_pk_mul_f32 v[232:233], v[124:125], v[124:125]
v_pk_mul_f32 v[234:235], v[126:127], v[126:127]
v_pk_fma_f32 v[228:229], v[228:229], s[76:77], v[224:225]
v_pk_fma_f32 v[230:231], v[230:231], s[76:77], v[224:225]
v_pk_fma_f32 v[232:233], v[232:233], s[76:77], v[224:225]
v_pk_fma_f32 v[234:235], v[234:235], s[76:77], v[224:225]
v_pk_mul_f32 v[228:229], v[228:229], v[108:109]
v_pk_mul_f32 v[230:231], v[230:231], v[110:111]
v_pk_mul_f32 v[232:233], v[232:233], v[124:125]
v_pk_mul_f32 v[234:235], v[234:235], v[126:127]
v_exp_f32 v228, v228
v_exp_f32 v229, v229
v_exp_f32 v230, v230
v_exp_f32 v231, v231
v_exp_f32 v232, v232
v_exp_f32 v233, v233
v_exp_f32 v234, v234
v_exp_f32 v235, v235
v_pk_add_f32 v[228:229], v[228:229], 1.0 op_sel_hi:[1,0]
v_pk_add_f32 v[230:231], v[230:231], 1.0 op_sel_hi:[1,0]
v_pk_add_f32 v[232:233], v[232:233], 1.0 op_sel_hi:[1,0]
v_pk_add_f32 v[234:235], v[234:235], 1.0 op_sel_hi:[1,0]
v_rcp_f32 v228, v228
v_rcp_f32 v229, v229
v_rcp_f32 v230, v230
v_rcp_f32 v231, v231
v_rcp_f32 v232, v232
v_rcp_f32 v233, v233
v_rcp_f32 v234, v234
v_rcp_f32 v235, v235
v_pk_mul_f32 v[108:109], v[108:109], v[228:229]
v_pk_mul_f32 v[110:111], v[110:111], v[230:231]
v_pk_mul_f32 v[124:125], v[124:125], v[232:233]
v_pk_mul_f32 v[126:127], v[126:127], v[234:235]
v_cvt_pk_bf16_f32 v108, v108, v109
v_cvt_pk_bf16_f32 v109, v110, v111
v_cvt_pk_bf16_f32 v110, v124, v125
v_cvt_pk_bf16_f32 v111, v126, v127
ds_write_b128 v29, v[108:111] offset:3072
buffer_load_dwordx4 v[184:187], v1, s[44:47], s62 offen offset:2048 sc1
buffer_load_dwordx4 v[188:191], v1, s[44:47], s62 offen offset:3072 sc1
s_waitcnt lgkmcnt(0)
s_barrier
ds_read_b128 a[0:3], v1 offset:0
ds_read_b128 a[4:7], v1 offset:1024
ds_read_b128 a[8:11], v1 offset:2048
ds_read_b128 a[12:15], v1 offset:3072
s_waitcnt lgkmcnt(3)
v_mfma_f32_16x16x32_bf16 v[192:195], v[32:35], a[0:3], 0
ds_read_b64_tr_b16 v[48:49], v10 offset:12288
s_waitcnt lgkmcnt(3)
v_mfma_f32_16x16x32_bf16 v[196:199], v[32:35], a[4:7], 0
ds_read_b128 a[16:19], v1 offset:4096
ds_read_b128 a[20:23], v1 offset:5120
s_waitcnt lgkmcnt(4)
v_mfma_f32_16x16x32_bf16 v[200:203], v[32:35], a[8:11], 0
ds_read_b64_tr_b16 v[50:51], v10 offset:14336
s_waitcnt lgkmcnt(4)
v_mfma_f32_16x16x32_bf16 v[204:207], v[32:35], a[12:15], 0
ds_read_b128 a[24:27], v1 offset:6144
v_mfma_f32_16x16x32_bf16 v[208:211], v[36:39], a[0:3], 0
ds_read_b64_tr_b16 v[52:53], v11 offset:12288
v_mfma_f32_16x16x32_bf16 v[212:215], v[36:39], a[4:7], 0
ds_read_b128 a[28:31], v1 offset:7168
ds_read_b64_tr_b16 v[54:55], v11 offset:14336
v_mfma_f32_16x16x32_bf16 v[216:219], v[36:39], a[8:11], 0
v_mfma_f32_16x16x32_bf16 v[220:223], v[36:39], a[12:15], 0
s_waitcnt lgkmcnt(0)
v_mfma_f32_16x16x32_bf16 v[192:195], v[48:51], a[16:19], v[192:195]
ds_read_b64_tr_b16 v[32:33], v20 offset:0
v_mfma_f32_16x16x32_bf16 v[196:199], v[48:51], a[20:23], v[196:199]
ds_read_b128 a[32:35], v1 offset:8192
ds_read_b128 a[36:39], v1 offset:9216
v_mfma_f32_16x16x32_bf16 v[200:203], v[48:51], a[24:27], v[200:203]
ds_read_b64_tr_b16 v[34:35], v20 offset:2048
v_mfma_f32_16x16x32_bf16 v[204:207], v[48:51], a[28:31], v[204:207]
ds_read_b128 a[40:43], v1 offset:10240
v_mfma_f32_16x16x32_bf16 v[208:211], v[52:55], a[16:19], v[208:211]
ds_read_b64_tr_b16 v[36:37], v21 offset:0
v_mfma_f32_16x16x32_bf16 v[212:215], v[52:55], a[20:23], v[212:215]
ds_read_b128 a[44:47], v1 offset:11264
ds_read_b64_tr_b16 v[38:39], v21 offset:2048
v_mfma_f32_16x16x32_bf16 v[216:219], v[52:55], a[24:27], v[216:219]
v_mfma_f32_16x16x32_bf16 v[220:223], v[52:55], a[28:31], v[220:223]
s_waitcnt lgkmcnt(0)
v_mfma_f32_16x16x32_bf16 v[192:195], v[32:35], a[32:35], v[192:195]
ds_read_b64_tr_b16 v[48:49], v20 offset:4096
v_mfma_f32_16x16x32_bf16 v[196:199], v[32:35], a[36:39], v[196:199]
ds_read_b128 a[48:51], v1 offset:12288
ds_read_b128 a[52:55], v1 offset:13312
v_mfma_f32_16x16x32_bf16 v[200:203], v[32:35], a[40:43], v[200:203]
ds_read_b64_tr_b16 v[50:51], v20 offset:6144
v_mfma_f32_16x16x32_bf16 v[204:207], v[32:35], a[44:47], v[204:207]
ds_read_b128 a[56:59], v1 offset:14336
v_mfma_f32_16x16x32_bf16 v[208:211], v[36:39], a[32:35], v[208:211]
ds_read_b64_tr_b16 v[52:53], v21 offset:4096
v_mfma_f32_16x16x32_bf16 v[212:215], v[36:39], a[36:39], v[212:215]
ds_read_b128 a[60:63], v1 offset:15360
ds_read_b64_tr_b16 v[54:55], v21 offset:6144
v_mfma_f32_16x16x32_bf16 v[216:219], v[36:39], a[40:43], v[216:219]
v_mfma_f32_16x16x32_bf16 v[220:223], v[36:39], a[44:47], v[220:223]
s_waitcnt lgkmcnt(0)
v_mfma_f32_16x16x32_bf16 v[192:195], v[48:51], a[48:51], v[192:195]
ds_read_b64_tr_b16 v[32:33], v10 offset:0
v_mfma_f32_16x16x32_bf16 v[196:199], v[48:51], a[52:55], v[196:199]
ds_read_b128 a[64:67], v1 offset:16384
ds_read_b128 a[68:71], v1 offset:17408
v_mfma_f32_16x16x32_bf16 v[200:203], v[48:51], a[56:59], v[200:203]
ds_read_b64_tr_b16 v[34:35], v10 offset:2048
v_mfma_f32_16x16x32_bf16 v[204:207], v[48:51], a[60:63], v[204:207]
ds_read_b128 a[72:75], v1 offset:18432
v_mfma_f32_16x16x32_bf16 v[208:211], v[52:55], a[48:51], v[208:211]
ds_read_b64_tr_b16 v[36:37], v11 offset:0
v_mfma_f32_16x16x32_bf16 v[212:215], v[52:55], a[52:55], v[212:215]
ds_read_b128 a[76:79], v1 offset:19456
ds_read_b64_tr_b16 v[38:39], v11 offset:2048
v_mfma_f32_16x16x32_bf16 v[216:219], v[52:55], a[56:59], v[216:219]
v_mfma_f32_16x16x32_bf16 v[220:223], v[52:55], a[60:63], v[220:223]
s_waitcnt lgkmcnt(0)
v_mfma_f32_16x16x32_bf16 v[192:195], v[32:35], a[64:67], v[192:195]
s_waitcnt vmcnt(20)
ds_read_b64_tr_b16 v[48:49], v10 offset:4096
v_mfma_f32_16x16x32_bf16 v[196:199], v[32:35], a[68:71], v[196:199]
ds_read_b128 a[80:83], v1 offset:20480
ds_read_b128 a[84:87], v1 offset:21504
v_mfma_f32_16x16x32_bf16 v[200:203], v[32:35], a[72:75], v[200:203]
ds_read_b64_tr_b16 v[50:51], v10 offset:6144
v_mfma_f32_16x16x32_bf16 v[204:207], v[32:35], a[76:79], v[204:207]
ds_read_b128 a[88:91], v1 offset:22528
v_mfma_f32_16x16x32_bf16 v[208:211], v[36:39], a[64:67], v[208:211]
ds_read_b64_tr_b16 v[52:53], v11 offset:4096
v_mfma_f32_16x16x32_bf16 v[212:215], v[36:39], a[68:71], v[212:215]
ds_read_b128 a[92:95], v1 offset:23552
ds_read_b64_tr_b16 v[54:55], v11 offset:6144
v_mfma_f32_16x16x32_bf16 v[216:219], v[36:39], a[72:75], v[216:219]
v_mfma_f32_16x16x32_bf16 v[220:223], v[36:39], a[76:79], v[220:223]
s_waitcnt lgkmcnt(0)
v_mfma_f32_16x16x32_bf16 v[192:195], v[48:51], a[80:83], v[192:195]
s_waitcnt vmcnt(16)
ds_read_b64_tr_b16 v[32:33], v6 offset:0
v_mfma_f32_16x16x32_bf16 v[196:199], v[48:51], a[84:87], v[196:199]
ds_read_b128 a[96:99], v1 offset:24576
ds_read_b128 a[100:103], v1 offset:25600
v_mfma_f32_16x16x32_bf16 v[200:203], v[48:51], a[88:91], v[200:203]
ds_read_b64_tr_b16 v[34:35], v6 offset:2048
v_mfma_f32_16x16x32_bf16 v[204:207], v[48:51], a[92:95], v[204:207]
ds_read_b128 a[104:107], v1 offset:26624
v_mfma_f32_16x16x32_bf16 v[208:211], v[52:55], a[80:83], v[208:211]
ds_read_b64_tr_b16 v[36:37], v7 offset:0
v_mfma_f32_16x16x32_bf16 v[212:215], v[52:55], a[84:87], v[212:215]
ds_read_b128 a[108:111], v1 offset:27648
ds_read_b64_tr_b16 v[38:39], v7 offset:2048
v_mfma_f32_16x16x32_bf16 v[216:219], v[52:55], a[88:91], v[216:219]
v_mfma_f32_16x16x32_bf16 v[220:223], v[52:55], a[92:95], v[220:223]
s_waitcnt lgkmcnt(0)
v_mfma_f32_16x16x32_bf16 v[192:195], v[32:35], a[96:99], v[192:195]
ds_read_b64_tr_b16 v[56:57], v12 offset:8192
v_mfma_f32_16x16x32_bf16 v[196:199], v[32:35], a[100:103], v[196:199]
v_mfma_f32_16x16x32_bf16 v[200:203], v[32:35], a[104:107], v[200:203]
ds_read_b64_tr_b16 v[58:59], v12 offset:10240
v_mfma_f32_16x16x32_bf16 v[204:207], v[32:35], a[108:111], v[204:207]
v_mfma_f32_16x16x32_bf16 v[208:211], v[36:39], a[96:99], v[208:211]
ds_read_b64_tr_b16 v[60:61], v13 offset:8192
v_mfma_f32_16x16x32_bf16 v[212:215], v[36:39], a[100:103], v[212:215]
ds_read_b64_tr_b16 v[62:63], v13 offset:10240
v_mfma_f32_16x16x32_bf16 v[216:219], v[36:39], a[104:107], v[216:219]
v_mfma_f32_16x16x32_bf16 v[220:223], v[36:39], a[108:111], v[220:223]
s_waitcnt lgkmcnt(0)
v_mfma_f32_16x16x32_bf16 v[224:227], v[56:59], a[0:3], 0
ds_read_b64_tr_b16 v[40:41], v12 offset:12288
ds_read_b64_tr_b16 v[42:43], v12 offset:14336
s_add_u32 m0, s60, 8192
v_mfma_f32_16x16x32_bf16 v[228:231], v[56:59], a[4:7], 0
s_add_u32 s61, s69, 128
s_lshl_b32 s63, s58, 6
s_lshl_b32 s62, s56, 4
s_add_u32 s63, s63, s62
v_mfma_f32_16x16x32_bf16 v[232:235], v[56:59], a[8:11], 0
buffer_load_dwordx4 v2, s[36:39], s61 offen offset:0 lds
v_mfma_f32_16x16x32_bf16 v[236:239], v[56:59], a[12:15], 0
buffer_load_dwordx4 v3, s[36:39], s61 offen offset:1024 lds
s_lshl_b32 s63, s63, 3
v_mfma_f32_16x16x32_bf16 v[240:243], v[60:63], a[0:3], 0
buffer_load_dwordx4 v4, s[36:39], s61 offen offset:2048 lds
s_add_u32 s63, s63, s57
v_mfma_f32_16x16x32_bf16 v[244:247], v[60:63], a[4:7], 0
buffer_load_dwordx4 v5, s[36:39], s61 offen offset:3072 lds
v_mfma_f32_16x16x32_bf16 v[248:251], v[60:63], a[8:11], 0
ds_read_b64_tr_b16 v[44:45], v13 offset:12288
ds_read_b64_tr_b16 v[46:47], v13 offset:14336
s_lshl_b32 s63, s63, 10
s_add_u32 s81, s63, 8388608
v_mfma_f32_16x16x32_bf16 v[252:255], v[60:63], a[12:15], 0
v_cvt_pk_bf16_f32 v192, v192, v193
v_cvt_pk_bf16_f32 v193, v194, v195
v_cvt_pk_bf16_f32 v194, v208, v209
s_waitcnt lgkmcnt(0)
v_mfma_f32_16x16x32_bf16 v[224:227], v[40:43], a[16:19], v[224:227]
ds_read_b64_tr_b16 v[56:57], v22 offset:0
ds_read_b64_tr_b16 v[58:59], v22 offset:2048
s_add_u32 m0, s60, 12288
v_mfma_f32_16x16x32_bf16 v[228:231], v[40:43], a[20:23], v[228:231]
s_add_u32 s61, s69, 32896
v_cvt_pk_bf16_f32 v195, v210, v211
v_mfma_f32_16x16x32_bf16 v[232:235], v[40:43], a[24:27], v[232:235]
buffer_store_dwordx4 v[192:195], v1, s[44:47], s81 offen sc1
s_add_u32 s81, s81, 8192
v_mfma_f32_16x16x32_bf16 v[236:239], v[40:43], a[28:31], v[236:239]
buffer_load_dwordx4 v2, s[36:39], s61 offen offset:0 lds
v_cvt_pk_bf16_f32 v196, v196, v197
v_mfma_f32_16x16x32_bf16 v[240:243], v[44:47], a[16:19], v[240:243]
buffer_load_dwordx4 v3, s[36:39], s61 offen offset:1024 lds
v_cvt_pk_bf16_f32 v197, v198, v199
v_cvt_pk_bf16_f32 v198, v212, v213
v_mfma_f32_16x16x32_bf16 v[244:247], v[44:47], a[20:23], v[244:247]
buffer_load_dwordx4 v4, s[36:39], s61 offen offset:2048 lds
v_cvt_pk_bf16_f32 v199, v214, v215
v_mfma_f32_16x16x32_bf16 v[248:251], v[44:47], a[24:27], v[248:251]
buffer_store_dwordx4 v[196:199], v1, s[44:47], s81 offen sc1
s_add_u32 s81, s81, 8192
v_mfma_f32_16x16x32_bf16 v[252:255], v[44:47], a[28:31], v[252:255]
buffer_load_dwordx4 v5, s[36:39], s61 offen offset:3072 lds
ds_read_b64_tr_b16 v[60:61], v23 offset:0
ds_read_b64_tr_b16 v[62:63], v23 offset:2048
v_cvt_pk_bf16_f32 v200, v200, v201
s_waitcnt lgkmcnt(0)
v_mfma_f32_16x16x32_bf16 v[224:227], v[56:59], a[32:35], v[224:227]
ds_read_b64_tr_b16 v[40:41], v22 offset:4096
ds_read_b64_tr_b16 v[42:43], v22 offset:6144
s_add_u32 m0, s91, 0
v_mfma_f32_16x16x32_bf16 v[228:231], v[56:59], a[36:39], v[228:231]
s_add_u32 s61, s69, 65664
v_cvt_pk_bf16_f32 v201, v202, v203
v_cvt_pk_bf16_f32 v202, v216, v217
v_cvt_pk_bf16_f32 v203, v218, v219
v_mfma_f32_16x16x32_bf16 v[232:235], v[56:59], a[40:43], v[232:235]
buffer_store_dwordx4 v[200:203], v1, s[44:47], s81 offen sc1
s_add_u32 s81, s81, 8192
v_mfma_f32_16x16x32_bf16 v[236:239], v[56:59], a[44:47], v[236:239]
buffer_load_dwordx4 v2, s[36:39], s61 offen offset:0 lds
v_cvt_pk_bf16_f32 v204, v204, v205
v_mfma_f32_16x16x32_bf16 v[240:243], v[60:63], a[32:35], v[240:243]
buffer_load_dwordx4 v3, s[36:39], s61 offen offset:1024 lds
v_cvt_pk_bf16_f32 v205, v206, v207
v_cvt_pk_bf16_f32 v206, v220, v221
v_mfma_f32_16x16x32_bf16 v[244:247], v[60:63], a[36:39], v[244:247]
buffer_load_dwordx4 v4, s[36:39], s61 offen offset:2048 lds
v_cvt_pk_bf16_f32 v207, v222, v223
v_mfma_f32_16x16x32_bf16 v[248:251], v[60:63], a[40:43], v[248:251]
buffer_load_dwordx4 v5, s[36:39], s61 offen offset:3072 lds
v_mfma_f32_16x16x32_bf16 v[252:255], v[60:63], a[44:47], v[252:255]
buffer_store_dwordx4 v[204:207], v1, s[44:47], s81 offen sc1
ds_read_b64_tr_b16 v[44:45], v23 offset:4096
ds_read_b64_tr_b16 v[46:47], v23 offset:6144
s_waitcnt lgkmcnt(0)
v_mfma_f32_16x16x32_bf16 v[224:227], v[40:43], a[48:51], v[224:227]
ds_read_b64_tr_b16 v[56:57], v12 offset:0
v_mfma_f32_16x16x32_bf16 v[228:231], v[40:43], a[52:55], v[228:231]
ds_read_b64_tr_b16 v[58:59], v12 offset:2048
s_add_u32 m0, s91, 4096
s_add_u32 s61, s69, 98432
v_mfma_f32_16x16x32_bf16 v[232:235], v[40:43], a[56:59], v[232:235]
buffer_load_dwordx4 v2, s[36:39], s61 offen offset:0 lds
v_mfma_f32_16x16x32_bf16 v[236:239], v[40:43], a[60:63], v[236:239]
buffer_load_dwordx4 v3, s[36:39], s61 offen offset:1024 lds
v_mfma_f32_16x16x32_bf16 v[240:243], v[44:47], a[48:51], v[240:243]
buffer_load_dwordx4 v4, s[36:39], s61 offen offset:2048 lds
v_mfma_f32_16x16x32_bf16 v[244:247], v[44:47], a[52:55], v[244:247]
buffer_load_dwordx4 v5, s[36:39], s61 offen offset:3072 lds
v_mfma_f32_16x16x32_bf16 v[248:251], v[44:47], a[56:59], v[248:251]
ds_read_b64_tr_b16 v[60:61], v13 offset:0
v_mfma_f32_16x16x32_bf16 v[252:255], v[44:47], a[60:63], v[252:255]
ds_read_b64_tr_b16 v[62:63], v13 offset:2048
s_waitcnt lgkmcnt(0)
v_mfma_f32_16x16x32_bf16 v[224:227], v[56:59], a[64:67], v[224:227]
ds_read_b64_tr_b16 v[40:41], v12 offset:4096
v_mfma_f32_16x16x32_bf16 v[228:231], v[56:59], a[68:71], v[228:231]
ds_read_b64_tr_b16 v[42:43], v12 offset:6144
s_add_u32 m0, s60, 0
s_add_u32 s61, s69, 131200
v_mfma_f32_16x16x32_bf16 v[232:235], v[56:59], a[72:75], v[232:235]
buffer_load_dwordx4 v2, s[36:39], s61 offen offset:0 lds
v_mfma_f32_16x16x32_bf16 v[236:239], v[56:59], a[76:79], v[236:239]
buffer_load_dwordx4 v3, s[36:39], s61 offen offset:1024 lds
v_mfma_f32_16x16x32_bf16 v[240:243], v[60:63], a[64:67], v[240:243]
buffer_load_dwordx4 v4, s[36:39], s61 offen offset:2048 lds
v_mfma_f32_16x16x32_bf16 v[244:247], v[60:63], a[68:71], v[244:247]
buffer_load_dwordx4 v5, s[36:39], s61 offen offset:3072 lds
v_mfma_f32_16x16x32_bf16 v[248:251], v[60:63], a[72:75], v[248:251]
ds_read_b64_tr_b16 v[44:45], v13 offset:4096
v_mfma_f32_16x16x32_bf16 v[252:255], v[60:63], a[76:79], v[252:255]
ds_read_b64_tr_b16 v[46:47], v13 offset:6144
s_waitcnt lgkmcnt(0)
v_mfma_f32_16x16x32_bf16 v[224:227], v[40:43], a[80:83], v[224:227]
ds_read_b64_tr_b16 v[56:57], v8 offset:0
v_mfma_f32_16x16x32_bf16 v[228:231], v[40:43], a[84:87], v[228:231]
ds_read_b64_tr_b16 v[58:59], v8 offset:2048
s_add_u32 m0, s60, 4096
s_add_u32 s61, s69, 163968
v_mfma_f32_16x16x32_bf16 v[232:235], v[40:43], a[88:91], v[232:235]
buffer_load_dwordx4 v2, s[36:39], s61 offen offset:0 lds
v_mfma_f32_16x16x32_bf16 v[236:239], v[40:43], a[92:95], v[236:239]
buffer_load_dwordx4 v3, s[36:39], s61 offen offset:1024 lds
v_mfma_f32_16x16x32_bf16 v[240:243], v[44:47], a[80:83], v[240:243]
buffer_load_dwordx4 v4, s[36:39], s61 offen offset:2048 lds
v_mfma_f32_16x16x32_bf16 v[244:247], v[44:47], a[84:87], v[244:247]
buffer_load_dwordx4 v5, s[36:39], s61 offen offset:3072 lds
v_mfma_f32_16x16x32_bf16 v[248:251], v[44:47], a[88:91], v[248:251]
ds_read_b64_tr_b16 v[60:61], v9 offset:0
v_mfma_f32_16x16x32_bf16 v[252:255], v[44:47], a[92:95], v[252:255]
ds_read_b64_tr_b16 v[62:63], v9 offset:2048
s_waitcnt lgkmcnt(0)
v_mfma_f32_16x16x32_bf16 v[224:227], v[56:59], a[96:99], v[224:227]
s_waitcnt vmcnt(24)
ds_read_b64_tr_b16 v[32:33], v10 offset:8192
v_mfma_f32_16x16x32_bf16 v[228:231], v[56:59], a[100:103], v[228:231]
ds_read_b64_tr_b16 v[34:35], v10 offset:10240
s_add_u32 m0, s100, 0
s_add_u32 s61, s69, 196736
v_mfma_f32_16x16x32_bf16 v[232:235], v[56:59], a[104:107], v[232:235]
buffer_load_dwordx4 v2, s[36:39], s61 offen offset:0 lds
v_mfma_f32_16x16x32_bf16 v[236:239], v[56:59], a[108:111], v[236:239]
buffer_load_dwordx4 v3, s[36:39], s61 offen offset:1024 lds
v_mfma_f32_16x16x32_bf16 v[240:243], v[60:63], a[96:99], v[240:243]
buffer_load_dwordx4 v4, s[36:39], s61 offen offset:2048 lds
v_mfma_f32_16x16x32_bf16 v[244:247], v[60:63], a[100:103], v[244:247]
buffer_load_dwordx4 v5, s[36:39], s61 offen offset:3072 lds
v_mfma_f32_16x16x32_bf16 v[248:251], v[60:63], a[104:107], v[248:251]
ds_read_b64_tr_b16 v[36:37], v11 offset:8192
v_mfma_f32_16x16x32_bf16 v[252:255], v[60:63], a[108:111], v[252:255]
ds_read_b64_tr_b16 v[38:39], v11 offset:10240
s_waitcnt lgkmcnt(0)
v_mfma_f32_16x16x32_bf16 v[64:67], v[32:35], a[0:3], 0
s_waitcnt vmcnt(22)
ds_read_b64_tr_b16 v[48:49], v10 offset:12288
v_mfma_f32_16x16x32_bf16 v[68:71], v[32:35], a[4:7], 0
ds_read_b64_tr_b16 v[50:51], v10 offset:14336
ds_read_b64_tr_b16 v[52:53], v11 offset:12288
v_mfma_f32_16x16x32_bf16 v[72:75], v[32:35], a[8:11], 0
ds_read_b64_tr_b16 v[54:55], v11 offset:14336
s_lshl_b32 s63, s58, 6
v_mfma_f32_16x16x32_bf16 v[76:79], v[32:35], a[12:15], 0
s_lshl_b32 s62, s56, 4
s_add_u32 s63, s63, s62
v_mfma_f32_16x16x32_bf16 v[80:83], v[36:39], a[0:3], 0
s_lshl_b32 s63, s63, 3
s_add_u32 s63, s63, s57
v_mfma_f32_16x16x32_bf16 v[84:87], v[36:39], a[4:7], 0
s_lshl_b32 s63, s63, 10
s_add_u32 s81, s63, 8421376
v_mfma_f32_16x16x32_bf16 v[88:91], v[36:39], a[8:11], 0
v_cvt_pk_bf16_f32 v224, v224, v225
v_cvt_pk_bf16_f32 v225, v226, v227
v_mfma_f32_16x16x32_bf16 v[92:95], v[36:39], a[12:15], 0
v_cvt_pk_bf16_f32 v226, v240, v241
s_waitcnt lgkmcnt(0)
v_mfma_f32_16x16x32_bf16 v[64:67], v[48:51], a[16:19], v[64:67]
s_waitcnt vmcnt(17)
ds_read_b64_tr_b16 v[32:33], v20 offset:0
v_cvt_pk_bf16_f32 v227, v242, v243
v_mfma_f32_16x16x32_bf16 v[68:71], v[48:51], a[20:23], v[68:71]
buffer_store_dwordx4 v[224:227], v1, s[44:47], s81 offen sc1
v_mfma_f32_16x16x32_bf16 v[72:75], v[48:51], a[24:27], v[72:75]
ds_read_b64_tr_b16 v[34:35], v20 offset:2048
ds_read_b64_tr_b16 v[36:37], v21 offset:0
v_mfma_f32_16x16x32_bf16 v[76:79], v[48:51], a[28:31], v[76:79]
ds_read_b64_tr_b16 v[38:39], v21 offset:2048
s_add_u32 s81, s81, 8192
v_mfma_f32_16x16x32_bf16 v[80:83], v[52:55], a[16:19], v[80:83]
v_cvt_pk_bf16_f32 v228, v228, v229
v_cvt_pk_bf16_f32 v229, v230, v231
v_cvt_pk_bf16_f32 v230, v244, v245
v_mfma_f32_16x16x32_bf16 v[84:87], v[52:55], a[20:23], v[84:87]
v_cvt_pk_bf16_f32 v231, v246, v247
v_mfma_f32_16x16x32_bf16 v[88:91], v[52:55], a[24:27], v[88:91]
buffer_store_dwordx4 v[228:231], v1, s[44:47], s81 offen sc1
v_mfma_f32_16x16x32_bf16 v[92:95], v[52:55], a[28:31], v[92:95]
s_add_u32 s81, s81, 8192
v_cvt_pk_bf16_f32 v232, v232, v233
s_waitcnt lgkmcnt(0)
v_mfma_f32_16x16x32_bf16 v[64:67], v[32:35], a[32:35], v[64:67]
s_waitcnt vmcnt(14)
ds_read_b64_tr_b16 v[48:49], v20 offset:4096
v_cvt_pk_bf16_f32 v233, v234, v235
v_mfma_f32_16x16x32_bf16 v[68:71], v[32:35], a[36:39], v[68:71]
ds_read_b64_tr_b16 v[50:51], v20 offset:6144
ds_read_b64_tr_b16 v[52:53], v21 offset:4096
v_cvt_pk_bf16_f32 v234, v248, v249
v_mfma_f32_16x16x32_bf16 v[72:75], v[32:35], a[40:43], v[72:75]
ds_read_b64_tr_b16 v[54:55], v21 offset:6144
v_cvt_pk_bf16_f32 v235, v250, v251
v_mfma_f32_16x16x32_bf16 v[76:79], v[32:35], a[44:47], v[76:79]
buffer_store_dwordx4 v[232:235], v1, s[44:47], s81 offen sc1
v_mfma_f32_16x16x32_bf16 v[80:83], v[36:39], a[32:35], v[80:83]
s_add_u32 s81, s81, 8192
v_cvt_pk_bf16_f32 v236, v236, v237
v_mfma_f32_16x16x32_bf16 v[84:87], v[36:39], a[36:39], v[84:87]
v_cvt_pk_bf16_f32 v237, v238, v239
v_cvt_pk_bf16_f32 v238, v252, v253
v_mfma_f32_16x16x32_bf16 v[88:91], v[36:39], a[40:43], v[88:91]
v_cvt_pk_bf16_f32 v239, v254, v255
v_mfma_f32_16x16x32_bf16 v[92:95], v[36:39], a[44:47], v[92:95]
buffer_store_dwordx4 v[236:239], v1, s[44:47], s81 offen sc1
s_waitcnt lgkmcnt(0)
v_mfma_f32_16x16x32_bf16 v[64:67], v[48:51], a[48:51], v[64:67]
s_waitcnt vmcnt(12)
ds_read_b64_tr_b16 v[32:33], v10 offset:0
v_mfma_f32_16x16x32_bf16 v[68:71], v[48:51], a[52:55], v[68:71]
v_mfma_f32_16x16x32_bf16 v[72:75], v[48:51], a[56:59], v[72:75]
ds_read_b64_tr_b16 v[34:35], v10 offset:2048
v_mfma_f32_16x16x32_bf16 v[76:79], v[48:51], a[60:63], v[76:79]
v_mfma_f32_16x16x32_bf16 v[80:83], v[52:55], a[48:51], v[80:83]
ds_read_b64_tr_b16 v[36:37], v11 offset:0
v_mfma_f32_16x16x32_bf16 v[84:87], v[52:55], a[52:55], v[84:87]
ds_read_b64_tr_b16 v[38:39], v11 offset:2048
v_mfma_f32_16x16x32_bf16 v[88:91], v[52:55], a[56:59], v[88:91]
v_mfma_f32_16x16x32_bf16 v[92:95], v[52:55], a[60:63], v[92:95]
s_waitcnt lgkmcnt(0)
v_mfma_f32_16x16x32_bf16 v[64:67], v[32:35], a[64:67], v[64:67]
s_waitcnt vmcnt(8)
ds_read_b64_tr_b16 v[48:49], v10 offset:4096
v_mfma_f32_16x16x32_bf16 v[68:71], v[32:35], a[68:71], v[68:71]
v_mfma_f32_16x16x32_bf16 v[72:75], v[32:35], a[72:75], v[72:75]
ds_read_b64_tr_b16 v[50:51], v10 offset:6144
v_mfma_f32_16x16x32_bf16 v[76:79], v[32:35], a[76:79], v[76:79]
v_mfma_f32_16x16x32_bf16 v[80:83], v[36:39], a[64:67], v[80:83]
ds_read_b64_tr_b16 v[52:53], v11 offset:4096
v_mfma_f32_16x16x32_bf16 v[84:87], v[36:39], a[68:71], v[84:87]
ds_read_b64_tr_b16 v[54:55], v11 offset:6144
v_mfma_f32_16x16x32_bf16 v[88:91], v[36:39], a[72:75], v[88:91]
v_mfma_f32_16x16x32_bf16 v[92:95], v[36:39], a[76:79], v[92:95]
s_waitcnt lgkmcnt(0)
v_mfma_f32_16x16x32_bf16 v[64:67], v[48:51], a[80:83], v[64:67]
s_waitcnt vmcnt(4)
ds_read_b64_tr_b16 v[32:33], v6 offset:0
v_mfma_f32_16x16x32_bf16 v[68:71], v[48:51], a[84:87], v[68:71]
v_mfma_f32_16x16x32_bf16 v[72:75], v[48:51], a[88:91], v[72:75]
ds_read_b64_tr_b16 v[34:35], v6 offset:2048
v_mfma_f32_16x16x32_bf16 v[76:79], v[48:51], a[92:95], v[76:79]
v_mfma_f32_16x16x32_bf16 v[80:83], v[52:55], a[80:83], v[80:83]
ds_read_b64_tr_b16 v[36:37], v7 offset:0
v_mfma_f32_16x16x32_bf16 v[84:87], v[52:55], a[84:87], v[84:87]
ds_read_b64_tr_b16 v[38:39], v7 offset:2048
v_mfma_f32_16x16x32_bf16 v[88:91], v[52:55], a[88:91], v[88:91]
v_mfma_f32_16x16x32_bf16 v[92:95], v[52:55], a[92:95], v[92:95]
s_waitcnt lgkmcnt(0)
v_mfma_f32_16x16x32_bf16 v[64:67], v[32:35], a[96:99], v[64:67]
ds_read_b64_tr_b16 v[56:57], v12 offset:8192
v_mfma_f32_16x16x32_bf16 v[68:71], v[32:35], a[100:103], v[68:71]
v_mfma_f32_16x16x32_bf16 v[72:75], v[32:35], a[104:107], v[72:75]
ds_read_b64_tr_b16 v[58:59], v12 offset:10240
v_mfma_f32_16x16x32_bf16 v[76:79], v[32:35], a[108:111], v[76:79]
v_mfma_f32_16x16x32_bf16 v[80:83], v[36:39], a[96:99], v[80:83]
ds_read_b64_tr_b16 v[60:61], v13 offset:8192
v_mfma_f32_16x16x32_bf16 v[84:87], v[36:39], a[100:103], v[84:87]
ds_read_b64_tr_b16 v[62:63], v13 offset:10240
v_mfma_f32_16x16x32_bf16 v[88:91], v[36:39], a[104:107], v[88:91]
v_mfma_f32_16x16x32_bf16 v[92:95], v[36:39], a[108:111], v[92:95]
s_waitcnt lgkmcnt(0)
v_mfma_f32_16x16x32_bf16 v[96:99], v[56:59], a[0:3], 0
ds_read_b64_tr_b16 v[40:41], v12 offset:12288
v_mfma_f32_16x16x32_bf16 v[100:103], v[56:59], a[4:7], 0
ds_read_b64_tr_b16 v[42:43], v12 offset:14336
ds_read_b64_tr_b16 v[44:45], v13 offset:12288
v_mfma_f32_16x16x32_bf16 v[104:107], v[56:59], a[8:11], 0
ds_read_b64_tr_b16 v[46:47], v13 offset:14336
s_lshl_b32 s63, s58, 6
v_mfma_f32_16x16x32_bf16 v[108:111], v[56:59], a[12:15], 0
s_lshl_b32 s62, s56, 4
s_add_u32 s63, s63, s62
v_mfma_f32_16x16x32_bf16 v[112:115], v[60:63], a[0:3], 0
s_lshl_b32 s63, s63, 3
s_add_u32 s63, s63, s57
v_mfma_f32_16x16x32_bf16 v[116:119], v[60:63], a[4:7], 0
s_lshl_b32 s63, s63, 10
s_add_u32 s81, s63, 8454144
v_mfma_f32_16x16x32_bf16 v[120:123], v[60:63], a[8:11], 0
v_cvt_pk_bf16_f32 v64, v64, v65
v_cvt_pk_bf16_f32 v65, v66, v67
v_mfma_f32_16x16x32_bf16 v[124:127], v[60:63], a[12:15], 0
v_cvt_pk_bf16_f32 v66, v80, v81
s_waitcnt lgkmcnt(0)
v_mfma_f32_16x16x32_bf16 v[96:99], v[40:43], a[16:19], v[96:99]
ds_read_b64_tr_b16 v[56:57], v22 offset:0
v_cvt_pk_bf16_f32 v67, v82, v83
v_mfma_f32_16x16x32_bf16 v[100:103], v[40:43], a[20:23], v[100:103]
buffer_store_dwordx4 v[64:67], v1, s[44:47], s81 offen sc1
v_mfma_f32_16x16x32_bf16 v[104:107], v[40:43], a[24:27], v[104:107]
ds_read_b64_tr_b16 v[58:59], v22 offset:2048
ds_read_b64_tr_b16 v[60:61], v23 offset:0
v_mfma_f32_16x16x32_bf16 v[108:111], v[40:43], a[28:31], v[108:111]
ds_read_b64_tr_b16 v[62:63], v23 offset:2048
s_add_u32 s81, s81, 8192
v_mfma_f32_16x16x32_bf16 v[112:115], v[44:47], a[16:19], v[112:115]
v_cvt_pk_bf16_f32 v68, v68, v69
v_cvt_pk_bf16_f32 v69, v70, v71
v_cvt_pk_bf16_f32 v70, v84, v85
v_mfma_f32_16x16x32_bf16 v[116:119], v[44:47], a[20:23], v[116:119]
v_cvt_pk_bf16_f32 v71, v86, v87
v_mfma_f32_16x16x32_bf16 v[120:123], v[44:47], a[24:27], v[120:123]
buffer_store_dwordx4 v[68:71], v1, s[44:47], s81 offen sc1
v_mfma_f32_16x16x32_bf16 v[124:127], v[44:47], a[28:31], v[124:127]
s_add_u32 s81, s81, 8192
v_cvt_pk_bf16_f32 v72, v72, v73
s_waitcnt lgkmcnt(0)
v_mfma_f32_16x16x32_bf16 v[96:99], v[56:59], a[32:35], v[96:99]
ds_read_b64_tr_b16 v[40:41], v22 offset:4096
v_cvt_pk_bf16_f32 v73, v74, v75
v_mfma_f32_16x16x32_bf16 v[100:103], v[56:59], a[36:39], v[100:103]
ds_read_b64_tr_b16 v[42:43], v22 offset:6144
ds_read_b64_tr_b16 v[44:45], v23 offset:4096
v_cvt_pk_bf16_f32 v74, v88, v89
v_mfma_f32_16x16x32_bf16 v[104:107], v[56:59], a[40:43], v[104:107]
ds_read_b64_tr_b16 v[46:47], v23 offset:6144
v_cvt_pk_bf16_f32 v75, v90, v91
v_mfma_f32_16x16x32_bf16 v[108:111], v[56:59], a[44:47], v[108:111]
buffer_store_dwordx4 v[72:75], v1, s[44:47], s81 offen sc1
v_mfma_f32_16x16x32_bf16 v[112:115], v[60:63], a[32:35], v[112:115]
s_add_u32 s81, s81, 8192
v_cvt_pk_bf16_f32 v76, v76, v77
v_mfma_f32_16x16x32_bf16 v[116:119], v[60:63], a[36:39], v[116:119]
v_cvt_pk_bf16_f32 v77, v78, v79
v_cvt_pk_bf16_f32 v78, v92, v93
v_mfma_f32_16x16x32_bf16 v[120:123], v[60:63], a[40:43], v[120:123]
v_cvt_pk_bf16_f32 v79, v94, v95
v_mfma_f32_16x16x32_bf16 v[124:127], v[60:63], a[44:47], v[124:127]
buffer_store_dwordx4 v[76:79], v1, s[44:47], s81 offen sc1
s_waitcnt lgkmcnt(0)
v_mfma_f32_16x16x32_bf16 v[96:99], v[40:43], a[48:51], v[96:99]
ds_read_b64_tr_b16 v[56:57], v12 offset:0
ds_read_b64_tr_b16 v[58:59], v12 offset:2048
ds_read_b64_tr_b16 v[60:61], v13 offset:0
v_mfma_f32_16x16x32_bf16 v[100:103], v[40:43], a[52:55], v[100:103]
ds_read_b64_tr_b16 v[62:63], v13 offset:2048
v_and_b32 v16, 7, v0
v_lshlrev_b32 v16, 7, v16
s_lshr_b32 s63, s57, 1
v_mfma_f32_16x16x32_bf16 v[104:107], v[40:43], a[56:59], v[104:107]
s_lshl_b32 s63, s63, 2
v_add_u32 v16, s63, v16
v_and_b32 v26, 15, v0
v_lshlrev_b32 v26, 10, v26
v_mfma_f32_16x16x32_bf16 v[108:111], v[40:43], a[60:63], v[108:111]
v_lshrrev_b32 v27, 4, v0
s_and_b32 s63, s84, 3
s_lshl_b32 s63, s63, 14
s_and_b32 s62, s84, 60
v_mfma_f32_16x16x32_bf16 v[112:115], v[44:47], a[48:51], v[112:115]
s_lshl_b32 s62, s62, 4
s_add_u32 s63, s63, s62
v_add_u32 v28, s63, v26
v_lshl_add_u32 v17, v27, 3, v28
v_mfma_f32_16x16x32_bf16 v[116:119], v[44:47], a[52:55], v[116:119]
v_lshl_add_u32 v19, v27, 4, v28
s_and_b32 s63, s85, 3
s_lshl_b32 s63, s63, 14
s_and_b32 s62, s85, 60
v_mfma_f32_16x16x32_bf16 v[120:123], v[44:47], a[56:59], v[120:123]
s_lshl_b32 s62, s62, 4
s_add_u32 s63, s63, s62
v_add_u32 v28, s63, v26
v_lshl_add_u32 v18, v27, 3, v28
v_lshl_add_u32 v24, v27, 4, v28
v_mfma_f32_16x16x32_bf16 v[124:127], v[44:47], a[60:63], v[124:127]
s_lshr_b32 s93, s56, 1
s_mul_i32 s93, s93, 32768
s_add_u32 s93, s93, s90
s_add_u32 s93, s93, 131072
s_waitcnt lgkmcnt(0)
v_mfma_f32_16x16x32_bf16 v[96:99], v[56:59], a[64:67], v[96:99]
ds_read_b64_tr_b16 v[40:41], v12 offset:4096
ds_read_b64_tr_b16 v[42:43], v12 offset:6144
v_mfma_f32_16x16x32_bf16 v[100:103], v[56:59], a[68:71], v[100:103]
ds_read_b64_tr_b16 v[44:45], v13 offset:4096
ds_read_b64_tr_b16 v[46:47], v13 offset:6144
s_lshl_b32 s63, s84, 10
v_mfma_f32_16x16x32_bf16 v[104:107], v[56:59], a[72:75], v[104:107]
s_add_u32 s63, s63, 3145728
v_mfma_f32_16x16x32_bf16 v[108:111], v[56:59], a[76:79], v[108:111]
buffer_load_dwordx4 v[232:235], v1, s[44:47], s63 offen sc1
v_mfma_f32_16x16x32_bf16 v[112:115], v[60:63], a[64:67], v[112:115]
buffer_load_dwordx2 v[224:225], v17, s[4:7], 0 offen
v_mfma_f32_16x16x32_bf16 v[116:119], v[60:63], a[68:71], v[116:119]
buffer_load_dwordx2 v[226:227], v17, s[4:7], 0 offen offset:32
s_lshl_b32 s63, s85, 10
s_add_u32 s63, s63, 3145728
v_mfma_f32_16x16x32_bf16 v[120:123], v[60:63], a[72:75], v[120:123]
buffer_load_dwordx4 v[236:239], v1, s[44:47], s63 offen sc1
v_mfma_f32_16x16x32_bf16 v[124:127], v[60:63], a[76:79], v[124:127]
buffer_load_dwordx2 v[228:229], v18, s[4:7], 0 offen
buffer_load_dwordx2 v[230:231], v18, s[4:7], 0 offen offset:32
s_waitcnt lgkmcnt(0)
v_mfma_f32_16x16x32_bf16 v[96:99], v[40:43], a[80:83], v[96:99]
ds_read_b64_tr_b16 v[56:57], v8 offset:0
v_mfma_f32_16x16x32_bf16 v[100:103], v[40:43], a[84:87], v[100:103]
ds_read_b64_tr_b16 v[58:59], v8 offset:2048
ds_read_b64_tr_b16 v[60:61], v9 offset:0
v_mfma_f32_16x16x32_bf16 v[104:107], v[40:43], a[88:91], v[104:107]
ds_read_b64_tr_b16 v[62:63], v9 offset:2048
s_mul_i32 s63, s57, 128
v_mfma_f32_16x16x32_bf16 v[108:111], v[40:43], a[92:95], v[108:111]
s_lshl_b32 s62, s56, 2
s_add_u32 s63, s63, s62
v_mfma_f32_16x16x32_bf16 v[112:115], v[44:47], a[80:83], v[112:115]
s_add_u32 s63, s63, s90
s_add_u32 s63, s63, 98304
v_mfma_f32_16x16x32_bf16 v[116:119], v[44:47], a[84:87], v[116:119]
s_waitcnt vmcnt(10)
buffer_store_dword v14, v15, s[44:47], s63 offen sc1
v_mfma_f32_16x16x32_bf16 v[120:123], v[44:47], a[88:91], v[120:123]
v_mfma_f32_16x16x32_bf16 v[124:127], v[44:47], a[92:95], v[124:127]
s_waitcnt lgkmcnt(0)
v_mfma_f32_16x16x32_bf16 v[96:99], v[56:59], a[96:99], v[96:99]
v_mfma_f32_16x16x32_bf16 v[100:103], v[56:59], a[100:103], v[100:103]
v_mfma_f32_16x16x32_bf16 v[104:107], v[56:59], a[104:107], v[104:107]
v_mfma_f32_16x16x32_bf16 v[108:111], v[56:59], a[108:111], v[108:111]
v_mfma_f32_16x16x32_bf16 v[112:115], v[60:63], a[96:99], v[112:115]
v_mfma_f32_16x16x32_bf16 v[116:119], v[60:63], a[100:103], v[116:119]
v_mfma_f32_16x16x32_bf16 v[120:123], v[60:63], a[104:107], v[120:123]
v_mfma_f32_16x16x32_bf16 v[124:127], v[60:63], a[108:111], v[124:127]
s_lshl_b32 s63, s58, 6
s_lshl_b32 s62, s56, 4
s_add_u32 s63, s63, s62
s_lshl_b32 s63, s63, 3
s_add_u32 s63, s63, s57
s_lshl_b32 s63, s63, 10
s_add_u32 s81, s63, 8486912
v_cvt_pk_bf16_f32 v96, v96, v97
v_cvt_pk_bf16_f32 v97, v98, v99
v_cvt_pk_bf16_f32 v98, v112, v113
v_cvt_pk_bf16_f32 v99, v114, v115
buffer_store_dwordx4 v[96:99], v1, s[44:47], s81 offen sc1
s_add_u32 s81, s81, 8192
v_cvt_pk_bf16_f32 v100, v100, v101
v_cvt_pk_bf16_f32 v101, v102, v103
v_cvt_pk_bf16_f32 v102, v116, v117
v_cvt_pk_bf16_f32 v103, v118, v119
buffer_store_dwordx4 v[100:103], v1, s[44:47], s81 offen sc1
s_add_u32 s81, s81, 8192
v_cvt_pk_bf16_f32 v104, v104, v105
v_cvt_pk_bf16_f32 v105, v106, v107
v_cvt_pk_bf16_f32 v106, v120, v121
v_cvt_pk_bf16_f32 v107, v122, v123
buffer_store_dwordx4 v[104:107], v1, s[44:47], s81 offen sc1
s_add_u32 s81, s81, 8192
v_cvt_pk_bf16_f32 v108, v108, v109
v_cvt_pk_bf16_f32 v109, v110, v111
v_cvt_pk_bf16_f32 v110, v124, v125
v_cvt_pk_bf16_f32 v111, v126, v127
buffer_store_dwordx4 v[108:111], v1, s[44:47], s81 offen sc1
v_dot2_f32_bf16 v192, v128, s73, 0
v_dot2_f32_bf16 v193, v128, s74, 0
v_dot2_f32_bf16 v194, v129, s73, 0
v_dot2_f32_bf16 v195, v129, s74, 0
v_dot2_f32_bf16 v196, v130, s73, 0
v_dot2_f32_bf16 v197, v130, s74, 0
v_dot2_f32_bf16 v198, v131, s73, 0
v_dot2_f32_bf16 v199, v131, s74, 0
v_dot2_f32_bf16 v192, v132, s73, v192
v_dot2_f32_bf16 v193, v132, s74, v193
v_dot2_f32_bf16 v194, v133, s73, v194
v_dot2_f32_bf16 v195, v133, s74, v195
v_dot2_f32_bf16 v196, v134, s73, v196
v_dot2_f32_bf16 v197, v134, s74, v197
v_dot2_f32_bf16 v198, v135, s73, v198
v_dot2_f32_bf16 v199, v135, s74, v199
v_dot2_f32_bf16 v192, v136, s73, v192
v_dot2_f32_bf16 v193, v136, s74, v193
v_dot2_f32_bf16 v194, v137, s73, v194
v_dot2_f32_bf16 v195, v137, s74, v195
v_dot2_f32_bf16 v196, v138, s73, v196
v_dot2_f32_bf16 v197, v138, s74, v197
v_dot2_f32_bf16 v198, v139, s73, v198
v_dot2_f32_bf16 v199, v139, s74, v199
v_dot2_f32_bf16 v192, v140, s73, v192
v_dot2_f32_bf16 v193, v140, s74, v193
v_dot2_f32_bf16 v194, v141, s73, v194
v_dot2_f32_bf16 v195, v141, s74, v195
v_dot2_f32_bf16 v196, v142, s73, v196
v_dot2_f32_bf16 v197, v142, s74, v197
v_dot2_f32_bf16 v198, v143, s73, v198
v_dot2_f32_bf16 v199, v143, s74, v199
v_dot2_f32_bf16 v192, v144, s73, v192
v_dot2_f32_bf16 v193, v144, s74, v193
v_dot2_f32_bf16 v194, v145, s73, v194
v_dot2_f32_bf16 v195, v145, s74, v195
v_dot2_f32_bf16 v196, v146, s73, v196
v_dot2_f32_bf16 v197, v146, s74, v197
v_dot2_f32_bf16 v198, v147, s73, v198
v_dot2_f32_bf16 v199, v147, s74, v199
v_dot2_f32_bf16 v192, v148, s73, v192
v_dot2_f32_bf16 v193, v148, s74, v193
v_dot2_f32_bf16 v194, v149, s73, v194
v_dot2_f32_bf16 v195, v149, s74, v195
v_dot2_f32_bf16 v196, v150, s73, v196
v_dot2_f32_bf16 v197, v150, s74, v197
v_dot2_f32_bf16 v198, v151, s73, v198
v_dot2_f32_bf16 v199, v151, s74, v199
v_dot2_f32_bf16 v192, v152, s73, v192
v_dot2_f32_bf16 v193, v152, s74, v193
v_dot2_f32_bf16 v194, v153, s73, v194
v_dot2_f32_bf16 v195, v153, s74, v195
v_dot2_f32_bf16 v196, v154, s73, v196
v_dot2_f32_bf16 v197, v154, s74, v197
v_dot2_f32_bf16 v198, v155, s73, v198
v_dot2_f32_bf16 v199, v155, s74, v199
v_dot2_f32_bf16 v192, v156, s73, v192
v_dot2_f32_bf16 v193, v156, s74, v193
v_dot2_f32_bf16 v194, v157, s73, v194
v_dot2_f32_bf16 v195, v157, s74, v195
v_dot2_f32_bf16 v196, v158, s73, v196
v_dot2_f32_bf16 v197, v158, s74, v197
v_dot2_f32_bf16 v198, v159, s73, v198
v_dot2_f32_bf16 v199, v159, s74, v199
s_mul_i32 s63, s57, 128
s_lshl_b32 s62, s56, 2
s_add_u32 s63, s63, s62
s_add_u32 s63, s63, s90
s_add_u32 s63, s63, 131072
s_waitcnt vmcnt(11)
buffer_store_dword v14, v15, s[44:47], s63 offen sc1
s_mul_i32 s63, s57, 128
s_lshl_b32 s62, s56, 2
s_add_u32 s63, s63, s62
s_add_u32 s63, s63, s90
s_add_u32 s63, s63, 163840
s_waitcnt vmcnt(1)
buffer_store_dword v14, v15, s[44:47], s63 offen sc1
s_add_u32 s63, s90, 98304
buffer_load_dword v31, v16, s[44:47], s63 offen sc1
v_dot2_f32_bf16 v200, v160, s73, 0
v_dot2_f32_bf16 v201, v160, s74, 0
v_dot2_f32_bf16 v202, v161, s73, 0
v_dot2_f32_bf16 v203, v161, s74, 0
v_dot2_f32_bf16 v204, v162, s73, 0
v_dot2_f32_bf16 v205, v162, s74, 0
v_dot2_f32_bf16 v206, v163, s73, 0
v_dot2_f32_bf16 v207, v163, s74, 0
v_dot2_f32_bf16 v200, v164, s73, v200
v_dot2_f32_bf16 v201, v164, s74, v201
v_dot2_f32_bf16 v202, v165, s73, v202
v_dot2_f32_bf16 v203, v165, s74, v203
v_dot2_f32_bf16 v204, v166, s73, v204
v_dot2_f32_bf16 v205, v166, s74, v205
v_dot2_f32_bf16 v206, v167, s73, v206
v_dot2_f32_bf16 v207, v167, s74, v207
v_dot2_f32_bf16 v200, v168, s73, v200
v_dot2_f32_bf16 v201, v168, s74, v201
v_dot2_f32_bf16 v202, v169, s73, v202
v_dot2_f32_bf16 v203, v169, s74, v203
v_dot2_f32_bf16 v204, v170, s73, v204
v_dot2_f32_bf16 v205, v170, s74, v205
v_dot2_f32_bf16 v206, v171, s73, v206
v_dot2_f32_bf16 v207, v171, s74, v207
v_dot2_f32_bf16 v200, v172, s73, v200
v_dot2_f32_bf16 v201, v172, s74, v201
v_dot2_f32_bf16 v202, v173, s73, v202
v_dot2_f32_bf16 v203, v173, s74, v203
v_dot2_f32_bf16 v204, v174, s73, v204
v_dot2_f32_bf16 v205, v174, s74, v205
v_dot2_f32_bf16 v206, v175, s73, v206
v_dot2_f32_bf16 v207, v175, s74, v207
v_dot2_f32_bf16 v200, v176, s73, v200
v_dot2_f32_bf16 v201, v176, s74, v201
v_dot2_f32_bf16 v202, v177, s73, v202
v_dot2_f32_bf16 v203, v177, s74, v203
v_dot2_f32_bf16 v204, v178, s73, v204
v_dot2_f32_bf16 v205, v178, s74, v205
v_dot2_f32_bf16 v206, v179, s73, v206
v_dot2_f32_bf16 v207, v179, s74, v207
v_dot2_f32_bf16 v200, v180, s73, v200
v_dot2_f32_bf16 v201, v180, s74, v201
v_dot2_f32_bf16 v202, v181, s73, v202
v_dot2_f32_bf16 v203, v181, s74, v203
v_dot2_f32_bf16 v204, v182, s73, v204
v_dot2_f32_bf16 v205, v182, s74, v205
v_dot2_f32_bf16 v206, v183, s73, v206
v_dot2_f32_bf16 v207, v183, s74, v207
v_dot2_f32_bf16 v200, v184, s73, v200
v_dot2_f32_bf16 v201, v184, s74, v201
v_dot2_f32_bf16 v202, v185, s73, v202
v_dot2_f32_bf16 v203, v185, s74, v203
v_dot2_f32_bf16 v204, v186, s73, v204
v_dot2_f32_bf16 v205, v186, s74, v205
v_dot2_f32_bf16 v206, v187, s73, v206
v_dot2_f32_bf16 v207, v187, s74, v207
v_dot2_f32_bf16 v200, v188, s73, v200
v_dot2_f32_bf16 v201, v188, s74, v201
v_dot2_f32_bf16 v202, v189, s73, v202
v_dot2_f32_bf16 v203, v189, s74, v203
v_dot2_f32_bf16 v204, v190, s73, v204
v_dot2_f32_bf16 v205, v190, s74, v205
v_dot2_f32_bf16 v206, v191, s73, v206
v_dot2_f32_bf16 v207, v191, s74, v207
v_lshlrev_b32 v208, 16, v232
v_and_b32 v209, 0xffff0000, v232
v_lshlrev_b32 v64, 16, v224
v_and_b32 v65, 0xffff0000, v224
v_lshlrev_b32 v210, 16, v233
v_and_b32 v211, 0xffff0000, v233
v_lshlrev_b32 v66, 16, v225
v_and_b32 v67, 0xffff0000, v225
v_lshlrev_b32 v212, 16, v234
v_and_b32 v213, 0xffff0000, v234
v_lshlrev_b32 v68, 16, v226
v_and_b32 v69, 0xffff0000, v226
v_lshlrev_b32 v214, 16, v235
v_and_b32 v215, 0xffff0000, v235
v_lshlrev_b32 v70, 16, v227
v_and_b32 v71, 0xffff0000, v227
v_lshlrev_b32 v216, 16, v236
v_and_b32 v217, 0xffff0000, v236
v_lshlrev_b32 v72, 16, v228
v_and_b32 v73, 0xffff0000, v228
v_lshlrev_b32 v218, 16, v237
v_and_b32 v219, 0xffff0000, v237
v_lshlrev_b32 v74, 16, v229
v_and_b32 v75, 0xffff0000, v229
v_lshlrev_b32 v220, 16, v238
v_and_b32 v221, 0xffff0000, v238
v_lshlrev_b32 v76, 16, v230
v_and_b32 v77, 0xffff0000, v230
v_lshlrev_b32 v222, 16, v239
v_and_b32 v223, 0xffff0000, v239
v_lshlrev_b32 v78, 16, v231
v_and_b32 v79, 0xffff0000, v231
s_waitcnt vmcnt(0)
v_cmp_ne_u32 vcc, v31, v14
s_nop 3
s_cbranch_vccnz L_spin12
L_back11:
buffer_load_dword v20, v16, s[44:47], s93 offen sc1
s_lshl_b32 s63, s84, 13
s_add_u32 s63, s63, 8388608
s_add_u32 s62, s63, 4096
buffer_load_dwordx4 v[128:131], v1, s[44:47], s63 offen offset:0 sc1
buffer_load_dwordx4 v[132:135], v1, s[44:47], s63 offen offset:1024 sc1
buffer_load_dwordx4 v[136:139], v1, s[44:47], s63 offen offset:2048 sc1
buffer_load_dwordx4 v[140:143], v1, s[44:47], s63 offen offset:3072 sc1
buffer_load_dwordx4 v[144:147], v1, s[44:47], s62 offen offset:0 sc1
buffer_load_dwordx4 v[148:151], v1, s[44:47], s62 offen offset:1024 sc1
buffer_load_dwordx4 v[152:155], v1, s[44:47], s62 offen offset:2048 sc1
buffer_load_dwordx4 v[156:159], v1, s[44:47], s62 offen offset:3072 sc1
s_waitcnt vmcnt(8)
v_cmp_ne_u32 vcc, v20, v14
s_nop 3
s_cbranch_vccnz L_spin10
L_back9:
s_lshl_b32 s63, s85, 13
s_add_u32 s63, s63, 8388608
s_add_u32 s62, s63, 4096
buffer_load_dwordx4 v[160:163], v1, s[44:47], s63 offen offset:0 sc1
buffer_load_dwordx4 v[164:167], v1, s[44:47], s63 offen offset:1024 sc1
buffer_load_dwordx4 v[168:171], v1, s[44:47], s63 offen offset:2048 sc1
buffer_load_dwordx4 v[172:175], v1, s[44:47], s63 offen offset:3072 sc1
buffer_load_dwordx4 v[176:179], v1, s[44:47], s62 offen offset:0 sc1
buffer_load_dwordx4 v[180:183], v1, s[44:47], s62 offen offset:1024 sc1
buffer_load_dwordx4 v[184:187], v1, s[44:47], s62 offen offset:2048 sc1
buffer_load_dwordx4 v[188:191], v1, s[44:47], s62 offen offset:3072 sc1
s_waitcnt vmcnt(15)
v_dot2_f32_bf16 v208, v128, s73, v208
v_dot2_f32_bf16 v209, v128, s74, v209
v_dot2_f32_bf16 v210, v129, s73, v210
v_dot2_f32_bf16 v211, v129, s74, v211
v_dot2_f32_bf16 v212, v130, s73, v212
v_dot2_f32_bf16 v213, v130, s74, v213
v_dot2_f32_bf16 v214, v131, s73, v214
v_dot2_f32_bf16 v215, v131, s74, v215
s_waitcnt vmcnt(14)
v_dot2_f32_bf16 v208, v132, s73, v208
v_dot2_f32_bf16 v209, v132, s74, v209
v_dot2_f32_bf16 v210, v133, s73, v210
v_dot2_f32_bf16 v211, v133, s74, v211
v_dot2_f32_bf16 v212, v134, s73, v212
v_dot2_f32_bf16 v213, v134, s74, v213
v_dot2_f32_bf16 v214, v135, s73, v214
v_dot2_f32_bf16 v215, v135, s74, v215
s_waitcnt vmcnt(13)
v_dot2_f32_bf16 v208, v136, s73, v208
v_dot2_f32_bf16 v209, v136, s74, v209
v_dot2_f32_bf16 v210, v137, s73, v210
v_dot2_f32_bf16 v211, v137, s74, v211
v_dot2_f32_bf16 v212, v138, s73, v212
v_dot2_f32_bf16 v213, v138, s74, v213
v_dot2_f32_bf16 v214, v139, s73, v214
v_dot2_f32_bf16 v215, v139, s74, v215
s_waitcnt vmcnt(12)
v_dot2_f32_bf16 v208, v140, s73, v208
v_dot2_f32_bf16 v209, v140, s74, v209
v_dot2_f32_bf16 v210, v141, s73, v210
v_dot2_f32_bf16 v211, v141, s74, v211
v_dot2_f32_bf16 v212, v142, s73, v212
v_dot2_f32_bf16 v213, v142, s74, v213
v_dot2_f32_bf16 v214, v143, s73, v214
v_dot2_f32_bf16 v215, v143, s74, v215
s_waitcnt vmcnt(11)
v_dot2_f32_bf16 v208, v144, s73, v208
v_dot2_f32_bf16 v209, v144, s74, v209
v_dot2_f32_bf16 v210, v145, s73, v210
v_dot2_f32_bf16 v211, v145, s74, v211
v_dot2_f32_bf16 v212, v146, s73, v212
v_dot2_f32_bf16 v213, v146, s74, v213
v_dot2_f32_bf16 v214, v147, s73, v214
v_dot2_f32_bf16 v215, v147, s74, v215
s_waitcnt vmcnt(10)
v_dot2_f32_bf16 v208, v148, s73, v208
v_dot2_f32_bf16 v209, v148, s74, v209
v_dot2_f32_bf16 v210, v149, s73, v210
v_dot2_f32_bf16 v211, v149, s74, v211
v_dot2_f32_bf16 v212, v150, s73, v212
v_dot2_f32_bf16 v213, v150, s74, v213
v_dot2_f32_bf16 v214, v151, s73, v214
v_dot2_f32_bf16 v215, v151, s74, v215
s_waitcnt vmcnt(9)
v_dot2_f32_bf16 v208, v152, s73, v208
v_dot2_f32_bf16 v209, v152, s74, v209
v_dot2_f32_bf16 v210, v153, s73, v210
v_dot2_f32_bf16 v211, v153, s74, v211
v_dot2_f32_bf16 v212, v154, s73, v212
v_dot2_f32_bf16 v213, v154, s74, v213
v_dot2_f32_bf16 v214, v155, s73, v214
v_dot2_f32_bf16 v215, v155, s74, v215
s_waitcnt vmcnt(8)
v_dot2_f32_bf16 v208, v156, s73, v208
v_dot2_f32_bf16 v209, v156, s74, v209
v_dot2_f32_bf16 v210, v157, s73, v210
v_dot2_f32_bf16 v211, v157, s74, v211
v_dot2_f32_bf16 v212, v158, s73, v212
v_dot2_f32_bf16 v213, v158, s74, v213
v_dot2_f32_bf16 v214, v159, s73, v214
v_dot2_f32_bf16 v215, v159, s74, v215
v_mul_f32 v240, 0xbfb8aa3b, v208
v_mul_f32 v241, 0xbfb8aa3b, v209
v_mul_f32 v242, 0xbfb8aa3b, v210
v_mul_f32 v243, 0xbfb8aa3b, v211
v_mul_f32 v244, 0xbfb8aa3b, v212
v_mul_f32 v245, 0xbfb8aa3b, v213
v_mul_f32 v246, 0xbfb8aa3b, v214
v_mul_f32 v247, 0xbfb8aa3b, v215
v_exp_f32 v240, v240
v_exp_f32 v241, v241
v_exp_f32 v242, v242
v_exp_f32 v243, v243
v_exp_f32 v244, v244
v_exp_f32 v245, v245
v_exp_f32 v246, v246
v_exp_f32 v247, v247
v_pk_add_f32 v[240:241], v[240:241], 1.0 op_sel_hi:[1,0]
v_pk_add_f32 v[242:243], v[242:243], 1.0 op_sel_hi:[1,0]
v_pk_add_f32 v[244:245], v[244:245], 1.0 op_sel_hi:[1,0]
v_pk_add_f32 v[246:247], v[246:247], 1.0 op_sel_hi:[1,0]
v_rcp_f32 v240, v240
v_rcp_f32 v241, v241
v_rcp_f32 v242, v242
v_rcp_f32 v243, v243
v_rcp_f32 v244, v244
v_rcp_f32 v245, v245
v_rcp_f32 v246, v246
v_rcp_f32 v247, v247
v_pk_mul_f32 v[208:209], v[208:209], v[240:241]
v_pk_mul_f32 v[210:211], v[210:211], v[242:243]
v_pk_mul_f32 v[212:213], v[212:213], v[244:245]
v_pk_mul_f32 v[214:215], v[214:215], v[246:247]
v_pk_fma_f32 v[208:209], v[208:209], v[192:193], v[64:65]
v_pk_fma_f32 v[210:211], v[210:211], v[194:195], v[66:67]
v_pk_fma_f32 v[212:213], v[212:213], v[196:197], v[68:69]
v_pk_fma_f32 v[214:215], v[214:215], v[198:199], v[70:71]
v_cvt_pk_bf16_f32 v240, v208, v209
v_cvt_pk_bf16_f32 v241, v210, v211
v_cvt_pk_bf16_f32 v242, v212, v213
v_cvt_pk_bf16_f32 v243, v214, v215
s_nop 0
v_permlane32_swap_b32 v240, v242
v_permlane32_swap_b32 v241, v243
s_nop 0
v_permlane16_swap_b32 v240, v242
v_permlane16_swap_b32 v241, v243
buffer_store_dwordx4 v[240:243], v19, s[40:43], 0 offen
s_waitcnt vmcnt(8)
v_dot2_f32_bf16 v216, v160, s73, v216
v_dot2_f32_bf16 v217, v160, s74, v217
v_dot2_f32_bf16 v218, v161, s73, v218
v_dot2_f32_bf16 v219, v161, s74, v219
v_dot2_f32_bf16 v220, v162, s73, v220
v_dot2_f32_bf16 v221, v162, s74, v221
v_dot2_f32_bf16 v222, v163, s73, v222
v_dot2_f32_bf16 v223, v163, s74, v223
s_waitcnt vmcnt(7)
v_dot2_f32_bf16 v216, v164, s73, v216
v_dot2_f32_bf16 v217, v164, s74, v217
v_dot2_f32_bf16 v218, v165, s73, v218
v_dot2_f32_bf16 v219, v165, s74, v219
v_dot2_f32_bf16 v220, v166, s73, v220
v_dot2_f32_bf16 v221, v166, s74, v221
v_dot2_f32_bf16 v222, v167, s73, v222
v_dot2_f32_bf16 v223, v167, s74, v223
s_waitcnt vmcnt(6)
v_dot2_f32_bf16 v216, v168, s73, v216
v_dot2_f32_bf16 v217, v168, s74, v217
v_dot2_f32_bf16 v218, v169, s73, v218
v_dot2_f32_bf16 v219, v169, s74, v219
v_dot2_f32_bf16 v220, v170, s73, v220
v_dot2_f32_bf16 v221, v170, s74, v221
v_dot2_f32_bf16 v222, v171, s73, v222
v_dot2_f32_bf16 v223, v171, s74, v223
s_waitcnt vmcnt(5)
v_dot2_f32_bf16 v216, v172, s73, v216
v_dot2_f32_bf16 v217, v172, s74, v217
v_dot2_f32_bf16 v218, v173, s73, v218
v_dot2_f32_bf16 v219, v173, s74, v219
v_dot2_f32_bf16 v220, v174, s73, v220
v_dot2_f32_bf16 v221, v174, s74, v221
v_dot2_f32_bf16 v222, v175, s73, v222
v_dot2_f32_bf16 v223, v175, s74, v223
s_waitcnt vmcnt(4)
v_dot2_f32_bf16 v216, v176, s73, v216
v_dot2_f32_bf16 v217, v176, s74, v217
v_dot2_f32_bf16 v218, v177, s73, v218
v_dot2_f32_bf16 v219, v177, s74, v219
v_dot2_f32_bf16 v220, v178, s73, v220
v_dot2_f32_bf16 v221, v178, s74, v221
v_dot2_f32_bf16 v222, v179, s73, v222
v_dot2_f32_bf16 v223, v179, s74, v223
s_waitcnt vmcnt(3)
v_dot2_f32_bf16 v216, v180, s73, v216
v_dot2_f32_bf16 v217, v180, s74, v217
v_dot2_f32_bf16 v218, v181, s73, v218
v_dot2_f32_bf16 v219, v181, s74, v219
v_dot2_f32_bf16 v220, v182, s73, v220
v_dot2_f32_bf16 v221, v182, s74, v221
v_dot2_f32_bf16 v222, v183, s73, v222
v_dot2_f32_bf16 v223, v183, s74, v223
s_waitcnt vmcnt(2)
v_dot2_f32_bf16 v216, v184, s73, v216
v_dot2_f32_bf16 v217, v184, s74, v217
v_dot2_f32_bf16 v218, v185, s73, v218
v_dot2_f32_bf16 v219, v185, s74, v219
v_dot2_f32_bf16 v220, v186, s73, v220
v_dot2_f32_bf16 v221, v186, s74, v221
v_dot2_f32_bf16 v222, v187, s73, v222
v_dot2_f32_bf16 v223, v187, s74, v223
s_waitcnt vmcnt(1)
v_dot2_f32_bf16 v216, v188, s73, v216
v_dot2_f32_bf16 v217, v188, s74, v217
v_dot2_f32_bf16 v218, v189, s73, v218
v_dot2_f32_bf16 v219, v189, s74, v219
v_dot2_f32_bf16 v220, v190, s73, v220
v_dot2_f32_bf16 v221, v190, s74, v221
v_dot2_f32_bf16 v222, v191, s73, v222
v_dot2_f32_bf16 v223, v191, s74, v223
v_mul_f32 v240, 0xbfb8aa3b, v216
v_mul_f32 v241, 0xbfb8aa3b, v217
v_mul_f32 v242, 0xbfb8aa3b, v218
v_mul_f32 v243, 0xbfb8aa3b, v219
v_mul_f32 v244, 0xbfb8aa3b, v220
v_mul_f32 v245, 0xbfb8aa3b, v221
v_mul_f32 v246, 0xbfb8aa3b, v222
v_mul_f32 v247, 0xbfb8aa3b, v223
v_exp_f32 v240, v240
v_exp_f32 v241, v241
v_exp_f32 v242, v242
v_exp_f32 v243, v243
v_exp_f32 v244, v244
v_exp_f32 v245, v245
v_exp_f32 v246, v246
v_exp_f32 v247, v247
v_pk_add_f32 v[240:241], v[240:241], 1.0 op_sel_hi:[1,0]
v_pk_add_f32 v[242:243], v[242:243], 1.0 op_sel_hi:[1,0]
v_pk_add_f32 v[244:245], v[244:245], 1.0 op_sel_hi:[1,0]
v_pk_add_f32 v[246:247], v[246:247], 1.0 op_sel_hi:[1,0]
v_rcp_f32 v240, v240
v_rcp_f32 v241, v241
v_rcp_f32 v242, v242
v_rcp_f32 v243, v243
v_rcp_f32 v244, v244
v_rcp_f32 v245, v245
v_rcp_f32 v246, v246
v_rcp_f32 v247, v247
v_pk_mul_f32 v[216:217], v[216:217], v[240:241]
v_pk_mul_f32 v[218:219], v[218:219], v[242:243]
v_pk_mul_f32 v[220:221], v[220:221], v[244:245]
v_pk_mul_f32 v[222:223], v[222:223], v[246:247]
v_pk_fma_f32 v[216:217], v[216:217], v[200:201], v[72:73]
v_pk_fma_f32 v[218:219], v[218:219], v[202:203], v[74:75]
v_pk_fma_f32 v[220:221], v[220:221], v[204:205], v[76:77]
v_pk_fma_f32 v[222:223], v[222:223], v[206:207], v[78:79]
v_cvt_pk_bf16_f32 v240, v216, v217
v_cvt_pk_bf16_f32 v241, v218, v219
v_cvt_pk_bf16_f32 v242, v220, v221
v_cvt_pk_bf16_f32 v243, v222, v223
s_nop 0
v_permlane32_swap_b32 v240, v242
v_permlane32_swap_b32 v241, v243
s_nop 0
v_permlane16_swap_b32 v240, v242
v_permlane16_swap_b32 v241, v243
buffer_store_dwordx4 v[240:243], v24, s[40:43], 0 offen
s_endpgm
L_spin2:
s_mov_b32 s71, 0
L_spin2_loop:
s_sleep 4
s_add_u32 s63, s90, -1024
buffer_load_dword v70, v68, s[44:47], s63 offen sc1
s_waitcnt vmcnt(0)
v_cmp_ne_u32 vcc, v70, v14
s_nop 4
s_cbranch_vccz L_back1
s_add_u32 s71, s71, 1
s_cmp_lt_u32 s71, 0x80000
s_cbranch_scc1 L_spin2_loop
s_branch L_back1
L_spin4:
s_mov_b32 s71, 0
L_spin4_loop:
s_sleep 4
buffer_load_dword v125, off, s[52:55], 0 sc1
s_waitcnt vmcnt(0)
v_and_b32 v125, 0xff, v125
v_cmp_ne_u32 vcc, 0, v125
s_nop 4
s_cbranch_vccz L_back3
s_add_u32 s71, s71, 1
s_cmp_lt_u32 s71, 0x80000
s_cbranch_scc1 L_spin4_loop
s_branch L_back3
L_spin6:
s_mov_b32 s71, 0
L_spin6_loop:
s_sleep 4
s_add_u32 s63, s90, 32768
buffer_load_dword v126, v127, s[44:47], s63 offen sc1
s_waitcnt vmcnt(0)
v_cmp_ne_u32 vcc, v126, v14
s_nop 4
s_cbranch_vccz L_back5
s_add_u32 s71, s71, 1
s_cmp_lt_u32 s71, 0x80000
s_cbranch_scc1 L_spin6_loop
s_branch L_back5
L_spin8:
s_mov_b32 s71, 0
L_spin8_loop:
s_sleep 4
s_add_u32 s63, s90, 65536
buffer_load_dword v249, v248, s[44:47], s63 offen sc1
s_waitcnt vmcnt(0)
v_cmp_ne_u32 vcc, v249, v14
s_nop 4
s_cbranch_vccz L_back7
s_add_u32 s71, s71, 1
s_cmp_lt_u32 s71, 0x80000
s_cbranch_scc1 L_spin8_loop
s_branch L_back7
L_spin10:
s_mov_b32 s71, 0
L_spin10_loop:
s_sleep 4
buffer_load_dword v20, v16, s[44:47], s93 offen sc1
s_waitcnt vmcnt(0)
v_cmp_ne_u32 vcc, v20, v14
s_nop 4
s_cbranch_vccz L_back9
s_add_u32 s71, s71, 1
s_cmp_lt_u32 s71, 0x80000
s_cbranch_scc1 L_spin10_loop
s_branch L_back9
L_spin12:
s_mov_b32 s71, 0
L_spin12_loop:
s_sleep 4
s_add_u32 s63, s90, 98304
buffer_load_dword v31, v16, s[44:47], s63 offen sc1
s_waitcnt vmcnt(0)
v_cmp_ne_u32 vcc, v31, v14
s_nop 4
s_cbranch_vccz L_back11
s_add_u32 s71, s71, 1
s_cmp_lt_u32 s71, 0x80000
s_cbranch_scc1 L_spin12_loop
s_branch L_back11
L_fallback:
s_waitcnt vmcnt(0) lgkmcnt(0)
s_barrier
s_mov_b32 s70, 1
s_mov_b32 s81, 0
v_lshrrev_b32 v26, 4, v0
v_and_b32 v27, 15, v0
s_lshl_b32 s63, s56, 3
v_add_u32 v28, s63, v26
v_lshlrev_b32 v28, 8, v28
s_and_b32 s63, s63, 8
v_xor_b32 v29, v27, v26
v_xor_b32 v29, s63, v29
v_lshl_add_u32 v44, v29, 4, v28
v_xor_b32 v45, 64, v44
v_lshlrev_b32 v29, 1, v26
v_xor_b32 v29, v27, v29
v_lshl_add_u32 v46, v29, 4, v28
v_xor_b32 v47, 128, v46
v_lshrrev_b32 v26, 4, v0
v_and_b32 v27, 15, v0
v_xor_b32 v28, v26, v27
v_lshlrev_b32 v28, 4, v28
v_lshl_add_u32 v28, v27, 8, v28
v_add_u32 v32, 65536, v28
v_xor_b32 v33, 64, v32
v_xor_b32 v34, 128, v32
v_xor_b32 v35, 192, v32
v_lshrrev_b32 v26, 2, v0
v_and_b32 v27, 3, v0
v_and_b32 v28, 7, v26
v_lshlrev_b32 v28, 5, v28
v_lshl_add_u32 v28, v26, 8, v28
v_lshl_add_u32 v28, v27, 3, v28
v_add_u32 v36, 98304, v28
v_xor_b32 v37, 32, v36
v_xor_b32 v38, 64, v36
v_xor_b32 v39, 96, v36
v_xor_b32 v40, 128, v36
v_xor_b32 v41, 160, v36
v_xor_b32 v42, 192, v36
v_xor_b32 v43, 224, v36
L_fb_loop:
s_add_u32 m0, s80, 65536
s_nop 0
buffer_load_dwordx4 v44, s[8:11], s81 offen lds
buffer_load_dwordx4 v45, s[8:11], s81 offen offset:1024 lds
s_waitcnt vmcnt(0)
s_barrier
ds_read_b128 a[128:131], v32 offset:0
ds_read_b128 a[144:147], v32 offset:4096
ds_read_b128 a[132:135], v33 offset:0
ds_read_b128 a[148:151], v33 offset:4096
ds_read_b128 a[136:139], v34 offset:0
ds_read_b128 a[152:155], v34 offset:4096
ds_read_b128 a[140:143], v35 offset:0
ds_read_b128 a[156:159], v35 offset:4096
s_waitcnt lgkmcnt(7)
v_mfma_f32_16x16x32_bf16 v[64:67], a[128:131], a[64:67], 0
s_waitcnt lgkmcnt(6)
v_mfma_f32_16x16x32_bf16 v[68:71], a[144:147], a[64:67], 0
s_waitcnt lgkmcnt(5)
v_mfma_f32_16x16x32_bf16 v[64:67], a[132:135], a[80:83], v[64:67]
s_waitcnt lgkmcnt(4)
v_mfma_f32_16x16x32_bf16 v[68:71], a[148:151], a[80:83], v[68:71]
s_waitcnt lgkmcnt(3)
v_mfma_f32_16x16x32_bf16 v[64:67], a[136:139], a[96:99], v[64:67]
s_waitcnt lgkmcnt(2)
v_mfma_f32_16x16x32_bf16 v[68:71], a[152:155], a[96:99], v[68:71]
s_waitcnt lgkmcnt(1)
v_mfma_f32_16x16x32_bf16 v[64:67], a[140:143], a[112:115], v[64:67]
s_waitcnt lgkmcnt(0)
v_mfma_f32_16x16x32_bf16 v[68:71], a[156:159], a[112:115], v[68:71]
v_mfma_f32_16x16x32_bf16 v[72:75], a[128:131], a[68:71], 0
v_mfma_f32_16x16x32_bf16 v[76:79], a[144:147], a[68:71], 0
v_mfma_f32_16x16x32_bf16 v[72:75], a[132:135], a[84:87], v[72:75]
v_mfma_f32_16x16x32_bf16 v[76:79], a[148:151], a[84:87], v[76:79]
v_mfma_f32_16x16x32_bf16 v[72:75], a[136:139], a[100:103], v[72:75]
v_mfma_f32_16x16x32_bf16 v[76:79], a[152:155], a[100:103], v[76:79]
v_mfma_f32_16x16x32_bf16 v[72:75], a[140:143], a[116:119], v[72:75]
v_mfma_f32_16x16x32_bf16 v[76:79], a[156:159], a[116:119], v[76:79]
v_mfma_f32_16x16x32_bf16 v[80:83], a[128:131], a[72:75], 0
v_mfma_f32_16x16x32_bf16 v[84:87], a[144:147], a[72:75], 0
v_mfma_f32_16x16x32_bf16 v[80:83], a[132:135], a[88:91], v[80:83]
v_mfma_f32_16x16x32_bf16 v[84:87], a[148:151], a[88:91], v[84:87]
v_mfma_f32_16x16x32_bf16 v[80:83], a[136:139], a[104:107], v[80:83]
v_mfma_f32_16x16x32_bf16 v[84:87], a[152:155], a[104:107], v[84:87]
v_mfma_f32_16x16x32_bf16 v[80:83], a[140:143], a[120:123], v[80:83]
v_mfma_f32_16x16x32_bf16 v[84:87], a[156:159], a[120:123], v[84:87]
v_mfma_f32_16x16x32_bf16 v[88:91], a[128:131], a[76:79], 0
v_mfma_f32_16x16x32_bf16 v[92:95], a[144:147], a[76:79], 0
v_mfma_f32_16x16x32_bf16 v[88:91], a[132:135], a[92:95], v[88:91]
v_mfma_f32_16x16x32_bf16 v[92:95], a[148:151], a[92:95], v[92:95]
v_mfma_f32_16x16x32_bf16 v[88:91], a[136:139], a[108:111], v[88:91]
v_mfma_f32_16x16x32_bf16 v[92:95], a[152:155], a[108:111], v[92:95]
v_mfma_f32_16x16x32_bf16 v[88:91], a[140:143], a[124:127], v[88:91]
v_mfma_f32_16x16x32_bf16 v[92:95], a[156:159], a[124:127], v[92:95]
v_max3_f32 v20, v20, v64, v65
v_max3_f32 v20, v20, v66, v67
v_max3_f32 v20, v20, v68, v69
v_max3_f32 v20, v20, v70, v71
v_max3_f32 v21, v21, v72, v73
v_max3_f32 v21, v21, v74, v75
v_max3_f32 v21, v21, v76, v77
v_max3_f32 v21, v21, v78, v79
v_max3_f32 v22, v22, v80, v81
v_max3_f32 v22, v22, v82, v83
v_max3_f32 v22, v22, v84, v85
v_max3_f32 v22, v22, v86, v87
v_max3_f32 v23, v23, v88, v89
v_max3_f32 v23, v23, v90, v91
v_max3_f32 v23, v23, v92, v93
v_max3_f32 v23, v23, v94, v95
s_barrier
s_add_u32 s81, s81, 8192
s_cmp_lt_u32 s81, 131072
s_cbranch_scc1 L_fb_loop
v_permlane32_swap_b32 v20, v21
v_max_f32 v20, v20, v21
v_mov_b32 v21, v20
s_nop 1
v_permlane16_swap_b32 v20, v21
v_max_f32 v20, v20, v21
v_mov_b32 v21, v20
s_nop 1
v_permlane32_swap_b32 v20, v21
v_permlane32_swap_b32 v22, v23
v_max_f32 v22, v22, v23
v_mov_b32 v23, v22
s_nop 1
v_permlane16_swap_b32 v22, v23
v_max_f32 v22, v22, v23
v_mov_b32 v23, v22
s_nop 1
v_permlane32_swap_b32 v22, v23
s_add_u32 m0, s80, 65536
s_mov_b32 s61, 0
buffer_load_dwordx4 v44, s[8:11], s61 offen lds
buffer_load_dwordx4 v45, s[8:11], s61 offen offset:1024 lds
s_add_u32 m0, s80, 98304
s_nop 0
buffer_load_dwordx4 v46, s[12:15], s61 offen lds
buffer_load_dwordx4 v47, s[12:15], s61 offen offset:1024 lds
s_add_u32 m0, s80, 73728
s_mov_b32 s61, 8192
buffer_load_dwordx4 v44, s[8:11], s61 offen lds
buffer_load_dwordx4 v45, s[8:11], s61 offen offset:1024 lds
s_add_u32 m0, s80, 106496
s_nop 0
buffer_load_dwordx4 v46, s[12:15], s61 offen lds
buffer_load_dwordx4 v47, s[12:15], s61 offen offset:1024 lds
s_add_u32 m0, s80, 81920
s_mov_b32 s61, 16384
buffer_load_dwordx4 v44, s[8:11], s61 offen lds
buffer_load_dwordx4 v45, s[8:11], s61 offen offset:1024 lds
s_add_u32 m0, s80, 114688
s_nop 0
buffer_load_dwordx4 v46, s[12:15], s61 offen lds
buffer_load_dwordx4 v47, s[12:15], s61 offen offset:1024 lds
s_add_u32 m0, s80, 90112
s_mov_b32 s61, 24576
buffer_load_dwordx4 v44, s[8:11], s61 offen lds
buffer_load_dwordx4 v45, s[8:11], s61 offen offset:1024 lds
s_add_u32 m0, s80, 122880
s_nop 0
buffer_load_dwordx4 v46, s[12:15], s61 offen lds
buffer_load_dwordx4 v47, s[12:15], s61 offen offset:1024 lds
s_waitcnt vmcnt(0)
s_barrier
ds_read_b128 a[128:131], v32 offset:0
ds_read_b128 a[144:147], v32 offset:4096
ds_read_b128 a[132:135], v33 offset:0
ds_read_b128 a[148:151], v33 offset:4096
ds_read_b128 a[136:139], v34 offset:0
ds_read_b128 a[152:155], v34 offset:4096
ds_read_b128 a[140:143], v35 offset:0
ds_read_b128 a[156:159], v35 offset:4096
ds_read_b64_tr_b16 a[192:193], v36 offset:0
ds_read_b64_tr_b16 a[194:195], v36 offset:4096
ds_read_b64_tr_b16 a[196:197], v37 offset:0
ds_read_b64_tr_b16 a[198:199], v37 offset:4096
ds_read_b64_tr_b16 a[200:201], v38 offset:0
ds_read_b64_tr_b16 a[202:203], v38 offset:4096
ds_read_b64_tr_b16 a[204:205], v39 offset:0
ds_read_b64_tr_b16 a[206:207], v39 offset:4096
ds_read_b64_tr_b16 a[208:209], v40 offset:0
ds_read_b64_tr_b16 a[210:211], v40 offset:4096
ds_read_b64_tr_b16 a[212:213], v41 offset:0
ds_read_b64_tr_b16 a[214:215], v41 offset:4096
ds_read_b64_tr_b16 a[216:217], v42 offset:0
ds_read_b64_tr_b16 a[218:219], v42 offset:4096
ds_read_b64_tr_b16 a[220:221], v43 offset:0
ds_read_b64_tr_b16 a[222:223], v43 offset:4096
s_waitcnt lgkmcnt(15)
v_mfma_f32_16x16x32_bf16 v[64:67], a[128:131], a[64:67], 0
v_mfma_f32_16x16x32_bf16 v[68:71], a[144:147], a[64:67], 0
v_mfma_f32_16x16x32_bf16 v[64:67], a[132:135], a[80:83], v[64:67]
v_mfma_f32_16x16x32_bf16 v[68:71], a[148:151], a[80:83], v[68:71]
v_mfma_f32_16x16x32_bf16 v[64:67], a[136:139], a[96:99], v[64:67]
v_mfma_f32_16x16x32_bf16 v[68:71], a[152:155], a[96:99], v[68:71]
v_mfma_f32_16x16x32_bf16 v[64:67], a[140:143], a[112:115], v[64:67]
v_mfma_f32_16x16x32_bf16 v[68:71], a[156:159], a[112:115], v[68:71]
v_mfma_f32_16x16x32_bf16 v[72:75], a[128:131], a[68:71], 0
v_mfma_f32_16x16x32_bf16 v[76:79], a[144:147], a[68:71], 0
v_mfma_f32_16x16x32_bf16 v[72:75], a[132:135], a[84:87], v[72:75]
v_mfma_f32_16x16x32_bf16 v[76:79], a[148:151], a[84:87], v[76:79]
v_mfma_f32_16x16x32_bf16 v[72:75], a[136:139], a[100:103], v[72:75]
v_mfma_f32_16x16x32_bf16 v[76:79], a[152:155], a[100:103], v[76:79]
v_mfma_f32_16x16x32_bf16 v[72:75], a[140:143], a[116:119], v[72:75]
v_mfma_f32_16x16x32_bf16 v[76:79], a[156:159], a[116:119], v[76:79]
v_mfma_f32_16x16x32_bf16 v[80:83], a[128:131], a[72:75], 0
v_mfma_f32_16x16x32_bf16 v[84:87], a[144:147], a[72:75], 0
v_mfma_f32_16x16x32_bf16 v[80:83], a[132:135], a[88:91], v[80:83]
v_mfma_f32_16x16x32_bf16 v[84:87], a[148:151], a[88:91], v[84:87]
v_mfma_f32_16x16x32_bf16 v[80:83], a[136:139], a[104:107], v[80:83]
v_mfma_f32_16x16x32_bf16 v[84:87], a[152:155], a[104:107], v[84:87]
v_mfma_f32_16x16x32_bf16 v[80:83], a[140:143], a[120:123], v[80:83]
v_mfma_f32_16x16x32_bf16 v[84:87], a[156:159], a[120:123], v[84:87]
v_mfma_f32_16x16x32_bf16 v[88:91], a[128:131], a[76:79], 0
v_mfma_f32_16x16x32_bf16 v[92:95], a[144:147], a[76:79], 0
v_mfma_f32_16x16x32_bf16 v[88:91], a[132:135], a[92:95], v[88:91]
v_mfma_f32_16x16x32_bf16 v[92:95], a[148:151], a[92:95], v[92:95]
v_mfma_f32_16x16x32_bf16 v[88:91], a[136:139], a[108:111], v[88:91]
v_mfma_f32_16x16x32_bf16 v[92:95], a[152:155], a[108:111], v[92:95]
v_mfma_f32_16x16x32_bf16 v[88:91], a[140:143], a[124:127], v[88:91]
v_mfma_f32_16x16x32_bf16 v[92:95], a[156:159], a[124:127], v[92:95]
s_waitcnt lgkmcnt(0)
s_nop 15
s_branch L_att
L_code_end:
s_endpgm
.section .rodata,"a"
.p2align 6
.amdhsa_kernel recurrent_scan__sliding_block_cached__mixer_s_mlp__prompt_kernel
  .amdhsa_next_free_vgpr 512
  .amdhsa_next_free_sgpr 102
  .amdhsa_accum_offset 256
  .amdhsa_group_segment_fixed_size 0
  .amdhsa_kernarg_size 104
  .amdhsa_user_sgpr_count 2
  .amdhsa_user_sgpr_kernarg_segment_ptr 1
  .amdhsa_system_sgpr_workgroup_id_x 1
  .amdhsa_float_denorm_mode_32 3
.end_amdhsa_kernel
```
